```python
import torch

def _softmax(x, axis=-1):
    return torch.softmax(x, dim=axis)

def _gelu(x):
    return torch.nn.functional.gelu(x, approximate='tanh')

def _silu(x):
    return torch.nn.functional.silu(x)

def _sigmoid(x):
    return torch.sigmoid(x)

def _layernorm(x, axis=-1, eps=1e-05):
    m = x.mean(dim=axis, keepdim=True)
    v = x.var(dim=axis, keepdim=True, unbiased=False)
    return (x - m) / torch.sqrt(v + eps)

def _scatter_add(tgt, idx, src, axis=0):
    return tgt.clone().index_add_(axis, idx, src)

def _segment_sum(src, seg, n):
    out = torch.zeros((n,) + src.shape[1:], dtype=src.dtype)
    return out.index_add_(0, seg, src)

def _pad(x, pw):
    flat = tuple((v for pair in reversed(pw) for v in pair))
    return torch.nn.functional.pad(x, flat)
kernel_name = 'adaLN_cond__sliding_block_cached__glu_gated_reglu__prompt'

def setup_inputs():

    _w = lambda a: (lambda t: t.to(torch.bfloat16) if t.is_floating_point() else t)(torch.as_tensor(a))

    def _A_setup():
        B, Sq, D = (1, 2048, 640)
        Hq, Hkv, Sk, Dh = (32, 32, 2048, 128)
        assert Hq % Hkv == 0, (Hq, Hkv)
        return {'x': _w((lambda *s: torch.randn(*s, dtype=torch.bfloat16) * 0.05)(B, Sq, D)), 'k_cache': _w((lambda *s: torch.randn(*s, dtype=torch.bfloat16) * 1.6)(B, Hkv, Sk, Dh)), 'v_cache': _w((lambda *s: torch.randn(*s, dtype=torch.bfloat16) * 0.8)(B, Hkv, Sk, Dh)), 'wq': _w((lambda *s: torch.randn(*s, dtype=torch.bfloat16) * 1.6)(D, Hq * Dh) * D ** (-0.5)), 'wo': _w((lambda *s: torch.randn(*s, dtype=torch.bfloat16) * 0.8)(Hq * Dh, D) * (Hq * Dh) ** (-0.5))}
    _A_in = _A_setup()

    def _B_setup():
        B, S, D, F = (1, 2048, 640, 1728)
        return {'x': _w((lambda *s: torch.randn(*s, dtype=torch.bfloat16) * 0.05)(B, S, D)), 'W_gate': _w((lambda *s: torch.randn(*s, dtype=torch.bfloat16) * 0.4)(D, F) * (2.0 / D) ** 0.5), 'W_up': _w((lambda *s: torch.randn(*s, dtype=torch.bfloat16) * 0.4)(D, F) * (2.0 / D) ** 0.5), 'W_down': _w((lambda *s: torch.randn(*s, dtype=torch.bfloat16) * 0.4)(F, D) * (1.0 / F) ** 0.5)}
    _B_in = _B_setup()
    return {'A_x': _A_in['x'], 'A_k_cache': _A_in['k_cache'], 'A_v_cache': _A_in['v_cache'], 'A_wq': _A_in['wq'], 'A_wo': _A_in['wo'], 'B_x': _B_in['x'], 'B_W_gate': _B_in['W_gate'], 'B_W_up': _B_in['W_up'], 'B_W_down': _B_in['W_down'], 'c': _w((lambda *s: torch.randn(*s, dtype=torch.bfloat16) * 0.2)(1, 640) * 8.0), 'w_mod': _w((lambda *s: torch.randn(*s, dtype=torch.bfloat16) * 0.2)(640, 6 * 640) * 640 ** (-0.5) * 8.0)}

def reference(A_x, A_k_cache, A_v_cache, A_wq, A_wo, B_x, B_W_gate, B_W_up, B_W_down, c, w_mod):

    def _A_ref(x, k_cache, v_cache, wq, wo):
        B, Sq, D = x.shape
        Hq, Dh = (32, 128)
        Hkv, Sk = (k_cache.shape[1], k_cache.shape[2])
        W = min(4096, max(256, Sk // 4))
        rep = Hq // Hkv
        q = (lambda x, *d: x.permute(*d))((x @ wq).reshape(B, Sq, Hq, Dh), 0, 2, 1, 3)
        k = (lambda x, n, axis: torch.repeat_interleave(x, n, dim=axis))(k_cache[:, :, Sk - W:, :], rep, axis=1)
        v = (lambda x, n, axis: torch.repeat_interleave(x, n, dim=axis))(v_cache[:, :, Sk - W:, :], rep, axis=1)
        scores = torch.einsum('bhqd,bhkd->bhqk', q, k) * Dh ** (-0.5)
        p = _softmax(scores, axis=-1)
        o = torch.einsum('bhqk,bhkd->bhqd', p, v)
        return (lambda x, *d: x.permute(*d))(o, 0, 2, 1, 3).reshape(B, Sq, Hq * Dh) @ wo

    def _B_ref(x, W_gate, W_up, W_down):
        gate = torch.einsum('bsd,df->bsf', x, W_gate)
        up = torch.einsum('bsd,df->bsf', x, W_up)
        gate = gate * (lambda x, dt: x.to(dt))(gate > 0, gate.dtype)
        h = gate * up
        return torch.einsum('bsf,fd->bsd', h, W_down)
    x = A_x
    mod = (_silu(c) @ w_mod).reshape(c.shape[0], 6, 1, -1)
    sa, ca, ga, sb, cb, gb = (mod[:, 0].clone(), mod[:, 1].clone(), mod[:, 2].clone(), mod[:, 3].clone(), mod[:, 4].clone(), mod[:, 5].clone())
    h = _layernorm(x, axis=-1) * (1 + ca) + sa
    x = x + ga * _A_ref(h, A_k_cache, A_v_cache, A_wq, A_wo)
    h = _layernorm(x, axis=-1) * (1 + cb) + sb
    x = x + gb * _B_ref(h, B_W_gate, B_W_up, B_W_down)
    return x
```

```asm
; @launch grid=(256,1,1) block=(256,1,1) lds=163840
.amdgcn_target "amdgcn-amd-amdhsa--gfx950"
.text
.globl adaLN_cond__sliding_block_cached__glu_gated_reglu__prompt_kernel
.p2align 8
.type adaLN_cond__sliding_block_cached__glu_gated_reglu__prompt_kernel,@function
adaLN_cond__sliding_block_cached__glu_gated_reglu__prompt_kernel:
    s_cmp_ge_u32 s2, 256
    s_cbranch_scc1 F_END
    s_getpc_b64 s[98:99]
F_PC:
    s_load_dwordx16 s[4:19], s[0:1], 0
    s_lshr_b32 s3, s2, 3
    s_lshl_b32 s3, s3, 12
    v_lshl_add_u32 v1, v0, 4, s3
    v_min_u32 v1, F_CODE_END-F_PC-16, v1
    global_load_dwordx4 v[100:103], v1, s[98:99]
    s_load_dwordx8 s[20:27], s[0:1], 64
    s_load_dwordx4 s[28:31], s[0:1], 96
    s_memrealtime s[100:101]
    v_mov_b32 v128, v0
    v_lshrrev_b32 v129, 6, v128
    v_and_b32 v130, 63, v128
    v_readfirstlane_b32 s64, v129
    v_lshrrev_b32 v131, 5, v128
    v_and_b32 v132, 31, v128
    v_mul_u32_u24 v133, 1280, v131
    v_lshl_add_u32 v133, v132, 4, v133
    v_lshrrev_b32 v135, 1, v132
    v_lshlrev_b32 v135, 10, v135
    v_and_b32 v136, 1, v132
    v_lshl_add_u32 v135, v136, 9, v135
    v_lshl_add_u32 v135, v131, 4, v135
    v_cmp_gt_u32 vcc, 16, v132
    v_mov_b32 v137, 0x7fff0000
    s_nop 0
    v_cndmask_b32 v134, v137, v133, vcc
    v_cndmask_b32 v136, v137, v135, vcc
    v_lshrrev_b32 v138, 3, v128
    v_and_b32 v139, 7, v128
    v_mul_u32_u24 v140, 7680, v138
    v_lshl_add_u32 v140, v139, 4, v140
    v_lshlrev_b32 v141, 1, v138
    s_mul_i32 s66, s2, 1093
    s_lshr_b32 s66, s66, 16
    s_mul_i32 s67, s66, 60
    s_sub_u32 s67, s2, s67
    s_mul_i32 s68, s66, 320
    s_mul_i32 s69, s66, 1228800
    s_lshl_b32 s70, s67, 7
    s_add_u32 s69, s69, s70
    s_mul_i32 s71, s66, 30720
    s_lshl_b32 s70, s67, 9
    s_add_u32 s71, s71, s70
    s_add_u32 s71, s71, 524288
    s_mul_i32 s65, s66, 15360
    s_lshl_b32 s78, s67, 8
    s_add_u32 s78, s78, s65
    s_cmp_lt_u32 s2, 240
    s_cselect_b32 s68, s68, 0x7fff0000
    s_cselect_b32 s69, s69, 0x7fff0000
    s_cselect_b32 s78, s78, 0x7fff0000
    s_cselect_b32 s71, s71, 0x7fff0000
    s_mul_i32 s72, s2, 10240
    s_lshr_b32 s73, s2, 2
    s_mul_i32 s73, s73, 40960
    s_and_b32 s74, s2, 3
    s_lshl_b32 s74, s74, 7
    s_add_u32 s73, s73, s74
    s_add_u32 s73, s73, 1048576
    s_waitcnt lgkmcnt(0)
    s_mov_b32 s36, s4
    s_mov_b32 s37, s5
    s_mov_b32 s38, 0x280000
    s_mov_b32 s39, 0x20000
    buffer_load_dwordx4 v[144:147], v133, s[36:39], s72 offen
    buffer_load_dwordx4 v[148:151], v133, s[36:39], s72 offen offset:512
    buffer_load_dwordx4 v[152:155], v134, s[36:39], s72 offen offset:1024
    s_mov_b32 s40, s22
    s_mov_b32 s41, s23
    s_mov_b32 s42, 0x500
    s_mov_b32 s43, 0x20000
    s_mov_b32 s44, s24
    s_mov_b32 s45, s25
    s_mov_b32 s46, 0x4b0000
    s_mov_b32 s47, 0x20000
    buffer_load_ushort v188, v141, s[40:43], s68 offen offset:0
    buffer_load_ushort v189, v141, s[40:43], s68 offen offset:64
    buffer_load_ushort v190, v141, s[40:43], s68 offen offset:128
    buffer_load_ushort v191, v141, s[40:43], s68 offen offset:192
    buffer_load_ushort v192, v141, s[40:43], s68 offen offset:256
    buffer_load_dwordx4 v[196:199], v140, s[44:47], s69 offen
    s_add_u32 s69, s69, 245760
    buffer_load_dwordx4 v[200:203], v140, s[44:47], s69 offen
    s_add_u32 s69, s69, 245760
    buffer_load_dwordx4 v[204:207], v140, s[44:47], s69 offen
    s_add_u32 s69, s69, 245760
    buffer_load_dwordx4 v[208:211], v140, s[44:47], s69 offen
    s_add_u32 s69, s69, 245760
    buffer_load_dwordx4 v[212:215], v140, s[44:47], s69 offen
    s_mov_b32 s32, s30
    s_mov_b32 s33, s31
    s_mov_b32 s34, 0x4000000
    s_mov_b32 s35, 0x20000
    s_mov_b32 s48, s28
    s_mov_b32 s49, s29
    s_mov_b32 s50, 0x100
    s_mov_b32 s51, 0x20000
    v_mov_b32 v142, 0
    s_or_b32 s75, s2, s64
    s_cmp_lg_u32 s75, 0
    s_cbranch_scc1 P0_NOPUB
    s_or_b32 s75, s100, 1
    s_mov_b64 exec, 1
    v_mov_b32 v143, s75
    buffer_store_dword v143, v142, s[48:51], 0 offen sc1
    s_mov_b64 exec, -1
P0_NOPUB:
    s_load_dword s85, s[30:31], s73
    s_load_dword s85, s[30:31], 393216
    s_mov_b32 s84, 0
    s_load_dword s85, s[10:11], s84
    s_mov_b32 s84, 2097152
    s_load_dword s85, s[10:11], s84
    s_mov_b32 s84, 4194304
    s_load_dword s85, s[10:11], s84
    v_mov_b32 v1, v129
    v_mov_b32 v2, v130
    s_and_b32 s80, s2, 7
    s_lshr_b32 s81, s2, 3
    s_and_b32 s82, s80, 3
    s_lshl_b32 s82, s82, 3
    s_and_b32 s83, s81, 7
    s_add_u32 s66, s82, s83
    s_lshr_b32 s82, s80, 2
    s_lshl_b32 s82, s82, 2
    s_lshr_b32 s83, s81, 3
    s_add_u32 s67, s82, s83
    v_lshlrev_b32 v245, 4, v2
    v_lshrrev_b32 v3, 4, v2
    v_and_b32 v4, 15, v2
    v_lshlrev_b32 v5, 2, v3
    v_xor_b32 v5, v4, v5
    v_lshlrev_b32 v5, 4, v5
    v_lshl_add_u32 v6, v1, 4, v3
    v_lshl_add_u32 v246, v6, 13, v5
    v_add_u32 v247, 31744, v246
    v_add_u32 v248, 63488, v246
    v_add_u32 v249, 95232, v246
    s_lshl_b32 s80, s66, 8
    s_sub_u32 s81, 5242880, s80
    s_add_u32 s60, s10, s80
    s_addc_u32 s61, s11, 0
    s_mov_b32 s62, s81
    s_mov_b32 s63, 0x20000
    s_lshl_b32 s72, s64, 12
    s_lshl_b32 s80, s66, 19
    s_add_u32 s80, s80, 393216
    s_add_u32 s52, s6, s80
    s_addc_u32 s53, s7, 0
    s_mov_b32 s54, 0x20000
    s_mov_b32 s55, 0x20000
    s_sub_u32 s80, s80, 2048
    s_add_u32 s56, s8, s80
    s_addc_u32 s57, s9, 0
    s_mov_b32 s58, 0x20800
    s_mov_b32 s59, 0x20000
    v_lshl_add_u32 v6, v1, 3, v3
    v_lshlrev_b32 v6, 8, v6
    v_add_u32 v255, v6, v5
    v_lshl_add_u32 v40, v1, 2, v3
    v_xor_b32 v40, v4, v40
    v_lshl_add_u32 v254, v40, 4, v6
    v_lshrrev_b32 v41, 5, v2
    v_bfe_u32 v42, v2, 2, 2
    v_and_b32 v43, 3, v2
    v_and_b32 v44, 1, v43
    v_lshrrev_b32 v45, 1, v43
    v_lshl_or_b32 v44, v44, 1, v45
    v_lshlrev_b32 v44, 3, v44
    v_and_b32 v45, 1, v3
    v_lshl_add_u32 v44, v45, 5, v44
    v_lshl_add_u32 v45, v41, 3, v42
    v_lshl_add_u32 v45, v45, 8, v44
    v_lshl_add_u32 v46, v41, 2, v42
    v_lshl_add_u32 v46, v46, 8, v44
    v_add_u32 v46, 2048, v46
    v_xor_b32 v47, 0, v42
    v_lshl_add_u32 v240, v47, 6, v45
    v_lshl_add_u32 v47, v47, 6, v46
    v_accvgpr_write_b32 a200, v47
    v_xor_b32 v47, 1, v42
    v_lshl_add_u32 v241, v47, 6, v45
    v_lshl_add_u32 v47, v47, 6, v46
    v_accvgpr_write_b32 a201, v47
    v_xor_b32 v47, 2, v42
    v_lshl_add_u32 v242, v47, 6, v45
    v_lshl_add_u32 v47, v47, 6, v46
    v_accvgpr_write_b32 a202, v47
    v_xor_b32 v47, 3, v42
    v_lshl_add_u32 v243, v47, 6, v45
    v_lshl_add_u32 v47, v47, 6, v46
    v_accvgpr_write_b32 a203, v47
    v_bfe_u32 v44, v2, 3, 2
    v_and_b32 v45, 7, v2
    v_lshlrev_b32 v46, 12, v44
    v_lshl_add_u32 v46, v45, 8, v46
    v_lshl_add_u32 v44, v44, 2, v43
    v_xor_b32 v44, v44, v41
    v_xor_b32 v47, 0, v44
    v_lshl_add_u32 v47, v47, 4, v46
    v_accvgpr_write_b32 a192, v47
    v_xor_b32 v47, 2, v44
    v_lshl_add_u32 v47, v47, 4, v46
    v_accvgpr_write_b32 a193, v47
    v_xor_b32 v47, 4, v44
    v_lshl_add_u32 v47, v47, 4, v46
    v_accvgpr_write_b32 a194, v47
    v_xor_b32 v47, 6, v44
    v_lshl_add_u32 v47, v47, 4, v46
    v_accvgpr_write_b32 a195, v47
    v_xor_b32 v47, 8, v44
    v_lshl_add_u32 v47, v47, 4, v46
    v_accvgpr_write_b32 a196, v47
    v_xor_b32 v47, 10, v44
    v_lshl_add_u32 v47, v47, 4, v46
    v_accvgpr_write_b32 a197, v47
    v_xor_b32 v47, 12, v44
    v_lshl_add_u32 v47, v47, 4, v46
    v_accvgpr_write_b32 a198, v47
    v_xor_b32 v47, 14, v44
    v_lshl_add_u32 v47, v47, 4, v46
    v_accvgpr_write_b32 a199, v47
    v_bfe_u32 v44, v2, 4, 1
    v_lshlrev_b32 v44, 17, v44
    v_lshl_add_u32 v44, v41, 8, v44
    v_lshl_add_u32 v44, v4, 4, v44
    v_accvgpr_write_b32 a204, v44
    v_lshlrev_b32 v244, 6, v41
    v_add_u32 v244, 131072, v244
    s_waitcnt vmcnt(12)
    v_lshlrev_b32 v160, 16, v144
    v_and_b32 v161, 0xffff0000, v144
    v_lshlrev_b32 v162, 16, v145
    v_and_b32 v163, 0xffff0000, v145
    v_lshlrev_b32 v164, 16, v146
    v_and_b32 v165, 0xffff0000, v146
    v_lshlrev_b32 v166, 16, v147
    v_and_b32 v167, 0xffff0000, v147
    s_waitcnt vmcnt(11)
    v_lshlrev_b32 v168, 16, v148
    v_and_b32 v169, 0xffff0000, v148
    v_lshlrev_b32 v170, 16, v149
    v_and_b32 v171, 0xffff0000, v149
    v_lshlrev_b32 v172, 16, v150
    v_and_b32 v173, 0xffff0000, v150
    v_lshlrev_b32 v174, 16, v151
    v_and_b32 v175, 0xffff0000, v151
    s_waitcnt vmcnt(10)
    v_lshlrev_b32 v176, 16, v152
    v_and_b32 v177, 0xffff0000, v152
    v_lshlrev_b32 v178, 16, v153
    v_and_b32 v179, 0xffff0000, v153
    v_lshlrev_b32 v180, 16, v154
    v_and_b32 v181, 0xffff0000, v154
    v_lshlrev_b32 v182, 16, v155
    v_and_b32 v183, 0xffff0000, v155
    v_pk_add_f32 v[144:145], v[160:161], v[164:165]
    v_pk_add_f32 v[146:147], v[162:163], v[166:167]
    v_pk_add_f32 v[144:145], v[144:145], v[168:169]
    v_pk_add_f32 v[146:147], v[146:147], v[170:171]
    v_pk_add_f32 v[144:145], v[144:145], v[172:173]
    v_pk_add_f32 v[146:147], v[146:147], v[174:175]
    v_pk_add_f32 v[144:145], v[144:145], v[176:177]
    v_pk_add_f32 v[146:147], v[146:147], v[178:179]
    v_pk_add_f32 v[144:145], v[144:145], v[180:181]
    v_pk_add_f32 v[146:147], v[146:147], v[182:183]
    v_add_f32 v144, v144, v145
    v_add_f32 v146, v146, v147
    v_add_f32 v144, v144, v146
    s_nop 1
    v_add_f32_dpp v144, v144, v144 row_ror:8 row_mask:0xf bank_mask:0xf
    s_nop 1
    v_add_f32_dpp v144, v144, v144 row_ror:4 row_mask:0xf bank_mask:0xf
    s_nop 1
    v_add_f32_dpp v144, v144, v144 row_ror:2 row_mask:0xf bank_mask:0xf
    s_nop 1
    v_add_f32_dpp v144, v144, v144 row_ror:1 row_mask:0xf bank_mask:0xf
    v_mov_b32 v145, v144
    s_nop 1
    v_permlane16_swap_b32 v144, v145
    v_add_f32 v144, v144, v145
    v_mul_f32 v148, 0x3acccccd, v144
    v_pk_add_f32 v[160:161], v[160:161], v[148:149] op_sel:[0,0] op_sel_hi:[1,0] neg_lo:[0,1] neg_hi:[0,1]
    v_pk_add_f32 v[162:163], v[162:163], v[148:149] op_sel:[0,0] op_sel_hi:[1,0] neg_lo:[0,1] neg_hi:[0,1]
    v_pk_add_f32 v[164:165], v[164:165], v[148:149] op_sel:[0,0] op_sel_hi:[1,0] neg_lo:[0,1] neg_hi:[0,1]
    v_pk_add_f32 v[166:167], v[166:167], v[148:149] op_sel:[0,0] op_sel_hi:[1,0] neg_lo:[0,1] neg_hi:[0,1]
    v_pk_add_f32 v[168:169], v[168:169], v[148:149] op_sel:[0,0] op_sel_hi:[1,0] neg_lo:[0,1] neg_hi:[0,1]
    v_pk_add_f32 v[170:171], v[170:171], v[148:149] op_sel:[0,0] op_sel_hi:[1,0] neg_lo:[0,1] neg_hi:[0,1]
    v_pk_add_f32 v[172:173], v[172:173], v[148:149] op_sel:[0,0] op_sel_hi:[1,0] neg_lo:[0,1] neg_hi:[0,1]
    v_pk_add_f32 v[174:175], v[174:175], v[148:149] op_sel:[0,0] op_sel_hi:[1,0] neg_lo:[0,1] neg_hi:[0,1]
    s_mov_b32 s76, 0xffff
    s_mov_b32 s77, 0xffff
    s_mov_b64 exec, s[76:77]
    v_pk_add_f32 v[176:177], v[176:177], v[148:149] op_sel:[0,0] op_sel_hi:[1,0] neg_lo:[0,1] neg_hi:[0,1]
    v_pk_add_f32 v[178:179], v[178:179], v[148:149] op_sel:[0,0] op_sel_hi:[1,0] neg_lo:[0,1] neg_hi:[0,1]
    v_pk_add_f32 v[180:181], v[180:181], v[148:149] op_sel:[0,0] op_sel_hi:[1,0] neg_lo:[0,1] neg_hi:[0,1]
    v_pk_add_f32 v[182:183], v[182:183], v[148:149] op_sel:[0,0] op_sel_hi:[1,0] neg_lo:[0,1] neg_hi:[0,1]
    s_mov_b64 exec, -1
    v_pk_mul_f32 v[144:145], v[160:161], v[160:161]
    v_pk_mul_f32 v[146:147], v[162:163], v[162:163]
    v_pk_fma_f32 v[144:145], v[164:165], v[164:165], v[144:145]
    v_pk_fma_f32 v[146:147], v[166:167], v[166:167], v[146:147]
    v_pk_fma_f32 v[144:145], v[168:169], v[168:169], v[144:145]
    v_pk_fma_f32 v[146:147], v[170:171], v[170:171], v[146:147]
    v_pk_fma_f32 v[144:145], v[172:173], v[172:173], v[144:145]
    v_pk_fma_f32 v[146:147], v[174:175], v[174:175], v[146:147]
    v_pk_fma_f32 v[144:145], v[176:177], v[176:177], v[144:145]
    v_pk_fma_f32 v[146:147], v[178:179], v[178:179], v[146:147]
    v_pk_fma_f32 v[144:145], v[180:181], v[180:181], v[144:145]
    v_pk_fma_f32 v[146:147], v[182:183], v[182:183], v[146:147]
    v_add_f32 v144, v144, v145
    v_add_f32 v146, v146, v147
    v_add_f32 v144, v144, v146
    s_nop 1
    v_add_f32_dpp v144, v144, v144 row_ror:8 row_mask:0xf bank_mask:0xf
    s_nop 1
    v_add_f32_dpp v144, v144, v144 row_ror:4 row_mask:0xf bank_mask:0xf
    s_nop 1
    v_add_f32_dpp v144, v144, v144 row_ror:2 row_mask:0xf bank_mask:0xf
    s_nop 1
    v_add_f32_dpp v144, v144, v144 row_ror:1 row_mask:0xf bank_mask:0xf
    v_mov_b32 v145, v144
    s_nop 1
    v_permlane16_swap_b32 v144, v145
    v_add_f32 v144, v144, v145
    v_mul_f32 v148, 0x3acccccd, v144
    v_add_f32 v148, 0x3727c5ac, v148
    v_rsq_f32 v148, v148
    s_nop 0
    v_pk_mul_f32 v[160:161], v[160:161], v[148:149] op_sel:[0,0] op_sel_hi:[1,0]
    v_pk_mul_f32 v[162:163], v[162:163], v[148:149] op_sel:[0,0] op_sel_hi:[1,0]
    v_pk_mul_f32 v[164:165], v[164:165], v[148:149] op_sel:[0,0] op_sel_hi:[1,0]
    v_pk_mul_f32 v[166:167], v[166:167], v[148:149] op_sel:[0,0] op_sel_hi:[1,0]
    v_cvt_pk_f16_f32 v216, v160, v161
    v_cvt_pk_f16_f32 v217, v162, v163
    v_cvt_pk_f16_f32 v218, v164, v165
    v_cvt_pk_f16_f32 v219, v166, v167
    buffer_store_dwordx4 v[216:219], v135, s[32:35], s73 offen sc1
    s_add_u32 s73, s73, 16384
    v_pk_mul_f32 v[168:169], v[168:169], v[148:149] op_sel:[0,0] op_sel_hi:[1,0]
    v_pk_mul_f32 v[170:171], v[170:171], v[148:149] op_sel:[0,0] op_sel_hi:[1,0]
    v_pk_mul_f32 v[172:173], v[172:173], v[148:149] op_sel:[0,0] op_sel_hi:[1,0]
    v_pk_mul_f32 v[174:175], v[174:175], v[148:149] op_sel:[0,0] op_sel_hi:[1,0]
    v_cvt_pk_f16_f32 v220, v168, v169
    v_cvt_pk_f16_f32 v221, v170, v171
    v_cvt_pk_f16_f32 v222, v172, v173
    v_cvt_pk_f16_f32 v223, v174, v175
    buffer_store_dwordx4 v[220:223], v135, s[32:35], s73 offen sc1
    s_add_u32 s73, s73, 16384
    v_pk_mul_f32 v[176:177], v[176:177], v[148:149] op_sel:[0,0] op_sel_hi:[1,0]
    v_pk_mul_f32 v[178:179], v[178:179], v[148:149] op_sel:[0,0] op_sel_hi:[1,0]
    v_pk_mul_f32 v[180:181], v[180:181], v[148:149] op_sel:[0,0] op_sel_hi:[1,0]
    v_pk_mul_f32 v[182:183], v[182:183], v[148:149] op_sel:[0,0] op_sel_hi:[1,0]
    v_cvt_pk_f16_f32 v224, v176, v177
    v_cvt_pk_f16_f32 v225, v178, v179
    v_cvt_pk_f16_f32 v226, v180, v181
    v_cvt_pk_f16_f32 v227, v182, v183
    buffer_store_dwordx4 v[224:227], v136, s[32:35], s73 offen sc1
    buffer_load_dword v143, v142, s[48:51], 0 offen sc1
    s_mov_b32 s36, 0
    s_mov_b32 s37, 4096
    s_mov_b32 s38, 8192
    s_mov_b32 s39, 12288
    s_mov_b32 s40, 16384
    s_mov_b32 s41, 20480
    s_mov_b32 s42, 24576
    s_mov_b32 s43, 28672
    s_mov_b32 s69, 32768
    s_mov_b32 s70, 36864
    s_add_u32 m0, s72, 0
    s_lshl_b32 s68, s36, 7
    buffer_load_dwordx4 v246, s[60:63], s68 offen lds
    buffer_load_dwordx4 v247, s[60:63], s68 offen offset:1024 lds
    buffer_load_dwordx4 v248, s[60:63], s68 offen offset:2048 lds
    buffer_load_dwordx4 v249, s[60:63], s68 offen offset:3072 lds
    s_add_u32 m0, s72, 16384
    s_lshl_b32 s68, s37, 7
    buffer_load_dwordx4 v246, s[60:63], s68 offen lds
    buffer_load_dwordx4 v247, s[60:63], s68 offen offset:1024 lds
    buffer_load_dwordx4 v248, s[60:63], s68 offen offset:2048 lds
    buffer_load_dwordx4 v249, s[60:63], s68 offen offset:3072 lds
    v_add_u32 v48, 0, v0
    v_mul_u32_u24 v49, 52429, v48
    v_lshrrev_b32 v49, 21, v49
    v_mul_u32_u24 v50, 40, v49
    v_sub_u32 v48, v48, v50
    v_bfe_u32 v50, v49, 1, 1
    v_bfe_u32 v51, v49, 3, 1
    v_lshl_or_b32 v50, v51, 1, v50
    v_lshlrev_b32 v50, 1, v50
    v_xor_b32 v48, v48, v50
    v_mul_u32_u24 v49, 1280, v49
    v_lshl_add_u32 v233, v48, 4, v49
    v_accvgpr_write_b32 a205, v233
    v_add_u32 v48, 256, v0
    v_mul_u32_u24 v49, 52429, v48
    v_lshrrev_b32 v49, 21, v49
    v_mul_u32_u24 v50, 40, v49
    v_sub_u32 v48, v48, v50
    v_bfe_u32 v50, v49, 1, 1
    v_bfe_u32 v51, v49, 3, 1
    v_lshl_or_b32 v50, v51, 1, v50
    v_lshlrev_b32 v50, 1, v50
    v_xor_b32 v48, v48, v50
    v_mul_u32_u24 v49, 1280, v49
    v_lshl_add_u32 v234, v48, 4, v49
    v_accvgpr_write_b32 a206, v234
    v_add_u32 v48, 512, v0
    v_mul_u32_u24 v49, 52429, v48
    v_lshrrev_b32 v49, 21, v49
    v_mul_u32_u24 v50, 40, v49
    v_sub_u32 v48, v48, v50
    v_bfe_u32 v50, v49, 1, 1
    v_bfe_u32 v51, v49, 3, 1
    v_lshl_or_b32 v50, v51, 1, v50
    v_lshlrev_b32 v50, 1, v50
    v_xor_b32 v48, v48, v50
    v_mul_u32_u24 v49, 1280, v49
    v_lshl_add_u32 v235, v48, 4, v49
    v_accvgpr_write_b32 a207, v235
    v_add_u32 v48, 768, v0
    v_mul_u32_u24 v49, 52429, v48
    v_lshrrev_b32 v49, 21, v49
    v_mul_u32_u24 v50, 40, v49
    v_sub_u32 v48, v48, v50
    v_bfe_u32 v50, v49, 1, 1
    v_bfe_u32 v51, v49, 3, 1
    v_lshl_or_b32 v50, v51, 1, v50
    v_lshlrev_b32 v50, 1, v50
    v_xor_b32 v48, v48, v50
    v_mul_u32_u24 v49, 1280, v49
    v_lshl_add_u32 v236, v48, 4, v49
    v_accvgpr_write_b32 a208, v236
    v_add_u32 v48, 1024, v0
    v_mul_u32_u24 v49, 52429, v48
    v_lshrrev_b32 v49, 21, v49
    v_mul_u32_u24 v50, 40, v49
    v_sub_u32 v48, v48, v50
    v_bfe_u32 v50, v49, 1, 1
    v_bfe_u32 v51, v49, 3, 1
    v_lshl_or_b32 v50, v51, 1, v50
    v_lshlrev_b32 v50, 1, v50
    v_xor_b32 v48, v48, v50
    v_mul_u32_u24 v49, 1280, v49
    v_lshl_add_u32 v237, v48, 4, v49
    v_accvgpr_write_b32 a209, v237
    v_lshl_add_u32 v48, v3, 3, v42
    v_mul_u32_u24 v48, 640, v48
    v_lshl_add_u32 v48, v43, 3, v48
    v_add_u32 v48, 140800, v48
    v_lshrrev_b32 v49, 1, v42
    v_and_b32 v50, 1, v3
    v_lshl_or_b32 v49, v50, 1, v49
    s_mul_i32 s80, s64, 5
    v_xor_b32 v50, s80, v49
    v_lshl_add_u32 v50, v50, 5, v48
    v_accvgpr_write_b32 a210, v50
    s_add_u32 s80, s80, 1
    v_xor_b32 v50, s80, v49
    v_lshl_add_u32 v50, v50, 5, v48
    v_accvgpr_write_b32 a211, v50
    s_add_u32 s80, s80, 1
    v_xor_b32 v50, s80, v49
    v_lshl_add_u32 v50, v50, 5, v48
    v_accvgpr_write_b32 a212, v50
    s_add_u32 s80, s80, 1
    v_xor_b32 v50, s80, v49
    v_lshl_add_u32 v50, v50, 5, v48
    v_accvgpr_write_b32 a213, v50
    s_add_u32 s80, s80, 1
    v_xor_b32 v50, s80, v49
    v_lshl_add_u32 v50, v50, 5, v48
    v_accvgpr_write_b32 a214, v50
    s_add_u32 s80, s80, 1
    v_accvgpr_write_b32 a215, v0
    s_mov_b32 s75, 0xbfb8aa3b
    s_waitcnt vmcnt(21)
    v_lshlrev_b32 v188, 16, v188
    v_mul_f32 v160, s75, v188
    s_waitcnt vmcnt(20)
    v_lshlrev_b32 v189, 16, v189
    v_mul_f32 v161, s75, v189
    s_waitcnt vmcnt(19)
    v_lshlrev_b32 v190, 16, v190
    v_mul_f32 v162, s75, v190
    s_waitcnt vmcnt(18)
    v_lshlrev_b32 v191, 16, v191
    v_mul_f32 v163, s75, v191
    s_waitcnt vmcnt(17)
    v_lshlrev_b32 v192, 16, v192
    v_mul_f32 v164, s75, v192
    v_exp_f32 v160, v160
    v_exp_f32 v161, v161
    v_exp_f32 v162, v162
    v_exp_f32 v163, v163
    v_exp_f32 v164, v164
    v_add_f32 v160, 1.0, v160
    v_add_f32 v161, 1.0, v161
    v_add_f32 v162, 1.0, v162
    v_add_f32 v163, 1.0, v163
    v_add_f32 v164, 1.0, v164
    v_rcp_f32 v160, v160
    v_rcp_f32 v161, v161
    v_rcp_f32 v162, v162
    v_rcp_f32 v163, v163
    v_rcp_f32 v164, v164
    v_mul_f32 v188, v188, v160
    v_mul_f32 v189, v189, v161
    v_mul_f32 v190, v190, v162
    v_mul_f32 v191, v191, v163
    v_mul_f32 v192, v192, v164
    v_cvt_pk_bf16_f32 v188, v188, v188
    v_lshlrev_b32 v188, 16, v188
    v_cvt_pk_bf16_f32 v189, v189, v189
    v_lshlrev_b32 v189, 16, v189
    v_cvt_pk_bf16_f32 v190, v190, v190
    v_lshlrev_b32 v190, 16, v190
    v_cvt_pk_bf16_f32 v191, v191, v191
    v_lshlrev_b32 v191, 16, v191
    v_cvt_pk_bf16_f32 v192, v192, v192
    v_lshlrev_b32 v192, 16, v192
    s_waitcnt vmcnt(16)
    v_lshlrev_b32 v160, 16, v196
    v_and_b32 v161, 0xffff0000, v196
    v_pk_mul_f32 v[144:145], v[188:189], v[160:161] op_sel:[0,0] op_sel_hi:[0,1]
    v_lshlrev_b32 v160, 16, v197
    v_and_b32 v161, 0xffff0000, v197
    v_pk_mul_f32 v[146:147], v[188:189], v[160:161] op_sel:[0,0] op_sel_hi:[0,1]
    v_lshlrev_b32 v160, 16, v198
    v_and_b32 v161, 0xffff0000, v198
    v_pk_mul_f32 v[148:149], v[188:189], v[160:161] op_sel:[0,0] op_sel_hi:[0,1]
    v_lshlrev_b32 v160, 16, v199
    v_and_b32 v161, 0xffff0000, v199
    v_pk_mul_f32 v[150:151], v[188:189], v[160:161] op_sel:[0,0] op_sel_hi:[0,1]
    s_waitcnt vmcnt(15)
    v_lshlrev_b32 v160, 16, v200
    v_and_b32 v161, 0xffff0000, v200
    v_pk_fma_f32 v[144:145], v[188:189], v[160:161], v[144:145] op_sel:[1,0,0] op_sel_hi:[1,1,1]
    v_lshlrev_b32 v160, 16, v201
    v_and_b32 v161, 0xffff0000, v201
    v_pk_fma_f32 v[146:147], v[188:189], v[160:161], v[146:147] op_sel:[1,0,0] op_sel_hi:[1,1,1]
    v_lshlrev_b32 v160, 16, v202
    v_and_b32 v161, 0xffff0000, v202
    v_pk_fma_f32 v[148:149], v[188:189], v[160:161], v[148:149] op_sel:[1,0,0] op_sel_hi:[1,1,1]
    v_lshlrev_b32 v160, 16, v203
    v_and_b32 v161, 0xffff0000, v203
    v_pk_fma_f32 v[150:151], v[188:189], v[160:161], v[150:151] op_sel:[1,0,0] op_sel_hi:[1,1,1]
    s_waitcnt vmcnt(14)
    v_lshlrev_b32 v160, 16, v204
    v_and_b32 v161, 0xffff0000, v204
    v_pk_fma_f32 v[144:145], v[190:191], v[160:161], v[144:145] op_sel:[0,0,0] op_sel_hi:[0,1,1]
    v_lshlrev_b32 v160, 16, v205
    v_and_b32 v161, 0xffff0000, v205
    v_pk_fma_f32 v[146:147], v[190:191], v[160:161], v[146:147] op_sel:[0,0,0] op_sel_hi:[0,1,1]
    v_lshlrev_b32 v160, 16, v206
    v_and_b32 v161, 0xffff0000, v206
    v_pk_fma_f32 v[148:149], v[190:191], v[160:161], v[148:149] op_sel:[0,0,0] op_sel_hi:[0,1,1]
    v_lshlrev_b32 v160, 16, v207
    v_and_b32 v161, 0xffff0000, v207
    v_pk_fma_f32 v[150:151], v[190:191], v[160:161], v[150:151] op_sel:[0,0,0] op_sel_hi:[0,1,1]
    s_waitcnt vmcnt(13)
    v_lshlrev_b32 v160, 16, v208
    v_and_b32 v161, 0xffff0000, v208
    v_pk_fma_f32 v[144:145], v[190:191], v[160:161], v[144:145] op_sel:[1,0,0] op_sel_hi:[1,1,1]
    v_lshlrev_b32 v160, 16, v209
    v_and_b32 v161, 0xffff0000, v209
    v_pk_fma_f32 v[146:147], v[190:191], v[160:161], v[146:147] op_sel:[1,0,0] op_sel_hi:[1,1,1]
    v_lshlrev_b32 v160, 16, v210
    v_and_b32 v161, 0xffff0000, v210
    v_pk_fma_f32 v[148:149], v[190:191], v[160:161], v[148:149] op_sel:[1,0,0] op_sel_hi:[1,1,1]
    v_lshlrev_b32 v160, 16, v211
    v_and_b32 v161, 0xffff0000, v211
    v_pk_fma_f32 v[150:151], v[190:191], v[160:161], v[150:151] op_sel:[1,0,0] op_sel_hi:[1,1,1]
    s_waitcnt vmcnt(12)
    v_lshlrev_b32 v160, 16, v212
    v_and_b32 v161, 0xffff0000, v212
    v_pk_fma_f32 v[144:145], v[192:193], v[160:161], v[144:145] op_sel:[0,0,0] op_sel_hi:[0,1,1]
    v_lshlrev_b32 v160, 16, v213
    v_and_b32 v161, 0xffff0000, v213
    v_pk_fma_f32 v[146:147], v[192:193], v[160:161], v[146:147] op_sel:[0,0,0] op_sel_hi:[0,1,1]
    v_lshlrev_b32 v160, 16, v214
    v_and_b32 v161, 0xffff0000, v214
    v_pk_fma_f32 v[148:149], v[192:193], v[160:161], v[148:149] op_sel:[0,0,0] op_sel_hi:[0,1,1]
    v_lshlrev_b32 v160, 16, v215
    v_and_b32 v161, 0xffff0000, v215
    v_pk_fma_f32 v[150:151], v[192:193], v[160:161], v[150:151] op_sel:[0,0,0] op_sel_hi:[0,1,1]
    v_lshlrev_b32 v133, 5, v128
    v_add_u32 v133, 114688, v133
    ds_write_b128 v133, v[144:147]
    ds_write_b128 v133, v[148:151] offset:16
    s_waitcnt vmcnt(8) lgkmcnt(0)
    v_readfirstlane_b32 s65, v143
    s_mov_b32 s85, 100000
P0_TAG:
    s_cmp_lg_u32 s65, 0
    s_cbranch_scc1 P0_TAGD
    buffer_load_dword v143, v142, s[48:51], 0 offen sc1
    s_waitcnt vmcnt(0)
    v_readfirstlane_b32 s65, v143
    s_sub_u32 s85, s85, 1
    s_cbranch_scc1 F_END
    s_branch P0_TAG
P0_TAGD:
    s_barrier
    s_cmp_lg_u32 s64, 0
    s_cbranch_scc1 SIG_1
    s_mov_b64 exec, 1
    v_mov_b32 v144, s65
    v_mov_b32 v145, 0
    s_lshl_b32 s100, s2, 7
    s_add_u32 s100, s100, 655360
    buffer_store_dword v144, v145, s[32:35], s100 offen sc1
    s_mov_b64 exec, -1
    v_lshlrev_b32 v133, 2, v128
    v_add_u32 v134, 114688, v133
    ds_read_b32 v144, v134 offset:0
    ds_read_b32 v145, v134 offset:256
    ds_read_b32 v146, v134 offset:512
    ds_read_b32 v147, v134 offset:768
    ds_read_b32 v148, v134 offset:1024
    ds_read_b32 v149, v134 offset:1280
    ds_read_b32 v150, v134 offset:1536
    ds_read_b32 v151, v134 offset:1792
    ds_read_b32 v152, v134 offset:2048
    ds_read_b32 v153, v134 offset:2304
    ds_read_b32 v154, v134 offset:2560
    ds_read_b32 v155, v134 offset:2816
    ds_read_b32 v156, v134 offset:3072
    ds_read_b32 v157, v134 offset:3328
    ds_read_b32 v158, v134 offset:3584
    ds_read_b32 v159, v134 offset:3840
    ds_read_b32 v160, v134 offset:4096
    ds_read_b32 v161, v134 offset:4352
    ds_read_b32 v162, v134 offset:4608
    ds_read_b32 v163, v134 offset:4864
    ds_read_b32 v164, v134 offset:5120
    ds_read_b32 v165, v134 offset:5376
    ds_read_b32 v166, v134 offset:5632
    ds_read_b32 v167, v134 offset:5888
    ds_read_b32 v168, v134 offset:6144
    ds_read_b32 v169, v134 offset:6400
    ds_read_b32 v170, v134 offset:6656
    ds_read_b32 v171, v134 offset:6912
    ds_read_b32 v172, v134 offset:7168
    ds_read_b32 v173, v134 offset:7424
    ds_read_b32 v174, v134 offset:7680
    ds_read_b32 v175, v134 offset:7936
    v_lshlrev_b32 v133, 3, v128
    s_waitcnt lgkmcnt(0)
    v_add_f32 v144, v144, v160
    v_add_f32 v145, v145, v161
    v_add_f32 v146, v146, v162
    v_add_f32 v147, v147, v163
    v_add_f32 v148, v148, v164
    v_add_f32 v149, v149, v165
    v_add_f32 v150, v150, v166
    v_add_f32 v151, v151, v167
    v_add_f32 v152, v152, v168
    v_add_f32 v153, v153, v169
    v_add_f32 v154, v154, v170
    v_add_f32 v155, v155, v171
    v_add_f32 v156, v156, v172
    v_add_f32 v157, v157, v173
    v_add_f32 v158, v158, v174
    v_add_f32 v159, v159, v175
    v_add_f32 v144, v144, v152
    v_add_f32 v145, v145, v153
    v_add_f32 v146, v146, v154
    v_add_f32 v147, v147, v155
    v_add_f32 v148, v148, v156
    v_add_f32 v149, v149, v157
    v_add_f32 v150, v150, v158
    v_add_f32 v151, v151, v159
    v_add_f32 v144, v144, v148
    v_add_f32 v145, v145, v149
    v_add_f32 v146, v146, v150
    v_add_f32 v147, v147, v151
    v_add_f32 v144, v144, v146
    v_add_f32 v145, v145, v147
    v_add_f32 v144, v144, v145
    v_mov_b32 v145, s65
    buffer_store_dwordx2 v[144:145], v133, s[32:35], s71 offen sc1
    v_lshlrev_b32 v133, 2, v128
    buffer_store_dword v144, v133, s[32:35], s78 offen sc1
SIG_1:
    s_lshl_b32 s80, s67, 3
    s_lshl_b32 s81, s64, 1
    s_add_u32 s80, s80, s81
    s_mul_i32 s80, s80, 40960
    s_add_u32 s80, s80, 1048576
    s_add_u32 s44, s30, s80
    s_addc_u32 s45, s31, 0
    s_mov_b32 s46, 0xa000
    s_mov_b32 s47, 0x20000
    s_add_u32 s80, s80, 40960
    s_add_u32 s48, s30, s80
    s_addc_u32 s49, s31, 0
    s_mov_b32 s50, 0xa000
    s_mov_b32 s51, 0x20000
    s_and_b32 s80, s2, 7
    s_lshr_b32 s81, s2, 3
    s_lshr_b32 s82, s80, 1
    s_lshl_b32 s82, s82, 3
    s_and_b32 s83, s81, 7
    s_add_u32 s23, s82, s83
    s_and_b32 s82, s80, 1
    s_lshl_b32 s82, s82, 2
    s_lshr_b32 s83, s81, 3
    s_add_u32 s22, s82, s83
    s_lshr_b32 s71, s36, 3
    v_add_u32 v244, s71, v244
    v_lshlrev_b32 v50, 1, v128
    v_cmp_gt_u32 vcc, 64, v128
    v_add_u32 v51, 512, v50
    v_subrev_u32 v52, 128, v50
    v_cndmask_b32 v51, v52, v51, vcc
    v_cndmask_b32_e64 v53, 0, 32, vcc
    v_add_u32 v52, 384, v50
    v_lshrrev_b32 v56, 3, v50
    v_lshlrev_b32 v56, 6, v56
    v_and_b32 v50, 7, v50
    v_lshl_add_u32 v56, v50, 2, v56
    v_add_u32 v56, 131104, v56
    v_lshrrev_b32 v57, 3, v51
    v_lshlrev_b32 v57, 6, v57
    v_and_b32 v51, 7, v51
    v_lshl_add_u32 v57, v51, 2, v57
    v_add_u32 v57, 131072, v57
    v_lshrrev_b32 v58, 3, v52
    v_lshlrev_b32 v58, 6, v58
    v_and_b32 v52, 7, v52
    v_lshl_add_u32 v58, v52, 2, v58
    v_add_u32 v58, 131072, v58
    v_add_u32 v57, v57, v53
    v_cmp_gt_u32 vcc, 128, v128
    v_mov_b32 v50, 140608
    s_nop 0
    v_cndmask_b32 v58, v50, v58, vcc
    v_lshlrev_b32 v54, 4, v128
    v_and_b32 v55, 0x7ff, v54
    v_and_b32 v47, 7, v130
    v_lshlrev_b32 v47, 7, v47
    s_lshl_b32 s82, s67, 12
    s_lshl_b32 s83, s64, 10
    s_add_u32 s82, s82, s83
    s_add_u32 s82, s82, 655360
    s_add_u32 m0, s72, 32768
    s_lshl_b32 s68, s38, 7
    buffer_load_dwordx4 v246, s[60:63], s68 offen lds
    buffer_load_dwordx4 v247, s[60:63], s68 offen offset:1024 lds
    buffer_load_dwordx4 v248, s[60:63], s68 offen offset:2048 lds
    buffer_load_dwordx4 v249, s[60:63], s68 offen offset:3072 lds
    s_add_u32 m0, s72, 49152
    s_lshl_b32 s68, s39, 7
    buffer_load_dwordx4 v246, s[60:63], s68 offen lds
    buffer_load_dwordx4 v247, s[60:63], s68 offen offset:1024 lds
    buffer_load_dwordx4 v248, s[60:63], s68 offen offset:2048 lds
    buffer_load_dwordx4 v249, s[60:63], s68 offen offset:3072 lds
    s_add_u32 m0, s72, 65536
    s_lshl_b32 s68, s40, 7
    buffer_load_dwordx4 v246, s[60:63], s68 offen lds
    buffer_load_dwordx4 v247, s[60:63], s68 offen offset:1024 lds
    buffer_load_dwordx4 v248, s[60:63], s68 offen offset:2048 lds
    buffer_load_dwordx4 v249, s[60:63], s68 offen offset:3072 lds
    s_mov_b32 s85, 100000
POLL_2:
    buffer_load_dword v48, v47, s[32:35], s82 offen sc1
    s_waitcnt vmcnt(0)
    v_xor_b32 v48, s65, v48
    v_cmp_ne_u32 vcc, 0, v48
    s_nop 1
    s_cbranch_vccz POLLD_3
    s_sub_u32 s85, s85, 1
    s_cbranch_scc1 F_END
    s_sleep 3
    s_branch POLL_2
POLLD_3:
    s_mov_b32 s85, 100000
P1_WAIT:
    s_mov_b32 s80, 524288
    buffer_load_dwordx4 v[0:3], v54, s[32:35], s80 offen sc1
    s_mov_b32 s80, 555008
    buffer_load_dwordx4 v[4:7], v54, s[32:35], s80 offen sc1
    s_mov_b32 s80, 585728
    buffer_load_dwordx4 v[8:11], v54, s[32:35], s80 offen sc1
    s_mov_b32 s80, 616448
    buffer_load_dwordx4 v[12:15], v54, s[32:35], s80 offen sc1
    s_mov_b32 s80, 528384
    buffer_load_dwordx4 v[16:19], v54, s[32:35], s80 offen sc1
    s_mov_b32 s80, 559104
    buffer_load_dwordx4 v[20:23], v54, s[32:35], s80 offen sc1
    s_mov_b32 s80, 589824
    buffer_load_dwordx4 v[24:27], v54, s[32:35], s80 offen sc1
    s_mov_b32 s80, 620544
    buffer_load_dwordx4 v[28:31], v54, s[32:35], s80 offen sc1
    s_mov_b32 s80, 532480
    buffer_load_dwordx4 v[32:35], v55, s[32:35], s80 offen sc1
    s_mov_b32 s80, 563200
    buffer_load_dwordx4 v[36:39], v55, s[32:35], s80 offen sc1
    s_mov_b32 s80, 593920
    buffer_load_dwordx4 v[40:43], v55, s[32:35], s80 offen sc1
    s_mov_b32 s80, 624640
    buffer_load_dwordx4 v[44:47], v55, s[32:35], s80 offen sc1
    buffer_load_dwordx4 v[128:131], v245, s[44:47], s36 offen sc1
    buffer_load_dwordx4 v[132:135], v245, s[48:51], s36 offen sc1
    buffer_load_dwordx4 v[136:139], v245, s[44:47], s36 offen offset:1024 sc1
    buffer_load_dwordx4 v[140:143], v245, s[48:51], s36 offen offset:1024 sc1
    buffer_load_dwordx4 v[144:147], v245, s[44:47], s36 offen offset:2048 sc1
    buffer_load_dwordx4 v[148:151], v245, s[48:51], s36 offen offset:2048 sc1
    buffer_load_dwordx4 v[152:155], v245, s[44:47], s36 offen offset:3072 sc1
    buffer_load_dwordx4 v[156:159], v245, s[48:51], s36 offen offset:3072 sc1
    s_waitcnt vmcnt(8)
    v_xor_b32 v1, s65, v1
    v_xor_b32 v3, s65, v3
    v_xor_b32 v5, s65, v5
    v_xor_b32 v7, s65, v7
    v_xor_b32 v9, s65, v9
    v_xor_b32 v11, s65, v11
    v_xor_b32 v13, s65, v13
    v_xor_b32 v15, s65, v15
    v_xor_b32 v17, s65, v17
    v_xor_b32 v19, s65, v19
    v_xor_b32 v21, s65, v21
    v_xor_b32 v23, s65, v23
    v_xor_b32 v25, s65, v25
    v_xor_b32 v27, s65, v27
    v_xor_b32 v29, s65, v29
    v_xor_b32 v31, s65, v31
    v_xor_b32 v33, s65, v33
    v_xor_b32 v35, s65, v35
    v_xor_b32 v37, s65, v37
    v_xor_b32 v39, s65, v39
    v_xor_b32 v41, s65, v41
    v_xor_b32 v43, s65, v43
    v_xor_b32 v45, s65, v45
    v_xor_b32 v47, s65, v47
    v_or_b32 v48, v1, v3
    v_or3_b32 v48, v48, v5, v7
    v_or3_b32 v48, v48, v9, v11
    v_or3_b32 v48, v48, v13, v15
    v_or3_b32 v48, v48, v17, v19
    v_or3_b32 v48, v48, v21, v23
    v_or3_b32 v48, v48, v25, v27
    v_or3_b32 v48, v48, v29, v31
    v_or3_b32 v48, v48, v33, v35
    v_or3_b32 v48, v48, v37, v39
    v_or3_b32 v48, v48, v41, v43
    v_or3_b32 v48, v48, v45, v47
    v_cmp_ne_u32 vcc, 0, v48
    s_nop 1
    s_cbranch_vccz P1_GO
    s_sub_u32 s85, s85, 1
    s_cbranch_scc1 F_END
    s_sleep 2
    s_branch P1_WAIT
P1_GO:
    s_and_b32 s82, s67, 3
    s_lshl_b32 s82, s82, 15
    s_mov_b32 s83, s82
    v_cmp_ne_u32 vcc, 0, v53
    s_cmp_lg_u32 s64, 0
    s_cbranch_scc1 SIG_4
    s_mov_b64 exec, 1
    v_mov_b32 v48, s65
    v_mov_b32 v49, 0
    s_lshl_b32 s100, s2, 2
    s_add_u32 s100, s100, 399360
    buffer_store_dword v48, v49, s[32:35], s100 offen sc1
    s_mov_b64 exec, -1
SIG_4:
    s_mov_b32 s80, 0x3e0293ee
    v_add_f32 v0, v0, v4
    v_add_f32 v8, v8, v12
    v_add_f32 v2, v2, v6
    v_add_f32 v10, v10, v14
    v_add_f32 v16, v16, v20
    v_add_f32 v24, v24, v28
    v_add_f32 v18, v18, v22
    v_add_f32 v26, v26, v30
    v_add_f32 v32, v32, v36
    v_add_f32 v40, v40, v44
    v_add_f32 v34, v34, v38
    v_add_f32 v42, v42, v46
    v_add_f32 v0, v0, v8
    v_add_f32 v2, v2, v10
    v_add_f32 v16, v16, v24
    v_add_f32 v18, v18, v26
    v_add_f32 v32, v32, v40
    v_add_f32 v34, v34, v42
    v_cvt_pk_bf16_f32 v0, v0, v0
    v_lshlrev_b32 v0, 16, v0
    v_cvt_pk_bf16_f32 v2, v2, v2
    v_lshlrev_b32 v2, 16, v2
    v_cvt_pk_bf16_f32 v16, v16, v16
    v_lshlrev_b32 v16, 16, v16
    v_cvt_pk_bf16_f32 v18, v18, v18
    v_lshlrev_b32 v18, 16, v18
    v_cvt_pk_bf16_f32 v32, v32, v32
    v_lshlrev_b32 v32, 16, v32
    v_cvt_pk_bf16_f32 v34, v34, v34
    v_lshlrev_b32 v34, 16, v34
    v_add_f32 v17, 1.0, v16
    v_cvt_pk_bf16_f32 v17, v17, v17
    v_lshlrev_b32 v17, 16, v17
    v_add_f32 v19, 1.0, v18
    v_cvt_pk_bf16_f32 v19, v19, v19
    v_lshlrev_b32 v19, 16, v19
    v_add_f32 v33, 1.0, v32
    v_cvt_pk_bf16_f32 v33, v33, v33
    v_lshlrev_b32 v33, 16, v33
    v_add_f32 v35, 1.0, v34
    v_cvt_pk_bf16_f32 v35, v35, v35
    v_lshlrev_b32 v35, 16, v35
    v_cndmask_b32 v17, v17, v16, vcc
    v_cndmask_b32 v19, v19, v18, vcc
    v_mul_f32 v4, s80, v0
    v_mul_f32 v5, s80, v2
    ds_write_b64 v56, v[4:5]
    v_mul_f32 v20, s80, v17
    v_mul_f32 v21, s80, v19
    ds_write_b64 v57, v[20:21]
    v_mul_f32 v36, s80, v33
    v_mul_f32 v37, s80, v35
    ds_write_b64 v58, v[36:37]
    v_mov_b32 v192, 140544
    v_mov_b32 v193, 0
    ds_write_b32 v192, v193
    s_waitcnt lgkmcnt(0)
    s_barrier
    ds_read_b128 v[208:211], v244 offset:0
    ds_read_b128 v[212:215], v244 offset:16
    ds_read_b128 v[216:219], v244 offset:32
    ds_read_b128 v[220:223], v244 offset:48
    ds_read_b64_tr_b16 a[128:129], v240 offset:0
    ds_read_b64_tr_b16 a[130:131], v240 offset:1024
    ds_read_b64_tr_b16 a[132:133], v241 offset:0
    ds_read_b64_tr_b16 a[134:135], v241 offset:1024
    ds_read_b64_tr_b16 a[136:137], v242 offset:0
    ds_read_b64_tr_b16 a[138:139], v242 offset:1024
    ds_read_b64_tr_b16 a[140:141], v243 offset:0
    ds_read_b64_tr_b16 a[142:143], v243 offset:1024
    ds_read_b128 v[224:227], v244 offset:128
    ds_read_b128 v[228:231], v244 offset:144
    ds_read_b128 v[232:235], v244 offset:160
    ds_read_b128 v[236:239], v244 offset:176
    ds_read_b64_tr_b16 a[144:145], v240 offset:4096
    ds_read_b64_tr_b16 a[146:147], v240 offset:5120
    ds_read_b64_tr_b16 a[148:149], v241 offset:4096
    ds_read_b64_tr_b16 a[150:151], v241 offset:5120
    ds_read_b64_tr_b16 a[152:153], v242 offset:4096
    ds_read_b64_tr_b16 a[154:155], v242 offset:5120
    ds_read_b64_tr_b16 a[156:157], v243 offset:4096
    ds_read_b64_tr_b16 a[158:159], v243 offset:5120
    s_waitcnt vmcnt(6) lgkmcnt(15)
    v_fma_mix_f32 v250, v128, v208, v216 op_sel_hi:[1,0,0]
    v_fma_mix_f32 v251, v128, v209, v217 op_sel:[1,0,0] op_sel_hi:[1,0,0]
    v_cvt_pk_bf16_f32 v192, v250, v251
    v_fma_mix_f32 v252, v129, v210, v218 op_sel_hi:[1,0,0]
    v_fma_mix_f32 v253, v129, v211, v219 op_sel:[1,0,0] op_sel_hi:[1,0,0]
    v_cvt_pk_bf16_f32 v193, v252, v253
    v_fma_mix_f32 v250, v130, v212, v220 op_sel_hi:[1,0,0]
    v_fma_mix_f32 v251, v130, v213, v221 op_sel:[1,0,0] op_sel_hi:[1,0,0]
    v_cvt_pk_bf16_f32 v194, v250, v251
    v_fma_mix_f32 v252, v131, v214, v222 op_sel_hi:[1,0,0]
    v_fma_mix_f32 v253, v131, v215, v223 op_sel:[1,0,0] op_sel_hi:[1,0,0]
    v_cvt_pk_bf16_f32 v195, v252, v253
    v_fma_mix_f32 v250, v132, v208, v216 op_sel_hi:[1,0,0]
    v_fma_mix_f32 v251, v132, v209, v217 op_sel:[1,0,0] op_sel_hi:[1,0,0]
    v_cvt_pk_bf16_f32 v196, v250, v251
    v_fma_mix_f32 v252, v133, v210, v218 op_sel_hi:[1,0,0]
    v_fma_mix_f32 v253, v133, v211, v219 op_sel:[1,0,0] op_sel_hi:[1,0,0]
    v_cvt_pk_bf16_f32 v197, v252, v253
    v_fma_mix_f32 v250, v134, v212, v220 op_sel_hi:[1,0,0]
    v_fma_mix_f32 v251, v134, v213, v221 op_sel:[1,0,0] op_sel_hi:[1,0,0]
    v_cvt_pk_bf16_f32 v198, v250, v251
    v_fma_mix_f32 v252, v135, v214, v222 op_sel_hi:[1,0,0]
    v_fma_mix_f32 v253, v135, v215, v223 op_sel:[1,0,0] op_sel_hi:[1,0,0]
    v_cvt_pk_bf16_f32 v199, v252, v253
    s_waitcnt lgkmcnt(12)
    v_mfma_f32_32x32x16_bf16 v[0:15], a[128:131], v[192:195], 0
    s_barrier
    ds_read_b128 v[208:211], v244 offset:256
    ds_read_b128 v[212:215], v244 offset:272
    s_waitcnt vmcnt(4) lgkmcnt(10)
    v_fma_mix_f32 v250, v136, v224, v232 op_sel_hi:[1,0,0]
    v_fma_mix_f32 v251, v136, v225, v233 op_sel:[1,0,0] op_sel_hi:[1,0,0]
    v_cvt_pk_bf16_f32 v200, v250, v251
    v_mfma_f32_32x32x16_bf16 v[16:31], a[128:131], v[196:199], 0
    ds_read_b128 v[216:219], v244 offset:288
    ds_read_b128 v[220:223], v244 offset:304
    s_add_u32 m0, s72, 81920
    s_lshl_b32 s68, s41, 7
    buffer_load_dwordx4 v246, s[60:63], s68 offen lds
    v_mfma_f32_32x32x16_bf16 v[32:47], a[132:135], v[192:195], 0
    ds_read_b64_tr_b16 a[160:161], v240 offset:8192
    ds_read_b64_tr_b16 a[162:163], v240 offset:9216
    buffer_load_dwordx4 v[160:163], v245, s[44:47], s37 offen sc1
    v_fma_mix_f32 v252, v137, v226, v234 op_sel_hi:[1,0,0]
    v_mfma_f32_32x32x16_bf16 v[48:63], a[132:135], v[196:199], 0
    ds_read_b64_tr_b16 a[164:165], v241 offset:8192
    ds_read_b64_tr_b16 a[166:167], v241 offset:9216
    v_fma_mix_f32 v253, v137, v227, v235 op_sel:[1,0,0] op_sel_hi:[1,0,0]
    v_cvt_pk_bf16_f32 v201, v252, v253
    v_fma_mix_f32 v250, v138, v228, v236 op_sel_hi:[1,0,0]
    v_fma_mix_f32 v251, v138, v229, v237 op_sel:[1,0,0] op_sel_hi:[1,0,0]
    v_mfma_f32_32x32x16_bf16 v[64:79], a[136:139], v[192:195], 0
    ds_read_b64_tr_b16 a[168:169], v242 offset:8192
    ds_read_b64_tr_b16 a[170:171], v242 offset:9216
    buffer_load_dwordx4 v[164:167], v245, s[48:51], s37 offen sc1
    v_cvt_pk_bf16_f32 v202, v250, v251
    v_mfma_f32_32x32x16_bf16 v[80:95], a[136:139], v[196:199], 0
    ds_read_b64_tr_b16 a[172:173], v243 offset:8192
    ds_read_b64_tr_b16 a[174:175], v243 offset:9216
    v_fma_mix_f32 v252, v139, v230, v238 op_sel_hi:[1,0,0]
    v_fma_mix_f32 v253, v139, v231, v239 op_sel:[1,0,0] op_sel_hi:[1,0,0]
    v_cvt_pk_bf16_f32 v203, v252, v253
    v_fma_mix_f32 v250, v140, v224, v232 op_sel_hi:[1,0,0]
    v_mfma_f32_32x32x16_bf16 v[96:111], a[140:143], v[192:195], 0
    buffer_load_dwordx4 v[128:131], v245, s[44:47], s38 offen sc1
    v_fma_mix_f32 v251, v140, v225, v233 op_sel:[1,0,0] op_sel_hi:[1,0,0]
    v_cvt_pk_bf16_f32 v204, v250, v251
    v_fma_mix_f32 v252, v141, v226, v234 op_sel_hi:[1,0,0]
    v_mfma_f32_32x32x16_bf16 v[112:127], a[140:143], v[196:199], 0
    buffer_load_dwordx4 v[132:135], v245, s[48:51], s38 offen sc1
    v_fma_mix_f32 v253, v141, v227, v235 op_sel:[1,0,0] op_sel_hi:[1,0,0]
    v_cvt_pk_bf16_f32 v205, v252, v253
    v_fma_mix_f32 v250, v142, v228, v236 op_sel_hi:[1,0,0]
    v_fma_mix_f32 v251, v142, v229, v237 op_sel:[1,0,0] op_sel_hi:[1,0,0]
    v_cvt_pk_bf16_f32 v206, v250, v251
    v_fma_mix_f32 v252, v143, v230, v238 op_sel_hi:[1,0,0]
    v_fma_mix_f32 v253, v143, v231, v239 op_sel:[1,0,0] op_sel_hi:[1,0,0]
    v_cvt_pk_bf16_f32 v207, v252, v253
    s_waitcnt lgkmcnt(12)
    v_mfma_f32_32x32x16_bf16 v[0:15], a[144:147], v[200:203], v[0:15]
    ds_read_b128 v[224:227], v244 offset:384
    ds_read_b128 v[228:231], v244 offset:400
    s_waitcnt vmcnt(7) lgkmcnt(10)
    v_fma_mix_f32 v250, v144, v208, v216 op_sel_hi:[1,0,0]
    v_fma_mix_f32 v251, v144, v209, v217 op_sel:[1,0,0] op_sel_hi:[1,0,0]
    v_cvt_pk_bf16_f32 v192, v250, v251
    v_fma_mix_f32 v252, v145, v210, v218 op_sel_hi:[1,0,0]
    v_mfma_f32_32x32x16_bf16 v[16:31], a[144:147], v[204:207], v[16:31]
    ds_read_b128 v[232:235], v244 offset:416
    ds_read_b128 v[236:239], v244 offset:432
    buffer_load_dwordx4 v247, s[60:63], s68 offen offset:1024 lds
    v_fma_mix_f32 v253, v145, v211, v219 op_sel:[1,0,0] op_sel_hi:[1,0,0]
    v_mfma_f32_32x32x16_bf16 v[32:47], a[148:151], v[200:203], v[32:47]
    ds_read_b64_tr_b16 a[176:177], v240 offset:12288
    ds_read_b64_tr_b16 a[178:179], v240 offset:13312
    buffer_load_dwordx4 v[168:171], v245, s[44:47], s37 offen offset:1024 sc1
    s_sub_u32 s71, s37, s36
    v_mfma_f32_32x32x16_bf16 v[48:63], a[148:151], v[204:207], v[48:63]
    ds_read_b64_tr_b16 a[180:181], v241 offset:12288
    ds_read_b64_tr_b16 a[182:183], v241 offset:13312
    s_ashr_i32 s71, s71, 3
    v_cvt_pk_bf16_f32 v193, v252, v253
    v_fma_mix_f32 v250, v146, v212, v220 op_sel_hi:[1,0,0]
    v_fma_mix_f32 v251, v146, v213, v221 op_sel:[1,0,0] op_sel_hi:[1,0,0]
    v_mfma_f32_32x32x16_bf16 v[64:79], a[152:155], v[200:203], v[64:79]
    ds_read_b64_tr_b16 a[184:185], v242 offset:12288
    ds_read_b64_tr_b16 a[186:187], v242 offset:13312
    buffer_load_dwordx4 v[172:175], v245, s[48:51], s37 offen offset:1024 sc1
    v_cvt_pk_bf16_f32 v194, v250, v251
    v_mfma_f32_32x32x16_bf16 v[80:95], a[152:155], v[204:207], v[80:95]
    ds_read_b64_tr_b16 a[188:189], v243 offset:12288
    ds_read_b64_tr_b16 a[190:191], v243 offset:13312
    v_fma_mix_f32 v252, v147, v214, v222 op_sel_hi:[1,0,0]
    v_fma_mix_f32 v253, v147, v215, v223 op_sel:[1,0,0] op_sel_hi:[1,0,0]
    v_cvt_pk_bf16_f32 v195, v252, v253
    v_fma_mix_f32 v250, v148, v208, v216 op_sel_hi:[1,0,0]
    v_mfma_f32_32x32x16_bf16 v[96:111], a[156:159], v[200:203], v[96:111]
    buffer_load_dwordx4 v[136:139], v245, s[44:47], s38 offen offset:1024 sc1
    v_fma_mix_f32 v251, v148, v209, v217 op_sel:[1,0,0] op_sel_hi:[1,0,0]
    v_cvt_pk_bf16_f32 v196, v250, v251
    v_fma_mix_f32 v252, v149, v210, v218 op_sel_hi:[1,0,0]
    v_mfma_f32_32x32x16_bf16 v[112:127], a[156:159], v[204:207], v[112:127]
    buffer_load_dwordx4 v[140:143], v245, s[48:51], s38 offen offset:1024 sc1
    v_fma_mix_f32 v253, v149, v211, v219 op_sel:[1,0,0] op_sel_hi:[1,0,0]
    v_cvt_pk_bf16_f32 v197, v252, v253
    v_fma_mix_f32 v250, v150, v212, v220 op_sel_hi:[1,0,0]
    v_fma_mix_f32 v251, v150, v213, v221 op_sel:[1,0,0] op_sel_hi:[1,0,0]
    v_cvt_pk_bf16_f32 v198, v250, v251
    v_fma_mix_f32 v252, v151, v214, v222 op_sel_hi:[1,0,0]
    v_fma_mix_f32 v253, v151, v215, v223 op_sel:[1,0,0] op_sel_hi:[1,0,0]
    v_cvt_pk_bf16_f32 v199, v252, v253
    v_add_u32 v244, s71, v244
    s_waitcnt lgkmcnt(12)
    v_mfma_f32_32x32x16_bf16 v[0:15], a[160:163], v[192:195], v[0:15]
    ds_read_b128 v[208:211], v244 offset:0
    ds_read_b128 v[212:215], v244 offset:16
    s_waitcnt vmcnt(10) lgkmcnt(10)
    v_fma_mix_f32 v250, v152, v224, v232 op_sel_hi:[1,0,0]
    v_fma_mix_f32 v251, v152, v225, v233 op_sel:[1,0,0] op_sel_hi:[1,0,0]
    v_cvt_pk_bf16_f32 v200, v250, v251
    v_fma_mix_f32 v252, v153, v226, v234 op_sel_hi:[1,0,0]
    v_mfma_f32_32x32x16_bf16 v[16:31], a[160:163], v[196:199], v[16:31]
    ds_read_b128 v[216:219], v244 offset:32
    ds_read_b128 v[220:223], v244 offset:48
    buffer_load_dwordx4 v248, s[60:63], s68 offen offset:2048 lds
    v_fma_mix_f32 v253, v153, v227, v235 op_sel:[1,0,0] op_sel_hi:[1,0,0]
    v_mfma_f32_32x32x16_bf16 v[32:47], a[164:167], v[192:195], v[32:47]
    ds_read_b64_tr_b16 a[128:129], v240 offset:16384
    ds_read_b64_tr_b16 a[130:131], v240 offset:17408
    buffer_load_dwordx4 v[176:179], v245, s[44:47], s37 offen offset:2048 sc1
    v_cvt_pk_bf16_f32 v201, v252, v253
    v_mfma_f32_32x32x16_bf16 v[48:63], a[164:167], v[196:199], v[48:63]
    ds_read_b64_tr_b16 a[132:133], v241 offset:16384
    ds_read_b64_tr_b16 a[134:135], v241 offset:17408
    v_fma_mix_f32 v250, v154, v228, v236 op_sel_hi:[1,0,0]
    v_fma_mix_f32 v251, v154, v229, v237 op_sel:[1,0,0] op_sel_hi:[1,0,0]
    v_cvt_pk_bf16_f32 v202, v250, v251
    v_fma_mix_f32 v252, v155, v230, v238 op_sel_hi:[1,0,0]
    v_mfma_f32_32x32x16_bf16 v[64:79], a[168:171], v[192:195], v[64:79]
    ds_read_b64_tr_b16 a[136:137], v242 offset:16384
    ds_read_b64_tr_b16 a[138:139], v242 offset:17408
    buffer_load_dwordx4 v[180:183], v245, s[48:51], s37 offen offset:2048 sc1
    v_fma_mix_f32 v253, v155, v231, v239 op_sel:[1,0,0] op_sel_hi:[1,0,0]
    v_mfma_f32_32x32x16_bf16 v[80:95], a[168:171], v[196:199], v[80:95]
    ds_read_b64_tr_b16 a[140:141], v243 offset:16384
    ds_read_b64_tr_b16 a[142:143], v243 offset:17408
    v_cvt_pk_bf16_f32 v203, v252, v253
    v_fma_mix_f32 v250, v156, v224, v232 op_sel_hi:[1,0,0]
    v_fma_mix_f32 v251, v156, v225, v233 op_sel:[1,0,0] op_sel_hi:[1,0,0]
    v_cvt_pk_bf16_f32 v204, v250, v251
    v_mfma_f32_32x32x16_bf16 v[96:111], a[172:175], v[192:195], v[96:111]
    buffer_load_dwordx4 v[144:147], v245, s[44:47], s38 offen offset:2048 sc1
    v_fma_mix_f32 v252, v157, v226, v234 op_sel_hi:[1,0,0]
    v_fma_mix_f32 v253, v157, v227, v235 op_sel:[1,0,0] op_sel_hi:[1,0,0]
    v_cvt_pk_bf16_f32 v205, v252, v253
    v_mfma_f32_32x32x16_bf16 v[112:127], a[172:175], v[196:199], v[112:127]
    buffer_load_dwordx4 v[148:151], v245, s[48:51], s38 offen offset:2048 sc1
    v_fma_mix_f32 v250, v158, v228, v236 op_sel_hi:[1,0,0]
    v_fma_mix_f32 v251, v158, v229, v237 op_sel:[1,0,0] op_sel_hi:[1,0,0]
    v_cvt_pk_bf16_f32 v206, v250, v251
    v_fma_mix_f32 v252, v159, v230, v238 op_sel_hi:[1,0,0]
    v_fma_mix_f32 v253, v159, v231, v239 op_sel:[1,0,0] op_sel_hi:[1,0,0]
    v_cvt_pk_bf16_f32 v207, v252, v253
    s_waitcnt lgkmcnt(12)
    v_mfma_f32_32x32x16_bf16 v[0:15], a[176:179], v[200:203], v[0:15]
    ds_read_b128 v[224:227], v244 offset:128
    ds_read_b128 v[228:231], v244 offset:144
    s_waitcnt vmcnt(12) lgkmcnt(10)
    v_fma_mix_f32 v250, v160, v208, v216 op_sel_hi:[1,0,0]
    v_fma_mix_f32 v251, v160, v209, v217 op_sel:[1,0,0] op_sel_hi:[1,0,0]
    v_cvt_pk_bf16_f32 v192, v250, v251
    v_fma_mix_f32 v252, v161, v210, v218 op_sel_hi:[1,0,0]
    v_mfma_f32_32x32x16_bf16 v[16:31], a[176:179], v[204:207], v[16:31]
    ds_read_b128 v[232:235], v244 offset:160
    ds_read_b128 v[236:239], v244 offset:176
    buffer_load_dwordx4 v249, s[60:63], s68 offen offset:3072 lds
    v_fma_mix_f32 v253, v161, v211, v219 op_sel:[1,0,0] op_sel_hi:[1,0,0]
    v_mfma_f32_32x32x16_bf16 v[32:47], a[180:183], v[200:203], v[32:47]
    ds_read_b64_tr_b16 a[144:145], v240 offset:20480
    ds_read_b64_tr_b16 a[146:147], v240 offset:21504
    buffer_load_dwordx4 v[184:187], v245, s[44:47], s37 offen offset:3072 sc1
    v_cvt_pk_bf16_f32 v193, v252, v253
    v_mfma_f32_32x32x16_bf16 v[48:63], a[180:183], v[204:207], v[48:63]
    ds_read_b64_tr_b16 a[148:149], v241 offset:20480
    ds_read_b64_tr_b16 a[150:151], v241 offset:21504
    v_fma_mix_f32 v250, v162, v212, v220 op_sel_hi:[1,0,0]
    v_fma_mix_f32 v251, v162, v213, v221 op_sel:[1,0,0] op_sel_hi:[1,0,0]
    v_cvt_pk_bf16_f32 v194, v250, v251
    v_fma_mix_f32 v252, v163, v214, v222 op_sel_hi:[1,0,0]
    v_mfma_f32_32x32x16_bf16 v[64:79], a[184:187], v[200:203], v[64:79]
    ds_read_b64_tr_b16 a[152:153], v242 offset:20480
    ds_read_b64_tr_b16 a[154:155], v242 offset:21504
    buffer_load_dwordx4 v[188:191], v245, s[48:51], s37 offen offset:3072 sc1
    v_fma_mix_f32 v253, v163, v215, v223 op_sel:[1,0,0] op_sel_hi:[1,0,0]
    v_mfma_f32_32x32x16_bf16 v[80:95], a[184:187], v[204:207], v[80:95]
    ds_read_b64_tr_b16 a[156:157], v243 offset:20480
    ds_read_b64_tr_b16 a[158:159], v243 offset:21504
    v_cvt_pk_bf16_f32 v195, v252, v253
    v_fma_mix_f32 v250, v164, v208, v216 op_sel_hi:[1,0,0]
    v_fma_mix_f32 v251, v164, v209, v217 op_sel:[1,0,0] op_sel_hi:[1,0,0]
    v_cvt_pk_bf16_f32 v196, v250, v251
    v_mfma_f32_32x32x16_bf16 v[96:111], a[188:191], v[200:203], v[96:111]
    buffer_load_dwordx4 v[152:155], v245, s[44:47], s38 offen offset:3072 sc1
    v_fma_mix_f32 v252, v165, v210, v218 op_sel_hi:[1,0,0]
    v_fma_mix_f32 v253, v165, v211, v219 op_sel:[1,0,0] op_sel_hi:[1,0,0]
    v_cvt_pk_bf16_f32 v197, v252, v253
    v_mfma_f32_32x32x16_bf16 v[112:127], a[188:191], v[204:207], v[112:127]
    buffer_load_dwordx4 v[156:159], v245, s[48:51], s38 offen offset:3072 sc1
    v_fma_mix_f32 v250, v166, v212, v220 op_sel_hi:[1,0,0]
    v_fma_mix_f32 v251, v166, v213, v221 op_sel:[1,0,0] op_sel_hi:[1,0,0]
    v_cvt_pk_bf16_f32 v198, v250, v251
    v_fma_mix_f32 v252, v167, v214, v222 op_sel_hi:[1,0,0]
    v_fma_mix_f32 v253, v167, v215, v223 op_sel:[1,0,0] op_sel_hi:[1,0,0]
    v_cvt_pk_bf16_f32 v199, v252, v253
    s_waitcnt lgkmcnt(12)
    v_mfma_f32_32x32x16_bf16 v[0:15], a[128:131], v[192:195], v[0:15]
    s_barrier
    ds_read_b128 v[208:211], v244 offset:256
    ds_read_b128 v[212:215], v244 offset:272
    s_waitcnt vmcnt(12) lgkmcnt(10)
    v_fma_mix_f32 v250, v168, v224, v232 op_sel_hi:[1,0,0]
    v_fma_mix_f32 v251, v168, v225, v233 op_sel:[1,0,0] op_sel_hi:[1,0,0]
    v_cvt_pk_bf16_f32 v200, v250, v251
    v_mfma_f32_32x32x16_bf16 v[16:31], a[128:131], v[196:199], v[16:31]
    ds_read_b128 v[216:219], v244 offset:288
    ds_read_b128 v[220:223], v244 offset:304
    s_add_u32 m0, s72, 98304
    s_lshl_b32 s68, s42, 7
    buffer_load_dwordx4 v246, s[60:63], s68 offen lds
    v_mfma_f32_32x32x16_bf16 v[32:47], a[132:135], v[192:195], v[32:47]
    ds_read_b64_tr_b16 a[160:161], v240 offset:24576
    ds_read_b64_tr_b16 a[162:163], v240 offset:25600
    v_fma_mix_f32 v252, v169, v226, v234 op_sel_hi:[1,0,0]
    v_fma_mix_f32 v253, v169, v227, v235 op_sel:[1,0,0] op_sel_hi:[1,0,0]
    v_cvt_pk_bf16_f32 v201, v252, v253
    v_fma_mix_f32 v250, v170, v228, v236 op_sel_hi:[1,0,0]
    v_mfma_f32_32x32x16_bf16 v[48:63], a[132:135], v[196:199], v[48:63]
    ds_read_b64_tr_b16 a[164:165], v241 offset:24576
    ds_read_b64_tr_b16 a[166:167], v241 offset:25600
    v_fma_mix_f32 v251, v170, v229, v237 op_sel:[1,0,0] op_sel_hi:[1,0,0]
    v_cvt_pk_bf16_f32 v202, v250, v251
    v_fma_mix_f32 v252, v171, v230, v238 op_sel_hi:[1,0,0]
    v_fma_mix_f32 v253, v171, v231, v239 op_sel:[1,0,0] op_sel_hi:[1,0,0]
    v_mfma_f32_32x32x16_bf16 v[64:79], a[136:139], v[192:195], v[64:79]
    ds_read_b64_tr_b16 a[168:169], v242 offset:24576
    ds_read_b64_tr_b16 a[170:171], v242 offset:25600
    v_cvt_pk_bf16_f32 v203, v252, v253
    v_fma_mix_f32 v250, v172, v224, v232 op_sel_hi:[1,0,0]
    v_fma_mix_f32 v251, v172, v225, v233 op_sel:[1,0,0] op_sel_hi:[1,0,0]
    v_cvt_pk_bf16_f32 v204, v250, v251
    v_mfma_f32_32x32x16_bf16 v[80:95], a[136:139], v[196:199], v[80:95]
    ds_read_b64_tr_b16 a[172:173], v243 offset:24576
    ds_read_b64_tr_b16 a[174:175], v243 offset:25600
    v_fma_mix_f32 v252, v173, v226, v234 op_sel_hi:[1,0,0]
    v_fma_mix_f32 v253, v173, v227, v235 op_sel:[1,0,0] op_sel_hi:[1,0,0]
    v_cvt_pk_bf16_f32 v205, v252, v253
    v_fma_mix_f32 v250, v174, v228, v236 op_sel_hi:[1,0,0]
    v_mfma_f32_32x32x16_bf16 v[96:111], a[140:143], v[192:195], v[96:111]
    buffer_load_dwordx4 v[160:163], v245, s[44:47], s39 offen sc1
    v_fma_mix_f32 v251, v174, v229, v237 op_sel:[1,0,0] op_sel_hi:[1,0,0]
    v_cvt_pk_bf16_f32 v206, v250, v251
    v_fma_mix_f32 v252, v175, v230, v238 op_sel_hi:[1,0,0]
    v_mfma_f32_32x32x16_bf16 v[112:127], a[140:143], v[196:199], v[112:127]
    buffer_load_dwordx4 v[164:167], v245, s[48:51], s39 offen sc1
    v_fma_mix_f32 v253, v175, v231, v239 op_sel:[1,0,0] op_sel_hi:[1,0,0]
    v_cvt_pk_bf16_f32 v207, v252, v253
    s_waitcnt lgkmcnt(12)
    v_mfma_f32_32x32x16_bf16 v[0:15], a[144:147], v[200:203], v[0:15]
    ds_read_b128 v[224:227], v244 offset:384
    ds_read_b128 v[228:231], v244 offset:400
    s_waitcnt vmcnt(10) lgkmcnt(10)
    v_fma_mix_f32 v250, v176, v208, v216 op_sel_hi:[1,0,0]
    v_fma_mix_f32 v251, v176, v209, v217 op_sel:[1,0,0] op_sel_hi:[1,0,0]
    v_cvt_pk_bf16_f32 v192, v250, v251
    v_fma_mix_f32 v252, v177, v210, v218 op_sel_hi:[1,0,0]
    v_mfma_f32_32x32x16_bf16 v[16:31], a[144:147], v[204:207], v[16:31]
    ds_read_b128 v[232:235], v244 offset:416
    ds_read_b128 v[236:239], v244 offset:432
    buffer_load_dwordx4 v247, s[60:63], s68 offen offset:1024 lds
    v_fma_mix_f32 v253, v177, v211, v219 op_sel:[1,0,0] op_sel_hi:[1,0,0]
    v_mfma_f32_32x32x16_bf16 v[32:47], a[148:151], v[200:203], v[32:47]
    ds_read_b64_tr_b16 a[176:177], v240 offset:28672
    ds_read_b64_tr_b16 a[178:179], v240 offset:29696
    s_sub_u32 s71, s38, s37
    v_cvt_pk_bf16_f32 v193, v252, v253
    v_fma_mix_f32 v250, v178, v212, v220 op_sel_hi:[1,0,0]
    v_fma_mix_f32 v251, v178, v213, v221 op_sel:[1,0,0] op_sel_hi:[1,0,0]
    v_mfma_f32_32x32x16_bf16 v[48:63], a[148:151], v[204:207], v[48:63]
    ds_read_b64_tr_b16 a[180:181], v241 offset:28672
    ds_read_b64_tr_b16 a[182:183], v241 offset:29696
    s_ashr_i32 s71, s71, 3
    v_cvt_pk_bf16_f32 v194, v250, v251
    v_fma_mix_f32 v252, v179, v214, v222 op_sel_hi:[1,0,0]
    v_fma_mix_f32 v253, v179, v215, v223 op_sel:[1,0,0] op_sel_hi:[1,0,0]
    v_mfma_f32_32x32x16_bf16 v[64:79], a[152:155], v[200:203], v[64:79]
    ds_read_b64_tr_b16 a[184:185], v242 offset:28672
    ds_read_b64_tr_b16 a[186:187], v242 offset:29696
    v_cvt_pk_bf16_f32 v195, v252, v253
    v_fma_mix_f32 v250, v180, v208, v216 op_sel_hi:[1,0,0]
    v_fma_mix_f32 v251, v180, v209, v217 op_sel:[1,0,0] op_sel_hi:[1,0,0]
    v_cvt_pk_bf16_f32 v196, v250, v251
    v_mfma_f32_32x32x16_bf16 v[80:95], a[152:155], v[204:207], v[80:95]
    ds_read_b64_tr_b16 a[188:189], v243 offset:28672
    ds_read_b64_tr_b16 a[190:191], v243 offset:29696
    v_fma_mix_f32 v252, v181, v210, v218 op_sel_hi:[1,0,0]
    v_fma_mix_f32 v253, v181, v211, v219 op_sel:[1,0,0] op_sel_hi:[1,0,0]
    v_cvt_pk_bf16_f32 v197, v252, v253
    v_fma_mix_f32 v250, v182, v212, v220 op_sel_hi:[1,0,0]
    v_mfma_f32_32x32x16_bf16 v[96:111], a[156:159], v[200:203], v[96:111]
    buffer_load_dwordx4 v[168:171], v245, s[44:47], s39 offen offset:1024 sc1
    v_fma_mix_f32 v251, v182, v213, v221 op_sel:[1,0,0] op_sel_hi:[1,0,0]
    v_cvt_pk_bf16_f32 v198, v250, v251
    v_fma_mix_f32 v252, v183, v214, v222 op_sel_hi:[1,0,0]
    v_mfma_f32_32x32x16_bf16 v[112:127], a[156:159], v[204:207], v[112:127]
    buffer_load_dwordx4 v[172:175], v245, s[48:51], s39 offen offset:1024 sc1
    v_fma_mix_f32 v253, v183, v215, v223 op_sel:[1,0,0] op_sel_hi:[1,0,0]
    v_cvt_pk_bf16_f32 v199, v252, v253
    v_add_u32 v244, s71, v244
    s_waitcnt lgkmcnt(12)
    v_mfma_f32_32x32x16_bf16 v[0:15], a[160:163], v[192:195], v[0:15]
    ds_read_b128 v[208:211], v244 offset:0
    ds_read_b128 v[212:215], v244 offset:16
    s_waitcnt vmcnt(8) lgkmcnt(10)
    v_fma_mix_f32 v250, v184, v224, v232 op_sel_hi:[1,0,0]
    v_fma_mix_f32 v251, v184, v225, v233 op_sel:[1,0,0] op_sel_hi:[1,0,0]
    v_cvt_pk_bf16_f32 v200, v250, v251
    v_fma_mix_f32 v252, v185, v226, v234 op_sel_hi:[1,0,0]
    v_mfma_f32_32x32x16_bf16 v[16:31], a[160:163], v[196:199], v[16:31]
    ds_read_b128 v[216:219], v244 offset:32
    ds_read_b128 v[220:223], v244 offset:48
    buffer_load_dwordx4 v248, s[60:63], s68 offen offset:2048 lds
    v_fma_mix_f32 v253, v185, v227, v235 op_sel:[1,0,0] op_sel_hi:[1,0,0]
    v_mfma_f32_32x32x16_bf16 v[32:47], a[164:167], v[192:195], v[32:47]
    ds_read_b64_tr_b16 a[128:129], v240 offset:32768
    ds_read_b64_tr_b16 a[130:131], v240 offset:33792
    v_cvt_pk_bf16_f32 v201, v252, v253
    v_fma_mix_f32 v250, v186, v228, v236 op_sel_hi:[1,0,0]
    v_fma_mix_f32 v251, v186, v229, v237 op_sel:[1,0,0] op_sel_hi:[1,0,0]
    v_cvt_pk_bf16_f32 v202, v250, v251
    v_mfma_f32_32x32x16_bf16 v[48:63], a[164:167], v[196:199], v[48:63]
    ds_read_b64_tr_b16 a[132:133], v241 offset:32768
    ds_read_b64_tr_b16 a[134:135], v241 offset:33792
    v_fma_mix_f32 v252, v187, v230, v238 op_sel_hi:[1,0,0]
    v_fma_mix_f32 v253, v187, v231, v239 op_sel:[1,0,0] op_sel_hi:[1,0,0]
    v_cvt_pk_bf16_f32 v203, v252, v253
    v_fma_mix_f32 v250, v188, v224, v232 op_sel_hi:[1,0,0]
    v_mfma_f32_32x32x16_bf16 v[64:79], a[168:171], v[192:195], v[64:79]
    ds_read_b64_tr_b16 a[136:137], v242 offset:32768
    ds_read_b64_tr_b16 a[138:139], v242 offset:33792
    v_fma_mix_f32 v251, v188, v225, v233 op_sel:[1,0,0] op_sel_hi:[1,0,0]
    v_cvt_pk_bf16_f32 v204, v250, v251
    v_fma_mix_f32 v252, v189, v226, v234 op_sel_hi:[1,0,0]
    v_fma_mix_f32 v253, v189, v227, v235 op_sel:[1,0,0] op_sel_hi:[1,0,0]
    v_mfma_f32_32x32x16_bf16 v[80:95], a[168:171], v[196:199], v[80:95]
    ds_read_b64_tr_b16 a[140:141], v243 offset:32768
    ds_read_b64_tr_b16 a[142:143], v243 offset:33792
    v_cvt_pk_bf16_f32 v205, v252, v253
    v_fma_mix_f32 v250, v190, v228, v236 op_sel_hi:[1,0,0]
    v_fma_mix_f32 v251, v190, v229, v237 op_sel:[1,0,0] op_sel_hi:[1,0,0]
    v_cvt_pk_bf16_f32 v206, v250, v251
    v_mfma_f32_32x32x16_bf16 v[96:111], a[172:175], v[192:195], v[96:111]
    buffer_load_dwordx4 v[176:179], v245, s[44:47], s39 offen offset:2048 sc1
    v_fma_mix_f32 v252, v191, v230, v238 op_sel_hi:[1,0,0]
    v_fma_mix_f32 v253, v191, v231, v239 op_sel:[1,0,0] op_sel_hi:[1,0,0]
    v_cvt_pk_bf16_f32 v207, v252, v253
    v_mfma_f32_32x32x16_bf16 v[112:127], a[172:175], v[196:199], v[112:127]
    buffer_load_dwordx4 v[180:183], v245, s[48:51], s39 offen offset:2048 sc1
    s_waitcnt lgkmcnt(12)
    v_mfma_f32_32x32x16_bf16 v[0:15], a[176:179], v[200:203], v[0:15]
    ds_read_b128 v[224:227], v244 offset:128
    ds_read_b128 v[228:231], v244 offset:144
    s_waitcnt lgkmcnt(10)
    v_fma_mix_f32 v250, v128, v208, v216 op_sel_hi:[1,0,0]
    v_fma_mix_f32 v251, v128, v209, v217 op_sel:[1,0,0] op_sel_hi:[1,0,0]
    v_cvt_pk_bf16_f32 v192, v250, v251
    v_fma_mix_f32 v252, v129, v210, v218 op_sel_hi:[1,0,0]
    v_mfma_f32_32x32x16_bf16 v[16:31], a[176:179], v[204:207], v[16:31]
    ds_read_b128 v[232:235], v244 offset:160
    ds_read_b128 v[236:239], v244 offset:176
    buffer_load_dwordx4 v249, s[60:63], s68 offen offset:3072 lds
    v_fma_mix_f32 v253, v129, v211, v219 op_sel:[1,0,0] op_sel_hi:[1,0,0]
    v_mfma_f32_32x32x16_bf16 v[32:47], a[180:183], v[200:203], v[32:47]
    ds_read_b64_tr_b16 a[144:145], v240 offset:36864
    ds_read_b64_tr_b16 a[146:147], v240 offset:37888
    v_cvt_pk_bf16_f32 v193, v252, v253
    v_fma_mix_f32 v250, v130, v212, v220 op_sel_hi:[1,0,0]
    v_fma_mix_f32 v251, v130, v213, v221 op_sel:[1,0,0] op_sel_hi:[1,0,0]
    v_cvt_pk_bf16_f32 v194, v250, v251
    v_mfma_f32_32x32x16_bf16 v[48:63], a[180:183], v[204:207], v[48:63]
    ds_read_b64_tr_b16 a[148:149], v241 offset:36864
    ds_read_b64_tr_b16 a[150:151], v241 offset:37888
    v_fma_mix_f32 v252, v131, v214, v222 op_sel_hi:[1,0,0]
    v_fma_mix_f32 v253, v131, v215, v223 op_sel:[1,0,0] op_sel_hi:[1,0,0]
    v_cvt_pk_bf16_f32 v195, v252, v253
    v_fma_mix_f32 v250, v132, v208, v216 op_sel_hi:[1,0,0]
    v_mfma_f32_32x32x16_bf16 v[64:79], a[184:187], v[200:203], v[64:79]
    ds_read_b64_tr_b16 a[152:153], v242 offset:36864
    ds_read_b64_tr_b16 a[154:155], v242 offset:37888
    v_fma_mix_f32 v251, v132, v209, v217 op_sel:[1,0,0] op_sel_hi:[1,0,0]
    v_cvt_pk_bf16_f32 v196, v250, v251
    v_fma_mix_f32 v252, v133, v210, v218 op_sel_hi:[1,0,0]
    v_fma_mix_f32 v253, v133, v211, v219 op_sel:[1,0,0] op_sel_hi:[1,0,0]
    v_mfma_f32_32x32x16_bf16 v[80:95], a[184:187], v[204:207], v[80:95]
    ds_read_b64_tr_b16 a[156:157], v243 offset:36864
    ds_read_b64_tr_b16 a[158:159], v243 offset:37888
    v_cvt_pk_bf16_f32 v197, v252, v253
    v_fma_mix_f32 v250, v134, v212, v220 op_sel_hi:[1,0,0]
    v_fma_mix_f32 v251, v134, v213, v221 op_sel:[1,0,0] op_sel_hi:[1,0,0]
    v_cvt_pk_bf16_f32 v198, v250, v251
    v_mfma_f32_32x32x16_bf16 v[96:111], a[188:191], v[200:203], v[96:111]
    buffer_load_dwordx4 v[184:187], v245, s[44:47], s39 offen offset:3072 sc1
    v_fma_mix_f32 v252, v135, v214, v222 op_sel_hi:[1,0,0]
    v_fma_mix_f32 v253, v135, v215, v223 op_sel:[1,0,0] op_sel_hi:[1,0,0]
    v_cvt_pk_bf16_f32 v199, v252, v253
    v_mfma_f32_32x32x16_bf16 v[112:127], a[188:191], v[204:207], v[112:127]
    buffer_load_dwordx4 v[188:191], v245, s[48:51], s39 offen offset:3072 sc1
    s_waitcnt lgkmcnt(12)
    v_mfma_f32_32x32x16_bf16 v[0:15], a[128:131], v[192:195], v[0:15]
    s_barrier
    ds_read_b128 v[208:211], v244 offset:256
    ds_read_b128 v[212:215], v244 offset:272
    s_waitcnt lgkmcnt(10)
    v_fma_mix_f32 v250, v136, v224, v232 op_sel_hi:[1,0,0]
    v_fma_mix_f32 v251, v136, v225, v233 op_sel:[1,0,0] op_sel_hi:[1,0,0]
    v_cvt_pk_bf16_f32 v200, v250, v251
    v_mfma_f32_32x32x16_bf16 v[16:31], a[128:131], v[196:199], v[16:31]
    ds_read_b128 v[216:219], v244 offset:288
    ds_read_b128 v[220:223], v244 offset:304
    s_add_u32 m0, s72, 114688
    s_lshl_b32 s68, s43, 7
    buffer_load_dwordx4 v246, s[60:63], s68 offen lds
    v_mfma_f32_32x32x16_bf16 v[32:47], a[132:135], v[192:195], v[32:47]
    ds_read_b64_tr_b16 a[160:161], v240 offset:40960
    ds_read_b64_tr_b16 a[162:163], v240 offset:41984
    v_fma_mix_f32 v252, v137, v226, v234 op_sel_hi:[1,0,0]
    v_fma_mix_f32 v253, v137, v227, v235 op_sel:[1,0,0] op_sel_hi:[1,0,0]
    v_cvt_pk_bf16_f32 v201, v252, v253
    v_fma_mix_f32 v250, v138, v228, v236 op_sel_hi:[1,0,0]
    v_mfma_f32_32x32x16_bf16 v[48:63], a[132:135], v[196:199], v[48:63]
    ds_read_b64_tr_b16 a[164:165], v241 offset:40960
    ds_read_b64_tr_b16 a[166:167], v241 offset:41984
    v_fma_mix_f32 v251, v138, v229, v237 op_sel:[1,0,0] op_sel_hi:[1,0,0]
    v_cvt_pk_bf16_f32 v202, v250, v251
    v_fma_mix_f32 v252, v139, v230, v238 op_sel_hi:[1,0,0]
    v_fma_mix_f32 v253, v139, v231, v239 op_sel:[1,0,0] op_sel_hi:[1,0,0]
    v_mfma_f32_32x32x16_bf16 v[64:79], a[136:139], v[192:195], v[64:79]
    ds_read_b64_tr_b16 a[168:169], v242 offset:40960
    ds_read_b64_tr_b16 a[170:171], v242 offset:41984
    v_cvt_pk_bf16_f32 v203, v252, v253
    v_fma_mix_f32 v250, v140, v224, v232 op_sel_hi:[1,0,0]
    v_fma_mix_f32 v251, v140, v225, v233 op_sel:[1,0,0] op_sel_hi:[1,0,0]
    v_cvt_pk_bf16_f32 v204, v250, v251
    v_mfma_f32_32x32x16_bf16 v[80:95], a[136:139], v[196:199], v[80:95]
    ds_read_b64_tr_b16 a[172:173], v243 offset:40960
    ds_read_b64_tr_b16 a[174:175], v243 offset:41984
    v_fma_mix_f32 v252, v141, v226, v234 op_sel_hi:[1,0,0]
    v_fma_mix_f32 v253, v141, v227, v235 op_sel:[1,0,0] op_sel_hi:[1,0,0]
    v_cvt_pk_bf16_f32 v205, v252, v253
    v_fma_mix_f32 v250, v142, v228, v236 op_sel_hi:[1,0,0]
    v_mfma_f32_32x32x16_bf16 v[96:111], a[140:143], v[192:195], v[96:111]
    buffer_load_dwordx4 v[128:131], v245, s[44:47], s40 offen sc1
    v_fma_mix_f32 v251, v142, v229, v237 op_sel:[1,0,0] op_sel_hi:[1,0,0]
    v_cvt_pk_bf16_f32 v206, v250, v251
    v_fma_mix_f32 v252, v143, v230, v238 op_sel_hi:[1,0,0]
    v_mfma_f32_32x32x16_bf16 v[112:127], a[140:143], v[196:199], v[112:127]
    buffer_load_dwordx4 v[132:135], v245, s[48:51], s40 offen sc1
    v_fma_mix_f32 v253, v143, v231, v239 op_sel:[1,0,0] op_sel_hi:[1,0,0]
    v_cvt_pk_bf16_f32 v207, v252, v253
    s_waitcnt lgkmcnt(12)
    v_mfma_f32_32x32x16_bf16 v[0:15], a[144:147], v[200:203], v[0:15]
    ds_read_b128 v[224:227], v244 offset:384
    ds_read_b128 v[228:231], v244 offset:400
    s_waitcnt lgkmcnt(10)
    v_fma_mix_f32 v250, v144, v208, v216 op_sel_hi:[1,0,0]
    v_fma_mix_f32 v251, v144, v209, v217 op_sel:[1,0,0] op_sel_hi:[1,0,0]
    v_cvt_pk_bf16_f32 v192, v250, v251
    v_fma_mix_f32 v252, v145, v210, v218 op_sel_hi:[1,0,0]
    v_mfma_f32_32x32x16_bf16 v[16:31], a[144:147], v[204:207], v[16:31]
    ds_read_b128 v[232:235], v244 offset:416
    ds_read_b128 v[236:239], v244 offset:432
    buffer_load_dwordx4 v247, s[60:63], s68 offen offset:1024 lds
    v_fma_mix_f32 v253, v145, v211, v219 op_sel:[1,0,0] op_sel_hi:[1,0,0]
    v_mfma_f32_32x32x16_bf16 v[32:47], a[148:151], v[200:203], v[32:47]
    ds_read_b64_tr_b16 a[176:177], v240 offset:45056
    ds_read_b64_tr_b16 a[178:179], v240 offset:46080
    s_sub_u32 s71, s39, s38
    v_cvt_pk_bf16_f32 v193, v252, v253
    v_fma_mix_f32 v250, v146, v212, v220 op_sel_hi:[1,0,0]
    v_fma_mix_f32 v251, v146, v213, v221 op_sel:[1,0,0] op_sel_hi:[1,0,0]
    v_mfma_f32_32x32x16_bf16 v[48:63], a[148:151], v[204:207], v[48:63]
    ds_read_b64_tr_b16 a[180:181], v241 offset:45056
    ds_read_b64_tr_b16 a[182:183], v241 offset:46080
    s_ashr_i32 s71, s71, 3
    v_cvt_pk_bf16_f32 v194, v250, v251
    v_fma_mix_f32 v252, v147, v214, v222 op_sel_hi:[1,0,0]
    v_fma_mix_f32 v253, v147, v215, v223 op_sel:[1,0,0] op_sel_hi:[1,0,0]
    v_mfma_f32_32x32x16_bf16 v[64:79], a[152:155], v[200:203], v[64:79]
    ds_read_b64_tr_b16 a[184:185], v242 offset:45056
    ds_read_b64_tr_b16 a[186:187], v242 offset:46080
    v_cvt_pk_bf16_f32 v195, v252, v253
    v_fma_mix_f32 v250, v148, v208, v216 op_sel_hi:[1,0,0]
    v_fma_mix_f32 v251, v148, v209, v217 op_sel:[1,0,0] op_sel_hi:[1,0,0]
    v_cvt_pk_bf16_f32 v196, v250, v251
    v_mfma_f32_32x32x16_bf16 v[80:95], a[152:155], v[204:207], v[80:95]
    ds_read_b64_tr_b16 a[188:189], v243 offset:45056
    ds_read_b64_tr_b16 a[190:191], v243 offset:46080
    v_fma_mix_f32 v252, v149, v210, v218 op_sel_hi:[1,0,0]
    v_fma_mix_f32 v253, v149, v211, v219 op_sel:[1,0,0] op_sel_hi:[1,0,0]
    v_cvt_pk_bf16_f32 v197, v252, v253
    v_fma_mix_f32 v250, v150, v212, v220 op_sel_hi:[1,0,0]
    v_mfma_f32_32x32x16_bf16 v[96:111], a[156:159], v[200:203], v[96:111]
    buffer_load_dwordx4 v[136:139], v245, s[44:47], s40 offen offset:1024 sc1
    v_fma_mix_f32 v251, v150, v213, v221 op_sel:[1,0,0] op_sel_hi:[1,0,0]
    v_cvt_pk_bf16_f32 v198, v250, v251
    v_fma_mix_f32 v252, v151, v214, v222 op_sel_hi:[1,0,0]
    v_mfma_f32_32x32x16_bf16 v[112:127], a[156:159], v[204:207], v[112:127]
    buffer_load_dwordx4 v[140:143], v245, s[48:51], s40 offen offset:1024 sc1
    v_fma_mix_f32 v253, v151, v215, v223 op_sel:[1,0,0] op_sel_hi:[1,0,0]
    v_cvt_pk_bf16_f32 v199, v252, v253
    v_add_u32 v244, s71, v244
    s_waitcnt lgkmcnt(12)
    v_mfma_f32_32x32x16_bf16 v[0:15], a[160:163], v[192:195], v[0:15]
    ds_read_b128 v[208:211], v244 offset:0
    ds_read_b128 v[212:215], v244 offset:16
    s_waitcnt vmcnt(18) lgkmcnt(10)
    v_fma_mix_f32 v250, v152, v224, v232 op_sel_hi:[1,0,0]
    v_fma_mix_f32 v251, v152, v225, v233 op_sel:[1,0,0] op_sel_hi:[1,0,0]
    v_cvt_pk_bf16_f32 v200, v250, v251
    v_fma_mix_f32 v252, v153, v226, v234 op_sel_hi:[1,0,0]
    v_mfma_f32_32x32x16_bf16 v[16:31], a[160:163], v[196:199], v[16:31]
    ds_read_b128 v[216:219], v244 offset:32
    ds_read_b128 v[220:223], v244 offset:48
    buffer_load_dwordx4 v248, s[60:63], s68 offen offset:2048 lds
    v_fma_mix_f32 v253, v153, v227, v235 op_sel:[1,0,0] op_sel_hi:[1,0,0]
    v_mfma_f32_32x32x16_bf16 v[32:47], a[164:167], v[192:195], v[32:47]
    ds_read_b64_tr_b16 a[128:129], v240 offset:49152
    ds_read_b64_tr_b16 a[130:131], v240 offset:50176
    v_cvt_pk_bf16_f32 v201, v252, v253
    v_fma_mix_f32 v250, v154, v228, v236 op_sel_hi:[1,0,0]
    v_fma_mix_f32 v251, v154, v229, v237 op_sel:[1,0,0] op_sel_hi:[1,0,0]
    v_cvt_pk_bf16_f32 v202, v250, v251
    v_mfma_f32_32x32x16_bf16 v[48:63], a[164:167], v[196:199], v[48:63]
    ds_read_b64_tr_b16 a[132:133], v241 offset:49152
    ds_read_b64_tr_b16 a[134:135], v241 offset:50176
    v_fma_mix_f32 v252, v155, v230, v238 op_sel_hi:[1,0,0]
    v_fma_mix_f32 v253, v155, v231, v239 op_sel:[1,0,0] op_sel_hi:[1,0,0]
    v_cvt_pk_bf16_f32 v203, v252, v253
    v_fma_mix_f32 v250, v156, v224, v232 op_sel_hi:[1,0,0]
    v_mfma_f32_32x32x16_bf16 v[64:79], a[168:171], v[192:195], v[64:79]
    ds_read_b64_tr_b16 a[136:137], v242 offset:49152
    ds_read_b64_tr_b16 a[138:139], v242 offset:50176
    v_fma_mix_f32 v251, v156, v225, v233 op_sel:[1,0,0] op_sel_hi:[1,0,0]
    v_cvt_pk_bf16_f32 v204, v250, v251
    v_fma_mix_f32 v252, v157, v226, v234 op_sel_hi:[1,0,0]
    v_fma_mix_f32 v253, v157, v227, v235 op_sel:[1,0,0] op_sel_hi:[1,0,0]
    v_mfma_f32_32x32x16_bf16 v[80:95], a[168:171], v[196:199], v[80:95]
    ds_read_b64_tr_b16 a[140:141], v243 offset:49152
    ds_read_b64_tr_b16 a[142:143], v243 offset:50176
    v_cvt_pk_bf16_f32 v205, v252, v253
    v_fma_mix_f32 v250, v158, v228, v236 op_sel_hi:[1,0,0]
    v_fma_mix_f32 v251, v158, v229, v237 op_sel:[1,0,0] op_sel_hi:[1,0,0]
    v_cvt_pk_bf16_f32 v206, v250, v251
    v_mfma_f32_32x32x16_bf16 v[96:111], a[172:175], v[192:195], v[96:111]
    buffer_load_dwordx4 v[144:147], v245, s[44:47], s40 offen offset:2048 sc1
    v_fma_mix_f32 v252, v159, v230, v238 op_sel_hi:[1,0,0]
    v_fma_mix_f32 v253, v159, v231, v239 op_sel:[1,0,0] op_sel_hi:[1,0,0]
    v_cvt_pk_bf16_f32 v207, v252, v253
    v_mfma_f32_32x32x16_bf16 v[112:127], a[172:175], v[196:199], v[112:127]
    buffer_load_dwordx4 v[148:151], v245, s[48:51], s40 offen offset:2048 sc1
    s_waitcnt lgkmcnt(12)
    v_mfma_f32_32x32x16_bf16 v[0:15], a[176:179], v[200:203], v[0:15]
    ds_read_b128 v[224:227], v244 offset:128
    ds_read_b128 v[228:231], v244 offset:144
    s_waitcnt vmcnt(18) lgkmcnt(10)
    v_fma_mix_f32 v250, v160, v208, v216 op_sel_hi:[1,0,0]
    v_fma_mix_f32 v251, v160, v209, v217 op_sel:[1,0,0] op_sel_hi:[1,0,0]
    v_cvt_pk_bf16_f32 v192, v250, v251
    v_fma_mix_f32 v252, v161, v210, v218 op_sel_hi:[1,0,0]
    v_mfma_f32_32x32x16_bf16 v[16:31], a[176:179], v[204:207], v[16:31]
    ds_read_b128 v[232:235], v244 offset:160
    ds_read_b128 v[236:239], v244 offset:176
    buffer_load_dwordx4 v249, s[60:63], s68 offen offset:3072 lds
    v_fma_mix_f32 v253, v161, v211, v219 op_sel:[1,0,0] op_sel_hi:[1,0,0]
    v_mfma_f32_32x32x16_bf16 v[32:47], a[180:183], v[200:203], v[32:47]
    ds_read_b64_tr_b16 a[144:145], v240 offset:53248
    ds_read_b64_tr_b16 a[146:147], v240 offset:54272
    v_cvt_pk_bf16_f32 v193, v252, v253
    v_fma_mix_f32 v250, v162, v212, v220 op_sel_hi:[1,0,0]
    v_fma_mix_f32 v251, v162, v213, v221 op_sel:[1,0,0] op_sel_hi:[1,0,0]
    v_cvt_pk_bf16_f32 v194, v250, v251
    v_mfma_f32_32x32x16_bf16 v[48:63], a[180:183], v[204:207], v[48:63]
    ds_read_b64_tr_b16 a[148:149], v241 offset:53248
    ds_read_b64_tr_b16 a[150:151], v241 offset:54272
    v_fma_mix_f32 v252, v163, v214, v222 op_sel_hi:[1,0,0]
    v_fma_mix_f32 v253, v163, v215, v223 op_sel:[1,0,0] op_sel_hi:[1,0,0]
    v_cvt_pk_bf16_f32 v195, v252, v253
    v_fma_mix_f32 v250, v164, v208, v216 op_sel_hi:[1,0,0]
    v_mfma_f32_32x32x16_bf16 v[64:79], a[184:187], v[200:203], v[64:79]
    ds_read_b64_tr_b16 a[152:153], v242 offset:53248
    ds_read_b64_tr_b16 a[154:155], v242 offset:54272
    v_fma_mix_f32 v251, v164, v209, v217 op_sel:[1,0,0] op_sel_hi:[1,0,0]
    v_cvt_pk_bf16_f32 v196, v250, v251
    v_fma_mix_f32 v252, v165, v210, v218 op_sel_hi:[1,0,0]
    v_fma_mix_f32 v253, v165, v211, v219 op_sel:[1,0,0] op_sel_hi:[1,0,0]
    v_mfma_f32_32x32x16_bf16 v[80:95], a[184:187], v[204:207], v[80:95]
    ds_read_b64_tr_b16 a[156:157], v243 offset:53248
    ds_read_b64_tr_b16 a[158:159], v243 offset:54272
    v_cvt_pk_bf16_f32 v197, v252, v253
    v_fma_mix_f32 v250, v166, v212, v220 op_sel_hi:[1,0,0]
    v_fma_mix_f32 v251, v166, v213, v221 op_sel:[1,0,0] op_sel_hi:[1,0,0]
    v_cvt_pk_bf16_f32 v198, v250, v251
    v_mfma_f32_32x32x16_bf16 v[96:111], a[188:191], v[200:203], v[96:111]
    buffer_load_dwordx4 v[152:155], v245, s[44:47], s40 offen offset:3072 sc1
    v_fma_mix_f32 v252, v167, v214, v222 op_sel_hi:[1,0,0]
    v_fma_mix_f32 v253, v167, v215, v223 op_sel:[1,0,0] op_sel_hi:[1,0,0]
    v_cvt_pk_bf16_f32 v199, v252, v253
    v_mfma_f32_32x32x16_bf16 v[112:127], a[188:191], v[204:207], v[112:127]
    buffer_load_dwordx4 v[156:159], v245, s[48:51], s40 offen offset:3072 sc1
    s_waitcnt lgkmcnt(12)
    v_mfma_f32_32x32x16_bf16 v[0:15], a[128:131], v[192:195], v[0:15]
    s_barrier
    ds_read_b128 v[208:211], v244 offset:256
    ds_read_b128 v[212:215], v244 offset:272
    s_waitcnt vmcnt(18) lgkmcnt(10)
    v_fma_mix_f32 v250, v168, v224, v232 op_sel_hi:[1,0,0]
    v_fma_mix_f32 v251, v168, v225, v233 op_sel:[1,0,0] op_sel_hi:[1,0,0]
    v_cvt_pk_bf16_f32 v200, v250, v251
    v_mfma_f32_32x32x16_bf16 v[16:31], a[128:131], v[196:199], v[16:31]
    ds_read_b128 v[216:219], v244 offset:288
    ds_read_b128 v[220:223], v244 offset:304
    s_add_u32 m0, s72, 0
    s_lshl_b32 s68, s69, 7
    buffer_load_dwordx4 v246, s[60:63], s68 offen lds
    v_mfma_f32_32x32x16_bf16 v[32:47], a[132:135], v[192:195], v[32:47]
    ds_read_b64_tr_b16 a[160:161], v240 offset:57344
    ds_read_b64_tr_b16 a[162:163], v240 offset:58368
    v_fma_mix_f32 v252, v169, v226, v234 op_sel_hi:[1,0,0]
    v_fma_mix_f32 v253, v169, v227, v235 op_sel:[1,0,0] op_sel_hi:[1,0,0]
    v_cvt_pk_bf16_f32 v201, v252, v253
    v_fma_mix_f32 v250, v170, v228, v236 op_sel_hi:[1,0,0]
    v_mfma_f32_32x32x16_bf16 v[48:63], a[132:135], v[196:199], v[48:63]
    ds_read_b64_tr_b16 a[164:165], v241 offset:57344
    ds_read_b64_tr_b16 a[166:167], v241 offset:58368
    v_fma_mix_f32 v251, v170, v229, v237 op_sel:[1,0,0] op_sel_hi:[1,0,0]
    v_cvt_pk_bf16_f32 v202, v250, v251
    v_fma_mix_f32 v252, v171, v230, v238 op_sel_hi:[1,0,0]
    v_fma_mix_f32 v253, v171, v231, v239 op_sel:[1,0,0] op_sel_hi:[1,0,0]
    v_mfma_f32_32x32x16_bf16 v[64:79], a[136:139], v[192:195], v[64:79]
    ds_read_b64_tr_b16 a[168:169], v242 offset:57344
    ds_read_b64_tr_b16 a[170:171], v242 offset:58368
    v_cvt_pk_bf16_f32 v203, v252, v253
    v_fma_mix_f32 v250, v172, v224, v232 op_sel_hi:[1,0,0]
    v_fma_mix_f32 v251, v172, v225, v233 op_sel:[1,0,0] op_sel_hi:[1,0,0]
    v_cvt_pk_bf16_f32 v204, v250, v251
    v_mfma_f32_32x32x16_bf16 v[80:95], a[136:139], v[196:199], v[80:95]
    ds_read_b64_tr_b16 a[172:173], v243 offset:57344
    ds_read_b64_tr_b16 a[174:175], v243 offset:58368
    v_fma_mix_f32 v252, v173, v226, v234 op_sel_hi:[1,0,0]
    v_fma_mix_f32 v253, v173, v227, v235 op_sel:[1,0,0] op_sel_hi:[1,0,0]
    v_cvt_pk_bf16_f32 v205, v252, v253
    v_fma_mix_f32 v250, v174, v228, v236 op_sel_hi:[1,0,0]
    v_mfma_f32_32x32x16_bf16 v[96:111], a[140:143], v[192:195], v[96:111]
    buffer_load_dwordx4 v[160:163], v245, s[44:47], s41 offen sc1
    v_fma_mix_f32 v251, v174, v229, v237 op_sel:[1,0,0] op_sel_hi:[1,0,0]
    v_cvt_pk_bf16_f32 v206, v250, v251
    v_fma_mix_f32 v252, v175, v230, v238 op_sel_hi:[1,0,0]
    v_mfma_f32_32x32x16_bf16 v[112:127], a[140:143], v[196:199], v[112:127]
    buffer_load_dwordx4 v[164:167], v245, s[48:51], s41 offen sc1
    v_fma_mix_f32 v253, v175, v231, v239 op_sel:[1,0,0] op_sel_hi:[1,0,0]
    v_cvt_pk_bf16_f32 v207, v252, v253
    s_waitcnt lgkmcnt(12)
    v_mfma_f32_32x32x16_bf16 v[0:15], a[144:147], v[200:203], v[0:15]
    ds_read_b128 v[224:227], v244 offset:384
    ds_read_b128 v[228:231], v244 offset:400
    s_waitcnt vmcnt(18) lgkmcnt(10)
    v_fma_mix_f32 v250, v176, v208, v216 op_sel_hi:[1,0,0]
    v_fma_mix_f32 v251, v176, v209, v217 op_sel:[1,0,0] op_sel_hi:[1,0,0]
    v_cvt_pk_bf16_f32 v192, v250, v251
    v_fma_mix_f32 v252, v177, v210, v218 op_sel_hi:[1,0,0]
    v_mfma_f32_32x32x16_bf16 v[16:31], a[144:147], v[204:207], v[16:31]
    ds_read_b128 v[232:235], v244 offset:416
    ds_read_b128 v[236:239], v244 offset:432
    buffer_load_dwordx4 v247, s[60:63], s68 offen offset:1024 lds
    v_fma_mix_f32 v253, v177, v211, v219 op_sel:[1,0,0] op_sel_hi:[1,0,0]
    v_mfma_f32_32x32x16_bf16 v[32:47], a[148:151], v[200:203], v[32:47]
    ds_read_b64_tr_b16 a[176:177], v240 offset:61440
    ds_read_b64_tr_b16 a[178:179], v240 offset:62464
    s_sub_u32 s71, s40, s39
    v_cvt_pk_bf16_f32 v193, v252, v253
    v_fma_mix_f32 v250, v178, v212, v220 op_sel_hi:[1,0,0]
    v_fma_mix_f32 v251, v178, v213, v221 op_sel:[1,0,0] op_sel_hi:[1,0,0]
    v_mfma_f32_32x32x16_bf16 v[48:63], a[148:151], v[204:207], v[48:63]
    ds_read_b64_tr_b16 a[180:181], v241 offset:61440
    ds_read_b64_tr_b16 a[182:183], v241 offset:62464
    s_ashr_i32 s71, s71, 3
    v_cvt_pk_bf16_f32 v194, v250, v251
    v_fma_mix_f32 v252, v179, v214, v222 op_sel_hi:[1,0,0]
    v_fma_mix_f32 v253, v179, v215, v223 op_sel:[1,0,0] op_sel_hi:[1,0,0]
    v_mfma_f32_32x32x16_bf16 v[64:79], a[152:155], v[200:203], v[64:79]
    ds_read_b64_tr_b16 a[184:185], v242 offset:61440
    ds_read_b64_tr_b16 a[186:187], v242 offset:62464
    v_cvt_pk_bf16_f32 v195, v252, v253
    v_fma_mix_f32 v250, v180, v208, v216 op_sel_hi:[1,0,0]
    v_fma_mix_f32 v251, v180, v209, v217 op_sel:[1,0,0] op_sel_hi:[1,0,0]
    v_cvt_pk_bf16_f32 v196, v250, v251
    v_mfma_f32_32x32x16_bf16 v[80:95], a[152:155], v[204:207], v[80:95]
    ds_read_b64_tr_b16 a[188:189], v243 offset:61440
    ds_read_b64_tr_b16 a[190:191], v243 offset:62464
    v_fma_mix_f32 v252, v181, v210, v218 op_sel_hi:[1,0,0]
    v_fma_mix_f32 v253, v181, v211, v219 op_sel:[1,0,0] op_sel_hi:[1,0,0]
    v_cvt_pk_bf16_f32 v197, v252, v253
    v_fma_mix_f32 v250, v182, v212, v220 op_sel_hi:[1,0,0]
    v_mfma_f32_32x32x16_bf16 v[96:111], a[156:159], v[200:203], v[96:111]
    buffer_load_dwordx4 v[168:171], v245, s[44:47], s41 offen offset:1024 sc1
    v_fma_mix_f32 v251, v182, v213, v221 op_sel:[1,0,0] op_sel_hi:[1,0,0]
    v_cvt_pk_bf16_f32 v198, v250, v251
    v_fma_mix_f32 v252, v183, v214, v222 op_sel_hi:[1,0,0]
    v_mfma_f32_32x32x16_bf16 v[112:127], a[156:159], v[204:207], v[112:127]
    buffer_load_dwordx4 v[172:175], v245, s[48:51], s41 offen offset:1024 sc1
    v_fma_mix_f32 v253, v183, v215, v223 op_sel:[1,0,0] op_sel_hi:[1,0,0]
    v_cvt_pk_bf16_f32 v199, v252, v253
    v_add_u32 v244, s71, v244
    v_add_u32 v240, 0x10000, v240
    v_add_u32 v241, 0x10000, v241
    v_add_u32 v242, 0x10000, v242
    v_add_u32 v243, 0x10000, v243
    s_waitcnt lgkmcnt(12)
    v_mfma_f32_32x32x16_bf16 v[0:15], a[160:163], v[192:195], v[0:15]
    ds_read_b128 v[208:211], v244 offset:0
    ds_read_b128 v[212:215], v244 offset:16
    s_waitcnt vmcnt(18) lgkmcnt(10)
    v_fma_mix_f32 v250, v184, v224, v232 op_sel_hi:[1,0,0]
    v_fma_mix_f32 v251, v184, v225, v233 op_sel:[1,0,0] op_sel_hi:[1,0,0]
    v_cvt_pk_bf16_f32 v200, v250, v251
    v_fma_mix_f32 v252, v185, v226, v234 op_sel_hi:[1,0,0]
    v_mfma_f32_32x32x16_bf16 v[16:31], a[160:163], v[196:199], v[16:31]
    ds_read_b128 v[216:219], v244 offset:32
    ds_read_b128 v[220:223], v244 offset:48
    buffer_load_dwordx4 v248, s[60:63], s68 offen offset:2048 lds
    v_fma_mix_f32 v253, v185, v227, v235 op_sel:[1,0,0] op_sel_hi:[1,0,0]
    v_mfma_f32_32x32x16_bf16 v[32:47], a[164:167], v[192:195], v[32:47]
    ds_read_b64_tr_b16 a[128:129], v240 offset:0
    ds_read_b64_tr_b16 a[130:131], v240 offset:1024
    v_cvt_pk_bf16_f32 v201, v252, v253
    v_fma_mix_f32 v250, v186, v228, v236 op_sel_hi:[1,0,0]
    v_fma_mix_f32 v251, v186, v229, v237 op_sel:[1,0,0] op_sel_hi:[1,0,0]
    v_cvt_pk_bf16_f32 v202, v250, v251
    v_mfma_f32_32x32x16_bf16 v[48:63], a[164:167], v[196:199], v[48:63]
    ds_read_b64_tr_b16 a[132:133], v241 offset:0
    ds_read_b64_tr_b16 a[134:135], v241 offset:1024
    v_fma_mix_f32 v252, v187, v230, v238 op_sel_hi:[1,0,0]
    v_fma_mix_f32 v253, v187, v231, v239 op_sel:[1,0,0] op_sel_hi:[1,0,0]
    v_cvt_pk_bf16_f32 v203, v252, v253
    v_fma_mix_f32 v250, v188, v224, v232 op_sel_hi:[1,0,0]
    v_mfma_f32_32x32x16_bf16 v[64:79], a[168:171], v[192:195], v[64:79]
    ds_read_b64_tr_b16 a[136:137], v242 offset:0
    ds_read_b64_tr_b16 a[138:139], v242 offset:1024
    v_fma_mix_f32 v251, v188, v225, v233 op_sel:[1,0,0] op_sel_hi:[1,0,0]
    v_cvt_pk_bf16_f32 v204, v250, v251
    v_fma_mix_f32 v252, v189, v226, v234 op_sel_hi:[1,0,0]
    v_fma_mix_f32 v253, v189, v227, v235 op_sel:[1,0,0] op_sel_hi:[1,0,0]
    v_mfma_f32_32x32x16_bf16 v[80:95], a[168:171], v[196:199], v[80:95]
    ds_read_b64_tr_b16 a[140:141], v243 offset:0
    ds_read_b64_tr_b16 a[142:143], v243 offset:1024
    v_cvt_pk_bf16_f32 v205, v252, v253
    v_fma_mix_f32 v250, v190, v228, v236 op_sel_hi:[1,0,0]
    v_fma_mix_f32 v251, v190, v229, v237 op_sel:[1,0,0] op_sel_hi:[1,0,0]
    v_cvt_pk_bf16_f32 v206, v250, v251
    v_mfma_f32_32x32x16_bf16 v[96:111], a[172:175], v[192:195], v[96:111]
    buffer_load_dwordx4 v[176:179], v245, s[44:47], s41 offen offset:2048 sc1
    v_fma_mix_f32 v252, v191, v230, v238 op_sel_hi:[1,0,0]
    v_fma_mix_f32 v253, v191, v231, v239 op_sel:[1,0,0] op_sel_hi:[1,0,0]
    v_cvt_pk_bf16_f32 v207, v252, v253
    v_mfma_f32_32x32x16_bf16 v[112:127], a[172:175], v[196:199], v[112:127]
    buffer_load_dwordx4 v[180:183], v245, s[48:51], s41 offen offset:2048 sc1
    s_waitcnt lgkmcnt(12)
    v_mfma_f32_32x32x16_bf16 v[0:15], a[176:179], v[200:203], v[0:15]
    ds_read_b128 v[224:227], v244 offset:128
    ds_read_b128 v[228:231], v244 offset:144
    s_waitcnt vmcnt(18) lgkmcnt(10)
    v_fma_mix_f32 v250, v128, v208, v216 op_sel_hi:[1,0,0]
    v_fma_mix_f32 v251, v128, v209, v217 op_sel:[1,0,0] op_sel_hi:[1,0,0]
    v_cvt_pk_bf16_f32 v192, v250, v251
    v_fma_mix_f32 v252, v129, v210, v218 op_sel_hi:[1,0,0]
    v_mfma_f32_32x32x16_bf16 v[16:31], a[176:179], v[204:207], v[16:31]
    ds_read_b128 v[232:235], v244 offset:160
    ds_read_b128 v[236:239], v244 offset:176
    buffer_load_dwordx4 v249, s[60:63], s68 offen offset:3072 lds
    v_fma_mix_f32 v253, v129, v211, v219 op_sel:[1,0,0] op_sel_hi:[1,0,0]
    v_mfma_f32_32x32x16_bf16 v[32:47], a[180:183], v[200:203], v[32:47]
    ds_read_b64_tr_b16 a[144:145], v240 offset:4096
    ds_read_b64_tr_b16 a[146:147], v240 offset:5120
    v_cvt_pk_bf16_f32 v193, v252, v253
    v_fma_mix_f32 v250, v130, v212, v220 op_sel_hi:[1,0,0]
    v_fma_mix_f32 v251, v130, v213, v221 op_sel:[1,0,0] op_sel_hi:[1,0,0]
    v_cvt_pk_bf16_f32 v194, v250, v251
    v_mfma_f32_32x32x16_bf16 v[48:63], a[180:183], v[204:207], v[48:63]
    ds_read_b64_tr_b16 a[148:149], v241 offset:4096
    ds_read_b64_tr_b16 a[150:151], v241 offset:5120
    v_fma_mix_f32 v252, v131, v214, v222 op_sel_hi:[1,0,0]
    v_fma_mix_f32 v253, v131, v215, v223 op_sel:[1,0,0] op_sel_hi:[1,0,0]
    v_cvt_pk_bf16_f32 v195, v252, v253
    v_fma_mix_f32 v250, v132, v208, v216 op_sel_hi:[1,0,0]
    v_mfma_f32_32x32x16_bf16 v[64:79], a[184:187], v[200:203], v[64:79]
    ds_read_b64_tr_b16 a[152:153], v242 offset:4096
    ds_read_b64_tr_b16 a[154:155], v242 offset:5120
    v_fma_mix_f32 v251, v132, v209, v217 op_sel:[1,0,0] op_sel_hi:[1,0,0]
    v_cvt_pk_bf16_f32 v196, v250, v251
    v_fma_mix_f32 v252, v133, v210, v218 op_sel_hi:[1,0,0]
    v_fma_mix_f32 v253, v133, v211, v219 op_sel:[1,0,0] op_sel_hi:[1,0,0]
    v_mfma_f32_32x32x16_bf16 v[80:95], a[184:187], v[204:207], v[80:95]
    ds_read_b64_tr_b16 a[156:157], v243 offset:4096
    ds_read_b64_tr_b16 a[158:159], v243 offset:5120
    v_cvt_pk_bf16_f32 v197, v252, v253
    v_fma_mix_f32 v250, v134, v212, v220 op_sel_hi:[1,0,0]
    v_fma_mix_f32 v251, v134, v213, v221 op_sel:[1,0,0] op_sel_hi:[1,0,0]
    v_cvt_pk_bf16_f32 v198, v250, v251
    v_mfma_f32_32x32x16_bf16 v[96:111], a[188:191], v[200:203], v[96:111]
    buffer_load_dwordx4 v[184:187], v245, s[44:47], s41 offen offset:3072 sc1
    v_fma_mix_f32 v252, v135, v214, v222 op_sel_hi:[1,0,0]
    v_fma_mix_f32 v253, v135, v215, v223 op_sel:[1,0,0] op_sel_hi:[1,0,0]
    v_cvt_pk_bf16_f32 v199, v252, v253
    v_mfma_f32_32x32x16_bf16 v[112:127], a[188:191], v[204:207], v[112:127]
    buffer_load_dwordx4 v[188:191], v245, s[48:51], s41 offen offset:3072 sc1
    s_waitcnt lgkmcnt(12)
    v_mfma_f32_32x32x16_bf16 v[0:15], a[128:131], v[192:195], v[0:15]
    s_barrier
    ds_read_b128 v[208:211], v244 offset:256
    ds_read_b128 v[212:215], v244 offset:272
    s_waitcnt vmcnt(18) lgkmcnt(10)
    v_fma_mix_f32 v250, v136, v224, v232 op_sel_hi:[1,0,0]
    v_fma_mix_f32 v251, v136, v225, v233 op_sel:[1,0,0] op_sel_hi:[1,0,0]
    v_cvt_pk_bf16_f32 v200, v250, v251
    v_mfma_f32_32x32x16_bf16 v[16:31], a[128:131], v[196:199], v[16:31]
    ds_read_b128 v[216:219], v244 offset:288
    ds_read_b128 v[220:223], v244 offset:304
    s_add_u32 m0, s72, 16384
    s_lshl_b32 s68, s70, 7
    buffer_load_dwordx4 v246, s[60:63], s68 offen lds
    v_mfma_f32_32x32x16_bf16 v[32:47], a[132:135], v[192:195], v[32:47]
    ds_read_b64_tr_b16 a[160:161], v240 offset:8192
    ds_read_b64_tr_b16 a[162:163], v240 offset:9216
    v_fma_mix_f32 v252, v137, v226, v234 op_sel_hi:[1,0,0]
    v_fma_mix_f32 v253, v137, v227, v235 op_sel:[1,0,0] op_sel_hi:[1,0,0]
    v_cvt_pk_bf16_f32 v201, v252, v253
    v_fma_mix_f32 v250, v138, v228, v236 op_sel_hi:[1,0,0]
    v_mfma_f32_32x32x16_bf16 v[48:63], a[132:135], v[196:199], v[48:63]
    ds_read_b64_tr_b16 a[164:165], v241 offset:8192
    ds_read_b64_tr_b16 a[166:167], v241 offset:9216
    v_fma_mix_f32 v251, v138, v229, v237 op_sel:[1,0,0] op_sel_hi:[1,0,0]
    v_cvt_pk_bf16_f32 v202, v250, v251
    v_fma_mix_f32 v252, v139, v230, v238 op_sel_hi:[1,0,0]
    v_fma_mix_f32 v253, v139, v231, v239 op_sel:[1,0,0] op_sel_hi:[1,0,0]
    v_mfma_f32_32x32x16_bf16 v[64:79], a[136:139], v[192:195], v[64:79]
    ds_read_b64_tr_b16 a[168:169], v242 offset:8192
    ds_read_b64_tr_b16 a[170:171], v242 offset:9216
    v_cvt_pk_bf16_f32 v203, v252, v253
    v_fma_mix_f32 v250, v140, v224, v232 op_sel_hi:[1,0,0]
    v_fma_mix_f32 v251, v140, v225, v233 op_sel:[1,0,0] op_sel_hi:[1,0,0]
    v_cvt_pk_bf16_f32 v204, v250, v251
    v_mfma_f32_32x32x16_bf16 v[80:95], a[136:139], v[196:199], v[80:95]
    ds_read_b64_tr_b16 a[172:173], v243 offset:8192
    ds_read_b64_tr_b16 a[174:175], v243 offset:9216
    v_fma_mix_f32 v252, v141, v226, v234 op_sel_hi:[1,0,0]
    v_fma_mix_f32 v253, v141, v227, v235 op_sel:[1,0,0] op_sel_hi:[1,0,0]
    v_cvt_pk_bf16_f32 v205, v252, v253
    v_fma_mix_f32 v250, v142, v228, v236 op_sel_hi:[1,0,0]
    v_mfma_f32_32x32x16_bf16 v[96:111], a[140:143], v[192:195], v[96:111]
    buffer_load_dwordx4 v[128:131], v245, s[44:47], s42 offen sc1
    v_fma_mix_f32 v251, v142, v229, v237 op_sel:[1,0,0] op_sel_hi:[1,0,0]
    v_cvt_pk_bf16_f32 v206, v250, v251
    v_fma_mix_f32 v252, v143, v230, v238 op_sel_hi:[1,0,0]
    v_mfma_f32_32x32x16_bf16 v[112:127], a[140:143], v[196:199], v[112:127]
    buffer_load_dwordx4 v[132:135], v245, s[48:51], s42 offen sc1
    v_fma_mix_f32 v253, v143, v231, v239 op_sel:[1,0,0] op_sel_hi:[1,0,0]
    v_cvt_pk_bf16_f32 v207, v252, v253
    s_waitcnt lgkmcnt(12)
    v_mfma_f32_32x32x16_bf16 v[0:15], a[144:147], v[200:203], v[0:15]
    ds_read_b128 v[224:227], v244 offset:384
    ds_read_b128 v[228:231], v244 offset:400
    s_waitcnt vmcnt(18) lgkmcnt(10)
    v_fma_mix_f32 v250, v144, v208, v216 op_sel_hi:[1,0,0]
    v_fma_mix_f32 v251, v144, v209, v217 op_sel:[1,0,0] op_sel_hi:[1,0,0]
    v_cvt_pk_bf16_f32 v192, v250, v251
    v_fma_mix_f32 v252, v145, v210, v218 op_sel_hi:[1,0,0]
    v_mfma_f32_32x32x16_bf16 v[16:31], a[144:147], v[204:207], v[16:31]
    ds_read_b128 v[232:235], v244 offset:416
    ds_read_b128 v[236:239], v244 offset:432
    buffer_load_dwordx4 v247, s[60:63], s68 offen offset:1024 lds
    v_fma_mix_f32 v253, v145, v211, v219 op_sel:[1,0,0] op_sel_hi:[1,0,0]
    v_mfma_f32_32x32x16_bf16 v[32:47], a[148:151], v[200:203], v[32:47]
    ds_read_b64_tr_b16 a[176:177], v240 offset:12288
    ds_read_b64_tr_b16 a[178:179], v240 offset:13312
    s_sub_u32 s71, s41, s40
    v_cvt_pk_bf16_f32 v193, v252, v253
    v_fma_mix_f32 v250, v146, v212, v220 op_sel_hi:[1,0,0]
    v_fma_mix_f32 v251, v146, v213, v221 op_sel:[1,0,0] op_sel_hi:[1,0,0]
    v_mfma_f32_32x32x16_bf16 v[48:63], a[148:151], v[204:207], v[48:63]
    ds_read_b64_tr_b16 a[180:181], v241 offset:12288
    ds_read_b64_tr_b16 a[182:183], v241 offset:13312
    s_ashr_i32 s71, s71, 3
    v_cvt_pk_bf16_f32 v194, v250, v251
    v_fma_mix_f32 v252, v147, v214, v222 op_sel_hi:[1,0,0]
    v_fma_mix_f32 v253, v147, v215, v223 op_sel:[1,0,0] op_sel_hi:[1,0,0]
    v_mfma_f32_32x32x16_bf16 v[64:79], a[152:155], v[200:203], v[64:79]
    ds_read_b64_tr_b16 a[184:185], v242 offset:12288
    ds_read_b64_tr_b16 a[186:187], v242 offset:13312
    v_cvt_pk_bf16_f32 v195, v252, v253
    v_fma_mix_f32 v250, v148, v208, v216 op_sel_hi:[1,0,0]
    v_fma_mix_f32 v251, v148, v209, v217 op_sel:[1,0,0] op_sel_hi:[1,0,0]
    v_cvt_pk_bf16_f32 v196, v250, v251
    v_mfma_f32_32x32x16_bf16 v[80:95], a[152:155], v[204:207], v[80:95]
    ds_read_b64_tr_b16 a[188:189], v243 offset:12288
    ds_read_b64_tr_b16 a[190:191], v243 offset:13312
    v_fma_mix_f32 v252, v149, v210, v218 op_sel_hi:[1,0,0]
    v_fma_mix_f32 v253, v149, v211, v219 op_sel:[1,0,0] op_sel_hi:[1,0,0]
    v_cvt_pk_bf16_f32 v197, v252, v253
    v_fma_mix_f32 v250, v150, v212, v220 op_sel_hi:[1,0,0]
    v_mfma_f32_32x32x16_bf16 v[96:111], a[156:159], v[200:203], v[96:111]
    buffer_load_dwordx4 v[136:139], v245, s[44:47], s42 offen offset:1024 sc1
    v_fma_mix_f32 v251, v150, v213, v221 op_sel:[1,0,0] op_sel_hi:[1,0,0]
    v_cvt_pk_bf16_f32 v198, v250, v251
    v_fma_mix_f32 v252, v151, v214, v222 op_sel_hi:[1,0,0]
    v_mfma_f32_32x32x16_bf16 v[112:127], a[156:159], v[204:207], v[112:127]
    buffer_load_dwordx4 v[140:143], v245, s[48:51], s42 offen offset:1024 sc1
    v_fma_mix_f32 v253, v151, v215, v223 op_sel:[1,0,0] op_sel_hi:[1,0,0]
    v_cvt_pk_bf16_f32 v199, v252, v253
    v_add_u32 v244, s71, v244
    s_waitcnt lgkmcnt(12)
    v_mfma_f32_32x32x16_bf16 v[0:15], a[160:163], v[192:195], v[0:15]
    ds_read_b128 v[208:211], v244 offset:0
    ds_read_b128 v[212:215], v244 offset:16
    s_waitcnt vmcnt(18) lgkmcnt(10)
    v_fma_mix_f32 v250, v152, v224, v232 op_sel_hi:[1,0,0]
    v_fma_mix_f32 v251, v152, v225, v233 op_sel:[1,0,0] op_sel_hi:[1,0,0]
    v_cvt_pk_bf16_f32 v200, v250, v251
    v_fma_mix_f32 v252, v153, v226, v234 op_sel_hi:[1,0,0]
    v_mfma_f32_32x32x16_bf16 v[16:31], a[160:163], v[196:199], v[16:31]
    ds_read_b128 v[216:219], v244 offset:32
    ds_read_b128 v[220:223], v244 offset:48
    buffer_load_dwordx4 v248, s[60:63], s68 offen offset:2048 lds
    v_fma_mix_f32 v253, v153, v227, v235 op_sel:[1,0,0] op_sel_hi:[1,0,0]
    v_mfma_f32_32x32x16_bf16 v[32:47], a[164:167], v[192:195], v[32:47]
    ds_read_b64_tr_b16 a[128:129], v240 offset:16384
    ds_read_b64_tr_b16 a[130:131], v240 offset:17408
    v_cvt_pk_bf16_f32 v201, v252, v253
    v_fma_mix_f32 v250, v154, v228, v236 op_sel_hi:[1,0,0]
    v_fma_mix_f32 v251, v154, v229, v237 op_sel:[1,0,0] op_sel_hi:[1,0,0]
    v_cvt_pk_bf16_f32 v202, v250, v251
    v_mfma_f32_32x32x16_bf16 v[48:63], a[164:167], v[196:199], v[48:63]
    ds_read_b64_tr_b16 a[132:133], v241 offset:16384
    ds_read_b64_tr_b16 a[134:135], v241 offset:17408
    v_fma_mix_f32 v252, v155, v230, v238 op_sel_hi:[1,0,0]
    v_fma_mix_f32 v253, v155, v231, v239 op_sel:[1,0,0] op_sel_hi:[1,0,0]
    v_cvt_pk_bf16_f32 v203, v252, v253
    v_fma_mix_f32 v250, v156, v224, v232 op_sel_hi:[1,0,0]
    v_mfma_f32_32x32x16_bf16 v[64:79], a[168:171], v[192:195], v[64:79]
    ds_read_b64_tr_b16 a[136:137], v242 offset:16384
    ds_read_b64_tr_b16 a[138:139], v242 offset:17408
    v_fma_mix_f32 v251, v156, v225, v233 op_sel:[1,0,0] op_sel_hi:[1,0,0]
    v_cvt_pk_bf16_f32 v204, v250, v251
    v_fma_mix_f32 v252, v157, v226, v234 op_sel_hi:[1,0,0]
    v_fma_mix_f32 v253, v157, v227, v235 op_sel:[1,0,0] op_sel_hi:[1,0,0]
    v_mfma_f32_32x32x16_bf16 v[80:95], a[168:171], v[196:199], v[80:95]
    ds_read_b64_tr_b16 a[140:141], v243 offset:16384
    ds_read_b64_tr_b16 a[142:143], v243 offset:17408
    v_cvt_pk_bf16_f32 v205, v252, v253
    v_fma_mix_f32 v250, v158, v228, v236 op_sel_hi:[1,0,0]
    v_fma_mix_f32 v251, v158, v229, v237 op_sel:[1,0,0] op_sel_hi:[1,0,0]
    v_cvt_pk_bf16_f32 v206, v250, v251
    v_mfma_f32_32x32x16_bf16 v[96:111], a[172:175], v[192:195], v[96:111]
    buffer_load_dwordx4 v[144:147], v245, s[44:47], s42 offen offset:2048 sc1
    v_fma_mix_f32 v252, v159, v230, v238 op_sel_hi:[1,0,0]
    v_fma_mix_f32 v253, v159, v231, v239 op_sel:[1,0,0] op_sel_hi:[1,0,0]
    v_cvt_pk_bf16_f32 v207, v252, v253
    v_mfma_f32_32x32x16_bf16 v[112:127], a[172:175], v[196:199], v[112:127]
    buffer_load_dwordx4 v[148:151], v245, s[48:51], s42 offen offset:2048 sc1
    s_waitcnt lgkmcnt(12)
    v_mfma_f32_32x32x16_bf16 v[0:15], a[176:179], v[200:203], v[0:15]
    ds_read_b128 v[224:227], v244 offset:128
    ds_read_b128 v[228:231], v244 offset:144
    s_waitcnt vmcnt(18) lgkmcnt(10)
    v_fma_mix_f32 v250, v160, v208, v216 op_sel_hi:[1,0,0]
    v_fma_mix_f32 v251, v160, v209, v217 op_sel:[1,0,0] op_sel_hi:[1,0,0]
    v_cvt_pk_bf16_f32 v192, v250, v251
    v_fma_mix_f32 v252, v161, v210, v218 op_sel_hi:[1,0,0]
    v_mfma_f32_32x32x16_bf16 v[16:31], a[176:179], v[204:207], v[16:31]
    ds_read_b128 v[232:235], v244 offset:160
    ds_read_b128 v[236:239], v244 offset:176
    buffer_load_dwordx4 v249, s[60:63], s68 offen offset:3072 lds
    v_fma_mix_f32 v253, v161, v211, v219 op_sel:[1,0,0] op_sel_hi:[1,0,0]
    v_mfma_f32_32x32x16_bf16 v[32:47], a[180:183], v[200:203], v[32:47]
    ds_read_b64_tr_b16 a[144:145], v240 offset:20480
    ds_read_b64_tr_b16 a[146:147], v240 offset:21504
    v_cvt_pk_bf16_f32 v193, v252, v253
    v_fma_mix_f32 v250, v162, v212, v220 op_sel_hi:[1,0,0]
    v_fma_mix_f32 v251, v162, v213, v221 op_sel:[1,0,0] op_sel_hi:[1,0,0]
    v_cvt_pk_bf16_f32 v194, v250, v251
    v_mfma_f32_32x32x16_bf16 v[48:63], a[180:183], v[204:207], v[48:63]
    ds_read_b64_tr_b16 a[148:149], v241 offset:20480
    ds_read_b64_tr_b16 a[150:151], v241 offset:21504
    v_fma_mix_f32 v252, v163, v214, v222 op_sel_hi:[1,0,0]
    v_fma_mix_f32 v253, v163, v215, v223 op_sel:[1,0,0] op_sel_hi:[1,0,0]
    v_cvt_pk_bf16_f32 v195, v252, v253
    v_fma_mix_f32 v250, v164, v208, v216 op_sel_hi:[1,0,0]
    v_mfma_f32_32x32x16_bf16 v[64:79], a[184:187], v[200:203], v[64:79]
    ds_read_b64_tr_b16 a[152:153], v242 offset:20480
    ds_read_b64_tr_b16 a[154:155], v242 offset:21504
    v_fma_mix_f32 v251, v164, v209, v217 op_sel:[1,0,0] op_sel_hi:[1,0,0]
    v_cvt_pk_bf16_f32 v196, v250, v251
    v_fma_mix_f32 v252, v165, v210, v218 op_sel_hi:[1,0,0]
    v_fma_mix_f32 v253, v165, v211, v219 op_sel:[1,0,0] op_sel_hi:[1,0,0]
    v_mfma_f32_32x32x16_bf16 v[80:95], a[184:187], v[204:207], v[80:95]
    ds_read_b64_tr_b16 a[156:157], v243 offset:20480
    ds_read_b64_tr_b16 a[158:159], v243 offset:21504
    v_cvt_pk_bf16_f32 v197, v252, v253
    v_fma_mix_f32 v250, v166, v212, v220 op_sel_hi:[1,0,0]
    v_fma_mix_f32 v251, v166, v213, v221 op_sel:[1,0,0] op_sel_hi:[1,0,0]
    v_cvt_pk_bf16_f32 v198, v250, v251
    v_mfma_f32_32x32x16_bf16 v[96:111], a[188:191], v[200:203], v[96:111]
    buffer_load_dwordx4 v[152:155], v245, s[44:47], s42 offen offset:3072 sc1
    v_fma_mix_f32 v252, v167, v214, v222 op_sel_hi:[1,0,0]
    v_fma_mix_f32 v253, v167, v215, v223 op_sel:[1,0,0] op_sel_hi:[1,0,0]
    v_cvt_pk_bf16_f32 v199, v252, v253
    v_mfma_f32_32x32x16_bf16 v[112:127], a[188:191], v[204:207], v[112:127]
    buffer_load_dwordx4 v[156:159], v245, s[48:51], s42 offen offset:3072 sc1
    s_waitcnt lgkmcnt(12)
    v_mfma_f32_32x32x16_bf16 v[0:15], a[128:131], v[192:195], v[0:15]
    s_barrier
    ds_read_b128 v[208:211], v244 offset:256
    ds_read_b128 v[212:215], v244 offset:272
    s_waitcnt vmcnt(18) lgkmcnt(10)
    v_fma_mix_f32 v250, v168, v224, v232 op_sel_hi:[1,0,0]
    v_fma_mix_f32 v251, v168, v225, v233 op_sel:[1,0,0] op_sel_hi:[1,0,0]
    v_cvt_pk_bf16_f32 v200, v250, v251
    v_mfma_f32_32x32x16_bf16 v[16:31], a[128:131], v[196:199], v[16:31]
    ds_read_b128 v[216:219], v244 offset:288
    ds_read_b128 v[220:223], v244 offset:304
    v_fma_mix_f32 v252, v169, v226, v234 op_sel_hi:[1,0,0]
    v_fma_mix_f32 v253, v169, v227, v235 op_sel:[1,0,0] op_sel_hi:[1,0,0]
    v_cvt_pk_bf16_f32 v201, v252, v253
    v_fma_mix_f32 v250, v170, v228, v236 op_sel_hi:[1,0,0]
    v_mfma_f32_32x32x16_bf16 v[32:47], a[132:135], v[192:195], v[32:47]
    ds_read_b64_tr_b16 a[160:161], v240 offset:24576
    ds_read_b64_tr_b16 a[162:163], v240 offset:25600
    v_fma_mix_f32 v251, v170, v229, v237 op_sel:[1,0,0] op_sel_hi:[1,0,0]
    v_cvt_pk_bf16_f32 v202, v250, v251
    v_fma_mix_f32 v252, v171, v230, v238 op_sel_hi:[1,0,0]
    v_fma_mix_f32 v253, v171, v231, v239 op_sel:[1,0,0] op_sel_hi:[1,0,0]
    v_mfma_f32_32x32x16_bf16 v[48:63], a[132:135], v[196:199], v[48:63]
    ds_read_b64_tr_b16 a[164:165], v241 offset:24576
    ds_read_b64_tr_b16 a[166:167], v241 offset:25600
    v_cvt_pk_bf16_f32 v203, v252, v253
    v_fma_mix_f32 v250, v172, v224, v232 op_sel_hi:[1,0,0]
    v_fma_mix_f32 v251, v172, v225, v233 op_sel:[1,0,0] op_sel_hi:[1,0,0]
    v_cvt_pk_bf16_f32 v204, v250, v251
    v_mfma_f32_32x32x16_bf16 v[64:79], a[136:139], v[192:195], v[64:79]
    ds_read_b64_tr_b16 a[168:169], v242 offset:24576
    ds_read_b64_tr_b16 a[170:171], v242 offset:25600
    v_fma_mix_f32 v252, v173, v226, v234 op_sel_hi:[1,0,0]
    v_fma_mix_f32 v253, v173, v227, v235 op_sel:[1,0,0] op_sel_hi:[1,0,0]
    v_cvt_pk_bf16_f32 v205, v252, v253
    v_fma_mix_f32 v250, v174, v228, v236 op_sel_hi:[1,0,0]
    v_mfma_f32_32x32x16_bf16 v[80:95], a[136:139], v[196:199], v[80:95]
    ds_read_b64_tr_b16 a[172:173], v243 offset:24576
    ds_read_b64_tr_b16 a[174:175], v243 offset:25600
    v_fma_mix_f32 v251, v174, v229, v237 op_sel:[1,0,0] op_sel_hi:[1,0,0]
    v_cvt_pk_bf16_f32 v206, v250, v251
    v_fma_mix_f32 v252, v175, v230, v238 op_sel_hi:[1,0,0]
    v_fma_mix_f32 v253, v175, v231, v239 op_sel:[1,0,0] op_sel_hi:[1,0,0]
    v_mfma_f32_32x32x16_bf16 v[96:111], a[140:143], v[192:195], v[96:111]
    buffer_load_dwordx4 v[160:163], v245, s[44:47], s43 offen sc1
    v_cvt_pk_bf16_f32 v207, v252, v253
    v_mfma_f32_32x32x16_bf16 v[112:127], a[140:143], v[196:199], v[112:127]
    buffer_load_dwordx4 v[164:167], v245, s[48:51], s43 offen sc1
    s_waitcnt lgkmcnt(12)
    v_mfma_f32_32x32x16_bf16 v[0:15], a[144:147], v[200:203], v[0:15]
    ds_read_b128 v[224:227], v244 offset:384
    ds_read_b128 v[228:231], v244 offset:400
    s_waitcnt vmcnt(17) lgkmcnt(10)
    v_fma_mix_f32 v250, v176, v208, v216 op_sel_hi:[1,0,0]
    v_fma_mix_f32 v251, v176, v209, v217 op_sel:[1,0,0] op_sel_hi:[1,0,0]
    v_cvt_pk_bf16_f32 v192, v250, v251
    v_fma_mix_f32 v252, v177, v210, v218 op_sel_hi:[1,0,0]
    v_mfma_f32_32x32x16_bf16 v[16:31], a[144:147], v[204:207], v[16:31]
    ds_read_b128 v[232:235], v244 offset:416
    ds_read_b128 v[236:239], v244 offset:432
    v_fma_mix_f32 v253, v177, v211, v219 op_sel:[1,0,0] op_sel_hi:[1,0,0]
    v_cvt_pk_bf16_f32 v193, v252, v253
    v_fma_mix_f32 v250, v178, v212, v220 op_sel_hi:[1,0,0]
    v_fma_mix_f32 v251, v178, v213, v221 op_sel:[1,0,0] op_sel_hi:[1,0,0]
    v_mfma_f32_32x32x16_bf16 v[32:47], a[148:151], v[200:203], v[32:47]
    ds_read_b64_tr_b16 a[176:177], v240 offset:28672
    ds_read_b64_tr_b16 a[178:179], v240 offset:29696
    s_sub_u32 s71, s42, s41
    v_cvt_pk_bf16_f32 v194, v250, v251
    v_fma_mix_f32 v252, v179, v214, v222 op_sel_hi:[1,0,0]
    v_fma_mix_f32 v253, v179, v215, v223 op_sel:[1,0,0] op_sel_hi:[1,0,0]
    v_mfma_f32_32x32x16_bf16 v[48:63], a[148:151], v[204:207], v[48:63]
    ds_read_b64_tr_b16 a[180:181], v241 offset:28672
    ds_read_b64_tr_b16 a[182:183], v241 offset:29696
    s_ashr_i32 s71, s71, 3
    v_cvt_pk_bf16_f32 v195, v252, v253
    v_fma_mix_f32 v250, v180, v208, v216 op_sel_hi:[1,0,0]
    v_fma_mix_f32 v251, v180, v209, v217 op_sel:[1,0,0] op_sel_hi:[1,0,0]
    v_mfma_f32_32x32x16_bf16 v[64:79], a[152:155], v[200:203], v[64:79]
    ds_read_b64_tr_b16 a[184:185], v242 offset:28672
    ds_read_b64_tr_b16 a[186:187], v242 offset:29696
    v_cvt_pk_bf16_f32 v196, v250, v251
    v_fma_mix_f32 v252, v181, v210, v218 op_sel_hi:[1,0,0]
    v_fma_mix_f32 v253, v181, v211, v219 op_sel:[1,0,0] op_sel_hi:[1,0,0]
    v_cvt_pk_bf16_f32 v197, v252, v253
    v_mfma_f32_32x32x16_bf16 v[80:95], a[152:155], v[204:207], v[80:95]
    ds_read_b64_tr_b16 a[188:189], v243 offset:28672
    ds_read_b64_tr_b16 a[190:191], v243 offset:29696
    v_fma_mix_f32 v250, v182, v212, v220 op_sel_hi:[1,0,0]
    v_fma_mix_f32 v251, v182, v213, v221 op_sel:[1,0,0] op_sel_hi:[1,0,0]
    v_cvt_pk_bf16_f32 v198, v250, v251
    v_fma_mix_f32 v252, v183, v214, v222 op_sel_hi:[1,0,0]
    v_mfma_f32_32x32x16_bf16 v[96:111], a[156:159], v[200:203], v[96:111]
    buffer_load_dwordx4 v[168:171], v245, s[44:47], s43 offen offset:1024 sc1
    v_fma_mix_f32 v253, v183, v215, v223 op_sel:[1,0,0] op_sel_hi:[1,0,0]
    v_cvt_pk_bf16_f32 v199, v252, v253
    v_add_u32 v244, s71, v244
    v_mfma_f32_32x32x16_bf16 v[112:127], a[156:159], v[204:207], v[112:127]
    buffer_load_dwordx4 v[172:175], v245, s[48:51], s43 offen offset:1024 sc1
    s_waitcnt lgkmcnt(12)
    v_mfma_f32_32x32x16_bf16 v[0:15], a[160:163], v[192:195], v[0:15]
    ds_read_b128 v[208:211], v244 offset:0
    ds_read_b128 v[212:215], v244 offset:16
    s_waitcnt vmcnt(16) lgkmcnt(10)
    v_fma_mix_f32 v250, v184, v224, v232 op_sel_hi:[1,0,0]
    v_fma_mix_f32 v251, v184, v225, v233 op_sel:[1,0,0] op_sel_hi:[1,0,0]
    v_cvt_pk_bf16_f32 v200, v250, v251
    v_fma_mix_f32 v252, v185, v226, v234 op_sel_hi:[1,0,0]
    v_mfma_f32_32x32x16_bf16 v[16:31], a[160:163], v[196:199], v[16:31]
    ds_read_b128 v[216:219], v244 offset:32
    ds_read_b128 v[220:223], v244 offset:48
    v_fma_mix_f32 v253, v185, v227, v235 op_sel:[1,0,0] op_sel_hi:[1,0,0]
    v_cvt_pk_bf16_f32 v201, v252, v253
    v_fma_mix_f32 v250, v186, v228, v236 op_sel_hi:[1,0,0]
    v_fma_mix_f32 v251, v186, v229, v237 op_sel:[1,0,0] op_sel_hi:[1,0,0]
    v_mfma_f32_32x32x16_bf16 v[32:47], a[164:167], v[192:195], v[32:47]
    ds_read_b64_tr_b16 a[128:129], v240 offset:32768
    ds_read_b64_tr_b16 a[130:131], v240 offset:33792
    v_cvt_pk_bf16_f32 v202, v250, v251
    v_fma_mix_f32 v252, v187, v230, v238 op_sel_hi:[1,0,0]
    v_fma_mix_f32 v253, v187, v231, v239 op_sel:[1,0,0] op_sel_hi:[1,0,0]
    v_cvt_pk_bf16_f32 v203, v252, v253
    v_mfma_f32_32x32x16_bf16 v[48:63], a[164:167], v[196:199], v[48:63]
    ds_read_b64_tr_b16 a[132:133], v241 offset:32768
    ds_read_b64_tr_b16 a[134:135], v241 offset:33792
    v_fma_mix_f32 v250, v188, v224, v232 op_sel_hi:[1,0,0]
    v_fma_mix_f32 v251, v188, v225, v233 op_sel:[1,0,0] op_sel_hi:[1,0,0]
    v_cvt_pk_bf16_f32 v204, v250, v251
    v_fma_mix_f32 v252, v189, v226, v234 op_sel_hi:[1,0,0]
    v_mfma_f32_32x32x16_bf16 v[64:79], a[168:171], v[192:195], v[64:79]
    ds_read_b64_tr_b16 a[136:137], v242 offset:32768
    ds_read_b64_tr_b16 a[138:139], v242 offset:33792
    v_fma_mix_f32 v253, v189, v227, v235 op_sel:[1,0,0] op_sel_hi:[1,0,0]
    v_cvt_pk_bf16_f32 v205, v252, v253
    v_fma_mix_f32 v250, v190, v228, v236 op_sel_hi:[1,0,0]
    v_fma_mix_f32 v251, v190, v229, v237 op_sel:[1,0,0] op_sel_hi:[1,0,0]
    v_mfma_f32_32x32x16_bf16 v[80:95], a[168:171], v[196:199], v[80:95]
    ds_read_b64_tr_b16 a[140:141], v243 offset:32768
    ds_read_b64_tr_b16 a[142:143], v243 offset:33792
    v_cvt_pk_bf16_f32 v206, v250, v251
    v_fma_mix_f32 v252, v191, v230, v238 op_sel_hi:[1,0,0]
    v_fma_mix_f32 v253, v191, v231, v239 op_sel:[1,0,0] op_sel_hi:[1,0,0]
    v_cvt_pk_bf16_f32 v207, v252, v253
    v_mfma_f32_32x32x16_bf16 v[96:111], a[172:175], v[192:195], v[96:111]
    buffer_load_dwordx4 v[176:179], v245, s[44:47], s43 offen offset:2048 sc1
    v_mfma_f32_32x32x16_bf16 v[112:127], a[172:175], v[196:199], v[112:127]
    buffer_load_dwordx4 v[180:183], v245, s[48:51], s43 offen offset:2048 sc1
    s_waitcnt lgkmcnt(12)
    v_mfma_f32_32x32x16_bf16 v[0:15], a[176:179], v[200:203], v[0:15]
    ds_read_b128 v[224:227], v244 offset:128
    ds_read_b128 v[228:231], v244 offset:144
    s_waitcnt vmcnt(15) lgkmcnt(10)
    v_fma_mix_f32 v250, v128, v208, v216 op_sel_hi:[1,0,0]
    v_fma_mix_f32 v251, v128, v209, v217 op_sel:[1,0,0] op_sel_hi:[1,0,0]
    v_cvt_pk_bf16_f32 v192, v250, v251
    v_fma_mix_f32 v252, v129, v210, v218 op_sel_hi:[1,0,0]
    v_mfma_f32_32x32x16_bf16 v[16:31], a[176:179], v[204:207], v[16:31]
    ds_read_b128 v[232:235], v244 offset:160
    ds_read_b128 v[236:239], v244 offset:176
    v_fma_mix_f32 v253, v129, v211, v219 op_sel:[1,0,0] op_sel_hi:[1,0,0]
    v_cvt_pk_bf16_f32 v193, v252, v253
    v_fma_mix_f32 v250, v130, v212, v220 op_sel_hi:[1,0,0]
    v_fma_mix_f32 v251, v130, v213, v221 op_sel:[1,0,0] op_sel_hi:[1,0,0]
    v_mfma_f32_32x32x16_bf16 v[32:47], a[180:183], v[200:203], v[32:47]
    ds_read_b64_tr_b16 a[144:145], v240 offset:36864
    ds_read_b64_tr_b16 a[146:147], v240 offset:37888
    v_cvt_pk_bf16_f32 v194, v250, v251
    v_fma_mix_f32 v252, v131, v214, v222 op_sel_hi:[1,0,0]
    v_fma_mix_f32 v253, v131, v215, v223 op_sel:[1,0,0] op_sel_hi:[1,0,0]
    v_cvt_pk_bf16_f32 v195, v252, v253
    v_mfma_f32_32x32x16_bf16 v[48:63], a[180:183], v[204:207], v[48:63]
    ds_read_b64_tr_b16 a[148:149], v241 offset:36864
    ds_read_b64_tr_b16 a[150:151], v241 offset:37888
    v_fma_mix_f32 v250, v132, v208, v216 op_sel_hi:[1,0,0]
    v_fma_mix_f32 v251, v132, v209, v217 op_sel:[1,0,0] op_sel_hi:[1,0,0]
    v_cvt_pk_bf16_f32 v196, v250, v251
    v_fma_mix_f32 v252, v133, v210, v218 op_sel_hi:[1,0,0]
    v_mfma_f32_32x32x16_bf16 v[64:79], a[184:187], v[200:203], v[64:79]
    ds_read_b64_tr_b16 a[152:153], v242 offset:36864
    ds_read_b64_tr_b16 a[154:155], v242 offset:37888
    v_fma_mix_f32 v253, v133, v211, v219 op_sel:[1,0,0] op_sel_hi:[1,0,0]
    v_cvt_pk_bf16_f32 v197, v252, v253
    v_fma_mix_f32 v250, v134, v212, v220 op_sel_hi:[1,0,0]
    v_fma_mix_f32 v251, v134, v213, v221 op_sel:[1,0,0] op_sel_hi:[1,0,0]
    v_mfma_f32_32x32x16_bf16 v[80:95], a[184:187], v[204:207], v[80:95]
    ds_read_b64_tr_b16 a[156:157], v243 offset:36864
    ds_read_b64_tr_b16 a[158:159], v243 offset:37888
    v_cvt_pk_bf16_f32 v198, v250, v251
    v_fma_mix_f32 v252, v135, v214, v222 op_sel_hi:[1,0,0]
    v_fma_mix_f32 v253, v135, v215, v223 op_sel:[1,0,0] op_sel_hi:[1,0,0]
    v_cvt_pk_bf16_f32 v199, v252, v253
    v_mfma_f32_32x32x16_bf16 v[96:111], a[188:191], v[200:203], v[96:111]
    buffer_load_dwordx4 v[184:187], v245, s[44:47], s43 offen offset:3072 sc1
    v_mfma_f32_32x32x16_bf16 v[112:127], a[188:191], v[204:207], v[112:127]
    buffer_load_dwordx4 v[188:191], v245, s[48:51], s43 offen offset:3072 sc1
    s_waitcnt lgkmcnt(12)
    v_mfma_f32_32x32x16_bf16 v[0:15], a[128:131], v[192:195], v[0:15]
    s_barrier
    ds_read_b128 v[208:211], v244 offset:256
    ds_read_b128 v[212:215], v244 offset:272
    s_waitcnt vmcnt(14) lgkmcnt(10)
    v_fma_mix_f32 v250, v136, v224, v232 op_sel_hi:[1,0,0]
    v_fma_mix_f32 v251, v136, v225, v233 op_sel:[1,0,0] op_sel_hi:[1,0,0]
    v_cvt_pk_bf16_f32 v200, v250, v251
    v_mfma_f32_32x32x16_bf16 v[16:31], a[128:131], v[196:199], v[16:31]
    ds_read_b128 v[216:219], v244 offset:288
    ds_read_b128 v[220:223], v244 offset:304
    s_add_u32 m0, s72, 32768
    s_nop 0
    buffer_load_dwordx4 v254, s[52:55], s82 offen lds
    v_mfma_f32_32x32x16_bf16 v[32:47], a[132:135], v[192:195], v[32:47]
    ds_read_b64_tr_b16 a[160:161], v240 offset:40960
    ds_read_b64_tr_b16 a[162:163], v240 offset:41984
    v_fma_mix_f32 v252, v137, v226, v234 op_sel_hi:[1,0,0]
    v_fma_mix_f32 v253, v137, v227, v235 op_sel:[1,0,0] op_sel_hi:[1,0,0]
    v_cvt_pk_bf16_f32 v201, v252, v253
    v_fma_mix_f32 v250, v138, v228, v236 op_sel_hi:[1,0,0]
    v_mfma_f32_32x32x16_bf16 v[48:63], a[132:135], v[196:199], v[48:63]
    ds_read_b64_tr_b16 a[164:165], v241 offset:40960
    ds_read_b64_tr_b16 a[166:167], v241 offset:41984
    v_fma_mix_f32 v251, v138, v229, v237 op_sel:[1,0,0] op_sel_hi:[1,0,0]
    v_cvt_pk_bf16_f32 v202, v250, v251
    v_fma_mix_f32 v252, v139, v230, v238 op_sel_hi:[1,0,0]
    v_fma_mix_f32 v253, v139, v231, v239 op_sel:[1,0,0] op_sel_hi:[1,0,0]
    v_mfma_f32_32x32x16_bf16 v[64:79], a[136:139], v[192:195], v[64:79]
    ds_read_b64_tr_b16 a[168:169], v242 offset:40960
    ds_read_b64_tr_b16 a[170:171], v242 offset:41984
    v_cvt_pk_bf16_f32 v203, v252, v253
    v_fma_mix_f32 v250, v140, v224, v232 op_sel_hi:[1,0,0]
    v_fma_mix_f32 v251, v140, v225, v233 op_sel:[1,0,0] op_sel_hi:[1,0,0]
    v_cvt_pk_bf16_f32 v204, v250, v251
    v_mfma_f32_32x32x16_bf16 v[80:95], a[136:139], v[196:199], v[80:95]
    ds_read_b64_tr_b16 a[172:173], v243 offset:40960
    ds_read_b64_tr_b16 a[174:175], v243 offset:41984
    v_fma_mix_f32 v252, v141, v226, v234 op_sel_hi:[1,0,0]
    v_fma_mix_f32 v253, v141, v227, v235 op_sel:[1,0,0] op_sel_hi:[1,0,0]
    v_cvt_pk_bf16_f32 v205, v252, v253
    v_fma_mix_f32 v250, v142, v228, v236 op_sel_hi:[1,0,0]
    v_mfma_f32_32x32x16_bf16 v[96:111], a[140:143], v[192:195], v[96:111]
    buffer_load_dwordx4 v[128:131], v245, s[44:47], s69 offen sc1
    v_fma_mix_f32 v251, v142, v229, v237 op_sel:[1,0,0] op_sel_hi:[1,0,0]
    v_cvt_pk_bf16_f32 v206, v250, v251
    v_fma_mix_f32 v252, v143, v230, v238 op_sel_hi:[1,0,0]
    v_mfma_f32_32x32x16_bf16 v[112:127], a[140:143], v[196:199], v[112:127]
    buffer_load_dwordx4 v[132:135], v245, s[48:51], s69 offen sc1
    v_fma_mix_f32 v253, v143, v231, v239 op_sel:[1,0,0] op_sel_hi:[1,0,0]
    v_cvt_pk_bf16_f32 v207, v252, v253
    s_waitcnt lgkmcnt(12)
    v_mfma_f32_32x32x16_bf16 v[0:15], a[144:147], v[200:203], v[0:15]
    ds_read_b128 v[224:227], v244 offset:384
    ds_read_b128 v[228:231], v244 offset:400
    s_waitcnt vmcnt(14) lgkmcnt(10)
    v_fma_mix_f32 v250, v144, v208, v216 op_sel_hi:[1,0,0]
    v_fma_mix_f32 v251, v144, v209, v217 op_sel:[1,0,0] op_sel_hi:[1,0,0]
    v_cvt_pk_bf16_f32 v192, v250, v251
    v_fma_mix_f32 v252, v145, v210, v218 op_sel_hi:[1,0,0]
    v_mfma_f32_32x32x16_bf16 v[16:31], a[144:147], v[204:207], v[16:31]
    ds_read_b128 v[232:235], v244 offset:416
    ds_read_b128 v[236:239], v244 offset:432
    buffer_load_dwordx4 v254, s[52:55], s82 offen offset:1024 lds
    s_add_u32 s82, s82, 8192
    s_and_b32 s82, s82, 0x1ffff
    v_mfma_f32_32x32x16_bf16 v[32:47], a[148:151], v[200:203], v[32:47]
    ds_read_b64_tr_b16 a[176:177], v240 offset:45056
    ds_read_b64_tr_b16 a[178:179], v240 offset:46080
    s_sub_u32 s71, s43, s42
    v_fma_mix_f32 v253, v145, v211, v219 op_sel:[1,0,0] op_sel_hi:[1,0,0]
    v_cvt_pk_bf16_f32 v193, v252, v253
    v_fma_mix_f32 v250, v146, v212, v220 op_sel_hi:[1,0,0]
    v_mfma_f32_32x32x16_bf16 v[48:63], a[148:151], v[204:207], v[48:63]
    ds_read_b64_tr_b16 a[180:181], v241 offset:45056
    ds_read_b64_tr_b16 a[182:183], v241 offset:46080
    s_ashr_i32 s71, s71, 3
    v_fma_mix_f32 v251, v146, v213, v221 op_sel:[1,0,0] op_sel_hi:[1,0,0]
    v_cvt_pk_bf16_f32 v194, v250, v251
    v_fma_mix_f32 v252, v147, v214, v222 op_sel_hi:[1,0,0]
    v_mfma_f32_32x32x16_bf16 v[64:79], a[152:155], v[200:203], v[64:79]
    ds_read_b64_tr_b16 a[184:185], v242 offset:45056
    ds_read_b64_tr_b16 a[186:187], v242 offset:46080
    v_fma_mix_f32 v253, v147, v215, v223 op_sel:[1,0,0] op_sel_hi:[1,0,0]
    v_cvt_pk_bf16_f32 v195, v252, v253
    v_fma_mix_f32 v250, v148, v208, v216 op_sel_hi:[1,0,0]
    v_fma_mix_f32 v251, v148, v209, v217 op_sel:[1,0,0] op_sel_hi:[1,0,0]
    v_mfma_f32_32x32x16_bf16 v[80:95], a[152:155], v[204:207], v[80:95]
    ds_read_b64_tr_b16 a[188:189], v243 offset:45056
    ds_read_b64_tr_b16 a[190:191], v243 offset:46080
    v_cvt_pk_bf16_f32 v196, v250, v251
    v_fma_mix_f32 v252, v149, v210, v218 op_sel_hi:[1,0,0]
    v_fma_mix_f32 v253, v149, v211, v219 op_sel:[1,0,0] op_sel_hi:[1,0,0]
    v_cvt_pk_bf16_f32 v197, v252, v253
    v_mfma_f32_32x32x16_bf16 v[96:111], a[156:159], v[200:203], v[96:111]
    buffer_load_dwordx4 v[136:139], v245, s[44:47], s69 offen offset:1024 sc1
    v_fma_mix_f32 v250, v150, v212, v220 op_sel_hi:[1,0,0]
    v_fma_mix_f32 v251, v150, v213, v221 op_sel:[1,0,0] op_sel_hi:[1,0,0]
    v_cvt_pk_bf16_f32 v198, v250, v251
    v_mfma_f32_32x32x16_bf16 v[112:127], a[156:159], v[204:207], v[112:127]
    buffer_load_dwordx4 v[140:143], v245, s[48:51], s69 offen offset:1024 sc1
    v_fma_mix_f32 v252, v151, v214, v222 op_sel_hi:[1,0,0]
    v_fma_mix_f32 v253, v151, v215, v223 op_sel:[1,0,0] op_sel_hi:[1,0,0]
    v_cvt_pk_bf16_f32 v199, v252, v253
    v_add_u32 v244, s71, v244
    s_waitcnt lgkmcnt(12)
    v_mfma_f32_32x32x16_bf16 v[0:15], a[160:163], v[192:195], v[0:15]
    ds_read_b128 v[208:211], v244 offset:0
    ds_read_b128 v[212:215], v244 offset:16
    s_waitcnt vmcnt(14) lgkmcnt(10)
    v_fma_mix_f32 v250, v152, v224, v232 op_sel_hi:[1,0,0]
    v_fma_mix_f32 v251, v152, v225, v233 op_sel:[1,0,0] op_sel_hi:[1,0,0]
    v_cvt_pk_bf16_f32 v200, v250, v251
    v_fma_mix_f32 v252, v153, v226, v234 op_sel_hi:[1,0,0]
    v_mfma_f32_32x32x16_bf16 v[16:31], a[160:163], v[196:199], v[16:31]
    ds_read_b128 v[216:219], v244 offset:32
    ds_read_b128 v[220:223], v244 offset:48
    v_fma_mix_f32 v253, v153, v227, v235 op_sel:[1,0,0] op_sel_hi:[1,0,0]
    v_cvt_pk_bf16_f32 v201, v252, v253
    v_fma_mix_f32 v250, v154, v228, v236 op_sel_hi:[1,0,0]
    v_fma_mix_f32 v251, v154, v229, v237 op_sel:[1,0,0] op_sel_hi:[1,0,0]
    v_mfma_f32_32x32x16_bf16 v[32:47], a[164:167], v[192:195], v[32:47]
    ds_read_b64_tr_b16 a[128:129], v240 offset:49152
    ds_read_b64_tr_b16 a[130:131], v240 offset:50176
    v_cvt_pk_bf16_f32 v202, v250, v251
    v_fma_mix_f32 v252, v155, v230, v238 op_sel_hi:[1,0,0]
    v_fma_mix_f32 v253, v155, v231, v239 op_sel:[1,0,0] op_sel_hi:[1,0,0]
    v_cvt_pk_bf16_f32 v203, v252, v253
    v_mfma_f32_32x32x16_bf16 v[48:63], a[164:167], v[196:199], v[48:63]
    ds_read_b64_tr_b16 a[132:133], v241 offset:49152
    ds_read_b64_tr_b16 a[134:135], v241 offset:50176
    v_fma_mix_f32 v250, v156, v224, v232 op_sel_hi:[1,0,0]
    v_fma_mix_f32 v251, v156, v225, v233 op_sel:[1,0,0] op_sel_hi:[1,0,0]
    v_cvt_pk_bf16_f32 v204, v250, v251
    v_fma_mix_f32 v252, v157, v226, v234 op_sel_hi:[1,0,0]
    v_mfma_f32_32x32x16_bf16 v[64:79], a[168:171], v[192:195], v[64:79]
    ds_read_b64_tr_b16 a[136:137], v242 offset:49152
    ds_read_b64_tr_b16 a[138:139], v242 offset:50176
    v_fma_mix_f32 v253, v157, v227, v235 op_sel:[1,0,0] op_sel_hi:[1,0,0]
    v_cvt_pk_bf16_f32 v205, v252, v253
    v_fma_mix_f32 v250, v158, v228, v236 op_sel_hi:[1,0,0]
    v_fma_mix_f32 v251, v158, v229, v237 op_sel:[1,0,0] op_sel_hi:[1,0,0]
    v_mfma_f32_32x32x16_bf16 v[80:95], a[168:171], v[196:199], v[80:95]
    ds_read_b64_tr_b16 a[140:141], v243 offset:49152
    ds_read_b64_tr_b16 a[142:143], v243 offset:50176
    v_cvt_pk_bf16_f32 v206, v250, v251
    v_fma_mix_f32 v252, v159, v230, v238 op_sel_hi:[1,0,0]
    v_fma_mix_f32 v253, v159, v231, v239 op_sel:[1,0,0] op_sel_hi:[1,0,0]
    v_cvt_pk_bf16_f32 v207, v252, v253
    v_mfma_f32_32x32x16_bf16 v[96:111], a[172:175], v[192:195], v[96:111]
    buffer_load_dwordx4 v[144:147], v245, s[44:47], s69 offen offset:2048 sc1
    v_mfma_f32_32x32x16_bf16 v[112:127], a[172:175], v[196:199], v[112:127]
    buffer_load_dwordx4 v[148:151], v245, s[48:51], s69 offen offset:2048 sc1
    s_waitcnt lgkmcnt(12)
    v_mfma_f32_32x32x16_bf16 v[0:15], a[176:179], v[200:203], v[0:15]
    ds_read_b128 v[224:227], v244 offset:128
    ds_read_b128 v[228:231], v244 offset:144
    s_waitcnt vmcnt(14) lgkmcnt(10)
    v_fma_mix_f32 v250, v160, v208, v216 op_sel_hi:[1,0,0]
    v_fma_mix_f32 v251, v160, v209, v217 op_sel:[1,0,0] op_sel_hi:[1,0,0]
    v_cvt_pk_bf16_f32 v192, v250, v251
    v_fma_mix_f32 v252, v161, v210, v218 op_sel_hi:[1,0,0]
    v_mfma_f32_32x32x16_bf16 v[16:31], a[176:179], v[204:207], v[16:31]
    ds_read_b128 v[232:235], v244 offset:160
    ds_read_b128 v[236:239], v244 offset:176
    v_fma_mix_f32 v253, v161, v211, v219 op_sel:[1,0,0] op_sel_hi:[1,0,0]
    v_cvt_pk_bf16_f32 v193, v252, v253
    v_fma_mix_f32 v250, v162, v212, v220 op_sel_hi:[1,0,0]
    v_fma_mix_f32 v251, v162, v213, v221 op_sel:[1,0,0] op_sel_hi:[1,0,0]
    v_mfma_f32_32x32x16_bf16 v[32:47], a[180:183], v[200:203], v[32:47]
    ds_read_b64_tr_b16 a[144:145], v240 offset:53248
    ds_read_b64_tr_b16 a[146:147], v240 offset:54272
    v_cvt_pk_bf16_f32 v194, v250, v251
    v_fma_mix_f32 v252, v163, v214, v222 op_sel_hi:[1,0,0]
    v_fma_mix_f32 v253, v163, v215, v223 op_sel:[1,0,0] op_sel_hi:[1,0,0]
    v_cvt_pk_bf16_f32 v195, v252, v253
    v_mfma_f32_32x32x16_bf16 v[48:63], a[180:183], v[204:207], v[48:63]
    ds_read_b64_tr_b16 a[148:149], v241 offset:53248
    ds_read_b64_tr_b16 a[150:151], v241 offset:54272
    v_fma_mix_f32 v250, v164, v208, v216 op_sel_hi:[1,0,0]
    v_fma_mix_f32 v251, v164, v209, v217 op_sel:[1,0,0] op_sel_hi:[1,0,0]
    v_cvt_pk_bf16_f32 v196, v250, v251
    v_fma_mix_f32 v252, v165, v210, v218 op_sel_hi:[1,0,0]
    v_mfma_f32_32x32x16_bf16 v[64:79], a[184:187], v[200:203], v[64:79]
    ds_read_b64_tr_b16 a[152:153], v242 offset:53248
    ds_read_b64_tr_b16 a[154:155], v242 offset:54272
    v_fma_mix_f32 v253, v165, v211, v219 op_sel:[1,0,0] op_sel_hi:[1,0,0]
    v_cvt_pk_bf16_f32 v197, v252, v253
    v_fma_mix_f32 v250, v166, v212, v220 op_sel_hi:[1,0,0]
    v_fma_mix_f32 v251, v166, v213, v221 op_sel:[1,0,0] op_sel_hi:[1,0,0]
    v_mfma_f32_32x32x16_bf16 v[80:95], a[184:187], v[204:207], v[80:95]
    ds_read_b64_tr_b16 a[156:157], v243 offset:53248
    ds_read_b64_tr_b16 a[158:159], v243 offset:54272
    v_cvt_pk_bf16_f32 v198, v250, v251
    v_fma_mix_f32 v252, v167, v214, v222 op_sel_hi:[1,0,0]
    v_fma_mix_f32 v253, v167, v215, v223 op_sel:[1,0,0] op_sel_hi:[1,0,0]
    v_cvt_pk_bf16_f32 v199, v252, v253
    v_mfma_f32_32x32x16_bf16 v[96:111], a[188:191], v[200:203], v[96:111]
    buffer_load_dwordx4 v[152:155], v245, s[44:47], s69 offen offset:3072 sc1
    v_mfma_f32_32x32x16_bf16 v[112:127], a[188:191], v[204:207], v[112:127]
    buffer_load_dwordx4 v[156:159], v245, s[48:51], s69 offen offset:3072 sc1
    s_waitcnt lgkmcnt(12)
    v_mfma_f32_32x32x16_bf16 v[0:15], a[128:131], v[192:195], v[0:15]
    s_barrier
    ds_read_b128 v[208:211], v244 offset:256
    ds_read_b128 v[212:215], v244 offset:272
    s_waitcnt vmcnt(14) lgkmcnt(10)
    v_fma_mix_f32 v250, v168, v224, v232 op_sel_hi:[1,0,0]
    v_fma_mix_f32 v251, v168, v225, v233 op_sel:[1,0,0] op_sel_hi:[1,0,0]
    v_cvt_pk_bf16_f32 v200, v250, v251
    v_mfma_f32_32x32x16_bf16 v[16:31], a[128:131], v[196:199], v[16:31]
    ds_read_b128 v[216:219], v244 offset:288
    ds_read_b128 v[220:223], v244 offset:304
    s_add_u32 m0, s72, 49152
    s_nop 0
    buffer_load_dwordx4 v254, s[52:55], s82 offen lds
    v_mfma_f32_32x32x16_bf16 v[32:47], a[132:135], v[192:195], v[32:47]
    ds_read_b64_tr_b16 a[160:161], v240 offset:57344
    ds_read_b64_tr_b16 a[162:163], v240 offset:58368
    v_fma_mix_f32 v252, v169, v226, v234 op_sel_hi:[1,0,0]
    v_fma_mix_f32 v253, v169, v227, v235 op_sel:[1,0,0] op_sel_hi:[1,0,0]
    v_cvt_pk_bf16_f32 v201, v252, v253
    v_fma_mix_f32 v250, v170, v228, v236 op_sel_hi:[1,0,0]
    v_mfma_f32_32x32x16_bf16 v[48:63], a[132:135], v[196:199], v[48:63]
    ds_read_b64_tr_b16 a[164:165], v241 offset:57344
    ds_read_b64_tr_b16 a[166:167], v241 offset:58368
    v_fma_mix_f32 v251, v170, v229, v237 op_sel:[1,0,0] op_sel_hi:[1,0,0]
    v_cvt_pk_bf16_f32 v202, v250, v251
    v_fma_mix_f32 v252, v171, v230, v238 op_sel_hi:[1,0,0]
    v_fma_mix_f32 v253, v171, v231, v239 op_sel:[1,0,0] op_sel_hi:[1,0,0]
    v_mfma_f32_32x32x16_bf16 v[64:79], a[136:139], v[192:195], v[64:79]
    ds_read_b64_tr_b16 a[168:169], v242 offset:57344
    ds_read_b64_tr_b16 a[170:171], v242 offset:58368
    v_cvt_pk_bf16_f32 v203, v252, v253
    v_fma_mix_f32 v250, v172, v224, v232 op_sel_hi:[1,0,0]
    v_fma_mix_f32 v251, v172, v225, v233 op_sel:[1,0,0] op_sel_hi:[1,0,0]
    v_cvt_pk_bf16_f32 v204, v250, v251
    v_mfma_f32_32x32x16_bf16 v[80:95], a[136:139], v[196:199], v[80:95]
    ds_read_b64_tr_b16 a[172:173], v243 offset:57344
    ds_read_b64_tr_b16 a[174:175], v243 offset:58368
    v_fma_mix_f32 v252, v173, v226, v234 op_sel_hi:[1,0,0]
    v_fma_mix_f32 v253, v173, v227, v235 op_sel:[1,0,0] op_sel_hi:[1,0,0]
    v_cvt_pk_bf16_f32 v205, v252, v253
    v_fma_mix_f32 v250, v174, v228, v236 op_sel_hi:[1,0,0]
    v_mfma_f32_32x32x16_bf16 v[96:111], a[140:143], v[192:195], v[96:111]
    buffer_load_dwordx4 v[160:163], v245, s[44:47], s70 offen sc1
    v_fma_mix_f32 v251, v174, v229, v237 op_sel:[1,0,0] op_sel_hi:[1,0,0]
    v_cvt_pk_bf16_f32 v206, v250, v251
    v_fma_mix_f32 v252, v175, v230, v238 op_sel_hi:[1,0,0]
    v_mfma_f32_32x32x16_bf16 v[112:127], a[140:143], v[196:199], v[112:127]
    buffer_load_dwordx4 v[164:167], v245, s[48:51], s70 offen sc1
    v_fma_mix_f32 v253, v175, v231, v239 op_sel:[1,0,0] op_sel_hi:[1,0,0]
    v_cvt_pk_bf16_f32 v207, v252, v253
    s_waitcnt lgkmcnt(12)
    v_mfma_f32_32x32x16_bf16 v[0:15], a[144:147], v[200:203], v[0:15]
    ds_read_b128 v[224:227], v244 offset:384
    ds_read_b128 v[228:231], v244 offset:400
    s_waitcnt vmcnt(15) lgkmcnt(10)
    v_fma_mix_f32 v250, v176, v208, v216 op_sel_hi:[1,0,0]
    v_fma_mix_f32 v251, v176, v209, v217 op_sel:[1,0,0] op_sel_hi:[1,0,0]
    v_cvt_pk_bf16_f32 v192, v250, v251
    v_fma_mix_f32 v252, v177, v210, v218 op_sel_hi:[1,0,0]
    v_mfma_f32_32x32x16_bf16 v[16:31], a[144:147], v[204:207], v[16:31]
    ds_read_b128 v[232:235], v244 offset:416
    ds_read_b128 v[236:239], v244 offset:432
    buffer_load_dwordx4 v254, s[52:55], s82 offen offset:1024 lds
    s_add_u32 s82, s82, 8192
    s_and_b32 s82, s82, 0x1ffff
    v_mfma_f32_32x32x16_bf16 v[32:47], a[148:151], v[200:203], v[32:47]
    ds_read_b64_tr_b16 a[176:177], v240 offset:61440
    ds_read_b64_tr_b16 a[178:179], v240 offset:62464
    s_sub_u32 s71, s69, s43
    v_fma_mix_f32 v253, v177, v211, v219 op_sel:[1,0,0] op_sel_hi:[1,0,0]
    v_cvt_pk_bf16_f32 v193, v252, v253
    v_fma_mix_f32 v250, v178, v212, v220 op_sel_hi:[1,0,0]
    v_mfma_f32_32x32x16_bf16 v[48:63], a[148:151], v[204:207], v[48:63]
    ds_read_b64_tr_b16 a[180:181], v241 offset:61440
    ds_read_b64_tr_b16 a[182:183], v241 offset:62464
    s_ashr_i32 s71, s71, 3
    v_fma_mix_f32 v251, v178, v213, v221 op_sel:[1,0,0] op_sel_hi:[1,0,0]
    v_cvt_pk_bf16_f32 v194, v250, v251
    v_fma_mix_f32 v252, v179, v214, v222 op_sel_hi:[1,0,0]
    v_mfma_f32_32x32x16_bf16 v[64:79], a[152:155], v[200:203], v[64:79]
    ds_read_b64_tr_b16 a[184:185], v242 offset:61440
    ds_read_b64_tr_b16 a[186:187], v242 offset:62464
    v_fma_mix_f32 v253, v179, v215, v223 op_sel:[1,0,0] op_sel_hi:[1,0,0]
    v_cvt_pk_bf16_f32 v195, v252, v253
    v_fma_mix_f32 v250, v180, v208, v216 op_sel_hi:[1,0,0]
    v_fma_mix_f32 v251, v180, v209, v217 op_sel:[1,0,0] op_sel_hi:[1,0,0]
    v_mfma_f32_32x32x16_bf16 v[80:95], a[152:155], v[204:207], v[80:95]
    ds_read_b64_tr_b16 a[188:189], v243 offset:61440
    ds_read_b64_tr_b16 a[190:191], v243 offset:62464
    v_cvt_pk_bf16_f32 v196, v250, v251
    v_fma_mix_f32 v252, v181, v210, v218 op_sel_hi:[1,0,0]
    v_fma_mix_f32 v253, v181, v211, v219 op_sel:[1,0,0] op_sel_hi:[1,0,0]
    v_cvt_pk_bf16_f32 v197, v252, v253
    v_mfma_f32_32x32x16_bf16 v[96:111], a[156:159], v[200:203], v[96:111]
    buffer_load_dwordx4 v[168:171], v245, s[44:47], s70 offen offset:1024 sc1
    v_fma_mix_f32 v250, v182, v212, v220 op_sel_hi:[1,0,0]
    v_fma_mix_f32 v251, v182, v213, v221 op_sel:[1,0,0] op_sel_hi:[1,0,0]
    v_cvt_pk_bf16_f32 v198, v250, v251
    v_mfma_f32_32x32x16_bf16 v[112:127], a[156:159], v[204:207], v[112:127]
    buffer_load_dwordx4 v[172:175], v245, s[48:51], s70 offen offset:1024 sc1
    v_fma_mix_f32 v252, v183, v214, v222 op_sel_hi:[1,0,0]
    v_fma_mix_f32 v253, v183, v215, v223 op_sel:[1,0,0] op_sel_hi:[1,0,0]
    v_cvt_pk_bf16_f32 v199, v252, v253
    v_add_u32 v244, s71, v244
    v_subrev_u32 v240, 0x10000, v240
    v_subrev_u32 v241, 0x10000, v241
    v_subrev_u32 v242, 0x10000, v242
    v_subrev_u32 v243, 0x10000, v243
    s_waitcnt lgkmcnt(12)
    v_mfma_f32_32x32x16_bf16 v[0:15], a[160:163], v[192:195], v[0:15]
    ds_read_b128 v[208:211], v244 offset:0
    ds_read_b128 v[212:215], v244 offset:16
    s_waitcnt vmcnt(16) lgkmcnt(10)
    v_fma_mix_f32 v250, v184, v224, v232 op_sel_hi:[1,0,0]
    v_fma_mix_f32 v251, v184, v225, v233 op_sel:[1,0,0] op_sel_hi:[1,0,0]
    v_cvt_pk_bf16_f32 v200, v250, v251
    v_fma_mix_f32 v252, v185, v226, v234 op_sel_hi:[1,0,0]
    v_mfma_f32_32x32x16_bf16 v[16:31], a[160:163], v[196:199], v[16:31]
    ds_read_b128 v[216:219], v244 offset:32
    ds_read_b128 v[220:223], v244 offset:48
    v_fma_mix_f32 v253, v185, v227, v235 op_sel:[1,0,0] op_sel_hi:[1,0,0]
    v_cvt_pk_bf16_f32 v201, v252, v253
    v_fma_mix_f32 v250, v186, v228, v236 op_sel_hi:[1,0,0]
    v_fma_mix_f32 v251, v186, v229, v237 op_sel:[1,0,0] op_sel_hi:[1,0,0]
    v_mfma_f32_32x32x16_bf16 v[32:47], a[164:167], v[192:195], v[32:47]
    ds_read_b64_tr_b16 a[128:129], v240 offset:0
    ds_read_b64_tr_b16 a[130:131], v240 offset:1024
    v_cvt_pk_bf16_f32 v202, v250, v251
    v_fma_mix_f32 v252, v187, v230, v238 op_sel_hi:[1,0,0]
    v_fma_mix_f32 v253, v187, v231, v239 op_sel:[1,0,0] op_sel_hi:[1,0,0]
    v_cvt_pk_bf16_f32 v203, v252, v253
    v_mfma_f32_32x32x16_bf16 v[48:63], a[164:167], v[196:199], v[48:63]
    ds_read_b64_tr_b16 a[132:133], v241 offset:0
    ds_read_b64_tr_b16 a[134:135], v241 offset:1024
    v_fma_mix_f32 v250, v188, v224, v232 op_sel_hi:[1,0,0]
    v_fma_mix_f32 v251, v188, v225, v233 op_sel:[1,0,0] op_sel_hi:[1,0,0]
    v_cvt_pk_bf16_f32 v204, v250, v251
    v_fma_mix_f32 v252, v189, v226, v234 op_sel_hi:[1,0,0]
    v_mfma_f32_32x32x16_bf16 v[64:79], a[168:171], v[192:195], v[64:79]
    ds_read_b64_tr_b16 a[136:137], v242 offset:0
    ds_read_b64_tr_b16 a[138:139], v242 offset:1024
    v_fma_mix_f32 v253, v189, v227, v235 op_sel:[1,0,0] op_sel_hi:[1,0,0]
    v_cvt_pk_bf16_f32 v205, v252, v253
    v_fma_mix_f32 v250, v190, v228, v236 op_sel_hi:[1,0,0]
    v_fma_mix_f32 v251, v190, v229, v237 op_sel:[1,0,0] op_sel_hi:[1,0,0]
    v_mfma_f32_32x32x16_bf16 v[80:95], a[168:171], v[196:199], v[80:95]
    ds_read_b64_tr_b16 a[140:141], v243 offset:0
    ds_read_b64_tr_b16 a[142:143], v243 offset:1024
    v_cvt_pk_bf16_f32 v206, v250, v251
    v_fma_mix_f32 v252, v191, v230, v238 op_sel_hi:[1,0,0]
    v_fma_mix_f32 v253, v191, v231, v239 op_sel:[1,0,0] op_sel_hi:[1,0,0]
    v_cvt_pk_bf16_f32 v207, v252, v253
    v_mfma_f32_32x32x16_bf16 v[96:111], a[172:175], v[192:195], v[96:111]
    buffer_load_dwordx4 v[176:179], v245, s[44:47], s70 offen offset:2048 sc1
    v_mfma_f32_32x32x16_bf16 v[112:127], a[172:175], v[196:199], v[112:127]
    buffer_load_dwordx4 v[180:183], v245, s[48:51], s70 offen offset:2048 sc1
    s_waitcnt lgkmcnt(12)
    v_mfma_f32_32x32x16_bf16 v[0:15], a[176:179], v[200:203], v[0:15]
    ds_read_b128 v[224:227], v244 offset:128
    ds_read_b128 v[228:231], v244 offset:144
    s_waitcnt vmcnt(15) lgkmcnt(10)
    v_fma_mix_f32 v250, v128, v208, v216 op_sel_hi:[1,0,0]
    v_fma_mix_f32 v251, v128, v209, v217 op_sel:[1,0,0] op_sel_hi:[1,0,0]
    v_cvt_pk_bf16_f32 v192, v250, v251
    v_fma_mix_f32 v252, v129, v210, v218 op_sel_hi:[1,0,0]
    v_mfma_f32_32x32x16_bf16 v[16:31], a[176:179], v[204:207], v[16:31]
    ds_read_b128 v[232:235], v244 offset:160
    ds_read_b128 v[236:239], v244 offset:176
    v_fma_mix_f32 v253, v129, v211, v219 op_sel:[1,0,0] op_sel_hi:[1,0,0]
    v_cvt_pk_bf16_f32 v193, v252, v253
    v_fma_mix_f32 v250, v130, v212, v220 op_sel_hi:[1,0,0]
    v_fma_mix_f32 v251, v130, v213, v221 op_sel:[1,0,0] op_sel_hi:[1,0,0]
    v_mfma_f32_32x32x16_bf16 v[32:47], a[180:183], v[200:203], v[32:47]
    ds_read_b64_tr_b16 a[144:145], v240 offset:4096
    ds_read_b64_tr_b16 a[146:147], v240 offset:5120
    v_cvt_pk_bf16_f32 v194, v250, v251
    v_fma_mix_f32 v252, v131, v214, v222 op_sel_hi:[1,0,0]
    v_fma_mix_f32 v253, v131, v215, v223 op_sel:[1,0,0] op_sel_hi:[1,0,0]
    v_cvt_pk_bf16_f32 v195, v252, v253
    v_mfma_f32_32x32x16_bf16 v[48:63], a[180:183], v[204:207], v[48:63]
    ds_read_b64_tr_b16 a[148:149], v241 offset:4096
    ds_read_b64_tr_b16 a[150:151], v241 offset:5120
    v_fma_mix_f32 v250, v132, v208, v216 op_sel_hi:[1,0,0]
    v_fma_mix_f32 v251, v132, v209, v217 op_sel:[1,0,0] op_sel_hi:[1,0,0]
    v_cvt_pk_bf16_f32 v196, v250, v251
    v_fma_mix_f32 v252, v133, v210, v218 op_sel_hi:[1,0,0]
    v_mfma_f32_32x32x16_bf16 v[64:79], a[184:187], v[200:203], v[64:79]
    ds_read_b64_tr_b16 a[152:153], v242 offset:4096
    ds_read_b64_tr_b16 a[154:155], v242 offset:5120
    v_fma_mix_f32 v253, v133, v211, v219 op_sel:[1,0,0] op_sel_hi:[1,0,0]
    v_cvt_pk_bf16_f32 v197, v252, v253
    v_fma_mix_f32 v250, v134, v212, v220 op_sel_hi:[1,0,0]
    v_fma_mix_f32 v251, v134, v213, v221 op_sel:[1,0,0] op_sel_hi:[1,0,0]
    v_mfma_f32_32x32x16_bf16 v[80:95], a[184:187], v[204:207], v[80:95]
    ds_read_b64_tr_b16 a[156:157], v243 offset:4096
    ds_read_b64_tr_b16 a[158:159], v243 offset:5120
    v_cvt_pk_bf16_f32 v198, v250, v251
    v_fma_mix_f32 v252, v135, v214, v222 op_sel_hi:[1,0,0]
    v_fma_mix_f32 v253, v135, v215, v223 op_sel:[1,0,0] op_sel_hi:[1,0,0]
    v_cvt_pk_bf16_f32 v199, v252, v253
    v_mfma_f32_32x32x16_bf16 v[96:111], a[188:191], v[200:203], v[96:111]
    buffer_load_dwordx4 v[184:187], v245, s[44:47], s70 offen offset:3072 sc1
    v_mfma_f32_32x32x16_bf16 v[112:127], a[188:191], v[204:207], v[112:127]
    buffer_load_dwordx4 v[188:191], v245, s[48:51], s70 offen offset:3072 sc1
    s_waitcnt lgkmcnt(12)
    v_mfma_f32_32x32x16_bf16 v[0:15], a[128:131], v[192:195], v[0:15]
    s_barrier
    ds_read_b128 v[208:211], v244 offset:256
    ds_read_b128 v[212:215], v244 offset:272
    s_waitcnt vmcnt(14) lgkmcnt(10)
    v_fma_mix_f32 v250, v136, v224, v232 op_sel_hi:[1,0,0]
    v_fma_mix_f32 v251, v136, v225, v233 op_sel:[1,0,0] op_sel_hi:[1,0,0]
    v_cvt_pk_bf16_f32 v200, v250, v251
    v_mfma_f32_32x32x16_bf16 v[16:31], a[128:131], v[196:199], v[16:31]
    ds_read_b128 v[216:219], v244 offset:288
    ds_read_b128 v[220:223], v244 offset:304
    s_add_u32 m0, s72, 65536
    s_nop 0
    buffer_load_dwordx4 v254, s[52:55], s82 offen lds
    v_mfma_f32_32x32x16_bf16 v[32:47], a[132:135], v[192:195], v[32:47]
    ds_read_b64_tr_b16 a[160:161], v240 offset:8192
    ds_read_b64_tr_b16 a[162:163], v240 offset:9216
    v_fma_mix_f32 v252, v137, v226, v234 op_sel_hi:[1,0,0]
    v_fma_mix_f32 v253, v137, v227, v235 op_sel:[1,0,0] op_sel_hi:[1,0,0]
    v_cvt_pk_bf16_f32 v201, v252, v253
    v_fma_mix_f32 v250, v138, v228, v236 op_sel_hi:[1,0,0]
    v_mfma_f32_32x32x16_bf16 v[48:63], a[132:135], v[196:199], v[48:63]
    ds_read_b64_tr_b16 a[164:165], v241 offset:8192
    ds_read_b64_tr_b16 a[166:167], v241 offset:9216
    v_fma_mix_f32 v251, v138, v229, v237 op_sel:[1,0,0] op_sel_hi:[1,0,0]
    v_cvt_pk_bf16_f32 v202, v250, v251
    v_fma_mix_f32 v252, v139, v230, v238 op_sel_hi:[1,0,0]
    v_fma_mix_f32 v253, v139, v231, v239 op_sel:[1,0,0] op_sel_hi:[1,0,0]
    v_mfma_f32_32x32x16_bf16 v[64:79], a[136:139], v[192:195], v[64:79]
    ds_read_b64_tr_b16 a[168:169], v242 offset:8192
    ds_read_b64_tr_b16 a[170:171], v242 offset:9216
    v_cvt_pk_bf16_f32 v203, v252, v253
    v_fma_mix_f32 v250, v140, v224, v232 op_sel_hi:[1,0,0]
    v_fma_mix_f32 v251, v140, v225, v233 op_sel:[1,0,0] op_sel_hi:[1,0,0]
    v_cvt_pk_bf16_f32 v204, v250, v251
    v_mfma_f32_32x32x16_bf16 v[80:95], a[136:139], v[196:199], v[80:95]
    ds_read_b64_tr_b16 a[172:173], v243 offset:8192
    ds_read_b64_tr_b16 a[174:175], v243 offset:9216
    v_fma_mix_f32 v252, v141, v226, v234 op_sel_hi:[1,0,0]
    v_fma_mix_f32 v253, v141, v227, v235 op_sel:[1,0,0] op_sel_hi:[1,0,0]
    v_cvt_pk_bf16_f32 v205, v252, v253
    v_fma_mix_f32 v250, v142, v228, v236 op_sel_hi:[1,0,0]
    v_mfma_f32_32x32x16_bf16 v[96:111], a[140:143], v[192:195], v[96:111]
    v_fma_mix_f32 v251, v142, v229, v237 op_sel:[1,0,0] op_sel_hi:[1,0,0]
    v_cvt_pk_bf16_f32 v206, v250, v251
    v_fma_mix_f32 v252, v143, v230, v238 op_sel_hi:[1,0,0]
    v_fma_mix_f32 v253, v143, v231, v239 op_sel:[1,0,0] op_sel_hi:[1,0,0]
    v_cvt_pk_bf16_f32 v207, v252, v253
    v_mfma_f32_32x32x16_bf16 v[112:127], a[140:143], v[196:199], v[112:127]
    s_waitcnt lgkmcnt(12)
    v_mfma_f32_32x32x16_bf16 v[0:15], a[144:147], v[200:203], v[0:15]
    ds_read_b128 v[224:227], v244 offset:384
    ds_read_b128 v[228:231], v244 offset:400
    s_waitcnt vmcnt(13) lgkmcnt(10)
    v_fma_mix_f32 v250, v144, v208, v216 op_sel_hi:[1,0,0]
    v_fma_mix_f32 v251, v144, v209, v217 op_sel:[1,0,0] op_sel_hi:[1,0,0]
    v_cvt_pk_bf16_f32 v192, v250, v251
    v_fma_mix_f32 v252, v145, v210, v218 op_sel_hi:[1,0,0]
    v_mfma_f32_32x32x16_bf16 v[16:31], a[144:147], v[204:207], v[16:31]
    ds_read_b128 v[232:235], v244 offset:416
    ds_read_b128 v[236:239], v244 offset:432
    buffer_load_dwordx4 v254, s[52:55], s82 offen offset:1024 lds
    s_add_u32 s82, s82, 8192
    s_and_b32 s82, s82, 0x1ffff
    v_mfma_f32_32x32x16_bf16 v[32:47], a[148:151], v[200:203], v[32:47]
    ds_read_b64_tr_b16 a[176:177], v240 offset:12288
    ds_read_b64_tr_b16 a[178:179], v240 offset:13312
    s_sub_u32 s71, s70, s69
    v_fma_mix_f32 v253, v145, v211, v219 op_sel:[1,0,0] op_sel_hi:[1,0,0]
    v_cvt_pk_bf16_f32 v193, v252, v253
    v_fma_mix_f32 v250, v146, v212, v220 op_sel_hi:[1,0,0]
    v_mfma_f32_32x32x16_bf16 v[48:63], a[148:151], v[204:207], v[48:63]
    ds_read_b64_tr_b16 a[180:181], v241 offset:12288
    ds_read_b64_tr_b16 a[182:183], v241 offset:13312
    s_ashr_i32 s71, s71, 3
    v_fma_mix_f32 v251, v146, v213, v221 op_sel:[1,0,0] op_sel_hi:[1,0,0]
    v_cvt_pk_bf16_f32 v194, v250, v251
    v_fma_mix_f32 v252, v147, v214, v222 op_sel_hi:[1,0,0]
    v_mfma_f32_32x32x16_bf16 v[64:79], a[152:155], v[200:203], v[64:79]
    ds_read_b64_tr_b16 a[184:185], v242 offset:12288
    ds_read_b64_tr_b16 a[186:187], v242 offset:13312
    v_fma_mix_f32 v253, v147, v215, v223 op_sel:[1,0,0] op_sel_hi:[1,0,0]
    v_cvt_pk_bf16_f32 v195, v252, v253
    v_fma_mix_f32 v250, v148, v208, v216 op_sel_hi:[1,0,0]
    v_fma_mix_f32 v251, v148, v209, v217 op_sel:[1,0,0] op_sel_hi:[1,0,0]
    v_mfma_f32_32x32x16_bf16 v[80:95], a[152:155], v[204:207], v[80:95]
    ds_read_b64_tr_b16 a[188:189], v243 offset:12288
    ds_read_b64_tr_b16 a[190:191], v243 offset:13312
    v_cvt_pk_bf16_f32 v196, v250, v251
    v_fma_mix_f32 v252, v149, v210, v218 op_sel_hi:[1,0,0]
    v_fma_mix_f32 v253, v149, v211, v219 op_sel:[1,0,0] op_sel_hi:[1,0,0]
    v_cvt_pk_bf16_f32 v197, v252, v253
    v_mfma_f32_32x32x16_bf16 v[96:111], a[156:159], v[200:203], v[96:111]
    v_fma_mix_f32 v250, v150, v212, v220 op_sel_hi:[1,0,0]
    v_fma_mix_f32 v251, v150, v213, v221 op_sel:[1,0,0] op_sel_hi:[1,0,0]
    v_cvt_pk_bf16_f32 v198, v250, v251
    v_fma_mix_f32 v252, v151, v214, v222 op_sel_hi:[1,0,0]
    v_fma_mix_f32 v253, v151, v215, v223 op_sel:[1,0,0] op_sel_hi:[1,0,0]
    v_cvt_pk_bf16_f32 v199, v252, v253
    v_mfma_f32_32x32x16_bf16 v[112:127], a[156:159], v[204:207], v[112:127]
    v_add_u32 v244, s71, v244
    s_waitcnt lgkmcnt(12)
    v_mfma_f32_32x32x16_bf16 v[0:15], a[160:163], v[192:195], v[0:15]
    ds_read_b128 v[208:211], v244 offset:0
    ds_read_b128 v[212:215], v244 offset:16
    s_waitcnt vmcnt(12) lgkmcnt(10)
    v_fma_mix_f32 v250, v152, v224, v232 op_sel_hi:[1,0,0]
    v_fma_mix_f32 v251, v152, v225, v233 op_sel:[1,0,0] op_sel_hi:[1,0,0]
    v_cvt_pk_bf16_f32 v200, v250, v251
    v_fma_mix_f32 v252, v153, v226, v234 op_sel_hi:[1,0,0]
    v_mfma_f32_32x32x16_bf16 v[16:31], a[160:163], v[196:199], v[16:31]
    ds_read_b128 v[216:219], v244 offset:32
    ds_read_b128 v[220:223], v244 offset:48
    buffer_load_dwordx4 v255, s[56:59], s83 offen offset:2048 lds
    v_fma_mix_f32 v253, v153, v227, v235 op_sel:[1,0,0] op_sel_hi:[1,0,0]
    v_mfma_f32_32x32x16_bf16 v[32:47], a[164:167], v[192:195], v[32:47]
    ds_read_b64_tr_b16 a[128:129], v240 offset:16384
    ds_read_b64_tr_b16 a[130:131], v240 offset:17408
    v_cvt_pk_bf16_f32 v201, v252, v253
    v_fma_mix_f32 v250, v154, v228, v236 op_sel_hi:[1,0,0]
    v_fma_mix_f32 v251, v154, v229, v237 op_sel:[1,0,0] op_sel_hi:[1,0,0]
    v_cvt_pk_bf16_f32 v202, v250, v251
    v_mfma_f32_32x32x16_bf16 v[48:63], a[164:167], v[196:199], v[48:63]
    ds_read_b64_tr_b16 a[132:133], v241 offset:16384
    ds_read_b64_tr_b16 a[134:135], v241 offset:17408
    v_fma_mix_f32 v252, v155, v230, v238 op_sel_hi:[1,0,0]
    v_fma_mix_f32 v253, v155, v231, v239 op_sel:[1,0,0] op_sel_hi:[1,0,0]
    v_cvt_pk_bf16_f32 v203, v252, v253
    v_fma_mix_f32 v250, v156, v224, v232 op_sel_hi:[1,0,0]
    v_mfma_f32_32x32x16_bf16 v[64:79], a[168:171], v[192:195], v[64:79]
    ds_read_b64_tr_b16 a[136:137], v242 offset:16384
    ds_read_b64_tr_b16 a[138:139], v242 offset:17408
    v_fma_mix_f32 v251, v156, v225, v233 op_sel:[1,0,0] op_sel_hi:[1,0,0]
    v_cvt_pk_bf16_f32 v204, v250, v251
    v_fma_mix_f32 v252, v157, v226, v234 op_sel_hi:[1,0,0]
    v_fma_mix_f32 v253, v157, v227, v235 op_sel:[1,0,0] op_sel_hi:[1,0,0]
    v_mfma_f32_32x32x16_bf16 v[80:95], a[168:171], v[196:199], v[80:95]
    ds_read_b64_tr_b16 a[140:141], v243 offset:16384
    ds_read_b64_tr_b16 a[142:143], v243 offset:17408
    v_cvt_pk_bf16_f32 v205, v252, v253
    v_fma_mix_f32 v250, v158, v228, v236 op_sel_hi:[1,0,0]
    v_fma_mix_f32 v251, v158, v229, v237 op_sel:[1,0,0] op_sel_hi:[1,0,0]
    v_cvt_pk_bf16_f32 v206, v250, v251
    v_mfma_f32_32x32x16_bf16 v[96:111], a[172:175], v[192:195], v[96:111]
    v_fma_mix_f32 v252, v159, v230, v238 op_sel_hi:[1,0,0]
    v_fma_mix_f32 v253, v159, v231, v239 op_sel:[1,0,0] op_sel_hi:[1,0,0]
    v_cvt_pk_bf16_f32 v207, v252, v253
    v_mfma_f32_32x32x16_bf16 v[112:127], a[172:175], v[196:199], v[112:127]
    s_waitcnt lgkmcnt(12)
    v_mfma_f32_32x32x16_bf16 v[0:15], a[176:179], v[200:203], v[0:15]
    ds_read_b128 v[224:227], v244 offset:128
    ds_read_b128 v[228:231], v244 offset:144
    s_waitcnt vmcnt(10) lgkmcnt(10)
    v_fma_mix_f32 v250, v160, v208, v216 op_sel_hi:[1,0,0]
    v_fma_mix_f32 v251, v160, v209, v217 op_sel:[1,0,0] op_sel_hi:[1,0,0]
    v_cvt_pk_bf16_f32 v192, v250, v251
    v_fma_mix_f32 v252, v161, v210, v218 op_sel_hi:[1,0,0]
    v_mfma_f32_32x32x16_bf16 v[16:31], a[176:179], v[204:207], v[16:31]
    ds_read_b128 v[232:235], v244 offset:160
    ds_read_b128 v[236:239], v244 offset:176
    buffer_load_dwordx4 v255, s[56:59], s83 offen offset:3072 lds
    s_add_u32 s83, s83, 8192
    s_and_b32 s83, s83, 0x1ffff
    v_mfma_f32_32x32x16_bf16 v[32:47], a[180:183], v[200:203], v[32:47]
    ds_read_b64_tr_b16 a[144:145], v240 offset:20480
    ds_read_b64_tr_b16 a[146:147], v240 offset:21504
    v_fma_mix_f32 v253, v161, v211, v219 op_sel:[1,0,0] op_sel_hi:[1,0,0]
    v_cvt_pk_bf16_f32 v193, v252, v253
    v_fma_mix_f32 v250, v162, v212, v220 op_sel_hi:[1,0,0]
    v_fma_mix_f32 v251, v162, v213, v221 op_sel:[1,0,0] op_sel_hi:[1,0,0]
    v_mfma_f32_32x32x16_bf16 v[48:63], a[180:183], v[204:207], v[48:63]
    ds_read_b64_tr_b16 a[148:149], v241 offset:20480
    ds_read_b64_tr_b16 a[150:151], v241 offset:21504
    v_cvt_pk_bf16_f32 v194, v250, v251
    v_fma_mix_f32 v252, v163, v214, v222 op_sel_hi:[1,0,0]
    v_fma_mix_f32 v253, v163, v215, v223 op_sel:[1,0,0] op_sel_hi:[1,0,0]
    v_cvt_pk_bf16_f32 v195, v252, v253
    v_mfma_f32_32x32x16_bf16 v[64:79], a[184:187], v[200:203], v[64:79]
    ds_read_b64_tr_b16 a[152:153], v242 offset:20480
    ds_read_b64_tr_b16 a[154:155], v242 offset:21504
    v_fma_mix_f32 v250, v164, v208, v216 op_sel_hi:[1,0,0]
    v_fma_mix_f32 v251, v164, v209, v217 op_sel:[1,0,0] op_sel_hi:[1,0,0]
    v_cvt_pk_bf16_f32 v196, v250, v251
    v_fma_mix_f32 v252, v165, v210, v218 op_sel_hi:[1,0,0]
    v_mfma_f32_32x32x16_bf16 v[80:95], a[184:187], v[204:207], v[80:95]
    ds_read_b64_tr_b16 a[156:157], v243 offset:20480
    ds_read_b64_tr_b16 a[158:159], v243 offset:21504
    v_fma_mix_f32 v253, v165, v211, v219 op_sel:[1,0,0] op_sel_hi:[1,0,0]
    v_cvt_pk_bf16_f32 v197, v252, v253
    v_fma_mix_f32 v250, v166, v212, v220 op_sel_hi:[1,0,0]
    v_fma_mix_f32 v251, v166, v213, v221 op_sel:[1,0,0] op_sel_hi:[1,0,0]
    v_mfma_f32_32x32x16_bf16 v[96:111], a[188:191], v[200:203], v[96:111]
    v_cvt_pk_bf16_f32 v198, v250, v251
    v_fma_mix_f32 v252, v167, v214, v222 op_sel_hi:[1,0,0]
    v_fma_mix_f32 v253, v167, v215, v223 op_sel:[1,0,0] op_sel_hi:[1,0,0]
    v_cvt_pk_bf16_f32 v199, v252, v253
    v_mfma_f32_32x32x16_bf16 v[112:127], a[188:191], v[204:207], v[112:127]
    s_waitcnt lgkmcnt(12)
    v_mfma_f32_32x32x16_bf16 v[0:15], a[128:131], v[192:195], v[0:15]
    s_barrier
    ds_read_b128 v[208:211], v244 offset:256
    ds_read_b128 v[212:215], v244 offset:272
    s_waitcnt vmcnt(8) lgkmcnt(10)
    v_fma_mix_f32 v250, v168, v224, v232 op_sel_hi:[1,0,0]
    v_fma_mix_f32 v251, v168, v225, v233 op_sel:[1,0,0] op_sel_hi:[1,0,0]
    v_cvt_pk_bf16_f32 v200, v250, v251
    v_mfma_f32_32x32x16_bf16 v[16:31], a[128:131], v[196:199], v[16:31]
    ds_read_b128 v[216:219], v244 offset:288
    ds_read_b128 v[220:223], v244 offset:304
    s_add_u32 m0, s72, 81920
    s_nop 0
    buffer_load_dwordx4 v254, s[52:55], s82 offen lds
    v_mfma_f32_32x32x16_bf16 v[32:47], a[132:135], v[192:195], v[32:47]
    ds_read_b64_tr_b16 a[160:161], v240 offset:24576
    ds_read_b64_tr_b16 a[162:163], v240 offset:25600
    v_fma_mix_f32 v252, v169, v226, v234 op_sel_hi:[1,0,0]
    v_fma_mix_f32 v253, v169, v227, v235 op_sel:[1,0,0] op_sel_hi:[1,0,0]
    v_cvt_pk_bf16_f32 v201, v252, v253
    v_fma_mix_f32 v250, v170, v228, v236 op_sel_hi:[1,0,0]
    v_mfma_f32_32x32x16_bf16 v[48:63], a[132:135], v[196:199], v[48:63]
    ds_read_b64_tr_b16 a[164:165], v241 offset:24576
    ds_read_b64_tr_b16 a[166:167], v241 offset:25600
    v_fma_mix_f32 v251, v170, v229, v237 op_sel:[1,0,0] op_sel_hi:[1,0,0]
    v_cvt_pk_bf16_f32 v202, v250, v251
    v_fma_mix_f32 v252, v171, v230, v238 op_sel_hi:[1,0,0]
    v_fma_mix_f32 v253, v171, v231, v239 op_sel:[1,0,0] op_sel_hi:[1,0,0]
    v_mfma_f32_32x32x16_bf16 v[64:79], a[136:139], v[192:195], v[64:79]
    ds_read_b64_tr_b16 a[168:169], v242 offset:24576
    ds_read_b64_tr_b16 a[170:171], v242 offset:25600
    v_cvt_pk_bf16_f32 v203, v252, v253
    v_fma_mix_f32 v250, v172, v224, v232 op_sel_hi:[1,0,0]
    v_fma_mix_f32 v251, v172, v225, v233 op_sel:[1,0,0] op_sel_hi:[1,0,0]
    v_cvt_pk_bf16_f32 v204, v250, v251
    v_mfma_f32_32x32x16_bf16 v[80:95], a[136:139], v[196:199], v[80:95]
    ds_read_b64_tr_b16 a[172:173], v243 offset:24576
    ds_read_b64_tr_b16 a[174:175], v243 offset:25600
    v_fma_mix_f32 v252, v173, v226, v234 op_sel_hi:[1,0,0]
    v_fma_mix_f32 v253, v173, v227, v235 op_sel:[1,0,0] op_sel_hi:[1,0,0]
    v_cvt_pk_bf16_f32 v205, v252, v253
    v_fma_mix_f32 v250, v174, v228, v236 op_sel_hi:[1,0,0]
    v_mfma_f32_32x32x16_bf16 v[96:111], a[140:143], v[192:195], v[96:111]
    v_fma_mix_f32 v251, v174, v229, v237 op_sel:[1,0,0] op_sel_hi:[1,0,0]
    v_cvt_pk_bf16_f32 v206, v250, v251
    v_fma_mix_f32 v252, v175, v230, v238 op_sel_hi:[1,0,0]
    v_fma_mix_f32 v253, v175, v231, v239 op_sel:[1,0,0] op_sel_hi:[1,0,0]
    v_cvt_pk_bf16_f32 v207, v252, v253
    v_mfma_f32_32x32x16_bf16 v[112:127], a[140:143], v[196:199], v[112:127]
    s_waitcnt lgkmcnt(12)
    v_mfma_f32_32x32x16_bf16 v[0:15], a[144:147], v[200:203], v[0:15]
    ds_read_b128 v[224:227], v244 offset:384
    ds_read_b128 v[228:231], v244 offset:400
    s_waitcnt vmcnt(7) lgkmcnt(10)
    v_fma_mix_f32 v250, v176, v208, v216 op_sel_hi:[1,0,0]
    v_fma_mix_f32 v251, v176, v209, v217 op_sel:[1,0,0] op_sel_hi:[1,0,0]
    v_cvt_pk_bf16_f32 v192, v250, v251
    v_fma_mix_f32 v252, v177, v210, v218 op_sel_hi:[1,0,0]
    v_mfma_f32_32x32x16_bf16 v[16:31], a[144:147], v[204:207], v[16:31]
    ds_read_b128 v[232:235], v244 offset:416
    ds_read_b128 v[236:239], v244 offset:432
    buffer_load_dwordx4 v254, s[52:55], s82 offen offset:1024 lds
    s_add_u32 s82, s82, 8192
    s_and_b32 s82, s82, 0x1ffff
    v_mfma_f32_32x32x16_bf16 v[32:47], a[148:151], v[200:203], v[32:47]
    ds_read_b64_tr_b16 a[176:177], v240 offset:28672
    ds_read_b64_tr_b16 a[178:179], v240 offset:29696
    v_fma_mix_f32 v253, v177, v211, v219 op_sel:[1,0,0] op_sel_hi:[1,0,0]
    v_cvt_pk_bf16_f32 v193, v252, v253
    v_fma_mix_f32 v250, v178, v212, v220 op_sel_hi:[1,0,0]
    v_fma_mix_f32 v251, v178, v213, v221 op_sel:[1,0,0] op_sel_hi:[1,0,0]
    v_mfma_f32_32x32x16_bf16 v[48:63], a[148:151], v[204:207], v[48:63]
    ds_read_b64_tr_b16 a[180:181], v241 offset:28672
    ds_read_b64_tr_b16 a[182:183], v241 offset:29696
    v_cvt_pk_bf16_f32 v194, v250, v251
    v_fma_mix_f32 v252, v179, v214, v222 op_sel_hi:[1,0,0]
    v_fma_mix_f32 v253, v179, v215, v223 op_sel:[1,0,0] op_sel_hi:[1,0,0]
    v_cvt_pk_bf16_f32 v195, v252, v253
    v_mfma_f32_32x32x16_bf16 v[64:79], a[152:155], v[200:203], v[64:79]
    ds_read_b64_tr_b16 a[184:185], v242 offset:28672
    ds_read_b64_tr_b16 a[186:187], v242 offset:29696
    v_fma_mix_f32 v250, v180, v208, v216 op_sel_hi:[1,0,0]
    v_fma_mix_f32 v251, v180, v209, v217 op_sel:[1,0,0] op_sel_hi:[1,0,0]
    v_cvt_pk_bf16_f32 v196, v250, v251
    v_fma_mix_f32 v252, v181, v210, v218 op_sel_hi:[1,0,0]
    v_mfma_f32_32x32x16_bf16 v[80:95], a[152:155], v[204:207], v[80:95]
    ds_read_b64_tr_b16 a[188:189], v243 offset:28672
    ds_read_b64_tr_b16 a[190:191], v243 offset:29696
    v_fma_mix_f32 v253, v181, v211, v219 op_sel:[1,0,0] op_sel_hi:[1,0,0]
    v_cvt_pk_bf16_f32 v197, v252, v253
    v_fma_mix_f32 v250, v182, v212, v220 op_sel_hi:[1,0,0]
    v_fma_mix_f32 v251, v182, v213, v221 op_sel:[1,0,0] op_sel_hi:[1,0,0]
    v_mfma_f32_32x32x16_bf16 v[96:111], a[156:159], v[200:203], v[96:111]
    v_cvt_pk_bf16_f32 v198, v250, v251
    v_fma_mix_f32 v252, v183, v214, v222 op_sel_hi:[1,0,0]
    v_fma_mix_f32 v253, v183, v215, v223 op_sel:[1,0,0] op_sel_hi:[1,0,0]
    v_cvt_pk_bf16_f32 v199, v252, v253
    v_mfma_f32_32x32x16_bf16 v[112:127], a[156:159], v[204:207], v[112:127]
    s_waitcnt lgkmcnt(12)
    v_mfma_f32_32x32x16_bf16 v[0:15], a[160:163], v[192:195], v[0:15]
    v_accvgpr_read_b32 v208, a192
    v_accvgpr_read_b32 v209, a193
    v_accvgpr_read_b32 v210, a194
    v_accvgpr_read_b32 v211, a195
    v_accvgpr_read_b32 v212, a196
    v_accvgpr_read_b32 v213, a197
    v_mfma_f32_32x32x16_bf16 v[16:31], a[160:163], v[196:199], v[16:31]
    buffer_load_dwordx4 v255, s[56:59], s83 offen offset:2048 lds
    v_accvgpr_read_b32 v214, a198
    v_accvgpr_read_b32 v215, a199
    v_accvgpr_read_b32 v216, a200
    v_mfma_f32_32x32x16_bf16 v[32:47], a[164:167], v[192:195], v[32:47]
    v_accvgpr_read_b32 v217, a201
    v_accvgpr_read_b32 v218, a202
    v_accvgpr_read_b32 v219, a203
    s_waitcnt vmcnt(7) lgkmcnt(8)
    v_fma_mix_f32 v250, v184, v224, v232 op_sel_hi:[1,0,0]
    v_fma_mix_f32 v251, v184, v225, v233 op_sel:[1,0,0] op_sel_hi:[1,0,0]
    v_cvt_pk_bf16_f32 v200, v250, v251
    v_mfma_f32_32x32x16_bf16 v[48:63], a[164:167], v[196:199], v[48:63]
    v_fma_mix_f32 v252, v185, v226, v234 op_sel_hi:[1,0,0]
    v_fma_mix_f32 v253, v185, v227, v235 op_sel:[1,0,0] op_sel_hi:[1,0,0]
    v_cvt_pk_bf16_f32 v201, v252, v253
    v_fma_mix_f32 v250, v186, v228, v236 op_sel_hi:[1,0,0]
    v_fma_mix_f32 v251, v186, v229, v237 op_sel:[1,0,0] op_sel_hi:[1,0,0]
    v_cvt_pk_bf16_f32 v202, v250, v251
    v_mfma_f32_32x32x16_bf16 v[64:79], a[168:171], v[192:195], v[64:79]
    ds_read_b128 a[128:131], v208 offset:32768
    v_fma_mix_f32 v252, v187, v230, v238 op_sel_hi:[1,0,0]
    v_fma_mix_f32 v253, v187, v231, v239 op_sel:[1,0,0] op_sel_hi:[1,0,0]
    v_cvt_pk_bf16_f32 v203, v252, v253
    v_fma_mix_f32 v250, v188, v224, v232 op_sel_hi:[1,0,0]
    v_fma_mix_f32 v251, v188, v225, v233 op_sel:[1,0,0] op_sel_hi:[1,0,0]
    v_mfma_f32_32x32x16_bf16 v[80:95], a[168:171], v[196:199], v[80:95]
    ds_read_b128 a[132:135], v209 offset:32768
    v_cvt_pk_bf16_f32 v204, v250, v251
    v_fma_mix_f32 v252, v189, v226, v234 op_sel_hi:[1,0,0]
    v_fma_mix_f32 v253, v189, v227, v235 op_sel:[1,0,0] op_sel_hi:[1,0,0]
    v_cvt_pk_bf16_f32 v205, v252, v253
    v_fma_mix_f32 v250, v190, v228, v236 op_sel_hi:[1,0,0]
    v_mfma_f32_32x32x16_bf16 v[96:111], a[172:175], v[192:195], v[96:111]
    ds_read_b128 a[136:139], v210 offset:32768
    v_fma_mix_f32 v251, v190, v229, v237 op_sel:[1,0,0] op_sel_hi:[1,0,0]
    v_cvt_pk_bf16_f32 v206, v250, v251
    v_fma_mix_f32 v252, v191, v230, v238 op_sel_hi:[1,0,0]
    v_fma_mix_f32 v253, v191, v231, v239 op_sel:[1,0,0] op_sel_hi:[1,0,0]
    v_cvt_pk_bf16_f32 v207, v252, v253
    v_mfma_f32_32x32x16_bf16 v[112:127], a[172:175], v[196:199], v[112:127]
    ds_read_b128 a[140:143], v211 offset:32768
    s_waitcnt lgkmcnt(4)
    v_mfma_f32_32x32x16_bf16 v[0:15], a[176:179], v[200:203], v[0:15]
    ds_read_b128 a[144:147], v212 offset:32768
    v_mfma_f32_32x32x16_bf16 v[16:31], a[176:179], v[204:207], v[16:31]
    buffer_load_dwordx4 v255, s[56:59], s83 offen offset:3072 lds
    s_add_u32 s83, s83, 8192
    s_and_b32 s83, s83, 0x1ffff
    ds_read_b128 a[148:151], v213 offset:32768
    v_mfma_f32_32x32x16_bf16 v[32:47], a[180:183], v[200:203], v[32:47]
    ds_read_b128 a[152:155], v214 offset:32768
    v_mfma_f32_32x32x16_bf16 v[48:63], a[180:183], v[204:207], v[48:63]
    ds_read_b128 a[156:159], v215 offset:32768
    s_nop 1
    v_cvt_pk_bf16_f32 v0, v0, v1
    v_cvt_pk_bf16_f32 v1, v2, v3
    v_cvt_pk_bf16_f32 v2, v4, v5
    v_cvt_pk_bf16_f32 v3, v6, v7
    v_cvt_pk_bf16_f32 v4, v8, v9
    v_mfma_f32_32x32x16_bf16 v[64:79], a[184:187], v[200:203], v[64:79]
    v_cvt_pk_bf16_f32 v5, v10, v11
    v_cvt_pk_bf16_f32 v6, v12, v13
    v_cvt_pk_bf16_f32 v7, v14, v15
    v_cvt_pk_bf16_f32 v8, v16, v17
    v_cvt_pk_bf16_f32 v9, v18, v19
    v_cvt_pk_bf16_f32 v10, v20, v21
    v_mfma_f32_32x32x16_bf16 v[80:95], a[184:187], v[204:207], v[80:95]
    v_cvt_pk_bf16_f32 v11, v22, v23
    v_cvt_pk_bf16_f32 v12, v24, v25
    v_cvt_pk_bf16_f32 v13, v26, v27
    v_cvt_pk_bf16_f32 v14, v28, v29
    v_cvt_pk_bf16_f32 v15, v30, v31
    v_cvt_pk_bf16_f32 v16, v32, v33
    v_mfma_f32_32x32x16_bf16 v[96:111], a[188:191], v[200:203], v[96:111]
    v_cvt_pk_bf16_f32 v17, v34, v35
    v_cvt_pk_bf16_f32 v18, v36, v37
    v_cvt_pk_bf16_f32 v19, v38, v39
    v_cvt_pk_bf16_f32 v20, v40, v41
    v_cvt_pk_bf16_f32 v21, v42, v43
    v_cvt_pk_bf16_f32 v22, v44, v45
    v_mfma_f32_32x32x16_bf16 v[112:127], a[188:191], v[204:207], v[112:127]
    v_cvt_pk_bf16_f32 v23, v46, v47
    v_cvt_pk_bf16_f32 v24, v48, v49
    v_cvt_pk_bf16_f32 v25, v50, v51
    v_cvt_pk_bf16_f32 v26, v52, v53
    v_cvt_pk_bf16_f32 v27, v54, v55
    v_cvt_pk_bf16_f32 v28, v56, v57
    v_cvt_pk_bf16_f32 v29, v58, v59
    v_cvt_pk_bf16_f32 v30, v60, v61
    v_cvt_pk_bf16_f32 v31, v62, v63
    v_cvt_pk_bf16_f32 v32, v64, v65
    v_cvt_pk_bf16_f32 v33, v66, v67
    v_cvt_pk_bf16_f32 v34, v68, v69
    v_cvt_pk_bf16_f32 v35, v70, v71
    v_cvt_pk_bf16_f32 v36, v72, v73
    v_cvt_pk_bf16_f32 v37, v74, v75
    v_cvt_pk_bf16_f32 v38, v76, v77
    v_cvt_pk_bf16_f32 v39, v78, v79
    v_cvt_pk_bf16_f32 v40, v80, v81
    v_cvt_pk_bf16_f32 v41, v82, v83
    v_cvt_pk_bf16_f32 v42, v84, v85
    v_cvt_pk_bf16_f32 v43, v86, v87
    v_cvt_pk_bf16_f32 v44, v88, v89
    v_cvt_pk_bf16_f32 v45, v90, v91
    v_cvt_pk_bf16_f32 v46, v92, v93
    v_cvt_pk_bf16_f32 v47, v94, v95
    v_cvt_pk_bf16_f32 v48, v96, v97
    v_cvt_pk_bf16_f32 v49, v98, v99
    v_cvt_pk_bf16_f32 v50, v100, v101
    v_cvt_pk_bf16_f32 v51, v102, v103
    v_cvt_pk_bf16_f32 v52, v104, v105
    v_cvt_pk_bf16_f32 v53, v106, v107
    v_cvt_pk_bf16_f32 v54, v108, v109
    v_cvt_pk_bf16_f32 v55, v110, v111
    v_cvt_pk_bf16_f32 v56, v112, v113
    v_cvt_pk_bf16_f32 v57, v114, v115
    v_cvt_pk_bf16_f32 v58, v116, v117
    v_cvt_pk_bf16_f32 v59, v118, v119
    v_cvt_pk_bf16_f32 v60, v120, v121
    v_cvt_pk_bf16_f32 v61, v122, v123
    v_cvt_pk_bf16_f32 v62, v124, v125
    v_cvt_pk_bf16_f32 v63, v126, v127
    s_waitcnt lgkmcnt(6)
    v_mfma_f32_32x32x16_bf16 v[64:79], a[128:131], v[0:3], 0
    s_add_u32 m0, s72, 98304
    v_mov_b32 v220, 0
    v_mov_b32 v221, 0
    v_mov_b32 v222, 0
    v_mfma_f32_32x32x16_bf16 v[80:95], a[128:131], v[8:11], 0
    buffer_load_dwordx4 v254, s[52:55], s82 offen lds
    v_mov_b32 v223, 0
    v_accvgpr_read_b32 v228, a210
    v_accvgpr_read_b32 v229, a211
    v_mfma_f32_32x32x16_bf16 v[64:79], a[132:135], v[4:7], v[64:79]
    buffer_load_dwordx4 v254, s[52:55], s82 offen offset:1024 lds
    s_add_u32 s82, s82, 8192
    s_and_b32 s82, s82, 0x1ffff
    v_accvgpr_read_b32 v230, a212
    v_mfma_f32_32x32x16_bf16 v[80:95], a[132:135], v[12:15], v[80:95]
    buffer_load_dwordx4 v255, s[56:59], s83 offen offset:2048 lds
    v_accvgpr_read_b32 v231, a213
    v_accvgpr_read_b32 v232, a214
    s_waitcnt lgkmcnt(4)
    v_mfma_f32_32x32x16_bf16 v[64:79], a[136:139], v[16:19], v[64:79]
    buffer_load_dwordx4 v255, s[56:59], s83 offen offset:3072 lds
    s_add_u32 s83, s83, 8192
    s_and_b32 s83, s83, 0x1ffff
    v_accvgpr_read_b32 v233, a205
    v_mfma_f32_32x32x16_bf16 v[80:95], a[136:139], v[24:27], v[80:95]
    v_accvgpr_read_b32 v234, a206
    v_accvgpr_read_b32 v235, a207
    v_accvgpr_read_b32 v236, a208
    v_accvgpr_read_b32 v237, a209
    v_add_u32 v238, 0x1000, v245
    v_lshrrev_b32 v194, 1, v245
    v_mfma_f32_32x32x16_bf16 v[64:79], a[140:143], v[20:23], v[64:79]
    v_accvgpr_read_b32 v195, a215
    s_lshl_b32 s80, s67, 4
    s_lshl_b32 s81, s64, 2
    s_add_u32 s80, s80, s81
    s_lshl_b32 s80, s80, 17
    s_lshl_b32 s81, s66, 12
    v_mfma_f32_32x32x16_bf16 v[80:95], a[140:143], v[28:31], v[80:95]
    s_barrier
    s_add_u32 m0, s72, 114688
    s_add_u32 s80, s80, s81
    s_add_u32 s46, s80, 33554432
    s_add_u32 s47, s46, 0x40000
    s_waitcnt lgkmcnt(2)
    v_mfma_f32_32x32x16_bf16 v[64:79], a[144:147], v[32:35], v[64:79]
    ds_read_b128 a[128:131], v208 offset:49152
    s_lshl_b32 s48, s67, 5
    s_add_u32 s48, s48, s66
    s_lshl_b32 s80, s67, 14
    s_lshl_b32 s81, s64, 12
    s_add_u32 s80, s80, s81
    v_mfma_f32_32x32x16_bf16 v[80:95], a[144:147], v[40:43], v[80:95]
    buffer_load_dwordx4 v254, s[52:55], s82 offen lds
    s_lshl_b32 s81, s66, 7
    s_add_u32 s80, s80, s81
    s_add_u32 s49, s80, 3670016
    v_mfma_f32_32x32x16_bf16 v[64:79], a[148:151], v[36:39], v[64:79]
    ds_read_b128 a[132:135], v209 offset:49152
    s_and_b32 s77, s2, 1
    s_lshl_b32 s77, s77, 9
    s_add_u32 s77, s77, 394240
    s_mov_b32 s36, s12
    s_mov_b32 s37, s13
    v_mfma_f32_32x32x16_bf16 v[80:95], a[148:151], v[44:47], v[80:95]
    buffer_load_dwordx4 v254, s[52:55], s82 offen offset:1024 lds
    s_add_u32 s82, s82, 8192
    s_and_b32 s82, s82, 0x1ffff
    s_waitcnt lgkmcnt(2)
    v_mfma_f32_32x32x16_bf16 v[64:79], a[152:155], v[48:51], v[64:79]
    ds_read_b128 a[136:139], v210 offset:49152
    s_mov_b32 s38, 0x500000
    s_mov_b32 s39, 0x20000
    s_lshr_b32 s70, s2, 1
    s_and_b32 s73, s2, 1
    s_mul_i32 s76, s70, 40960
    v_mfma_f32_32x32x16_bf16 v[80:95], a[152:155], v[56:59], v[80:95]
    buffer_load_dwordx4 v255, s[56:59], s83 offen offset:2048 lds
    s_mul_i32 s74, s73, 640
    s_add_u32 s76, s76, s74
    s_lshl_b32 s75, s64, 10
    v_mfma_f32_32x32x16_bf16 v[64:79], a[156:159], v[52:55], v[64:79]
    ds_read_b128 a[140:143], v211 offset:49152
    s_add_u32 s75, s75, 140800
    v_mfma_f32_32x32x16_bf16 v[80:95], a[156:159], v[60:63], v[80:95]
    buffer_load_dwordx4 v255, s[56:59], s83 offen offset:3072 lds
    s_add_u32 s83, s83, 8192
    s_and_b32 s83, s83, 0x1ffff
    s_nop 5
    v_max3_f32 v224, v64, v65, v66
    v_max3_f32 v224, v224, v67, v68
    v_max3_f32 v224, v224, v69, v70
    v_max3_f32 v224, v224, v71, v72
    v_max3_f32 v224, v224, v73, v74
    v_max3_f32 v224, v224, v75, v76
    v_max3_f32 v224, v224, v77, v78
    v_max_f32 v224, v224, v79
    v_mov_b32 v225, v224
    v_max3_f32 v226, v80, v81, v82
    v_max3_f32 v226, v226, v83, v84
    v_max3_f32 v226, v226, v85, v86
    v_max3_f32 v226, v226, v87, v88
    v_max3_f32 v226, v226, v89, v90
    v_max3_f32 v226, v226, v91, v92
    v_max3_f32 v226, v226, v93, v94
    v_max_f32 v226, v226, v95
    v_mov_b32 v227, v226
    v_permlane32_swap_b32 v224, v225
    s_nop 0
    v_permlane32_swap_b32 v226, v227
    v_max_f32 v224, v224, v225
    v_max_f32 v226, v226, v227
    v_add_f32 v224, 0x42200000, v224
    v_sub_f32 v225, 0, v224
    v_pk_mov_b32 v[128:129], v[224:225], v[224:225] op_sel:[1,1]
    v_pk_mov_b32 v[130:131], v[224:225], v[224:225] op_sel:[1,1]
    v_pk_mov_b32 v[132:133], v[224:225], v[224:225] op_sel:[1,1]
    v_pk_mov_b32 v[134:135], v[224:225], v[224:225] op_sel:[1,1]
    v_pk_mov_b32 v[136:137], v[224:225], v[224:225] op_sel:[1,1]
    v_pk_mov_b32 v[138:139], v[224:225], v[224:225] op_sel:[1,1]
    v_pk_mov_b32 v[140:141], v[224:225], v[224:225] op_sel:[1,1]
    v_pk_mov_b32 v[142:143], v[224:225], v[224:225] op_sel:[1,1]
    v_add_f32 v226, 0x42200000, v226
    v_sub_f32 v227, 0, v226
    v_pk_mov_b32 v[144:145], v[226:227], v[226:227] op_sel:[1,1]
    v_pk_mov_b32 v[146:147], v[226:227], v[226:227] op_sel:[1,1]
    v_pk_mov_b32 v[148:149], v[226:227], v[226:227] op_sel:[1,1]
    v_pk_mov_b32 v[150:151], v[226:227], v[226:227] op_sel:[1,1]
    v_pk_mov_b32 v[152:153], v[226:227], v[226:227] op_sel:[1,1]
    v_pk_mov_b32 v[154:155], v[226:227], v[226:227] op_sel:[1,1]
    v_pk_mov_b32 v[156:157], v[226:227], v[226:227] op_sel:[1,1]
    v_pk_mov_b32 v[158:159], v[226:227], v[226:227] op_sel:[1,1]
    s_waitcnt lgkmcnt(2)
    v_mfma_f32_32x32x16_bf16 v[96:111], a[128:131], v[0:3], v[128:143]
    s_add_u32 m0, s72, 16384
    ds_read_b128 a[144:147], v212 offset:49152
    v_sub_f32 v64, v64, v224
    v_sub_f32 v65, v65, v224
    v_sub_f32 v66, v66, v224
    v_sub_f32 v67, v67, v224
    v_mfma_f32_32x32x16_bf16 v[112:127], a[128:131], v[8:11], v[144:159]
    ds_read_b128 a[148:151], v213 offset:49152
    v_sub_f32 v68, v68, v224
    v_sub_f32 v69, v69, v224
    v_sub_f32 v70, v70, v224
    v_sub_f32 v71, v71, v224
    v_sub_f32 v80, v80, v226
    v_mfma_f32_32x32x16_bf16 v[96:111], a[132:135], v[4:7], v[96:111]
    ds_read_b128 a[152:155], v214 offset:49152
    v_sub_f32 v81, v81, v226
    v_sub_f32 v82, v82, v226
    v_sub_f32 v83, v83, v226
    v_sub_f32 v84, v84, v226
    v_sub_f32 v85, v85, v226
    v_mfma_f32_32x32x16_bf16 v[112:127], a[132:135], v[12:15], v[112:127]
    buffer_load_dwordx4 v254, s[52:55], s82 offen lds
    ds_read_b128 a[156:159], v215 offset:49152
    v_sub_f32 v86, v86, v226
    s_waitcnt lgkmcnt(4)
    v_mfma_f32_32x32x16_bf16 v[96:111], a[136:139], v[16:19], v[96:111]
    buffer_load_dwordx4 v254, s[52:55], s82 offen offset:1024 lds
    s_add_u32 s82, s82, 8192
    s_and_b32 s82, s82, 0x1ffff
    v_sub_f32 v87, v87, v226
    v_mfma_f32_32x32x16_bf16 v[112:127], a[136:139], v[24:27], v[112:127]
    buffer_load_dwordx4 v255, s[56:59], s83 offen offset:2048 lds
    v_add_u32 v208, 0x10000, v208
    v_add_u32 v209, 0x10000, v209
    v_add_u32 v210, 0x10000, v210
    v_mfma_f32_32x32x16_bf16 v[96:111], a[140:143], v[20:23], v[96:111]
    buffer_load_dwordx4 v255, s[56:59], s83 offen offset:3072 lds
    s_add_u32 s83, s83, 8192
    s_and_b32 s83, s83, 0x1ffff
    v_add_u32 v211, 0x10000, v211
    v_mfma_f32_32x32x16_bf16 v[112:127], a[140:143], v[28:31], v[112:127]
    s_waitcnt vmcnt(16)
    s_barrier
    s_add_u32 m0, s72, 32768
    v_add_u32 v212, 0x10000, v212
    v_add_u32 v213, 0x10000, v213
    v_add_u32 v214, 0x10000, v214
    v_add_u32 v215, 0x10000, v215
    s_waitcnt lgkmcnt(2)
    v_mfma_f32_32x32x16_bf16 v[96:111], a[144:147], v[32:35], v[96:111]
    ds_read_b128 a[128:131], v208 offset:0
    v_sub_f32 v72, v72, v224
    v_sub_f32 v73, v73, v224
    v_sub_f32 v74, v74, v224
    v_sub_f32 v75, v75, v224
    v_sub_f32 v76, v76, v224
    v_mfma_f32_32x32x16_bf16 v[112:127], a[144:147], v[40:43], v[112:127]
    buffer_load_dwordx4 v254, s[52:55], s82 offen lds
    v_sub_f32 v77, v77, v224
    v_sub_f32 v78, v78, v224
    v_sub_f32 v79, v79, v224
    v_mfma_f32_32x32x16_bf16 v[96:111], a[148:151], v[36:39], v[96:111]
    ds_read_b128 a[132:135], v209 offset:0
    v_sub_f32 v88, v88, v226
    v_sub_f32 v89, v89, v226
    v_sub_f32 v90, v90, v226
    v_sub_f32 v91, v91, v226
    v_sub_f32 v92, v92, v226
    v_mfma_f32_32x32x16_bf16 v[112:127], a[148:151], v[44:47], v[112:127]
    buffer_load_dwordx4 v254, s[52:55], s82 offen offset:1024 lds
    s_add_u32 s82, s82, 8192
    s_and_b32 s82, s82, 0x1ffff
    s_waitcnt lgkmcnt(2)
    v_mfma_f32_32x32x16_bf16 v[96:111], a[152:155], v[48:51], v[96:111]
    ds_read_b128 a[136:139], v210 offset:0
    v_sub_f32 v93, v93, v226
    v_sub_f32 v94, v94, v226
    v_sub_f32 v95, v95, v226
    v_add_u32 v216, 0x10000, v216
    v_add_u32 v217, 0x10000, v217
    v_mfma_f32_32x32x16_bf16 v[112:127], a[152:155], v[56:59], v[112:127]
    buffer_load_dwordx4 v255, s[56:59], s83 offen offset:2048 lds
    v_add_u32 v218, 0x10000, v218
    v_add_u32 v219, 0x10000, v219
    v_mfma_f32_32x32x16_bf16 v[96:111], a[156:159], v[52:55], v[96:111]
    ds_read_b128 a[140:143], v211 offset:0
    v_exp_f32 v64, v64
    v_exp_f32 v65, v65
    v_mfma_f32_32x32x16_bf16 v[112:127], a[156:159], v[60:63], v[112:127]
    buffer_load_dwordx4 v255, s[56:59], s83 offen offset:3072 lds
    s_add_u32 s83, s83, 8192
    s_and_b32 s83, s83, 0x1ffff
    v_exp_f32 v66, v66
    v_exp_f32 v67, v67
    v_add_f32 v220, v220, v64
    v_add_f32 v221, v221, v65
    v_cvt_pk_bf16_f32 v160, v64, v65
    v_exp_f32 v68, v68
    v_exp_f32 v69, v69
    v_add_f32 v220, v220, v66
    v_add_f32 v221, v221, v67
    v_cvt_pk_bf16_f32 v161, v66, v67
    v_exp_f32 v70, v70
    v_exp_f32 v71, v71
    v_add_f32 v220, v220, v68
    v_add_f32 v221, v221, v69
    v_cvt_pk_bf16_f32 v162, v68, v69
    v_exp_f32 v80, v80
    v_exp_f32 v81, v81
    v_add_f32 v220, v220, v70
    v_add_f32 v221, v221, v71
    v_cvt_pk_bf16_f32 v163, v70, v71
    v_exp_f32 v82, v82
    v_exp_f32 v83, v83
    v_add_f32 v222, v222, v80
    v_add_f32 v223, v223, v81
    v_cvt_pk_bf16_f32 v168, v80, v81
    v_exp_f32 v84, v84
    v_exp_f32 v85, v85
    v_add_f32 v222, v222, v82
    v_add_f32 v223, v223, v83
    v_cvt_pk_bf16_f32 v169, v82, v83
    v_exp_f32 v86, v86
    v_exp_f32 v87, v87
    v_add_f32 v222, v222, v84
    v_add_f32 v223, v223, v85
    v_cvt_pk_bf16_f32 v170, v84, v85
    v_exp_f32 v72, v72
    v_exp_f32 v73, v73
    v_add_f32 v222, v222, v86
    v_add_f32 v223, v223, v87
    v_cvt_pk_bf16_f32 v171, v86, v87
    v_exp_f32 v74, v74
    v_exp_f32 v75, v75
    v_add_f32 v220, v220, v72
    v_add_f32 v221, v221, v73
    v_cvt_pk_bf16_f32 v164, v72, v73
    v_exp_f32 v76, v76
    v_exp_f32 v77, v77
    v_add_f32 v220, v220, v74
    v_add_f32 v221, v221, v75
    v_cvt_pk_bf16_f32 v165, v74, v75
    v_exp_f32 v78, v78
    v_exp_f32 v79, v79
    v_add_f32 v220, v220, v76
    v_add_f32 v221, v221, v77
    v_cvt_pk_bf16_f32 v166, v76, v77
    v_exp_f32 v88, v88
    v_exp_f32 v89, v89
    v_add_f32 v220, v220, v78
    v_add_f32 v221, v221, v79
    v_cvt_pk_bf16_f32 v167, v78, v79
    v_exp_f32 v90, v90
    v_exp_f32 v91, v91
    v_add_f32 v222, v222, v88
    v_add_f32 v223, v223, v89
    v_cvt_pk_bf16_f32 v172, v88, v89
    v_exp_f32 v92, v92
    v_exp_f32 v93, v93
    v_add_f32 v222, v222, v90
    v_add_f32 v223, v223, v91
    v_cvt_pk_bf16_f32 v173, v90, v91
    v_exp_f32 v94, v94
    v_exp_f32 v95, v95
    v_add_f32 v222, v222, v92
    v_add_f32 v223, v223, v93
    v_cvt_pk_bf16_f32 v174, v92, v93
    v_add_f32 v222, v222, v94
    v_add_f32 v223, v223, v95
    v_cvt_pk_bf16_f32 v175, v94, v95
    s_waitcnt lgkmcnt(2)
    v_mfma_f32_32x32x16_bf16 v[64:79], a[128:131], v[0:3], v[128:143]
    ds_read_b128 a[144:147], v212 offset:0
    v_exp_f32 v96, v96
    v_exp_f32 v97, v97
    v_mfma_f32_32x32x16_bf16 v[80:95], a[128:131], v[8:11], v[144:159]
    v_exp_f32 v98, v98
    v_exp_f32 v99, v99
    v_add_f32 v220, v220, v96
    v_add_f32 v221, v221, v97
    v_mfma_f32_32x32x16_bf16 v[64:79], a[132:135], v[4:7], v[64:79]
    ds_read_b128 a[148:151], v213 offset:0
    v_cvt_pk_bf16_f32 v176, v96, v97
    v_exp_f32 v100, v100
    v_exp_f32 v101, v101
    v_mfma_f32_32x32x16_bf16 v[80:95], a[132:135], v[12:15], v[80:95]
    s_add_u32 m0, s75, 0
    s_nop 0
    buffer_load_dwordx4 v233, s[36:39], s76 offen lds
    s_waitcnt lgkmcnt(2)
    v_mfma_f32_32x32x16_bf16 v[64:79], a[136:139], v[16:19], v[64:79]
    ds_read_b128 a[152:155], v214 offset:0
    v_add_f32 v220, v220, v98
    v_add_f32 v221, v221, v99
    v_cvt_pk_bf16_f32 v177, v98, v99
    s_lshr_b32 s80, s2, 3
    v_mfma_f32_32x32x16_bf16 v[80:95], a[136:139], v[24:27], v[80:95]
    v_exp_f32 v102, v102
    v_exp_f32 v103, v103
    v_add_f32 v220, v220, v100
    s_lshl_b32 s80, s80, 21
    v_mfma_f32_32x32x16_bf16 v[64:79], a[140:143], v[20:23], v[64:79]
    ds_read_b128 a[156:159], v215 offset:0
    v_add_f32 v221, v221, v101
    v_cvt_pk_bf16_f32 v178, v100, v101
    v_exp_f32 v112, v112
    v_mfma_f32_32x32x16_bf16 v[80:95], a[140:143], v[28:31], v[80:95]
    v_exp_f32 v113, v113
    v_add_f32 v220, v220, v102
    v_add_f32 v221, v221, v103
    v_cvt_pk_bf16_f32 v179, v102, v103
    s_waitcnt lgkmcnt(2)
    v_mfma_f32_32x32x16_bf16 v[64:79], a[144:147], v[32:35], v[64:79]
    ds_read_b64_tr_b16 a[160:161], v216 offset:0
    ds_read_b64_tr_b16 a[162:163], v216 offset:4096
    v_exp_f32 v114, v114
    v_exp_f32 v115, v115
    v_mfma_f32_32x32x16_bf16 v[80:95], a[144:147], v[40:43], v[80:95]
    s_add_u32 m0, s75, 4096
    s_nop 0
    buffer_load_dwordx4 v234, s[36:39], s76 offen lds
    v_add_f32 v222, v222, v112
    v_mfma_f32_32x32x16_bf16 v[64:79], a[148:151], v[36:39], v[64:79]
    ds_read_b64_tr_b16 a[164:165], v217 offset:0
    ds_read_b64_tr_b16 a[166:167], v217 offset:4096
    v_add_f32 v223, v223, v113
    v_cvt_pk_bf16_f32 v184, v112, v113
    v_mov_b32 v240, 0
    v_mfma_f32_32x32x16_bf16 v[80:95], a[148:151], v[44:47], v[80:95]
    v_exp_f32 v116, v116
    v_exp_f32 v117, v117
    v_add_f32 v222, v222, v114
    s_waitcnt lgkmcnt(4)
    v_mfma_f32_32x32x16_bf16 v[64:79], a[152:155], v[48:51], v[64:79]
    ds_read_b64_tr_b16 a[168:169], v218 offset:0
    ds_read_b64_tr_b16 a[170:171], v218 offset:4096
    v_add_f32 v223, v223, v115
    v_cvt_pk_bf16_f32 v185, v114, v115
    v_exp_f32 v118, v118
    v_mfma_f32_32x32x16_bf16 v[80:95], a[152:155], v[56:59], v[80:95]
    v_exp_f32 v119, v119
    v_add_f32 v222, v222, v116
    v_add_f32 v223, v223, v117
    v_cvt_pk_bf16_f32 v186, v116, v117
    v_mfma_f32_32x32x16_bf16 v[64:79], a[156:159], v[52:55], v[64:79]
    ds_read_b64_tr_b16 a[172:173], v219 offset:0
    ds_read_b64_tr_b16 a[174:175], v219 offset:4096
    v_exp_f32 v104, v104
    v_exp_f32 v105, v105
    v_mfma_f32_32x32x16_bf16 v[80:95], a[156:159], v[60:63], v[80:95]
    s_add_u32 m0, s75, 8192
    s_nop 0
    buffer_load_dwordx4 v235, s[36:39], s76 offen lds
    s_waitcnt lgkmcnt(4)
    v_mfma_f32_32x32x16_bf16 a[0:15], a[160:163], v[160:163], 0
    ds_read_b64_tr_b16 a[176:177], v216 offset:8192
    ds_read_b64_tr_b16 a[178:179], v216 offset:12288
    buffer_load_dword v207, v240, s[32:35], s80 offen sc1
    v_add_f32 v222, v222, v118
    v_mfma_f32_32x32x16_bf16 a[16:31], a[160:163], v[168:171], 0
    v_add_f32 v223, v223, v119
    v_cvt_pk_bf16_f32 v187, v118, v119
    v_exp_f32 v106, v106
    s_min_u32 s80, s80, 2621436
    v_mfma_f32_32x32x16_bf16 a[32:47], a[164:167], v[160:163], 0
    ds_read_b64_tr_b16 a[180:181], v217 offset:8192
    ds_read_b64_tr_b16 a[182:183], v217 offset:12288
    v_exp_f32 v107, v107
    v_add_f32 v220, v220, v104
    v_mov_b32 v240, s80
    v_mfma_f32_32x32x16_bf16 a[48:63], a[164:167], v[168:171], 0
    v_add_f32 v221, v221, v105
    v_cvt_pk_bf16_f32 v180, v104, v105
    v_exp_f32 v108, v108
    s_waitcnt lgkmcnt(4)
    v_mfma_f32_32x32x16_bf16 a[64:79], a[168:171], v[160:163], 0
    ds_read_b64_tr_b16 a[184:185], v218 offset:8192
    ds_read_b64_tr_b16 a[186:187], v218 offset:12288
    v_exp_f32 v109, v109
    v_add_f32 v220, v220, v106
    v_add_f32 v221, v221, v107
    v_mfma_f32_32x32x16_bf16 a[80:95], a[168:171], v[168:171], 0
    v_cvt_pk_bf16_f32 v181, v106, v107
    v_exp_f32 v110, v110
    v_exp_f32 v111, v111
    v_add_f32 v220, v220, v108
    v_mfma_f32_32x32x16_bf16 a[96:111], a[172:175], v[160:163], 0
    ds_read_b64_tr_b16 a[188:189], v219 offset:8192
    ds_read_b64_tr_b16 a[190:191], v219 offset:12288
    v_add_f32 v221, v221, v109
    v_cvt_pk_bf16_f32 v182, v108, v109
    v_exp_f32 v120, v120
    v_mfma_f32_32x32x16_bf16 a[112:127], a[172:175], v[168:171], 0
    s_waitcnt vmcnt(20)
    s_barrier
    s_add_u32 m0, s72, 49152
    global_load_dword v207, v240, s[26:27] sc1
    s_waitcnt lgkmcnt(4)
    v_mfma_f32_32x32x16_bf16 a[0:15], a[176:179], v[164:167], a[0:15]
    ds_read_b128 a[128:131], v208 offset:16384
    s_mul_i32 s24, s2, 1214
    s_lshr_b32 s24, s24, 16
    s_mul_i32 s25, s24, 54
    s_sub_u32 s25, s2, s25
    v_mfma_f32_32x32x16_bf16 a[16:31], a[176:179], v[172:175], a[16:31]
    buffer_load_dwordx4 v254, s[52:55], s82 offen lds
    v_exp_f32 v121, v121
    s_mov_b32 s81, 399360
    v_mfma_f32_32x32x16_bf16 a[32:47], a[180:183], v[164:167], a[32:47]
    ds_read_b128 a[132:135], v209 offset:16384
    v_add_f32 v220, v220, v110
    v_add_f32 v221, v221, v111
    v_cvt_pk_bf16_f32 v183, v110, v111
    v_exp_f32 v122, v122
    v_mfma_f32_32x32x16_bf16 a[48:63], a[180:183], v[172:175], a[48:63]
    buffer_load_dwordx4 v254, s[52:55], s82 offen offset:1024 lds
    s_add_u32 s82, s82, 8192
    s_and_b32 s82, s82, 0x1ffff
    s_waitcnt lgkmcnt(2)
    v_mfma_f32_32x32x16_bf16 a[64:79], a[184:187], v[164:167], a[64:79]
    ds_read_b128 a[136:139], v210 offset:16384
    buffer_load_dwordx4 v[196:199], v245, s[32:35], s81 offen sc1
    s_mul_i32 s80, s22, 320
    v_mfma_f32_32x32x16_bf16 a[80:95], a[184:187], v[172:175], a[80:95]
    buffer_load_dwordx4 v255, s[56:59], s83 offen offset:2048 lds
    v_exp_f32 v123, v123
    s_add_u32 s80, s80, 5120
    v_mfma_f32_32x32x16_bf16 a[96:111], a[188:191], v[164:167], a[96:111]
    ds_read_b128 a[140:143], v211 offset:16384
    v_add_f32 v222, v222, v120
    v_add_f32 v223, v223, v121
    v_cvt_pk_bf16_f32 v188, v120, v121
    v_mul_u32_u24 v239, 205, v195
    v_mfma_f32_32x32x16_bf16 a[112:127], a[188:191], v[172:175], a[112:127]
    buffer_load_dwordx4 v255, s[56:59], s83 offen offset:3072 lds
    s_add_u32 s83, s83, 8192
    s_and_b32 s83, s83, 0x1ffff
    v_exp_f32 v124, v124
    v_exp_f32 v125, v125
    v_add_f32 v222, v222, v122
    v_add_f32 v223, v223, v123
    v_cvt_pk_bf16_f32 v189, v122, v123
    v_exp_f32 v126, v126
    v_exp_f32 v127, v127
    v_add_f32 v222, v222, v124
    v_add_f32 v223, v223, v125
    v_cvt_pk_bf16_f32 v190, v124, v125
    v_add_f32 v222, v222, v126
    v_add_f32 v223, v223, v127
    v_cvt_pk_bf16_f32 v191, v126, v127
    v_lshrrev_b32 v239, 14, v239
    s_waitcnt lgkmcnt(2)
    v_mfma_f32_32x32x16_bf16 v[96:111], a[128:131], v[0:3], v[128:143]
    ds_read_b128 a[144:147], v212 offset:16384
    v_exp_f32 v64, v64
    v_exp_f32 v65, v65
    v_mfma_f32_32x32x16_bf16 v[112:127], a[128:131], v[8:11], v[144:159]
    v_exp_f32 v66, v66
    v_exp_f32 v67, v67
    v_add_f32 v220, v220, v64
    v_add_f32 v221, v221, v65
    v_mfma_f32_32x32x16_bf16 v[96:111], a[132:135], v[4:7], v[96:111]
    ds_read_b128 a[148:151], v213 offset:16384
    v_cvt_pk_bf16_f32 v160, v64, v65
    v_exp_f32 v68, v68
    v_exp_f32 v69, v69
    v_mfma_f32_32x32x16_bf16 v[112:127], a[132:135], v[12:15], v[112:127]
    s_add_u32 m0, s75, 12288
    s_nop 0
    buffer_load_dwordx4 v236, s[36:39], s76 offen lds
    s_waitcnt lgkmcnt(2)
    v_mfma_f32_32x32x16_bf16 v[96:111], a[136:139], v[16:19], v[96:111]
    ds_read_b128 a[152:155], v214 offset:16384
    v_add_f32 v220, v220, v66
    v_add_f32 v221, v221, v67
    v_cvt_pk_bf16_f32 v161, v66, v67
    v_mul_u32_u24 v240, 1200, v239
    v_mfma_f32_32x32x16_bf16 v[112:127], a[136:139], v[24:27], v[112:127]
    v_exp_f32 v70, v70
    v_exp_f32 v71, v71
    v_add_f32 v220, v220, v68
    v_lshrrev_b32 v241, 1, v239
    v_mfma_f32_32x32x16_bf16 v[96:111], a[140:143], v[20:23], v[96:111]
    ds_read_b128 a[156:159], v215 offset:16384
    v_add_f32 v221, v221, v69
    v_cvt_pk_bf16_f32 v162, v68, v69
    v_exp_f32 v80, v80
    v_mfma_f32_32x32x16_bf16 v[112:127], a[140:143], v[28:31], v[112:127]
    v_exp_f32 v81, v81
    v_add_f32 v220, v220, v70
    v_add_f32 v221, v221, v71
    v_cvt_pk_bf16_f32 v163, v70, v71
    s_waitcnt lgkmcnt(2)
    v_mfma_f32_32x32x16_bf16 v[96:111], a[144:147], v[32:35], v[96:111]
    ds_read_b64_tr_b16 a[160:161], v216 offset:16384
    ds_read_b64_tr_b16 a[162:163], v216 offset:20480
    v_exp_f32 v82, v82
    v_exp_f32 v83, v83
    v_mfma_f32_32x32x16_bf16 v[112:127], a[144:147], v[40:43], v[112:127]
    s_add_u32 m0, s75, 16384
    s_nop 0
    buffer_load_dwordx4 v237, s[36:39], s76 offen lds
    v_add_f32 v222, v222, v80
    v_mfma_f32_32x32x16_bf16 v[96:111], a[148:151], v[36:39], v[96:111]
    ds_read_b64_tr_b16 a[164:165], v217 offset:16384
    ds_read_b64_tr_b16 a[166:167], v217 offset:20480
    v_add_f32 v223, v223, v81
    v_cvt_pk_bf16_f32 v168, v80, v81
    s_lshl_b32 s79, s73, 7
    v_mfma_f32_32x32x16_bf16 v[112:127], a[148:151], v[44:47], v[112:127]
    v_exp_f32 v84, v84
    v_exp_f32 v85, v85
    s_add_u32 s79, s79, s70
    s_waitcnt lgkmcnt(4)
    v_mfma_f32_32x32x16_bf16 v[96:111], a[152:155], v[48:51], v[96:111]
    ds_read_b64_tr_b16 a[168:169], v218 offset:16384
    ds_read_b64_tr_b16 a[170:171], v218 offset:20480
    v_add_f32 v222, v222, v82
    v_add_f32 v223, v223, v83
    v_cvt_pk_bf16_f32 v169, v82, v83
    s_lshl_b32 s74, s73, 2
    v_mfma_f32_32x32x16_bf16 v[112:127], a[152:155], v[56:59], v[112:127]
    v_exp_f32 v86, v86
    v_exp_f32 v87, v87
    v_add_f32 v222, v222, v84
    s_add_u32 s74, s74, s64
    v_mfma_f32_32x32x16_bf16 v[96:111], a[156:159], v[52:55], v[96:111]
    ds_read_b64_tr_b16 a[172:173], v219 offset:16384
    ds_read_b64_tr_b16 a[174:175], v219 offset:20480
    v_add_f32 v223, v223, v85
    v_cvt_pk_bf16_f32 v170, v84, v85
    s_lshl_b32 s78, s74, 7
    v_mfma_f32_32x32x16_bf16 v[112:127], a[156:159], v[60:63], v[112:127]
    v_exp_f32 v72, v72
    v_exp_f32 v73, v73
    s_add_u32 s78, s78, s70
    s_waitcnt lgkmcnt(4)
    v_mfma_f32_32x32x16_bf16 a[0:15], a[160:163], v[176:179], a[0:15]
    ds_read_b64_tr_b16 a[176:177], v216 offset:24576
    ds_read_b64_tr_b16 a[178:179], v216 offset:28672
    v_add_f32 v222, v222, v86
    v_add_f32 v223, v223, v87
    v_cvt_pk_bf16_f32 v171, v86, v87
    s_mul_i32 s78, s78, 5120
    v_mfma_f32_32x32x16_bf16 a[16:31], a[160:163], v[184:187], a[16:31]
    v_exp_f32 v74, v74
    v_exp_f32 v75, v75
    v_add_f32 v220, v220, v72
    s_add_u32 s78, s78, 10485760
    v_mfma_f32_32x32x16_bf16 a[32:47], a[164:167], v[176:179], a[32:47]
    ds_read_b64_tr_b16 a[180:181], v217 offset:24576
    ds_read_b64_tr_b16 a[182:183], v217 offset:28672
    v_add_f32 v221, v221, v73
    v_cvt_pk_bf16_f32 v164, v72, v73
    s_mul_i32 s69, s74, 54
    v_mfma_f32_32x32x16_bf16 a[48:63], a[164:167], v[184:187], a[48:63]
    v_exp_f32 v76, v76
    v_exp_f32 v77, v77
    s_add_u32 s69, s69, s70
    s_waitcnt lgkmcnt(4)
    v_mfma_f32_32x32x16_bf16 a[64:79], a[168:171], v[176:179], a[64:79]
    ds_read_b64_tr_b16 a[184:185], v218 offset:24576
    ds_read_b64_tr_b16 a[186:187], v218 offset:28672
    v_add_f32 v220, v220, v74
    v_add_f32 v221, v221, v75
    v_cvt_pk_bf16_f32 v165, v74, v75
    s_mul_i32 s69, s69, 5120
    v_mfma_f32_32x32x16_bf16 a[80:95], a[168:171], v[184:187], a[80:95]
    v_exp_f32 v78, v78
    v_exp_f32 v79, v79
    v_add_f32 v220, v220, v76
    s_add_u32 s69, s69, 15728640
    v_mfma_f32_32x32x16_bf16 a[96:111], a[172:175], v[176:179], a[96:111]
    ds_read_b64_tr_b16 a[188:189], v219 offset:24576
    ds_read_b64_tr_b16 a[190:191], v219 offset:28672
    v_add_f32 v221, v221, v77
    v_cvt_pk_bf16_f32 v166, v76, v77
    v_exp_f32 v88, v88
    v_mfma_f32_32x32x16_bf16 a[112:127], a[172:175], v[184:187], a[112:127]
    s_waitcnt vmcnt(24)
    s_barrier
    s_add_u32 m0, s72, 65536
    s_cmp_lt_u32 s2, 108
    s_cselect_b32 s69, s69, 0x7fff0000
    s_mov_b32 s36, s20
    s_waitcnt lgkmcnt(4)
    v_mfma_f32_32x32x16_bf16 a[0:15], a[176:179], v[180:183], a[0:15]
    ds_read_b128 a[128:131], v208 offset:32768
    v_exp_f32 v89, v89
    v_add_f32 v220, v220, v78
    v_add_f32 v221, v221, v79
    s_mov_b32 s37, s21
    v_mfma_f32_32x32x16_bf16 a[16:31], a[176:179], v[188:191], a[16:31]
    buffer_load_dwordx4 v254, s[52:55], s82 offen lds
    v_cvt_pk_bf16_f32 v167, v78, v79
    s_mov_b32 s38, 0x21c000
    v_mfma_f32_32x32x16_bf16 a[32:47], a[180:183], v[180:183], a[32:47]
    ds_read_b128 a[132:135], v209 offset:32768
    v_exp_f32 v90, v90
    v_exp_f32 v91, v91
    s_mov_b32 s39, 0x20000
    v_mfma_f32_32x32x16_bf16 a[48:63], a[180:183], v[188:191], a[48:63]
    buffer_load_dwordx4 v254, s[52:55], s82 offen offset:1024 lds
    s_add_u32 s82, s82, 8192
    s_and_b32 s82, s82, 0x1ffff
    s_waitcnt lgkmcnt(2)
    v_mfma_f32_32x32x16_bf16 a[64:79], a[184:187], v[180:183], a[64:79]
    ds_read_b128 a[136:139], v210 offset:32768
    v_add_f32 v222, v222, v88
    v_add_f32 v223, v223, v89
    v_cvt_pk_bf16_f32 v172, v88, v89
    v_mul_u32_u24 v241, 640, v241
    v_sub_u32 v240, v240, v241
    v_mfma_f32_32x32x16_bf16 a[80:95], a[184:187], v[188:191], a[80:95]
    buffer_load_dwordx4 v255, s[56:59], s83 offen offset:2048 lds
    v_exp_f32 v92, v92
    v_add_u32 v240, v240, v195
    v_mfma_f32_32x32x16_bf16 a[96:111], a[188:191], v[180:183], a[96:111]
    ds_read_b128 a[140:143], v211 offset:32768
    v_exp_f32 v93, v93
    v_add_f32 v222, v222, v90
    v_add_f32 v223, v223, v91
    v_lshlrev_b32 v240, 2, v240
    v_mfma_f32_32x32x16_bf16 a[112:127], a[188:191], v[188:191], a[112:127]
    buffer_load_dwordx4 v255, s[56:59], s83 offen offset:3072 lds
    s_add_u32 s83, s83, 8192
    s_and_b32 s83, s83, 0x1ffff
    v_cvt_pk_bf16_f32 v173, v90, v91
    v_exp_f32 v94, v94
    v_exp_f32 v95, v95
    v_add_f32 v222, v222, v92
    v_add_f32 v223, v223, v93
    v_cvt_pk_bf16_f32 v174, v92, v93
    v_add_f32 v222, v222, v94
    v_add_f32 v223, v223, v95
    v_cvt_pk_bf16_f32 v175, v94, v95
    v_lshlrev_b32 v241, 2, v195
    s_waitcnt lgkmcnt(2)
    v_mfma_f32_32x32x16_bf16 v[64:79], a[128:131], v[0:3], v[128:143]
    ds_read_b128 a[144:147], v212 offset:32768
    v_exp_f32 v96, v96
    v_exp_f32 v97, v97
    v_mfma_f32_32x32x16_bf16 v[80:95], a[128:131], v[8:11], v[144:159]
    v_exp_f32 v98, v98
    v_exp_f32 v99, v99
    v_add_f32 v220, v220, v96
    v_mfma_f32_32x32x16_bf16 v[64:79], a[132:135], v[4:7], v[64:79]
    ds_read_b128 a[148:151], v213 offset:32768
    v_add_f32 v221, v221, v97
    v_cvt_pk_bf16_f32 v176, v96, v97
    v_exp_f32 v100, v100
    v_mfma_f32_32x32x16_bf16 v[80:95], a[132:135], v[12:15], v[80:95]
    v_exp_f32 v101, v101
    v_add_f32 v220, v220, v98
    v_add_f32 v221, v221, v99
    s_waitcnt lgkmcnt(2)
    v_mfma_f32_32x32x16_bf16 v[64:79], a[136:139], v[16:19], v[64:79]
    ds_read_b128 a[152:155], v214 offset:32768
    v_cvt_pk_bf16_f32 v177, v98, v99
    v_exp_f32 v102, v102
    v_mfma_f32_32x32x16_bf16 v[80:95], a[136:139], v[24:27], v[80:95]
    v_exp_f32 v103, v103
    v_add_f32 v220, v220, v100
    v_add_f32 v221, v221, v101
    v_cvt_pk_bf16_f32 v178, v100, v101
    v_mfma_f32_32x32x16_bf16 v[64:79], a[140:143], v[20:23], v[64:79]
    ds_read_b128 a[156:159], v215 offset:32768
    v_exp_f32 v112, v112
    v_exp_f32 v113, v113
    v_mfma_f32_32x32x16_bf16 v[80:95], a[140:143], v[28:31], v[80:95]
    v_add_f32 v220, v220, v102
    v_add_f32 v221, v221, v103
    v_cvt_pk_bf16_f32 v179, v102, v103
    s_waitcnt lgkmcnt(2)
    v_mfma_f32_32x32x16_bf16 v[64:79], a[144:147], v[32:35], v[64:79]
    ds_read_b64_tr_b16 a[160:161], v216 offset:32768
    ds_read_b64_tr_b16 a[162:163], v216 offset:36864
    v_exp_f32 v114, v114
    v_exp_f32 v115, v115
    v_mfma_f32_32x32x16_bf16 v[80:95], a[144:147], v[40:43], v[80:95]
    v_add_f32 v222, v222, v112
    v_add_f32 v223, v223, v113
    v_cvt_pk_bf16_f32 v184, v112, v113
    v_exp_f32 v116, v116
    v_mfma_f32_32x32x16_bf16 v[64:79], a[148:151], v[36:39], v[64:79]
    ds_read_b64_tr_b16 a[164:165], v217 offset:32768
    ds_read_b64_tr_b16 a[166:167], v217 offset:36864
    v_exp_f32 v117, v117
    v_add_f32 v222, v222, v114
    v_mfma_f32_32x32x16_bf16 v[80:95], a[148:151], v[44:47], v[80:95]
    v_add_f32 v223, v223, v115
    v_cvt_pk_bf16_f32 v185, v114, v115
    v_exp_f32 v118, v118
    s_waitcnt lgkmcnt(4)
    v_mfma_f32_32x32x16_bf16 v[64:79], a[152:155], v[48:51], v[64:79]
    ds_read_b64_tr_b16 a[168:169], v218 offset:32768
    ds_read_b64_tr_b16 a[170:171], v218 offset:36864
    v_exp_f32 v119, v119
    v_add_f32 v222, v222, v116
    v_mfma_f32_32x32x16_bf16 v[80:95], a[152:155], v[56:59], v[80:95]
    v_add_f32 v223, v223, v117
    v_cvt_pk_bf16_f32 v186, v116, v117
    v_exp_f32 v104, v104
    v_mfma_f32_32x32x16_bf16 v[64:79], a[156:159], v[52:55], v[64:79]
    ds_read_b64_tr_b16 a[172:173], v219 offset:32768
    ds_read_b64_tr_b16 a[174:175], v219 offset:36864
    v_exp_f32 v105, v105
    v_add_f32 v222, v222, v118
    v_mfma_f32_32x32x16_bf16 v[80:95], a[156:159], v[60:63], v[80:95]
    v_add_f32 v223, v223, v119
    v_cvt_pk_bf16_f32 v187, v118, v119
    v_exp_f32 v106, v106
    s_waitcnt lgkmcnt(4)
    v_mfma_f32_32x32x16_bf16 a[0:15], a[160:163], v[160:163], a[0:15]
    ds_read_b64_tr_b16 a[176:177], v216 offset:40960
    ds_read_b64_tr_b16 a[178:179], v216 offset:45056
    v_exp_f32 v107, v107
    v_add_f32 v220, v220, v104
    v_mfma_f32_32x32x16_bf16 a[16:31], a[160:163], v[168:171], a[16:31]
    v_add_f32 v221, v221, v105
    v_cvt_pk_bf16_f32 v180, v104, v105
    v_exp_f32 v108, v108
    v_mfma_f32_32x32x16_bf16 a[32:47], a[164:167], v[160:163], a[32:47]
    ds_read_b64_tr_b16 a[180:181], v217 offset:40960
    ds_read_b64_tr_b16 a[182:183], v217 offset:45056
    v_exp_f32 v109, v109
    v_add_f32 v220, v220, v106
    v_mfma_f32_32x32x16_bf16 a[48:63], a[164:167], v[168:171], a[48:63]
    v_add_f32 v221, v221, v107
    v_cvt_pk_bf16_f32 v181, v106, v107
    v_exp_f32 v110, v110
    s_waitcnt lgkmcnt(4)
    v_mfma_f32_32x32x16_bf16 a[64:79], a[168:171], v[160:163], a[64:79]
    ds_read_b64_tr_b16 a[184:185], v218 offset:40960
    ds_read_b64_tr_b16 a[186:187], v218 offset:45056
    v_exp_f32 v111, v111
    v_add_f32 v220, v220, v108
    v_mfma_f32_32x32x16_bf16 a[80:95], a[168:171], v[168:171], a[80:95]
    v_add_f32 v221, v221, v109
    v_cvt_pk_bf16_f32 v182, v108, v109
    v_exp_f32 v120, v120
    v_mfma_f32_32x32x16_bf16 a[96:111], a[172:175], v[160:163], a[96:111]
    ds_read_b64_tr_b16 a[188:189], v219 offset:40960
    ds_read_b64_tr_b16 a[190:191], v219 offset:45056
    v_exp_f32 v121, v121
    v_add_f32 v220, v220, v110
    v_mfma_f32_32x32x16_bf16 a[112:127], a[172:175], v[168:171], a[112:127]
    s_waitcnt vmcnt(24)
    s_barrier
    s_add_u32 m0, s72, 81920
    v_add_f32 v221, v221, v111
    v_cvt_pk_bf16_f32 v183, v110, v111
    s_waitcnt lgkmcnt(4)
    v_mfma_f32_32x32x16_bf16 a[0:15], a[176:179], v[164:167], a[0:15]
    ds_read_b128 a[128:131], v208 offset:49152
    v_exp_f32 v122, v122
    v_exp_f32 v123, v123
    v_mfma_f32_32x32x16_bf16 a[16:31], a[176:179], v[172:175], a[16:31]
    buffer_load_dwordx4 v254, s[52:55], s82 offen lds
    v_add_f32 v222, v222, v120
    v_add_f32 v223, v223, v121
    v_cvt_pk_bf16_f32 v188, v120, v121
    v_mfma_f32_32x32x16_bf16 a[32:47], a[180:183], v[164:167], a[32:47]
    ds_read_b128 a[132:135], v209 offset:49152
    v_exp_f32 v124, v124
    v_exp_f32 v125, v125
    v_mfma_f32_32x32x16_bf16 a[48:63], a[180:183], v[172:175], a[48:63]
    buffer_load_dwordx4 v254, s[52:55], s82 offen offset:1024 lds
    s_add_u32 s82, s82, 8192
    s_and_b32 s82, s82, 0x1ffff
    s_waitcnt lgkmcnt(2)
    v_mfma_f32_32x32x16_bf16 a[64:79], a[184:187], v[164:167], a[64:79]
    ds_read_b128 a[136:139], v210 offset:49152
    v_add_f32 v222, v222, v122
    v_add_f32 v223, v223, v123
    v_cvt_pk_bf16_f32 v189, v122, v123
    v_exp_f32 v126, v126
    v_mfma_f32_32x32x16_bf16 a[80:95], a[184:187], v[172:175], a[80:95]
    buffer_load_dwordx4 v255, s[56:59], s83 offen offset:2048 lds
    v_exp_f32 v127, v127
    v_add_f32 v222, v222, v124
    v_mfma_f32_32x32x16_bf16 a[96:111], a[188:191], v[164:167], a[96:111]
    ds_read_b128 a[140:143], v211 offset:49152
    v_add_f32 v223, v223, v125
    v_cvt_pk_bf16_f32 v190, v124, v125
    v_add_f32 v222, v222, v126
    v_add_f32 v223, v223, v127
    v_mfma_f32_32x32x16_bf16 a[112:127], a[188:191], v[172:175], a[112:127]
    buffer_load_dwordx4 v255, s[56:59], s83 offen offset:3072 lds
    s_add_u32 s83, s83, 8192
    s_and_b32 s83, s83, 0x1ffff
    v_cvt_pk_bf16_f32 v191, v126, v127
    s_waitcnt lgkmcnt(2)
    v_mfma_f32_32x32x16_bf16 v[96:111], a[128:131], v[0:3], v[128:143]
    ds_read_b128 a[144:147], v212 offset:49152
    v_exp_f32 v64, v64
    v_exp_f32 v65, v65
    v_mfma_f32_32x32x16_bf16 v[112:127], a[128:131], v[8:11], v[144:159]
    v_exp_f32 v66, v66
    v_exp_f32 v67, v67
    v_add_f32 v220, v220, v64
    v_add_f32 v221, v221, v65
    v_mfma_f32_32x32x16_bf16 v[96:111], a[132:135], v[4:7], v[96:111]
    ds_read_b128 a[148:151], v213 offset:49152
    v_cvt_pk_bf16_f32 v160, v64, v65
    v_exp_f32 v68, v68
    s_waitcnt vmcnt(12)
    v_xor_b32 v196, s65, v196
    v_mfma_f32_32x32x16_bf16 v[112:127], a[132:135], v[12:15], v[112:127]
    v_exp_f32 v69, v69
    v_add_f32 v220, v220, v66
    v_add_f32 v221, v221, v67
    v_cvt_pk_bf16_f32 v161, v66, v67
    s_waitcnt lgkmcnt(2)
    v_mfma_f32_32x32x16_bf16 v[96:111], a[136:139], v[16:19], v[96:111]
    ds_read_b128 a[152:155], v214 offset:49152
    v_exp_f32 v70, v70
    v_exp_f32 v71, v71
    v_add_f32 v220, v220, v68
    v_mfma_f32_32x32x16_bf16 v[112:127], a[136:139], v[24:27], v[112:127]
    v_add_f32 v221, v221, v69
    v_cvt_pk_bf16_f32 v162, v68, v69
    v_exp_f32 v80, v80
    v_xor_b32 v197, s65, v197
    v_mfma_f32_32x32x16_bf16 v[96:111], a[140:143], v[20:23], v[96:111]
    ds_read_b128 a[156:159], v215 offset:49152
    v_exp_f32 v81, v81
    v_add_f32 v220, v220, v70
    v_add_f32 v221, v221, v71
    v_cvt_pk_bf16_f32 v163, v70, v71
    v_mfma_f32_32x32x16_bf16 v[112:127], a[140:143], v[28:31], v[112:127]
    v_exp_f32 v82, v82
    v_exp_f32 v83, v83
    v_add_f32 v222, v222, v80
    s_waitcnt lgkmcnt(2)
    v_mfma_f32_32x32x16_bf16 v[96:111], a[144:147], v[32:35], v[96:111]
    ds_read_b64_tr_b16 a[160:161], v216 offset:49152
    ds_read_b64_tr_b16 a[162:163], v216 offset:53248
    v_add_f32 v223, v223, v81
    v_cvt_pk_bf16_f32 v168, v80, v81
    v_xor_b32 v198, s65, v198
    v_mfma_f32_32x32x16_bf16 v[112:127], a[144:147], v[40:43], v[112:127]
    v_exp_f32 v84, v84
    v_exp_f32 v85, v85
    v_add_f32 v222, v222, v82
    v_subrev_u32 v208, 0x10000, v208
    v_mfma_f32_32x32x16_bf16 v[96:111], a[148:151], v[36:39], v[96:111]
    ds_read_b64_tr_b16 a[164:165], v217 offset:49152
    ds_read_b64_tr_b16 a[166:167], v217 offset:53248
    v_subrev_u32 v209, 0x10000, v209
    v_subrev_u32 v210, 0x10000, v210
    v_subrev_u32 v211, 0x10000, v211
    v_subrev_u32 v212, 0x10000, v212
    v_mfma_f32_32x32x16_bf16 v[112:127], a[148:151], v[44:47], v[112:127]
    v_subrev_u32 v213, 0x10000, v213
    v_subrev_u32 v214, 0x10000, v214
    v_subrev_u32 v215, 0x10000, v215
    v_xor_b32 v199, s65, v199
    s_waitcnt lgkmcnt(4)
    v_mfma_f32_32x32x16_bf16 v[96:111], a[152:155], v[48:51], v[96:111]
    ds_read_b64_tr_b16 a[168:169], v218 offset:49152
    ds_read_b64_tr_b16 a[170:171], v218 offset:53248
    v_add_f32 v223, v223, v83
    v_cvt_pk_bf16_f32 v169, v82, v83
    v_exp_f32 v86, v86
    v_mfma_f32_32x32x16_bf16 v[112:127], a[152:155], v[56:59], v[112:127]
    v_exp_f32 v87, v87
    v_add_f32 v222, v222, v84
    v_add_f32 v223, v223, v85
    v_cvt_pk_bf16_f32 v170, v84, v85
    v_or_b32 v196, v196, v197
    v_mfma_f32_32x32x16_bf16 v[96:111], a[156:159], v[52:55], v[96:111]
    ds_read_b64_tr_b16 a[172:173], v219 offset:49152
    ds_read_b64_tr_b16 a[174:175], v219 offset:53248
    v_exp_f32 v72, v72
    v_or3_b32 v196, v196, v198, v199
    v_mfma_f32_32x32x16_bf16 v[112:127], a[156:159], v[60:63], v[112:127]
    v_exp_f32 v73, v73
    v_add_f32 v222, v222, v86
    v_add_f32 v223, v223, v87
    v_cvt_pk_bf16_f32 v171, v86, v87
    s_waitcnt lgkmcnt(4)
    v_mfma_f32_32x32x16_bf16 a[0:15], a[160:163], v[176:179], a[0:15]
    ds_read_b64_tr_b16 a[176:177], v216 offset:57344
    ds_read_b64_tr_b16 a[178:179], v216 offset:61440
    v_exp_f32 v74, v74
    v_exp_f32 v75, v75
    v_mfma_f32_32x32x16_bf16 a[16:31], a[160:163], v[184:187], a[16:31]
    v_add_f32 v220, v220, v72
    v_add_f32 v221, v221, v73
    v_cvt_pk_bf16_f32 v164, v72, v73
    v_exp_f32 v76, v76
    v_mfma_f32_32x32x16_bf16 a[32:47], a[164:167], v[176:179], a[32:47]
    ds_read_b64_tr_b16 a[180:181], v217 offset:57344
    ds_read_b64_tr_b16 a[182:183], v217 offset:61440
    v_cmp_ne_u32 vcc, 0, v196
    s_nop 1
    s_cbranch_vccz P1_MOK
    s_mov_b32 s85, 100000
POLL_6:
    buffer_load_dwordx4 v[196:199], v245, s[32:35], s81 offen sc1
    s_waitcnt vmcnt(0)
    v_xor_b32 v196, s65, v196
    v_xor_b32 v197, s65, v197
    v_xor_b32 v198, s65, v198
    v_xor_b32 v199, s65, v199
    v_or_b32 v196, v196, v197
    v_or_b32 v196, v196, v198
    v_or_b32 v196, v196, v199
    v_cmp_ne_u32 vcc, 0, v196
    s_nop 1
    s_cbranch_vccz POLLD_7
    s_sub_u32 s85, s85, 1
    s_cbranch_scc1 F_END
    s_sleep 1
    s_branch POLL_6
POLLD_7:
P1_MOK:
    v_mfma_f32_32x32x16_bf16 a[48:63], a[164:167], v[184:187], a[48:63]
    v_exp_f32 v77, v77
    v_add_f32 v220, v220, v74
    v_add_f32 v221, v221, v75
    v_cvt_pk_bf16_f32 v165, v74, v75
    s_waitcnt lgkmcnt(4)
    v_mfma_f32_32x32x16_bf16 a[64:79], a[168:171], v[176:179], a[64:79]
    ds_read_b64_tr_b16 a[184:185], v218 offset:57344
    ds_read_b64_tr_b16 a[186:187], v218 offset:61440
    v_exp_f32 v78, v78
    s_mul_i32 s81, s24, 640
    v_mfma_f32_32x32x16_bf16 a[80:95], a[168:171], v[184:187], a[80:95]
    v_exp_f32 v79, v79
    v_add_f32 v220, v220, v76
    v_add_f32 v221, v221, v77
    v_cvt_pk_bf16_f32 v166, v76, v77
    s_add_u32 s81, s81, 7680
    v_mfma_f32_32x32x16_bf16 a[96:111], a[172:175], v[176:179], a[96:111]
    ds_read_b64_tr_b16 a[188:189], v219 offset:57344
    ds_read_b64_tr_b16 a[190:191], v219 offset:61440
    v_exp_f32 v88, v88
    v_exp_f32 v89, v89
    v_mfma_f32_32x32x16_bf16 a[112:127], a[172:175], v[184:187], a[112:127]
    s_waitcnt vmcnt(8)
    s_barrier
    s_add_u32 m0, s72, 98304
    ds_read_b64_tr_b16 a[216:217], v228 offset:0
    v_add_f32 v220, v220, v78
    v_add_f32 v221, v221, v79
    s_waitcnt lgkmcnt(5)
    v_mfma_f32_32x32x16_bf16 a[0:15], a[176:179], v[180:183], a[0:15]
    ds_read_b128 a[128:131], v208 offset:16384
    ds_read_b64_tr_b16 a[218:219], v228 offset:2560
    v_cvt_pk_bf16_f32 v167, v78, v79
    v_exp_f32 v90, v90
    v_mfma_f32_32x32x16_bf16 a[16:31], a[176:179], v[188:191], a[16:31]
    buffer_load_dwordx4 v254, s[52:55], s82 offen lds
    v_exp_f32 v91, v91
    v_add_f32 v222, v222, v88
    v_mfma_f32_32x32x16_bf16 a[32:47], a[180:183], v[180:183], a[32:47]
    ds_read_b128 a[132:135], v209 offset:16384
    ds_read_b64_tr_b16 a[220:221], v229 offset:0
    v_subrev_u32 v216, 0x10000, v216
    v_subrev_u32 v217, 0x10000, v217
    v_subrev_u32 v218, 0x10000, v218
    v_subrev_u32 v219, 0x10000, v219
    v_mfma_f32_32x32x16_bf16 a[48:63], a[180:183], v[188:191], a[48:63]
    buffer_load_dwordx4 v254, s[52:55], s82 offen offset:1024 lds
    s_add_u32 s82, s82, 8192
    s_and_b32 s82, s82, 0x1ffff
    s_waitcnt lgkmcnt(5)
    v_mfma_f32_32x32x16_bf16 a[64:79], a[184:187], v[180:183], a[64:79]
    ds_read_b128 a[136:139], v210 offset:16384
    ds_read_b64_tr_b16 a[222:223], v229 offset:2560
    v_add_f32 v223, v223, v89
    v_cvt_pk_bf16_f32 v172, v88, v89
    v_exp_f32 v92, v92
    v_mfma_f32_32x32x16_bf16 a[80:95], a[184:187], v[188:191], a[80:95]
    buffer_load_dwordx4 v255, s[56:59], s83 offen offset:2048 lds
    ds_read_b64_tr_b16 a[224:225], v230 offset:0
    v_exp_f32 v93, v93
    v_mfma_f32_32x32x16_bf16 a[96:111], a[188:191], v[180:183], a[96:111]
    ds_read_b128 a[140:143], v211 offset:16384
    ds_read_b64_tr_b16 a[226:227], v230 offset:2560
    v_add_f32 v222, v222, v90
    v_add_f32 v223, v223, v91
    v_cvt_pk_bf16_f32 v173, v90, v91
    v_mfma_f32_32x32x16_bf16 a[112:127], a[188:191], v[188:191], a[112:127]
    buffer_load_dwordx4 v255, s[56:59], s83 offen offset:3072 lds
    s_add_u32 s83, s83, 8192
    s_and_b32 s83, s83, 0x1ffff
    ds_read_b64_tr_b16 a[228:229], v231 offset:0
    v_exp_f32 v94, v94
    v_exp_f32 v95, v95
    v_add_f32 v222, v222, v92
    v_add_f32 v223, v223, v93
    v_cvt_pk_bf16_f32 v174, v92, v93
    v_add_f32 v222, v222, v94
    v_add_f32 v223, v223, v95
    v_cvt_pk_bf16_f32 v175, v94, v95
    s_waitcnt lgkmcnt(7)
    v_mfma_f32_32x32x16_bf16 v[64:79], a[128:131], v[0:3], v[128:143]
    ds_read_b128 a[144:147], v212 offset:16384
    ds_read_b64_tr_b16 a[230:231], v231 offset:2560
    v_exp_f32 v96, v96
    v_exp_f32 v97, v97
    v_mfma_f32_32x32x16_bf16 v[80:95], a[128:131], v[8:11], v[144:159]
    ds_read_b64_tr_b16 a[232:233], v232 offset:0
    v_exp_f32 v98, v98
    v_exp_f32 v99, v99
    v_add_f32 v220, v220, v96
    v_mfma_f32_32x32x16_bf16 v[64:79], a[132:135], v[4:7], v[64:79]
    ds_read_b128 a[148:151], v213 offset:16384
    ds_read_b64_tr_b16 a[234:235], v232 offset:2560
    v_add_f32 v221, v221, v97
    v_cvt_pk_bf16_f32 v176, v96, v97
    v_exp_f32 v100, v100
    v_mfma_f32_32x32x16_bf16 v[80:95], a[132:135], v[12:15], v[80:95]
    v_exp_f32 v101, v101
    v_add_f32 v220, v220, v98
    v_add_f32 v221, v221, v99
    v_cvt_pk_bf16_f32 v177, v98, v99
    s_waitcnt lgkmcnt(7)
    v_mfma_f32_32x32x16_bf16 v[64:79], a[136:139], v[16:19], v[64:79]
    ds_read_b128 a[152:155], v214 offset:16384
    v_exp_f32 v102, v102
    v_exp_f32 v103, v103
    v_add_f32 v220, v220, v100
    v_mfma_f32_32x32x16_bf16 v[80:95], a[136:139], v[24:27], v[80:95]
    buffer_store_dwordx4 a[216:219], v245, s[32:35], s78 offen offset:0 sc1
    v_add_f32 v221, v221, v101
    v_cvt_pk_bf16_f32 v178, v100, v101
    v_mfma_f32_32x32x16_bf16 v[64:79], a[140:143], v[20:23], v[64:79]
    ds_read_b128 a[156:159], v215 offset:16384
    v_exp_f32 v112, v112
    v_exp_f32 v113, v113
    v_add_f32 v220, v220, v102
    v_mfma_f32_32x32x16_bf16 v[80:95], a[140:143], v[28:31], v[80:95]
    v_add_f32 v221, v221, v103
    v_cvt_pk_bf16_f32 v179, v102, v103
    v_exp_f32 v114, v114
    s_waitcnt lgkmcnt(3)
    v_mfma_f32_32x32x16_bf16 v[64:79], a[144:147], v[32:35], v[64:79]
    ds_read_b64_tr_b16 a[160:161], v216 offset:16384
    ds_read_b64_tr_b16 a[162:163], v216 offset:20480
    buffer_store_dwordx4 a[220:223], v245, s[32:35], s78 offen offset:1024 sc1
    v_mfma_f32_32x32x16_bf16 v[80:95], a[144:147], v[40:43], v[80:95]
    v_exp_f32 v115, v115
    v_add_f32 v222, v222, v112
    v_add_f32 v223, v223, v113
    v_cvt_pk_bf16_f32 v184, v112, v113
    v_mfma_f32_32x32x16_bf16 v[64:79], a[148:151], v[36:39], v[64:79]
    ds_read_b64_tr_b16 a[164:165], v217 offset:16384
    ds_read_b64_tr_b16 a[166:167], v217 offset:20480
    v_exp_f32 v116, v116
    v_exp_f32 v117, v117
    v_mfma_f32_32x32x16_bf16 v[80:95], a[148:151], v[44:47], v[80:95]
    buffer_load_dword v196, v240, s[32:35], s80 offen sc1
    v_add_f32 v222, v222, v114
    v_add_f32 v223, v223, v115
    s_waitcnt lgkmcnt(4)
    v_mfma_f32_32x32x16_bf16 v[64:79], a[152:155], v[48:51], v[64:79]
    ds_read_b64_tr_b16 a[168:169], v218 offset:16384
    ds_read_b64_tr_b16 a[170:171], v218 offset:20480
    v_cvt_pk_bf16_f32 v185, v114, v115
    v_exp_f32 v118, v118
    v_mfma_f32_32x32x16_bf16 v[80:95], a[152:155], v[56:59], v[80:95]
    v_exp_f32 v119, v119
    v_add_f32 v222, v222, v116
    v_add_f32 v223, v223, v117
    v_cvt_pk_bf16_f32 v186, v116, v117
    v_mfma_f32_32x32x16_bf16 v[64:79], a[156:159], v[52:55], v[64:79]
    ds_read_b64_tr_b16 a[172:173], v219 offset:16384
    ds_read_b64_tr_b16 a[174:175], v219 offset:20480
    buffer_store_dwordx4 a[224:227], v245, s[32:35], s78 offen offset:2048 sc1
    v_mfma_f32_32x32x16_bf16 v[80:95], a[156:159], v[60:63], v[80:95]
    v_exp_f32 v104, v104
    v_exp_f32 v105, v105
    v_add_f32 v222, v222, v118
    s_waitcnt lgkmcnt(4)
    v_mfma_f32_32x32x16_bf16 a[0:15], a[160:163], v[160:163], a[0:15]
    ds_read_b64_tr_b16 a[176:177], v216 offset:24576
    ds_read_b64_tr_b16 a[178:179], v216 offset:28672
    buffer_load_dword v200, v241, s[32:35], s81 offen offset:2560 sc1
    v_add_f32 v223, v223, v119
    v_mfma_f32_32x32x16_bf16 a[16:31], a[160:163], v[168:171], a[16:31]
    v_cvt_pk_bf16_f32 v187, v118, v119
    v_exp_f32 v106, v106
    v_exp_f32 v107, v107
    v_add_f32 v220, v220, v104
    v_mfma_f32_32x32x16_bf16 a[32:47], a[164:167], v[160:163], a[32:47]
    ds_read_b64_tr_b16 a[180:181], v217 offset:24576
    ds_read_b64_tr_b16 a[182:183], v217 offset:28672
    buffer_load_dword v204, v241, s[32:35], s81 offen sc1
    v_add_f32 v221, v221, v105
    v_mfma_f32_32x32x16_bf16 a[48:63], a[164:167], v[168:171], a[48:63]
    v_cvt_pk_bf16_f32 v180, v104, v105
    v_exp_f32 v108, v108
    v_exp_f32 v109, v109
    s_waitcnt lgkmcnt(4)
    v_mfma_f32_32x32x16_bf16 a[64:79], a[168:171], v[160:163], a[64:79]
    ds_read_b64_tr_b16 a[184:185], v218 offset:24576
    ds_read_b64_tr_b16 a[186:187], v218 offset:28672
    v_add_f32 v220, v220, v106
    v_add_f32 v221, v221, v107
    v_cvt_pk_bf16_f32 v181, v106, v107
    v_mfma_f32_32x32x16_bf16 a[80:95], a[168:171], v[168:171], a[80:95]
    buffer_store_dwordx4 a[228:231], v245, s[32:35], s78 offen offset:3072 sc1
    v_exp_f32 v110, v110
    v_mfma_f32_32x32x16_bf16 a[96:111], a[172:175], v[160:163], a[96:111]
    ds_read_b64_tr_b16 a[188:189], v219 offset:24576
    ds_read_b64_tr_b16 a[190:191], v219 offset:28672
    v_exp_f32 v111, v111
    v_add_f32 v220, v220, v108
    s_add_u32 s80, s80, 15360
    v_mfma_f32_32x32x16_bf16 a[112:127], a[172:175], v[168:171], a[112:127]
    s_barrier
    s_add_u32 m0, s72, 114688
    v_add_f32 v221, v221, v109
    v_cvt_pk_bf16_f32 v182, v108, v109
    s_add_u32 s81, s81, 15360
    s_waitcnt lgkmcnt(4)
    v_mfma_f32_32x32x16_bf16 a[0:15], a[176:179], v[164:167], a[0:15]
    ds_read_b128 a[128:131], v208 offset:32768
    v_exp_f32 v120, v120
    v_exp_f32 v121, v121
    v_add_f32 v220, v220, v110
    v_mfma_f32_32x32x16_bf16 a[16:31], a[176:179], v[172:175], a[16:31]
    buffer_load_dwordx4 v254, s[52:55], s82 offen lds
    v_add_f32 v221, v221, v111
    v_cvt_pk_bf16_f32 v183, v110, v111
    v_mfma_f32_32x32x16_bf16 a[32:47], a[180:183], v[164:167], a[32:47]
    ds_read_b128 a[132:135], v209 offset:32768
    buffer_store_dwordx4 a[232:235], v238, s[32:35], s78 offen sc1
    v_mfma_f32_32x32x16_bf16 a[48:63], a[180:183], v[172:175], a[48:63]
    buffer_load_dwordx4 v254, s[52:55], s82 offen offset:1024 lds
    s_add_u32 s82, s82, 8192
    s_and_b32 s82, s82, 0x1ffff
    s_waitcnt lgkmcnt(2)
    v_mfma_f32_32x32x16_bf16 a[64:79], a[184:187], v[164:167], a[64:79]
    ds_read_b128 a[136:139], v210 offset:32768
    v_exp_f32 v122, v122
    v_exp_f32 v123, v123
    s_mov_b32 s78, s69
    v_mfma_f32_32x32x16_bf16 a[80:95], a[184:187], v[172:175], a[80:95]
    buffer_load_dwordx4 v255, s[56:59], s83 offen offset:2048 lds
    buffer_load_dword v197, v240, s[32:35], s80 offen sc1
    v_add_f32 v222, v222, v120
    v_mfma_f32_32x32x16_bf16 a[96:111], a[188:191], v[164:167], a[96:111]
    ds_read_b128 a[140:143], v211 offset:32768
    v_add_f32 v223, v223, v121
    v_cvt_pk_bf16_f32 v188, v120, v121
    v_exp_f32 v124, v124
    v_mfma_f32_32x32x16_bf16 a[112:127], a[188:191], v[172:175], a[112:127]
    buffer_load_dwordx4 v255, s[56:59], s83 offen offset:3072 lds
    s_add_u32 s83, s83, 8192
    s_and_b32 s83, s83, 0x1ffff
    v_exp_f32 v125, v125
    v_add_f32 v222, v222, v122
    v_add_f32 v223, v223, v123
    v_cvt_pk_bf16_f32 v189, v122, v123
    v_exp_f32 v126, v126
    v_exp_f32 v127, v127
    v_add_f32 v222, v222, v124
    v_add_f32 v223, v223, v125
    v_cvt_pk_bf16_f32 v190, v124, v125
    v_add_f32 v222, v222, v126
    v_add_f32 v223, v223, v127
    v_cvt_pk_bf16_f32 v191, v126, v127
    s_waitcnt lgkmcnt(2)
    v_mfma_f32_32x32x16_bf16 v[96:111], a[128:131], v[0:3], v[128:143]
    ds_read_b128 a[144:147], v212 offset:32768
    v_exp_f32 v64, v64
    v_exp_f32 v65, v65
    v_mfma_f32_32x32x16_bf16 v[112:127], a[128:131], v[8:11], v[144:159]
    v_exp_f32 v66, v66
    v_exp_f32 v67, v67
    v_add_f32 v220, v220, v64
    v_add_f32 v221, v221, v65
    v_mfma_f32_32x32x16_bf16 v[96:111], a[132:135], v[4:7], v[96:111]
    ds_read_b128 a[148:151], v213 offset:32768
    buffer_load_dword v201, v241, s[32:35], s81 offen offset:2560 sc1
    v_cvt_pk_bf16_f32 v160, v64, v65
    v_mfma_f32_32x32x16_bf16 v[112:127], a[132:135], v[12:15], v[112:127]
    v_exp_f32 v68, v68
    v_exp_f32 v69, v69
    v_add_f32 v220, v220, v66
    s_waitcnt lgkmcnt(2)
    v_mfma_f32_32x32x16_bf16 v[96:111], a[136:139], v[16:19], v[96:111]
    ds_read_b128 a[152:155], v214 offset:32768
    buffer_load_dword v205, v241, s[32:35], s81 offen sc1
    v_add_f32 v221, v221, v67
    v_cvt_pk_bf16_f32 v161, v66, v67
    v_mfma_f32_32x32x16_bf16 v[112:127], a[136:139], v[24:27], v[112:127]
    v_exp_f32 v70, v70
    v_exp_f32 v71, v71
    v_add_f32 v220, v220, v68
    s_add_u32 s80, s80, 15360
    v_mfma_f32_32x32x16_bf16 v[96:111], a[140:143], v[20:23], v[96:111]
    ds_read_b128 a[156:159], v215 offset:32768
    v_add_f32 v221, v221, v69
    v_cvt_pk_bf16_f32 v162, v68, v69
    v_exp_f32 v80, v80
    s_add_u32 s81, s81, 15360
    v_mfma_f32_32x32x16_bf16 v[112:127], a[140:143], v[28:31], v[112:127]
    v_exp_f32 v81, v81
    v_add_f32 v220, v220, v70
    v_add_f32 v221, v221, v71
    v_cvt_pk_bf16_f32 v163, v70, v71
    s_waitcnt lgkmcnt(2)
    v_mfma_f32_32x32x16_bf16 v[96:111], a[144:147], v[32:35], v[96:111]
    ds_read_b64_tr_b16 a[160:161], v216 offset:32768
    ds_read_b64_tr_b16 a[162:163], v216 offset:36864
    buffer_load_dword v198, v240, s[32:35], s80 offen sc1
    v_mfma_f32_32x32x16_bf16 v[112:127], a[144:147], v[40:43], v[112:127]
    v_exp_f32 v82, v82
    v_exp_f32 v83, v83
    v_add_f32 v222, v222, v80
    v_add_f32 v223, v223, v81
    v_mfma_f32_32x32x16_bf16 v[96:111], a[148:151], v[36:39], v[96:111]
    ds_read_b64_tr_b16 a[164:165], v217 offset:32768
    ds_read_b64_tr_b16 a[166:167], v217 offset:36864
    buffer_load_dword v202, v241, s[32:35], s81 offen offset:2560 sc1
    v_cvt_pk_bf16_f32 v168, v80, v81
    v_mfma_f32_32x32x16_bf16 v[112:127], a[148:151], v[44:47], v[112:127]
    v_exp_f32 v84, v84
    v_exp_f32 v85, v85
    v_add_f32 v222, v222, v82
    s_waitcnt lgkmcnt(4)
    v_mfma_f32_32x32x16_bf16 v[96:111], a[152:155], v[48:51], v[96:111]
    ds_read_b64_tr_b16 a[168:169], v218 offset:32768
    ds_read_b64_tr_b16 a[170:171], v218 offset:36864
    buffer_load_dword v206, v241, s[32:35], s81 offen sc1
    v_add_f32 v223, v223, v83
    v_mfma_f32_32x32x16_bf16 v[112:127], a[152:155], v[56:59], v[112:127]
    v_cvt_pk_bf16_f32 v169, v82, v83
    v_exp_f32 v86, v86
    v_exp_f32 v87, v87
    s_add_u32 s80, s80, 15360
    v_mfma_f32_32x32x16_bf16 v[96:111], a[156:159], v[52:55], v[96:111]
    ds_read_b64_tr_b16 a[172:173], v219 offset:32768
    ds_read_b64_tr_b16 a[174:175], v219 offset:36864
    v_add_f32 v222, v222, v84
    v_add_f32 v223, v223, v85
    v_cvt_pk_bf16_f32 v170, v84, v85
    s_add_u32 s81, s81, 15360
    v_mfma_f32_32x32x16_bf16 v[112:127], a[156:159], v[60:63], v[112:127]
    v_exp_f32 v72, v72
    v_exp_f32 v73, v73
    v_add_f32 v222, v222, v86
    s_waitcnt lgkmcnt(4)
    v_mfma_f32_32x32x16_bf16 a[0:15], a[160:163], v[176:179], a[0:15]
    ds_read_b64_tr_b16 a[176:177], v216 offset:40960
    ds_read_b64_tr_b16 a[178:179], v216 offset:45056
    buffer_load_dword v199, v240, s[32:35], s80 offen sc1
    v_add_f32 v223, v223, v87
    v_mfma_f32_32x32x16_bf16 a[16:31], a[160:163], v[184:187], a[16:31]
    v_cvt_pk_bf16_f32 v171, v86, v87
    v_exp_f32 v74, v74
    v_exp_f32 v75, v75
    v_add_f32 v220, v220, v72
    v_mfma_f32_32x32x16_bf16 a[32:47], a[164:167], v[176:179], a[32:47]
    ds_read_b64_tr_b16 a[180:181], v217 offset:40960
    ds_read_b64_tr_b16 a[182:183], v217 offset:45056
    buffer_load_dword v203, v241, s[32:35], s81 offen offset:2560 sc1
    v_add_f32 v221, v221, v73
    v_mfma_f32_32x32x16_bf16 a[48:63], a[164:167], v[184:187], a[48:63]
    v_cvt_pk_bf16_f32 v164, v72, v73
    v_exp_f32 v76, v76
    v_exp_f32 v77, v77
    s_waitcnt lgkmcnt(4)
    v_mfma_f32_32x32x16_bf16 a[64:79], a[168:171], v[176:179], a[64:79]
    ds_read_b64_tr_b16 a[184:185], v218 offset:40960
    ds_read_b64_tr_b16 a[186:187], v218 offset:45056
    buffer_load_dword v207, v241, s[32:35], s81 offen sc1
    v_add_f32 v220, v220, v74
    v_mfma_f32_32x32x16_bf16 a[80:95], a[168:171], v[184:187], a[80:95]
    v_add_f32 v221, v221, v75
    v_cvt_pk_bf16_f32 v165, v74, v75
    v_exp_f32 v78, v78
    v_lshrrev_b32 v242, 3, v195
    v_mfma_f32_32x32x16_bf16 a[96:111], a[172:175], v[176:179], a[96:111]
    ds_read_b64_tr_b16 a[188:189], v219 offset:40960
    ds_read_b64_tr_b16 a[190:191], v219 offset:45056
    v_exp_f32 v79, v79
    v_add_f32 v220, v220, v76
    v_and_b32 v243, 7, v195
    v_mfma_f32_32x32x16_bf16 a[112:127], a[172:175], v[184:187], a[112:127]
    s_barrier
    s_add_u32 m0, s72, 16384
    v_add_f32 v221, v221, v77
    v_cvt_pk_bf16_f32 v166, v76, v77
    v_mul_u32_u24 v244, 3456, v242
    s_waitcnt lgkmcnt(4)
    v_mfma_f32_32x32x16_bf16 a[0:15], a[176:179], v[180:183], a[0:15]
    ds_read_b128 a[128:131], v208 offset:49152
    v_exp_f32 v88, v88
    v_exp_f32 v89, v89
    v_lshl_add_u32 v244, v243, 4, v244
    v_mfma_f32_32x32x16_bf16 a[16:31], a[176:179], v[188:191], a[16:31]
    buffer_load_dwordx4 v254, s[52:55], s82 offen lds
    v_add_f32 v220, v220, v78
    v_add_f32 v221, v221, v79
    v_cvt_pk_bf16_f32 v167, v78, v79
    v_mfma_f32_32x32x16_bf16 a[32:47], a[180:183], v[180:183], a[32:47]
    ds_read_b128 a[132:135], v209 offset:49152
    v_exp_f32 v90, v90
    v_exp_f32 v91, v91
    v_add_f32 v222, v222, v88
    v_mfma_f32_32x32x16_bf16 a[48:63], a[180:183], v[188:191], a[48:63]
    buffer_load_dwordx4 v254, s[52:55], s82 offen offset:1024 lds
    s_add_u32 s82, s82, 8192
    s_and_b32 s82, s82, 0x1ffff
    s_waitcnt lgkmcnt(2)
    v_mfma_f32_32x32x16_bf16 a[64:79], a[184:187], v[180:183], a[64:79]
    ds_read_b128 a[136:139], v210 offset:49152
    v_add_f32 v223, v223, v89
    s_cmp_lt_u32 s25, 27
    s_cselect_b32 s40, s16, s18
    s_cselect_b32 s41, s17, s19
    s_cselect_b32 s84, 0, 27
    v_mfma_f32_32x32x16_bf16 a[80:95], a[184:187], v[188:191], a[80:95]
    buffer_load_dwordx4 v255, s[56:59], s83 offen offset:2048 lds
    v_cvt_pk_bf16_f32 v172, v88, v89
    s_sub_u32 s84, s25, s84
    v_mfma_f32_32x32x16_bf16 a[96:111], a[188:191], v[180:183], a[96:111]
    ds_read_b128 a[140:143], v211 offset:49152
    v_exp_f32 v92, v92
    v_exp_f32 v93, v93
    s_lshl_b32 s84, s84, 7
    v_mfma_f32_32x32x16_bf16 a[112:127], a[188:191], v[188:191], a[112:127]
    buffer_load_dwordx4 v255, s[56:59], s83 offen offset:3072 lds
    s_add_u32 s83, s83, 8192
    s_and_b32 s83, s83, 0x1ffff
    v_add_f32 v222, v222, v90
    v_add_f32 v223, v223, v91
    v_cvt_pk_bf16_f32 v173, v90, v91
    v_exp_f32 v94, v94
    v_exp_f32 v95, v95
    v_add_f32 v222, v222, v92
    v_add_f32 v223, v223, v93
    v_cvt_pk_bf16_f32 v174, v92, v93
    v_add_f32 v222, v222, v94
    v_add_f32 v223, v223, v95
    v_cvt_pk_bf16_f32 v175, v94, v95
    s_waitcnt lgkmcnt(2)
    v_mfma_f32_32x32x16_bf16 v[64:79], a[128:131], v[0:3], v[128:143]
    ds_read_b128 a[144:147], v212 offset:49152
    v_exp_f32 v96, v96
    v_exp_f32 v97, v97
    v_mfma_f32_32x32x16_bf16 v[80:95], a[128:131], v[8:11], v[144:159]
    v_exp_f32 v98, v98
    v_exp_f32 v99, v99
    v_add_f32 v220, v220, v96
    v_add_f32 v221, v221, v97
    v_mfma_f32_32x32x16_bf16 v[64:79], a[132:135], v[4:7], v[64:79]
    ds_read_b128 a[148:151], v213 offset:49152
    v_cvt_pk_bf16_f32 v176, v96, v97
    v_exp_f32 v100, v100
    v_exp_f32 v101, v101
    v_mfma_f32_32x32x16_bf16 v[80:95], a[132:135], v[12:15], v[80:95]
    v_add_f32 v220, v220, v98
    v_add_f32 v221, v221, v99
    v_cvt_pk_bf16_f32 v177, v98, v99
    v_exp_f32 v102, v102
    s_waitcnt lgkmcnt(2)
    v_mfma_f32_32x32x16_bf16 v[64:79], a[136:139], v[16:19], v[64:79]
    ds_read_b128 a[152:155], v214 offset:49152
    v_exp_f32 v103, v103
    v_add_f32 v220, v220, v100
    v_add_f32 v221, v221, v101
    v_cvt_pk_bf16_f32 v178, v100, v101
    v_mfma_f32_32x32x16_bf16 v[80:95], a[136:139], v[24:27], v[80:95]
    v_exp_f32 v112, v112
    v_exp_f32 v113, v113
    v_add_f32 v220, v220, v102
    v_add_f32 v221, v221, v103
    v_mfma_f32_32x32x16_bf16 v[64:79], a[140:143], v[20:23], v[64:79]
    ds_read_b128 a[156:159], v215 offset:49152
    s_add_u32 m0, s75, 0
    s_nop 0
    buffer_load_dwordx4 v233, s[36:39], s76 offen lds
    v_mfma_f32_32x32x16_bf16 v[80:95], a[140:143], v[28:31], v[80:95]
    v_cvt_pk_bf16_f32 v179, v102, v103
    v_exp_f32 v114, v114
    v_exp_f32 v115, v115
    s_waitcnt lgkmcnt(2)
    v_mfma_f32_32x32x16_bf16 v[64:79], a[144:147], v[32:35], v[64:79]
    ds_read_b64_tr_b16 a[160:161], v216 offset:49152
    ds_read_b64_tr_b16 a[162:163], v216 offset:53248
    v_add_f32 v222, v222, v112
    v_add_f32 v223, v223, v113
    v_cvt_pk_bf16_f32 v184, v112, v113
    v_mfma_f32_32x32x16_bf16 v[80:95], a[144:147], v[40:43], v[80:95]
    v_exp_f32 v116, v116
    v_exp_f32 v117, v117
    v_add_f32 v222, v222, v114
    v_add_u32 v208, 0x10000, v208
    v_mfma_f32_32x32x16_bf16 v[64:79], a[148:151], v[36:39], v[64:79]
    ds_read_b64_tr_b16 a[164:165], v217 offset:49152
    ds_read_b64_tr_b16 a[166:167], v217 offset:53248
    v_add_u32 v209, 0x10000, v209
    v_add_u32 v210, 0x10000, v210
    v_add_u32 v211, 0x10000, v211
    v_add_u32 v212, 0x10000, v212
    v_mfma_f32_32x32x16_bf16 v[80:95], a[148:151], v[44:47], v[80:95]
    v_add_u32 v213, 0x10000, v213
    v_add_u32 v214, 0x10000, v214
    v_add_u32 v215, 0x10000, v215
    v_add_f32 v223, v223, v115
    v_cvt_pk_bf16_f32 v185, v114, v115
    s_waitcnt lgkmcnt(4)
    v_mfma_f32_32x32x16_bf16 v[64:79], a[152:155], v[48:51], v[64:79]
    ds_read_b64_tr_b16 a[168:169], v218 offset:49152
    ds_read_b64_tr_b16 a[170:171], v218 offset:53248
    v_exp_f32 v118, v118
    v_exp_f32 v119, v119
    v_mfma_f32_32x32x16_bf16 v[80:95], a[152:155], v[56:59], v[80:95]
    s_add_u32 m0, s75, 4096
    s_nop 0
    buffer_load_dwordx4 v234, s[36:39], s76 offen lds
    v_add_f32 v222, v222, v116
    v_mfma_f32_32x32x16_bf16 v[64:79], a[156:159], v[52:55], v[64:79]
    ds_read_b64_tr_b16 a[172:173], v219 offset:49152
    ds_read_b64_tr_b16 a[174:175], v219 offset:53248
    v_add_f32 v223, v223, v117
    v_cvt_pk_bf16_f32 v186, v116, v117
    v_exp_f32 v104, v104
    v_mfma_f32_32x32x16_bf16 v[80:95], a[156:159], v[60:63], v[80:95]
    v_exp_f32 v105, v105
    v_add_f32 v222, v222, v118
    s_mul_i32 s100, s24, 552960
    s_add_u32 s84, s84, s100
    s_waitcnt lgkmcnt(4)
    v_mfma_f32_32x32x16_bf16 a[0:15], a[160:163], v[160:163], a[0:15]
    ds_read_b64_tr_b16 a[176:177], v216 offset:57344
    ds_read_b64_tr_b16 a[178:179], v216 offset:61440
    v_add_f32 v223, v223, v119
    v_cvt_pk_bf16_f32 v187, v118, v119
    s_mov_b32 s42, 2211840
    v_mfma_f32_32x32x16_bf16 a[16:31], a[160:163], v[168:171], a[16:31]
    v_exp_f32 v106, v106
    v_exp_f32 v107, v107
    v_add_f32 v220, v220, v104
    v_add_f32 v221, v221, v105
    v_mfma_f32_32x32x16_bf16 a[32:47], a[164:167], v[160:163], a[32:47]
    ds_read_b64_tr_b16 a[180:181], v217 offset:57344
    ds_read_b64_tr_b16 a[182:183], v217 offset:61440
    v_cvt_pk_bf16_f32 v180, v104, v105
    v_exp_f32 v108, v108
    s_mov_b32 s43, 0x20000
    v_mfma_f32_32x32x16_bf16 a[48:63], a[164:167], v[168:171], a[48:63]
    v_exp_f32 v109, v109
    v_add_f32 v220, v220, v106
    v_add_f32 v221, v221, v107
    s_mul_i32 s24, s24, 27648
    s_waitcnt lgkmcnt(4)
    v_mfma_f32_32x32x16_bf16 a[64:79], a[168:171], v[160:163], a[64:79]
    ds_read_b64_tr_b16 a[184:185], v218 offset:57344
    ds_read_b64_tr_b16 a[186:187], v218 offset:61440
    v_cvt_pk_bf16_f32 v181, v106, v107
    v_exp_f32 v110, v110
    v_mfma_f32_32x32x16_bf16 a[80:95], a[168:171], v[168:171], a[80:95]
    v_exp_f32 v111, v111
    v_add_f32 v220, v220, v108
    v_add_f32 v221, v221, v109
    v_cvt_pk_bf16_f32 v182, v108, v109
    s_lshl_b32 s25, s25, 8
    v_mfma_f32_32x32x16_bf16 a[96:111], a[172:175], v[160:163], a[96:111]
    ds_read_b64_tr_b16 a[188:189], v219 offset:57344
    ds_read_b64_tr_b16 a[190:191], v219 offset:61440
    v_exp_f32 v120, v120
    s_add_u32 s24, s24, s25
    v_mfma_f32_32x32x16_bf16 a[112:127], a[172:175], v[168:171], a[112:127]
    s_waitcnt vmcnt(35)
    s_barrier
    s_add_u32 m0, s72, 32768
    v_exp_f32 v121, v121
    s_add_u32 s24, s24, 81920
    s_waitcnt lgkmcnt(4)
    v_mfma_f32_32x32x16_bf16 a[0:15], a[176:179], v[164:167], a[0:15]
    ds_read_b128 a[128:131], v208 offset:0
    v_add_f32 v220, v220, v110
    v_add_f32 v221, v221, v111
    v_cvt_pk_bf16_f32 v183, v110, v111
    v_exp_f32 v122, v122
    v_mfma_f32_32x32x16_bf16 a[16:31], a[176:179], v[172:175], a[16:31]
    buffer_load_dwordx4 v254, s[52:55], s82 offen lds
    v_exp_f32 v123, v123
    v_add_f32 v222, v222, v120
    v_mfma_f32_32x32x16_bf16 a[32:47], a[180:183], v[164:167], a[32:47]
    ds_read_b128 a[132:135], v209 offset:0
    v_add_u32 v216, 0x10000, v216
    v_add_u32 v217, 0x10000, v217
    v_add_u32 v218, 0x10000, v218
    s_cmp_lt_u32 s2, 216
    s_cselect_b32 s24, s24, 0x7fff0000
    v_mfma_f32_32x32x16_bf16 a[48:63], a[180:183], v[172:175], a[48:63]
    buffer_load_dwordx4 v254, s[52:55], s82 offen offset:1024 lds
    s_add_u32 s82, s82, 8192
    s_and_b32 s82, s82, 0x1ffff
    s_waitcnt lgkmcnt(2)
    v_mfma_f32_32x32x16_bf16 a[64:79], a[184:187], v[164:167], a[64:79]
    ds_read_b128 a[136:139], v210 offset:0
    v_add_u32 v219, 0x10000, v219
    v_add_f32 v223, v223, v121
    v_cvt_pk_bf16_f32 v188, v120, v121
    v_cmp_eq_u32 vcc, 1, v239
    v_mfma_f32_32x32x16_bf16 a[80:95], a[184:187], v[172:175], a[80:95]
    buffer_load_dwordx4 v255, s[56:59], s83 offen offset:2048 lds
    v_exp_f32 v124, v124
    v_mfma_f32_32x32x16_bf16 a[96:111], a[188:191], v[164:167], a[96:111]
    ds_read_b128 a[140:143], v211 offset:0
    v_exp_f32 v125, v125
    v_add_f32 v222, v222, v122
    v_add_f32 v223, v223, v123
    v_cvt_pk_bf16_f32 v189, v122, v123
    v_mfma_f32_32x32x16_bf16 a[112:127], a[188:191], v[172:175], a[112:127]
    buffer_load_dwordx4 v255, s[56:59], s83 offen offset:3072 lds
    s_add_u32 s83, s83, 8192
    s_and_b32 s83, s83, 0x1ffff
    v_exp_f32 v126, v126
    v_exp_f32 v127, v127
    v_add_f32 v222, v222, v124
    v_add_f32 v223, v223, v125
    v_cvt_pk_bf16_f32 v190, v124, v125
    v_add_f32 v222, v222, v126
    v_add_f32 v223, v223, v127
    v_cvt_pk_bf16_f32 v191, v126, v127
    s_waitcnt lgkmcnt(2)
    v_mfma_f32_32x32x16_bf16 v[96:111], a[128:131], v[0:3], v[128:143]
    ds_read_b128 a[144:147], v212 offset:0
    v_exp_f32 v64, v64
    v_exp_f32 v65, v65
    v_mfma_f32_32x32x16_bf16 v[112:127], a[128:131], v[8:11], v[144:159]
    v_exp_f32 v66, v66
    v_exp_f32 v67, v67
    s_waitcnt vmcnt(12)
    v_add_f32 v196, v196, v197
    v_mfma_f32_32x32x16_bf16 v[96:111], a[132:135], v[4:7], v[96:111]
    ds_read_b128 a[148:151], v213 offset:0
    v_add_f32 v220, v220, v64
    v_add_f32 v221, v221, v65
    v_cvt_pk_bf16_f32 v160, v64, v65
    v_add_f32 v198, v198, v199
    v_mfma_f32_32x32x16_bf16 v[112:127], a[132:135], v[12:15], v[112:127]
    v_exp_f32 v68, v68
    v_exp_f32 v69, v69
    v_add_f32 v196, v196, v198
    s_waitcnt lgkmcnt(2)
    v_mfma_f32_32x32x16_bf16 v[96:111], a[136:139], v[16:19], v[96:111]
    ds_read_b128 a[152:155], v214 offset:0
    v_add_f32 v220, v220, v66
    v_add_f32 v221, v221, v67
    v_cvt_pk_bf16_f32 v161, v66, v67
    v_cvt_pk_bf16_f32 v196, v196, v196
    v_mfma_f32_32x32x16_bf16 v[112:127], a[136:139], v[24:27], v[112:127]
    v_exp_f32 v70, v70
    v_exp_f32 v71, v71
    v_add_f32 v220, v220, v68
    v_lshlrev_b32 v196, 16, v196
    v_mfma_f32_32x32x16_bf16 v[96:111], a[140:143], v[20:23], v[96:111]
    ds_read_b128 a[156:159], v215 offset:0
    v_add_f32 v221, v221, v69
    v_cvt_pk_bf16_f32 v162, v68, v69
    v_exp_f32 v80, v80
    v_add_f32 v197, 1.0, v196
    v_mfma_f32_32x32x16_bf16 v[112:127], a[140:143], v[28:31], v[112:127]
    v_exp_f32 v81, v81
    v_add_f32 v220, v220, v70
    v_add_f32 v221, v221, v71
    v_cvt_pk_bf16_f32 v197, v197, v197
    s_waitcnt lgkmcnt(2)
    v_mfma_f32_32x32x16_bf16 v[96:111], a[144:147], v[32:35], v[96:111]
    ds_read_b64_tr_b16 a[160:161], v216 offset:0
    ds_read_b64_tr_b16 a[162:163], v216 offset:4096
    v_cvt_pk_bf16_f32 v163, v70, v71
    v_exp_f32 v82, v82
    v_lshlrev_b32 v197, 16, v197
    v_mfma_f32_32x32x16_bf16 v[112:127], a[144:147], v[40:43], v[112:127]
    v_exp_f32 v83, v83
    v_add_f32 v222, v222, v80
    v_add_f32 v223, v223, v81
    v_cvt_pk_bf16_f32 v168, v80, v81
    v_mfma_f32_32x32x16_bf16 v[96:111], a[148:151], v[36:39], v[96:111]
    ds_read_b64_tr_b16 a[164:165], v217 offset:0
    ds_read_b64_tr_b16 a[166:167], v217 offset:4096
    v_exp_f32 v84, v84
    s_waitcnt vmcnt(11)
    v_add_f32 v200, v200, v201
    v_mfma_f32_32x32x16_bf16 v[112:127], a[148:151], v[44:47], v[112:127]
    v_exp_f32 v85, v85
    v_add_f32 v222, v222, v82
    v_add_f32 v223, v223, v83
    v_add_f32 v202, v202, v203
    s_waitcnt lgkmcnt(4)
    v_mfma_f32_32x32x16_bf16 v[96:111], a[152:155], v[48:51], v[96:111]
    ds_read_b64_tr_b16 a[168:169], v218 offset:0
    ds_read_b64_tr_b16 a[170:171], v218 offset:4096
    v_cvt_pk_bf16_f32 v169, v82, v83
    v_exp_f32 v86, v86
    v_add_f32 v200, v200, v202
    v_mfma_f32_32x32x16_bf16 v[112:127], a[152:155], v[56:59], v[112:127]
    v_exp_f32 v87, v87
    v_add_f32 v222, v222, v84
    v_add_f32 v223, v223, v85
    v_cvt_pk_bf16_f32 v170, v84, v85
    v_cvt_pk_bf16_f32 v200, v200, v200
    v_mfma_f32_32x32x16_bf16 v[96:111], a[156:159], v[52:55], v[96:111]
    ds_read_b64_tr_b16 a[172:173], v219 offset:0
    ds_read_b64_tr_b16 a[174:175], v219 offset:4096
    v_exp_f32 v72, v72
    v_lshlrev_b32 v200, 16, v200
    v_mfma_f32_32x32x16_bf16 v[112:127], a[156:159], v[60:63], v[112:127]
    v_exp_f32 v73, v73
    v_add_f32 v222, v222, v86
    v_add_f32 v201, 1.0, v200
    v_cvt_pk_bf16_f32 v201, v201, v201
    s_waitcnt lgkmcnt(4)
    v_mfma_f32_32x32x16_bf16 a[0:15], a[160:163], v[176:179], a[0:15]
    ds_read_b64_tr_b16 a[176:177], v216 offset:8192
    ds_read_b64_tr_b16 a[178:179], v216 offset:12288
    v_add_f32 v223, v223, v87
    v_cvt_pk_bf16_f32 v171, v86, v87
    v_lshlrev_b32 v201, 16, v201
    v_mfma_f32_32x32x16_bf16 a[16:31], a[160:163], v[184:187], a[16:31]
    v_exp_f32 v74, v74
    v_exp_f32 v75, v75
    v_add_f32 v220, v220, v72
    v_add_f32 v221, v221, v73
    v_mfma_f32_32x32x16_bf16 a[32:47], a[164:167], v[176:179], a[32:47]
    ds_read_b64_tr_b16 a[180:181], v217 offset:8192
    ds_read_b64_tr_b16 a[182:183], v217 offset:12288
    v_cvt_pk_bf16_f32 v164, v72, v73
    s_waitcnt vmcnt(10)
    v_add_f32 v204, v204, v205
    v_mfma_f32_32x32x16_bf16 a[48:63], a[164:167], v[184:187], a[48:63]
    v_exp_f32 v76, v76
    v_exp_f32 v77, v77
    v_add_f32 v206, v206, v207
    s_waitcnt lgkmcnt(4)
    v_mfma_f32_32x32x16_bf16 a[64:79], a[168:171], v[176:179], a[64:79]
    ds_read_b64_tr_b16 a[184:185], v218 offset:8192
    ds_read_b64_tr_b16 a[186:187], v218 offset:12288
    v_add_f32 v220, v220, v74
    v_add_f32 v221, v221, v75
    v_cvt_pk_bf16_f32 v165, v74, v75
    v_add_f32 v204, v204, v206
    v_mfma_f32_32x32x16_bf16 a[80:95], a[168:171], v[184:187], a[80:95]
    v_exp_f32 v78, v78
    v_exp_f32 v79, v79
    v_add_f32 v220, v220, v76
    v_cvt_pk_bf16_f32 v204, v204, v204
    v_mfma_f32_32x32x16_bf16 a[96:111], a[172:175], v[176:179], a[96:111]
    ds_read_b64_tr_b16 a[188:189], v219 offset:8192
    ds_read_b64_tr_b16 a[190:191], v219 offset:12288
    v_add_f32 v221, v221, v77
    v_cvt_pk_bf16_f32 v166, v76, v77
    v_lshlrev_b32 v204, 16, v204
    v_mfma_f32_32x32x16_bf16 a[112:127], a[172:175], v[184:187], a[112:127]
    s_barrier
    s_add_u32 m0, s72, 49152
    v_exp_f32 v88, v88
    s_waitcnt lgkmcnt(4)
    v_mfma_f32_32x32x16_bf16 a[0:15], a[176:179], v[180:183], a[0:15]
    ds_read_b128 a[128:131], v208 offset:16384
    v_exp_f32 v89, v89
    v_add_f32 v220, v220, v78
    s_cmp_lg_u32 s64, 0
    s_cbranch_scc1 SIG_5
    s_mov_b64 exec, 1
    v_mov_b32 v192, s65
    v_mov_b32 v193, 0
    s_lshl_b32 s100, s79, 2
    s_add_u32 s100, s100, 394240
    buffer_store_dword v192, v193, s[32:35], s100 offen sc1
    s_mov_b64 exec, -1
SIG_5:
    v_mfma_f32_32x32x16_bf16 a[16:31], a[176:179], v[188:191], a[16:31]
    buffer_load_dwordx4 v254, s[52:55], s82 offen lds
    v_add_f32 v221, v221, v79
    v_cvt_pk_bf16_f32 v167, v78, v79
    v_cndmask_b32 v196, v196, v197, vcc
    v_mfma_f32_32x32x16_bf16 a[32:47], a[180:183], v[180:183], a[32:47]
    ds_read_b128 a[132:135], v209 offset:16384
    v_exp_f32 v90, v90
    v_exp_f32 v91, v91
    v_add_u32 v241, 136448, v241
    v_mfma_f32_32x32x16_bf16 a[48:63], a[180:183], v[188:191], a[48:63]
    buffer_load_dwordx4 v254, s[52:55], s82 offen offset:1024 lds
    s_add_u32 s82, s82, 8192
    s_and_b32 s82, s82, 0x1ffff
    s_waitcnt lgkmcnt(2)
    v_mfma_f32_32x32x16_bf16 a[64:79], a[184:187], v[180:183], a[64:79]
    ds_read_b128 a[136:139], v210 offset:16384
    ds_write_b32 v241, v196
    ds_write_b32 v241, v201 offset:1024
    v_add_f32 v222, v222, v88
    v_add_f32 v223, v223, v89
    v_cvt_pk_bf16_f32 v172, v88, v89
    v_mfma_f32_32x32x16_bf16 a[80:95], a[184:187], v[188:191], a[80:95]
    buffer_load_dwordx4 v255, s[56:59], s83 offen offset:2048 lds
    ds_write_b32 v241, v204 offset:2048
    v_exp_f32 v92, v92
    v_mfma_f32_32x32x16_bf16 a[96:111], a[188:191], v[180:183], a[96:111]
    ds_read_b128 a[140:143], v211 offset:16384
    v_exp_f32 v93, v93
    v_add_f32 v222, v222, v90
    v_add_f32 v223, v223, v91
    v_cvt_pk_bf16_f32 v173, v90, v91
    v_mfma_f32_32x32x16_bf16 a[112:127], a[188:191], v[188:191], a[112:127]
    buffer_load_dwordx4 v255, s[56:59], s83 offen offset:3072 lds
    s_add_u32 s83, s83, 8192
    s_and_b32 s83, s83, 0x1ffff
    v_exp_f32 v94, v94
    v_exp_f32 v95, v95
    v_add_f32 v222, v222, v92
    v_add_f32 v223, v223, v93
    v_cvt_pk_bf16_f32 v174, v92, v93
    v_add_f32 v222, v222, v94
    v_add_f32 v223, v223, v95
    v_cvt_pk_bf16_f32 v175, v94, v95
    s_waitcnt lgkmcnt(5)
    v_mfma_f32_32x32x16_bf16 v[64:79], a[128:131], v[0:3], v[128:143]
    ds_read_b128 a[144:147], v212 offset:16384
    v_exp_f32 v96, v96
    v_exp_f32 v97, v97
    v_mfma_f32_32x32x16_bf16 v[80:95], a[128:131], v[8:11], v[144:159]
    v_exp_f32 v98, v98
    v_exp_f32 v99, v99
    v_add_f32 v220, v220, v96
    v_mfma_f32_32x32x16_bf16 v[64:79], a[132:135], v[4:7], v[64:79]
    ds_read_b128 a[148:151], v213 offset:16384
    v_add_f32 v221, v221, v97
    v_cvt_pk_bf16_f32 v176, v96, v97
    v_exp_f32 v100, v100
    v_mfma_f32_32x32x16_bf16 v[80:95], a[132:135], v[12:15], v[80:95]
    s_add_u32 m0, s75, 8192
    s_nop 0
    buffer_load_dwordx4 v235, s[36:39], s76 offen lds
    s_waitcnt lgkmcnt(2)
    v_mfma_f32_32x32x16_bf16 v[64:79], a[136:139], v[16:19], v[64:79]
    ds_read_b128 a[152:155], v214 offset:16384
    v_exp_f32 v101, v101
    v_add_f32 v220, v220, v98
    v_add_f32 v221, v221, v99
    v_cvt_pk_bf16_f32 v177, v98, v99
    v_mfma_f32_32x32x16_bf16 v[80:95], a[136:139], v[24:27], v[80:95]
    v_exp_f32 v102, v102
    v_exp_f32 v103, v103
    v_add_f32 v220, v220, v100
    v_add_f32 v221, v221, v101
    v_mfma_f32_32x32x16_bf16 v[64:79], a[140:143], v[20:23], v[64:79]
    ds_read_b128 a[156:159], v215 offset:16384
    s_add_u32 m0, s75, 12288
    s_nop 0
    buffer_load_dwordx4 v236, s[36:39], s76 offen lds
    v_mfma_f32_32x32x16_bf16 v[80:95], a[140:143], v[28:31], v[80:95]
    v_cvt_pk_bf16_f32 v178, v100, v101
    v_exp_f32 v112, v112
    v_exp_f32 v113, v113
    s_waitcnt lgkmcnt(2)
    v_mfma_f32_32x32x16_bf16 v[64:79], a[144:147], v[32:35], v[64:79]
    ds_read_b64_tr_b16 a[160:161], v216 offset:16384
    ds_read_b64_tr_b16 a[162:163], v216 offset:20480
    v_add_f32 v220, v220, v102
    v_add_f32 v221, v221, v103
    v_cvt_pk_bf16_f32 v179, v102, v103
    v_mfma_f32_32x32x16_bf16 v[80:95], a[144:147], v[40:43], v[80:95]
    v_exp_f32 v114, v114
    v_exp_f32 v115, v115
    v_add_f32 v222, v222, v112
    v_add_f32 v223, v223, v113
    v_mfma_f32_32x32x16_bf16 v[64:79], a[148:151], v[36:39], v[64:79]
    ds_read_b64_tr_b16 a[164:165], v217 offset:16384
    ds_read_b64_tr_b16 a[166:167], v217 offset:20480
    v_cvt_pk_bf16_f32 v184, v112, v113
    v_exp_f32 v116, v116
    v_mfma_f32_32x32x16_bf16 v[80:95], a[148:151], v[44:47], v[80:95]
    v_exp_f32 v117, v117
    v_add_f32 v222, v222, v114
    v_add_f32 v223, v223, v115
    v_cvt_pk_bf16_f32 v185, v114, v115
    s_waitcnt lgkmcnt(4)
    v_mfma_f32_32x32x16_bf16 v[64:79], a[152:155], v[48:51], v[64:79]
    ds_read_b64_tr_b16 a[168:169], v218 offset:16384
    ds_read_b64_tr_b16 a[170:171], v218 offset:20480
    v_exp_f32 v118, v118
    v_exp_f32 v119, v119
    v_mfma_f32_32x32x16_bf16 v[80:95], a[152:155], v[56:59], v[80:95]
    s_add_u32 m0, s75, 16384
    s_nop 0
    buffer_load_dwordx4 v237, s[36:39], s76 offen lds
    v_add_f32 v222, v222, v116
    v_mfma_f32_32x32x16_bf16 v[64:79], a[156:159], v[52:55], v[64:79]
    ds_read_b64_tr_b16 a[172:173], v219 offset:16384
    ds_read_b64_tr_b16 a[174:175], v219 offset:20480
    v_add_f32 v223, v223, v117
    v_cvt_pk_bf16_f32 v186, v116, v117
    v_exp_f32 v104, v104
    v_mfma_f32_32x32x16_bf16 v[80:95], a[156:159], v[60:63], v[80:95]
    v_exp_f32 v105, v105
    v_add_f32 v222, v222, v118
    v_add_f32 v223, v223, v119
    v_cvt_pk_bf16_f32 v187, v118, v119
    s_waitcnt lgkmcnt(4)
    v_mfma_f32_32x32x16_bf16 a[0:15], a[160:163], v[160:163], a[0:15]
    ds_read_b64_tr_b16 a[176:177], v216 offset:24576
    ds_read_b64_tr_b16 a[178:179], v216 offset:28672
    v_exp_f32 v106, v106
    v_exp_f32 v107, v107
    v_mfma_f32_32x32x16_bf16 a[16:31], a[160:163], v[168:171], a[16:31]
    v_add_f32 v220, v220, v104
    v_add_f32 v221, v221, v105
    v_cvt_pk_bf16_f32 v180, v104, v105
    v_exp_f32 v108, v108
    v_mfma_f32_32x32x16_bf16 a[32:47], a[164:167], v[160:163], a[32:47]
    ds_read_b64_tr_b16 a[180:181], v217 offset:24576
    ds_read_b64_tr_b16 a[182:183], v217 offset:28672
    v_exp_f32 v109, v109
    v_add_f32 v220, v220, v106
    v_add_f32 v221, v221, v107
    v_mfma_f32_32x32x16_bf16 a[48:63], a[164:167], v[168:171], a[48:63]
    buffer_load_dwordx4 a[236:239], v244, s[40:43], s84 offen
    v_cvt_pk_bf16_f32 v181, v106, v107
    s_add_u32 s84, s84, 110592
    s_waitcnt lgkmcnt(4)
    v_mfma_f32_32x32x16_bf16 a[64:79], a[168:171], v[160:163], a[64:79]
    ds_read_b64_tr_b16 a[184:185], v218 offset:24576
    ds_read_b64_tr_b16 a[186:187], v218 offset:28672
    v_exp_f32 v110, v110
    v_exp_f32 v111, v111
    v_mfma_f32_32x32x16_bf16 a[80:95], a[168:171], v[168:171], a[80:95]
    v_add_f32 v220, v220, v108
    v_add_f32 v221, v221, v109
    v_cvt_pk_bf16_f32 v182, v108, v109
    v_exp_f32 v120, v120
    v_mfma_f32_32x32x16_bf16 a[96:111], a[172:175], v[160:163], a[96:111]
    ds_read_b64_tr_b16 a[188:189], v219 offset:24576
    ds_read_b64_tr_b16 a[190:191], v219 offset:28672
    v_exp_f32 v121, v121
    v_add_f32 v220, v220, v110
    v_add_f32 v221, v221, v111
    v_mfma_f32_32x32x16_bf16 a[112:127], a[172:175], v[168:171], a[112:127]
    s_waitcnt vmcnt(1)
    s_barrier
    s_add_u32 m0, s72, 65536
    ds_read_b64_tr_b16 a[216:217], v228 offset:0
    ds_read_b64_tr_b16 a[218:219], v228 offset:2560
    ds_read_b64_tr_b16 a[220:221], v229 offset:0
    s_waitcnt lgkmcnt(7)
    v_mfma_f32_32x32x16_bf16 a[0:15], a[176:179], v[164:167], a[0:15]
    ds_read_b128 a[128:131], v208 offset:32768
    ds_read_b64_tr_b16 a[222:223], v229 offset:2560
    ds_read_b64_tr_b16 a[224:225], v230 offset:0
    ds_read_b64_tr_b16 a[226:227], v230 offset:2560
    ds_read_b64_tr_b16 a[228:229], v231 offset:0
    ds_read_b64_tr_b16 a[230:231], v231 offset:2560
    v_mfma_f32_32x32x16_bf16 a[16:31], a[176:179], v[172:175], a[16:31]
    buffer_load_dwordx4 v255, s[56:59], s83 offen offset:2048 lds
    ds_read_b64_tr_b16 a[232:233], v232 offset:0
    v_cvt_pk_bf16_f32 v183, v110, v111
    v_mfma_f32_32x32x16_bf16 a[32:47], a[180:183], v[164:167], a[32:47]
    ds_read_b128 a[132:135], v209 offset:32768
    ds_read_b64_tr_b16 a[234:235], v232 offset:2560
    v_exp_f32 v122, v122
    v_exp_f32 v123, v123
    v_mfma_f32_32x32x16_bf16 a[48:63], a[180:183], v[172:175], a[48:63]
    buffer_load_dwordx4 v255, s[56:59], s83 offen offset:3072 lds
    s_add_u32 s83, s83, 8192
    s_and_b32 s83, s83, 0x1ffff
    s_waitcnt lgkmcnt(12)
    v_mfma_f32_32x32x16_bf16 a[64:79], a[184:187], v[164:167], a[64:79]
    ds_read_b128 a[136:139], v210 offset:32768
    s_waitcnt lgkmcnt(11)
    buffer_store_dwordx4 a[216:219], v245, s[32:35], s78 offen offset:0 sc1
    v_add_f32 v222, v222, v120
    v_mfma_f32_32x32x16_bf16 a[80:95], a[184:187], v[172:175], a[80:95]
    v_add_f32 v223, v223, v121
    v_cvt_pk_bf16_f32 v188, v120, v121
    v_exp_f32 v124, v124
    v_exp_f32 v125, v125
    v_mfma_f32_32x32x16_bf16 a[96:111], a[188:191], v[164:167], a[96:111]
    ds_read_b128 a[140:143], v211 offset:32768
    v_add_f32 v222, v222, v122
    v_add_f32 v223, v223, v123
    v_cvt_pk_bf16_f32 v189, v122, v123
    v_exp_f32 v126, v126
    v_mfma_f32_32x32x16_bf16 a[112:127], a[188:191], v[172:175], a[112:127]
    v_exp_f32 v127, v127
    v_add_f32 v222, v222, v124
    v_add_f32 v223, v223, v125
    v_cvt_pk_bf16_f32 v190, v124, v125
    v_add_f32 v222, v222, v126
    v_add_f32 v223, v223, v127
    v_cvt_pk_bf16_f32 v191, v126, v127
    s_waitcnt lgkmcnt(3)
    v_mfma_f32_32x32x16_bf16 v[96:111], a[128:131], v[0:3], v[128:143]
    ds_read_b128 a[144:147], v212 offset:32768
    v_exp_f32 v64, v64
    v_exp_f32 v65, v65
    v_mfma_f32_32x32x16_bf16 v[112:127], a[128:131], v[8:11], v[144:159]
    buffer_load_dwordx2 v[192:193], v194, s[32:35], s77 offen sc1
    v_exp_f32 v66, v66
    v_mfma_f32_32x32x16_bf16 v[96:111], a[132:135], v[4:7], v[96:111]
    ds_read_b128 a[148:151], v213 offset:32768
    v_exp_f32 v67, v67
    v_add_f32 v220, v220, v64
    v_add_f32 v221, v221, v65
    v_mfma_f32_32x32x16_bf16 v[112:127], a[132:135], v[12:15], v[112:127]
    v_cvt_pk_bf16_f32 v160, v64, v65
    v_exp_f32 v68, v68
    v_exp_f32 v69, v69
    s_waitcnt lgkmcnt(2)
    v_mfma_f32_32x32x16_bf16 v[96:111], a[136:139], v[16:19], v[96:111]
    ds_read_b128 a[152:155], v214 offset:32768
    buffer_store_dwordx4 a[220:223], v245, s[32:35], s78 offen offset:1024 sc1
    v_add_f32 v220, v220, v66
    v_mfma_f32_32x32x16_bf16 v[112:127], a[136:139], v[24:27], v[112:127]
    v_add_f32 v221, v221, v67
    v_cvt_pk_bf16_f32 v161, v66, v67
    v_exp_f32 v70, v70
    v_exp_f32 v71, v71
    v_mfma_f32_32x32x16_bf16 v[96:111], a[140:143], v[20:23], v[96:111]
    ds_read_b128 a[156:159], v215 offset:32768
    buffer_store_dwordx4 a[224:227], v245, s[32:35], s78 offen offset:2048 sc1
    v_add_f32 v220, v220, v68
    v_mfma_f32_32x32x16_bf16 v[112:127], a[140:143], v[28:31], v[112:127]
    v_add_f32 v221, v221, v69
    v_cvt_pk_bf16_f32 v162, v68, v69
    v_exp_f32 v80, v80
    s_waitcnt lgkmcnt(2)
    v_mfma_f32_32x32x16_bf16 v[96:111], a[144:147], v[32:35], v[96:111]
    ds_read_b64_tr_b16 a[160:161], v216 offset:32768
    ds_read_b64_tr_b16 a[162:163], v216 offset:36864
    v_exp_f32 v81, v81
    v_add_f32 v220, v220, v70
    v_mfma_f32_32x32x16_bf16 v[112:127], a[144:147], v[40:43], v[112:127]
    v_add_f32 v221, v221, v71
    v_cvt_pk_bf16_f32 v163, v70, v71
    v_exp_f32 v82, v82
    v_exp_f32 v83, v83
    v_mfma_f32_32x32x16_bf16 v[96:111], a[148:151], v[36:39], v[96:111]
    ds_read_b64_tr_b16 a[164:165], v217 offset:32768
    ds_read_b64_tr_b16 a[166:167], v217 offset:36864
    v_add_f32 v222, v222, v80
    v_add_f32 v223, v223, v81
    v_cvt_pk_bf16_f32 v168, v80, v81
    v_mfma_f32_32x32x16_bf16 v[112:127], a[148:151], v[44:47], v[112:127]
    v_exp_f32 v84, v84
    v_exp_f32 v85, v85
    s_waitcnt lgkmcnt(4)
    v_mfma_f32_32x32x16_bf16 v[96:111], a[152:155], v[48:51], v[96:111]
    ds_read_b64_tr_b16 a[168:169], v218 offset:32768
    ds_read_b64_tr_b16 a[170:171], v218 offset:36864
    buffer_store_dwordx4 a[228:231], v245, s[32:35], s78 offen offset:3072 sc1
    v_mfma_f32_32x32x16_bf16 v[112:127], a[152:155], v[56:59], v[112:127]
    v_add_f32 v222, v222, v82
    v_add_f32 v223, v223, v83
    v_cvt_pk_bf16_f32 v169, v82, v83
    v_exp_f32 v86, v86
    v_mfma_f32_32x32x16_bf16 v[96:111], a[156:159], v[52:55], v[96:111]
    ds_read_b64_tr_b16 a[172:173], v219 offset:32768
    ds_read_b64_tr_b16 a[174:175], v219 offset:36864
    v_exp_f32 v87, v87
    v_add_f32 v222, v222, v84
    v_mfma_f32_32x32x16_bf16 v[112:127], a[156:159], v[60:63], v[112:127]
    v_add_f32 v223, v223, v85
    v_cvt_pk_bf16_f32 v170, v84, v85
    v_exp_f32 v72, v72
    s_waitcnt lgkmcnt(4)
    v_mfma_f32_32x32x16_bf16 a[0:15], a[160:163], v[176:179], a[0:15]
    ds_read_b64_tr_b16 a[176:177], v216 offset:40960
    ds_read_b64_tr_b16 a[178:179], v216 offset:45056
    v_exp_f32 v73, v73
    v_add_f32 v222, v222, v86
    v_mfma_f32_32x32x16_bf16 a[16:31], a[160:163], v[184:187], a[16:31]
    v_add_f32 v223, v223, v87
    v_cvt_pk_bf16_f32 v171, v86, v87
    v_exp_f32 v74, v74
    v_exp_f32 v75, v75
    v_mfma_f32_32x32x16_bf16 a[32:47], a[164:167], v[176:179], a[32:47]
    ds_read_b64_tr_b16 a[180:181], v217 offset:40960
    ds_read_b64_tr_b16 a[182:183], v217 offset:45056
    v_add_f32 v220, v220, v72
    v_add_f32 v221, v221, v73
    v_cvt_pk_bf16_f32 v164, v72, v73
    v_mfma_f32_32x32x16_bf16 a[48:63], a[164:167], v[184:187], a[48:63]
    buffer_store_dwordx4 a[232:235], v238, s[32:35], s78 offen sc1
    s_waitcnt lgkmcnt(4)
    v_mfma_f32_32x32x16_bf16 a[64:79], a[168:171], v[176:179], a[64:79]
    ds_read_b64_tr_b16 a[184:185], v218 offset:40960
    ds_read_b64_tr_b16 a[186:187], v218 offset:45056
    v_exp_f32 v76, v76
    v_exp_f32 v77, v77
    v_mfma_f32_32x32x16_bf16 a[80:95], a[168:171], v[184:187], a[80:95]
    v_add_f32 v220, v220, v74
    v_add_f32 v221, v221, v75
    v_cvt_pk_bf16_f32 v165, v74, v75
    v_exp_f32 v78, v78
    v_mfma_f32_32x32x16_bf16 a[96:111], a[172:175], v[176:179], a[96:111]
    ds_read_b64_tr_b16 a[188:189], v219 offset:40960
    ds_read_b64_tr_b16 a[190:191], v219 offset:45056
    v_exp_f32 v79, v79
    v_add_f32 v220, v220, v76
    v_add_f32 v221, v221, v77
    v_mfma_f32_32x32x16_bf16 a[112:127], a[172:175], v[184:187], a[112:127]
    s_barrier
    s_add_u32 m0, s72, 81920
    v_cvt_pk_bf16_f32 v166, v76, v77
    v_exp_f32 v88, v88
    s_waitcnt lgkmcnt(4)
    v_mfma_f32_32x32x16_bf16 a[0:15], a[176:179], v[180:183], a[0:15]
    ds_read_b128 a[128:131], v208 offset:49152
    v_exp_f32 v89, v89
    v_add_f32 v220, v220, v78
    v_add_f32 v221, v221, v79
    v_mfma_f32_32x32x16_bf16 a[16:31], a[176:179], v[188:191], a[16:31]
    buffer_load_dwordx4 v255, s[56:59], s83 offen offset:2048 lds
    buffer_load_dwordx4 a[240:243], v244, s[40:43], s84 offen
    s_add_u32 s84, s84, 110592
    v_mfma_f32_32x32x16_bf16 a[32:47], a[180:183], v[180:183], a[32:47]
    ds_read_b128 a[132:135], v209 offset:49152
    v_cvt_pk_bf16_f32 v167, v78, v79
    v_exp_f32 v90, v90
    v_exp_f32 v91, v91
    v_mfma_f32_32x32x16_bf16 a[48:63], a[180:183], v[188:191], a[48:63]
    buffer_load_dwordx4 v255, s[56:59], s83 offen offset:3072 lds
    s_add_u32 s83, s83, 8192
    s_and_b32 s83, s83, 0x1ffff
    s_waitcnt lgkmcnt(2)
    v_mfma_f32_32x32x16_bf16 a[64:79], a[184:187], v[180:183], a[64:79]
    ds_read_b128 a[136:139], v210 offset:49152
    v_add_f32 v222, v222, v88
    v_add_f32 v223, v223, v89
    v_cvt_pk_bf16_f32 v172, v88, v89
    v_exp_f32 v92, v92
    v_mfma_f32_32x32x16_bf16 a[80:95], a[184:187], v[188:191], a[80:95]
    v_exp_f32 v93, v93
    v_add_f32 v222, v222, v90
    v_add_f32 v223, v223, v91
    v_cvt_pk_bf16_f32 v173, v90, v91
    v_mfma_f32_32x32x16_bf16 a[96:111], a[188:191], v[180:183], a[96:111]
    ds_read_b128 a[140:143], v211 offset:49152
    v_exp_f32 v94, v94
    v_exp_f32 v95, v95
    v_add_f32 v222, v222, v92
    v_mfma_f32_32x32x16_bf16 a[112:127], a[188:191], v[188:191], a[112:127]
    v_add_f32 v223, v223, v93
    v_cvt_pk_bf16_f32 v174, v92, v93
    v_add_f32 v222, v222, v94
    v_add_f32 v223, v223, v95
    v_cvt_pk_bf16_f32 v175, v94, v95
    s_waitcnt lgkmcnt(2)
    v_mfma_f32_32x32x16_bf16 v[64:79], a[128:131], v[0:3], v[128:143]
    ds_read_b128 a[144:147], v212 offset:49152
    v_exp_f32 v96, v96
    v_exp_f32 v97, v97
    v_mfma_f32_32x32x16_bf16 v[80:95], a[128:131], v[8:11], v[144:159]
    v_exp_f32 v98, v98
    v_exp_f32 v99, v99
    s_waitcnt vmcnt(7)
    v_xor_b32 v192, s65, v192
    v_mfma_f32_32x32x16_bf16 v[64:79], a[132:135], v[4:7], v[64:79]
    ds_read_b128 a[148:151], v213 offset:49152
    v_add_f32 v220, v220, v96
    v_add_f32 v221, v221, v97
    v_cvt_pk_bf16_f32 v176, v96, v97
    v_xor_b32 v193, s65, v193
    v_or_b32 v192, v192, v193
    v_mfma_f32_32x32x16_bf16 v[80:95], a[132:135], v[12:15], v[80:95]
    v_exp_f32 v100, v100
    v_exp_f32 v101, v101
    v_add_f32 v220, v220, v98
    s_waitcnt lgkmcnt(2)
    v_mfma_f32_32x32x16_bf16 v[64:79], a[136:139], v[16:19], v[64:79]
    ds_read_b128 a[152:155], v214 offset:49152
    v_add_f32 v221, v221, v99
    v_cvt_pk_bf16_f32 v177, v98, v99
    v_cmp_ne_u32 vcc, 0, v192
    s_nop 1
    s_cbranch_vccz P1_FWOK
    s_mov_b32 s85, 100000
POLL_8:
    buffer_load_dwordx2 v[192:193], v194, s[32:35], s77 offen sc1
    s_waitcnt vmcnt(0)
    v_xor_b32 v192, s65, v192
    v_xor_b32 v193, s65, v193
    v_or_b32 v192, v192, v193
    v_cmp_ne_u32 vcc, 0, v192
    s_nop 1
    s_cbranch_vccz POLLD_9
    s_sub_u32 s85, s85, 1
    s_cbranch_scc1 F_END
    s_sleep 1
    s_branch POLL_8
POLLD_9:
P1_FWOK:
    v_mfma_f32_32x32x16_bf16 v[80:95], a[136:139], v[24:27], v[80:95]
    v_exp_f32 v102, v102
    v_exp_f32 v103, v103
    v_add_f32 v220, v220, v100
    s_lshl_b32 s70, s22, 2
    v_mfma_f32_32x32x16_bf16 v[64:79], a[140:143], v[20:23], v[64:79]
    ds_read_b128 a[156:159], v215 offset:49152
    v_add_f32 v221, v221, v101
    v_cvt_pk_bf16_f32 v178, v100, v101
    s_add_u32 s70, s70, s64
    s_mul_i32 s70, s70, 163840
    v_mfma_f32_32x32x16_bf16 v[80:95], a[140:143], v[28:31], v[80:95]
    v_exp_f32 v112, v112
    v_exp_f32 v113, v113
    s_add_u32 s70, s70, 10485760
    s_waitcnt lgkmcnt(2)
    v_mfma_f32_32x32x16_bf16 v[64:79], a[144:147], v[32:35], v[64:79]
    ds_read_b64_tr_b16 a[160:161], v216 offset:49152
    ds_read_b64_tr_b16 a[162:163], v216 offset:53248
    v_add_f32 v220, v220, v102
    v_add_f32 v221, v221, v103
    v_cvt_pk_bf16_f32 v179, v102, v103
    v_mfma_f32_32x32x16_bf16 v[80:95], a[144:147], v[40:43], v[80:95]
    buffer_load_dwordx4 a[192:195], v245, s[32:35], s70 offen sc1
    v_exp_f32 v114, v114
    v_mfma_f32_32x32x16_bf16 v[64:79], a[148:151], v[36:39], v[64:79]
    ds_read_b64_tr_b16 a[164:165], v217 offset:49152
    ds_read_b64_tr_b16 a[166:167], v217 offset:53248
    buffer_load_dwordx4 a[196:199], v245, s[32:35], s70 offen offset:1024 sc1
    v_mfma_f32_32x32x16_bf16 v[80:95], a[148:151], v[44:47], v[80:95]
    v_exp_f32 v115, v115
    v_add_f32 v222, v222, v112
    v_add_f32 v223, v223, v113
    v_cvt_pk_bf16_f32 v184, v112, v113
    s_waitcnt lgkmcnt(4)
    v_mfma_f32_32x32x16_bf16 v[64:79], a[152:155], v[48:51], v[64:79]
    ds_read_b64_tr_b16 a[168:169], v218 offset:49152
    ds_read_b64_tr_b16 a[170:171], v218 offset:53248
    buffer_load_dwordx4 a[200:203], v245, s[32:35], s70 offen offset:2048 sc1
    v_mfma_f32_32x32x16_bf16 v[80:95], a[152:155], v[56:59], v[80:95]
    buffer_load_dwordx4 a[208:211], v245, s[32:35], s70 offen offset:3072 sc1
    v_exp_f32 v116, v116
    v_mfma_f32_32x32x16_bf16 v[64:79], a[156:159], v[52:55], v[64:79]
    ds_read_b64_tr_b16 a[172:173], v219 offset:49152
    ds_read_b64_tr_b16 a[174:175], v219 offset:53248
    v_exp_f32 v117, v117
    v_add_f32 v222, v222, v114
    v_subrev_u32 v208, 0x10000, v208
    v_mfma_f32_32x32x16_bf16 v[80:95], a[156:159], v[60:63], v[80:95]
    buffer_load_dwordx4 a[212:215], v238, s[32:35], s70 offen sc1
    v_subrev_u32 v209, 0x10000, v209
    v_subrev_u32 v210, 0x10000, v210
    s_waitcnt lgkmcnt(4)
    v_mfma_f32_32x32x16_bf16 a[0:15], a[160:163], v[160:163], a[0:15]
    ds_read_b64_tr_b16 a[176:177], v216 offset:57344
    ds_read_b64_tr_b16 a[178:179], v216 offset:61440
    v_subrev_u32 v211, 0x10000, v211
    v_subrev_u32 v212, 0x10000, v212
    v_subrev_u32 v213, 0x10000, v213
    s_add_u32 s70, s70, 5120
    v_mfma_f32_32x32x16_bf16 a[16:31], a[160:163], v[168:171], a[16:31]
    buffer_load_dwordx4 v[200:203], v245, s[32:35], s70 offen sc1
    v_subrev_u32 v214, 0x10000, v214
    v_subrev_u32 v215, 0x10000, v215
    v_add_f32 v223, v223, v115
    v_mfma_f32_32x32x16_bf16 a[32:47], a[164:167], v[160:163], a[32:47]
    ds_read_b64_tr_b16 a[180:181], v217 offset:57344
    ds_read_b64_tr_b16 a[182:183], v217 offset:61440
    v_cvt_pk_bf16_f32 v185, v114, v115
    v_exp_f32 v118, v118
    v_mfma_f32_32x32x16_bf16 a[48:63], a[164:167], v[168:171], a[48:63]
    buffer_load_dwordx4 v[204:207], v245, s[32:35], s70 offen offset:1024 sc1
    v_exp_f32 v119, v119
    s_waitcnt lgkmcnt(4)
    v_mfma_f32_32x32x16_bf16 a[64:79], a[168:171], v[160:163], a[64:79]
    ds_read_b64_tr_b16 a[184:185], v218 offset:57344
    ds_read_b64_tr_b16 a[186:187], v218 offset:61440
    buffer_load_dwordx4 v[240:243], v245, s[32:35], s70 offen offset:2048 sc1
    v_add_f32 v222, v222, v116
    v_mfma_f32_32x32x16_bf16 a[80:95], a[168:171], v[168:171], a[80:95]
    v_add_f32 v223, v223, v117
    v_cvt_pk_bf16_f32 v186, v116, v117
    v_exp_f32 v104, v104
    v_exp_f32 v105, v105
    v_mfma_f32_32x32x16_bf16 a[96:111], a[172:175], v[160:163], a[96:111]
    ds_read_b64_tr_b16 a[188:189], v219 offset:57344
    ds_read_b64_tr_b16 a[190:191], v219 offset:61440
    buffer_load_dwordx4 v[228:231], v245, s[32:35], s70 offen offset:3072 sc1
    v_add_f32 v222, v222, v118
    v_mfma_f32_32x32x16_bf16 a[112:127], a[172:175], v[168:171], a[112:127]
    s_barrier
    buffer_load_dwordx4 v[232:235], v238, s[32:35], s70 offen sc1
    v_add_f32 v223, v223, v119
    s_waitcnt lgkmcnt(4)
    v_mfma_f32_32x32x16_bf16 a[0:15], a[176:179], v[164:167], a[0:15]
    ds_read_b128 a[128:131], v208 offset:16384
    v_cvt_pk_bf16_f32 v187, v118, v119
    v_exp_f32 v106, v106
    s_add_u32 s70, s70, 5120
    v_mfma_f32_32x32x16_bf16 a[16:31], a[176:179], v[172:175], a[16:31]
    v_exp_f32 v107, v107
    v_add_f32 v220, v220, v104
    v_add_f32 v221, v221, v105
    v_cvt_pk_bf16_f32 v180, v104, v105
    v_mfma_f32_32x32x16_bf16 a[32:47], a[180:183], v[164:167], a[32:47]
    ds_read_b128 a[132:135], v209 offset:16384
    buffer_load_dwordx4 v[196:199], v245, s[32:35], s70 offen sc1
    v_exp_f32 v108, v108
    v_mfma_f32_32x32x16_bf16 a[48:63], a[180:183], v[172:175], a[48:63]
    buffer_load_dwordx4 a[216:219], v245, s[32:35], s70 offen offset:1024 sc1
    v_exp_f32 v109, v109
    s_waitcnt lgkmcnt(2)
    v_mfma_f32_32x32x16_bf16 a[64:79], a[184:187], v[164:167], a[64:79]
    ds_read_b128 a[136:139], v210 offset:16384
    v_add_f32 v220, v220, v106
    v_add_f32 v221, v221, v107
    v_cvt_pk_bf16_f32 v181, v106, v107
    v_exp_f32 v110, v110
    v_mfma_f32_32x32x16_bf16 a[80:95], a[184:187], v[172:175], a[80:95]
    buffer_load_dwordx4 a[220:223], v245, s[32:35], s70 offen offset:2048 sc1
    v_exp_f32 v111, v111
    v_add_f32 v220, v220, v108
    v_mfma_f32_32x32x16_bf16 a[96:111], a[188:191], v[164:167], a[96:111]
    ds_read_b128 a[140:143], v211 offset:16384
    buffer_load_dwordx4 a[224:227], v245, s[32:35], s70 offen offset:3072 sc1
    v_add_f32 v221, v221, v109
    v_cvt_pk_bf16_f32 v182, v108, v109
    v_mfma_f32_32x32x16_bf16 a[112:127], a[188:191], v[172:175], a[112:127]
    v_exp_f32 v120, v120
    v_exp_f32 v121, v121
    v_add_f32 v220, v220, v110
    v_add_f32 v221, v221, v111
    v_cvt_pk_bf16_f32 v183, v110, v111
    v_exp_f32 v122, v122
    v_exp_f32 v123, v123
    v_add_f32 v222, v222, v120
    v_subrev_u32 v216, 0x10000, v216
    v_subrev_u32 v217, 0x10000, v217
    v_subrev_u32 v218, 0x10000, v218
    v_subrev_u32 v219, 0x10000, v219
    v_add_f32 v223, v223, v121
    v_cvt_pk_bf16_f32 v188, v120, v121
    v_exp_f32 v124, v124
    v_exp_f32 v125, v125
    v_add_f32 v222, v222, v122
    v_add_f32 v223, v223, v123
    v_cvt_pk_bf16_f32 v189, v122, v123
    v_exp_f32 v126, v126
    v_exp_f32 v127, v127
    v_add_f32 v222, v222, v124
    v_add_f32 v223, v223, v125
    v_cvt_pk_bf16_f32 v190, v124, v125
    v_add_f32 v222, v222, v126
    v_add_f32 v223, v223, v127
    v_cvt_pk_bf16_f32 v191, v126, v127
    s_waitcnt lgkmcnt(2)
    v_mfma_f32_32x32x16_bf16 v[96:111], a[128:131], v[0:3], v[128:143]
    ds_read_b128 a[144:147], v212 offset:16384
    v_exp_f32 v64, v64
    v_exp_f32 v65, v65
    v_mfma_f32_32x32x16_bf16 v[112:127], a[128:131], v[8:11], v[144:159]
    buffer_load_dwordx4 a[228:231], v238, s[32:35], s70 offen sc1
    v_exp_f32 v66, v66
    s_add_u32 s70, s70, 5120
    v_mfma_f32_32x32x16_bf16 v[96:111], a[132:135], v[4:7], v[96:111]
    ds_read_b128 a[148:151], v213 offset:16384
    v_exp_f32 v67, v67
    v_add_f32 v220, v220, v64
    v_add_f32 v221, v221, v65
    v_cvt_pk_bf16_f32 v160, v64, v65
    v_mfma_f32_32x32x16_bf16 v[112:127], a[132:135], v[12:15], v[112:127]
    buffer_load_dwordx4 a[232:235], v245, s[32:35], s70 offen sc1
    s_lshl_b32 s71, s22, 2
    s_waitcnt lgkmcnt(2)
    v_mfma_f32_32x32x16_bf16 v[96:111], a[136:139], v[16:19], v[96:111]
    ds_read_b128 a[152:155], v214 offset:16384
    buffer_load_dwordx4 a[244:247], v244, s[40:43], s84 offen
    v_exp_f32 v68, v68
    v_mfma_f32_32x32x16_bf16 v[112:127], a[136:139], v[24:27], v[112:127]
    v_exp_f32 v69, v69
    v_add_f32 v220, v220, v66
    v_add_f32 v221, v221, v67
    s_add_u32 s84, s84, 110592
    s_add_u32 s71, s71, s64
    v_mfma_f32_32x32x16_bf16 v[96:111], a[140:143], v[20:23], v[96:111]
    ds_read_b128 a[156:159], v215 offset:16384
    v_cvt_pk_bf16_f32 v161, v66, v67
    v_exp_f32 v70, v70
    v_exp_f32 v71, v71
    v_mfma_f32_32x32x16_bf16 v[112:127], a[140:143], v[28:31], v[112:127]
    buffer_load_dwordx4 a[248:251], v244, s[40:43], s84 offen
    v_add_f32 v220, v220, v68
    s_add_u32 s84, s84, 110592
    s_waitcnt lgkmcnt(2)
    v_mfma_f32_32x32x16_bf16 v[96:111], a[144:147], v[32:35], v[96:111]
    ds_read_b64_tr_b16 a[160:161], v216 offset:16384
    ds_read_b64_tr_b16 a[162:163], v216 offset:20480
    v_add_f32 v221, v221, v69
    v_cvt_pk_bf16_f32 v162, v68, v69
    s_mul_i32 s71, s71, 163840
    s_add_u32 s71, s71, 10613760
    v_mfma_f32_32x32x16_bf16 v[112:127], a[144:147], v[40:43], v[112:127]
    v_exp_f32 v80, v80
    v_exp_f32 v81, v81
    v_add_f32 v220, v220, v70
    v_add_f32 v221, v221, v71
    v_mfma_f32_32x32x16_bf16 v[96:111], a[148:151], v[36:39], v[96:111]
    ds_read_b64_tr_b16 a[164:165], v217 offset:16384
    ds_read_b64_tr_b16 a[166:167], v217 offset:20480
    buffer_load_dwordx4 a[252:255], v244, s[40:43], s84 offen
    s_mul_i32 s75, s64, 5120
    v_mfma_f32_32x32x16_bf16 v[112:127], a[148:151], v[44:47], v[112:127]
    v_cvt_pk_bf16_f32 v163, v70, v71
    v_exp_f32 v82, v82
    v_exp_f32 v83, v83
    s_waitcnt lgkmcnt(4)
    v_mfma_f32_32x32x16_bf16 v[96:111], a[152:155], v[48:51], v[96:111]
    ds_read_b64_tr_b16 a[168:169], v218 offset:16384
    ds_read_b64_tr_b16 a[170:171], v218 offset:20480
    v_add_f32 v222, v222, v80
    v_add_f32 v223, v223, v81
    v_cvt_pk_bf16_f32 v168, v80, v81
    v_mfma_f32_32x32x16_bf16 v[112:127], a[152:155], v[56:59], v[112:127]
    s_add_u32 m0, s75, 140800
    s_nop 0
    buffer_load_dwordx4 v245, s[32:35], s71 offen offset:0 sc1 lds
    v_mfma_f32_32x32x16_bf16 v[96:111], a[156:159], v[52:55], v[96:111]
    ds_read_b64_tr_b16 a[172:173], v219 offset:16384
    ds_read_b64_tr_b16 a[174:175], v219 offset:20480
    buffer_load_dwordx4 v245, s[32:35], s71 offen offset:1024 sc1 lds
    v_mfma_f32_32x32x16_bf16 v[112:127], a[156:159], v[60:63], v[112:127]
    v_exp_f32 v84, v84
    v_exp_f32 v85, v85
    v_add_f32 v222, v222, v82
    s_waitcnt lgkmcnt(4)
    v_mfma_f32_32x32x16_bf16 a[0:15], a[160:163], v[176:179], a[0:15]
    ds_read_b64_tr_b16 a[176:177], v216 offset:24576
    ds_read_b64_tr_b16 a[178:179], v216 offset:28672
    buffer_load_dwordx4 v245, s[32:35], s71 offen offset:2048 sc1 lds
    v_add_f32 v223, v223, v83
    v_mfma_f32_32x32x16_bf16 a[16:31], a[160:163], v[184:187], a[16:31]
    v_cvt_pk_bf16_f32 v169, v82, v83
    v_exp_f32 v86, v86
    v_exp_f32 v87, v87
    v_add_f32 v222, v222, v84
    v_mfma_f32_32x32x16_bf16 a[32:47], a[164:167], v[176:179], a[32:47]
    ds_read_b64_tr_b16 a[180:181], v217 offset:24576
    ds_read_b64_tr_b16 a[182:183], v217 offset:28672
    buffer_load_dwordx4 v245, s[32:35], s71 offen offset:3072 sc1 lds
    v_add_f32 v223, v223, v85
    v_mfma_f32_32x32x16_bf16 a[48:63], a[164:167], v[184:187], a[48:63]
    v_cvt_pk_bf16_f32 v170, v84, v85
    v_exp_f32 v72, v72
    v_exp_f32 v73, v73
    s_waitcnt lgkmcnt(4)
    v_mfma_f32_32x32x16_bf16 a[64:79], a[168:171], v[176:179], a[64:79]
    ds_read_b64_tr_b16 a[184:185], v218 offset:24576
    ds_read_b64_tr_b16 a[186:187], v218 offset:28672
    v_add_f32 v222, v222, v86
    v_add_f32 v223, v223, v87
    v_cvt_pk_bf16_f32 v171, v86, v87
    v_mfma_f32_32x32x16_bf16 a[80:95], a[168:171], v[184:187], a[80:95]
    s_add_u32 m0, m0, 1024
    s_add_u32 s71, s71, 1024
    buffer_load_dwordx4 v245, s[32:35], s71 offen offset:3072 sc1 lds
    v_mfma_f32_32x32x16_bf16 a[96:111], a[172:175], v[176:179], a[96:111]
    ds_read_b64_tr_b16 a[188:189], v219 offset:24576
    ds_read_b64_tr_b16 a[190:191], v219 offset:28672
    v_exp_f32 v74, v74
    v_exp_f32 v75, v75
    v_mfma_f32_32x32x16_bf16 a[112:127], a[172:175], v[184:187], a[112:127]
    s_barrier
    v_add_f32 v220, v220, v72
    v_add_f32 v221, v221, v73
    v_cvt_pk_bf16_f32 v164, v72, v73
    s_waitcnt lgkmcnt(4)
    v_mfma_f32_32x32x16_bf16 a[0:15], a[176:179], v[180:183], a[0:15]
    ds_read_b128 a[128:131], v208 offset:32768
    s_add_u32 m0, s72, 0
    s_add_u32 s71, s71, 4096
    buffer_load_dwordx4 v245, s[32:35], s71 offen offset:0 sc1 lds
    v_mfma_f32_32x32x16_bf16 a[16:31], a[176:179], v[188:191], a[16:31]
    s_nop 0
    buffer_load_dwordx4 v245, s[32:35], s71 offen offset:1024 sc1 lds
    v_exp_f32 v76, v76
    v_mfma_f32_32x32x16_bf16 a[32:47], a[180:183], v[180:183], a[32:47]
    ds_read_b128 a[132:135], v209 offset:32768
    v_exp_f32 v77, v77
    v_add_f32 v220, v220, v74
    v_add_f32 v221, v221, v75
    v_cvt_pk_bf16_f32 v165, v74, v75
    v_mfma_f32_32x32x16_bf16 a[48:63], a[180:183], v[188:191], a[48:63]
    buffer_load_dwordx4 v245, s[32:35], s71 offen offset:2048 sc1 lds
    v_exp_f32 v78, v78
    s_waitcnt lgkmcnt(2)
    v_mfma_f32_32x32x16_bf16 a[64:79], a[184:187], v[180:183], a[64:79]
    ds_read_b128 a[136:139], v210 offset:32768
    v_exp_f32 v79, v79
    v_add_f32 v220, v220, v76
    v_add_f32 v221, v221, v77
    v_cvt_pk_bf16_f32 v166, v76, v77
    v_mfma_f32_32x32x16_bf16 a[80:95], a[184:187], v[188:191], a[80:95]
    buffer_load_dwordx4 v245, s[32:35], s71 offen offset:3072 sc1 lds
    v_exp_f32 v88, v88
    v_mfma_f32_32x32x16_bf16 a[96:111], a[188:191], v[180:183], a[96:111]
    ds_read_b128 a[140:143], v211 offset:32768
    v_exp_f32 v89, v89
    v_add_f32 v220, v220, v78
    v_add_f32 v221, v221, v79
    v_cvt_pk_bf16_f32 v167, v78, v79
    v_mfma_f32_32x32x16_bf16 a[112:127], a[188:191], v[188:191], a[112:127]
    v_exp_f32 v90, v90
    v_exp_f32 v91, v91
    v_add_f32 v222, v222, v88
    v_add_f32 v223, v223, v89
    v_cvt_pk_bf16_f32 v172, v88, v89
    v_exp_f32 v92, v92
    v_exp_f32 v93, v93
    v_add_f32 v222, v222, v90
    v_add_f32 v223, v223, v91
    v_cvt_pk_bf16_f32 v173, v90, v91
    v_exp_f32 v94, v94
    v_exp_f32 v95, v95
    v_add_f32 v222, v222, v92
    v_add_f32 v223, v223, v93
    v_cvt_pk_bf16_f32 v174, v92, v93
    v_add_f32 v222, v222, v94
    v_add_f32 v223, v223, v95
    v_cvt_pk_bf16_f32 v175, v94, v95
    s_waitcnt lgkmcnt(2)
    v_mfma_f32_32x32x16_bf16 v[64:79], a[128:131], v[0:3], v[128:143]
    ds_read_b128 a[144:147], v212 offset:32768
    v_exp_f32 v96, v96
    v_exp_f32 v97, v97
    v_mfma_f32_32x32x16_bf16 v[80:95], a[128:131], v[8:11], v[144:159]
    v_exp_f32 v98, v98
    v_exp_f32 v99, v99
    v_add_f32 v220, v220, v96
    v_mfma_f32_32x32x16_bf16 v[64:79], a[132:135], v[4:7], v[64:79]
    ds_read_b128 a[148:151], v213 offset:32768
    s_add_u32 m0, s72, 98304
    s_add_u32 s71, s71, 4096
    buffer_load_dwordx4 v245, s[32:35], s71 offen offset:0 sc1 lds
    v_mfma_f32_32x32x16_bf16 v[80:95], a[132:135], v[12:15], v[80:95]
    v_add_f32 v221, v221, v97
    v_cvt_pk_bf16_f32 v176, v96, v97
    v_exp_f32 v100, v100
    s_waitcnt lgkmcnt(2)
    v_mfma_f32_32x32x16_bf16 v[64:79], a[136:139], v[16:19], v[64:79]
    ds_read_b128 a[152:155], v214 offset:32768
    s_nop 0
    buffer_load_dwordx4 v245, s[32:35], s71 offen offset:1024 sc1 lds
    v_mfma_f32_32x32x16_bf16 v[80:95], a[136:139], v[24:27], v[80:95]
    buffer_load_dwordx4 v245, s[32:35], s71 offen offset:2048 sc1 lds
    v_exp_f32 v101, v101
    v_add_f32 v220, v220, v98
    v_mfma_f32_32x32x16_bf16 v[64:79], a[140:143], v[20:23], v[64:79]
    ds_read_b128 a[156:159], v215 offset:32768
    buffer_load_dwordx4 v245, s[32:35], s71 offen offset:3072 sc1 lds
    v_add_f32 v221, v221, v99
    v_cvt_pk_bf16_f32 v177, v98, v99
    v_mfma_f32_32x32x16_bf16 v[80:95], a[140:143], v[28:31], v[80:95]
    v_exp_f32 v102, v102
    v_exp_f32 v103, v103
    s_waitcnt lgkmcnt(2)
    v_mfma_f32_32x32x16_bf16 v[64:79], a[144:147], v[32:35], v[64:79]
    ds_read_b64_tr_b16 a[160:161], v216 offset:32768
    ds_read_b64_tr_b16 a[162:163], v216 offset:36864
    v_add_f32 v220, v220, v100
    v_add_f32 v221, v221, v101
    v_cvt_pk_bf16_f32 v178, v100, v101
    v_mfma_f32_32x32x16_bf16 v[80:95], a[144:147], v[40:43], v[80:95]
    v_exp_f32 v112, v112
    v_exp_f32 v113, v113
    v_add_f32 v220, v220, v102
    v_mfma_f32_32x32x16_bf16 v[64:79], a[148:151], v[36:39], v[64:79]
    ds_read_b64_tr_b16 a[164:165], v217 offset:32768
    ds_read_b64_tr_b16 a[166:167], v217 offset:36864
    v_add_f32 v221, v221, v103
    v_cvt_pk_bf16_f32 v179, v102, v103
    v_exp_f32 v114, v114
    v_mfma_f32_32x32x16_bf16 v[80:95], a[148:151], v[44:47], v[80:95]
    v_exp_f32 v115, v115
    v_add_f32 v222, v222, v112
    v_add_f32 v223, v223, v113
    s_waitcnt lgkmcnt(4)
    v_mfma_f32_32x32x16_bf16 v[64:79], a[152:155], v[48:51], v[64:79]
    ds_read_b64_tr_b16 a[168:169], v218 offset:32768
    ds_read_b64_tr_b16 a[170:171], v218 offset:36864
    v_cvt_pk_bf16_f32 v184, v112, v113
    v_exp_f32 v116, v116
    v_mfma_f32_32x32x16_bf16 v[80:95], a[152:155], v[56:59], v[80:95]
    v_exp_f32 v117, v117
    v_add_f32 v222, v222, v114
    v_add_f32 v223, v223, v115
    v_cvt_pk_bf16_f32 v185, v114, v115
    v_mfma_f32_32x32x16_bf16 v[64:79], a[156:159], v[52:55], v[64:79]
    ds_read_b64_tr_b16 a[172:173], v219 offset:32768
    ds_read_b64_tr_b16 a[174:175], v219 offset:36864
    v_exp_f32 v118, v118
    v_exp_f32 v119, v119
    v_mfma_f32_32x32x16_bf16 v[80:95], a[156:159], v[60:63], v[80:95]
    v_add_f32 v222, v222, v116
    v_add_f32 v223, v223, v117
    v_cvt_pk_bf16_f32 v186, v116, v117
    v_exp_f32 v104, v104
    s_waitcnt lgkmcnt(4)
    v_mfma_f32_32x32x16_bf16 a[0:15], a[160:163], v[160:163], a[0:15]
    ds_read_b64_tr_b16 a[176:177], v216 offset:40960
    ds_read_b64_tr_b16 a[178:179], v216 offset:45056
    v_exp_f32 v105, v105
    v_add_f32 v222, v222, v118
    v_mfma_f32_32x32x16_bf16 a[16:31], a[160:163], v[168:171], a[16:31]
    v_add_f32 v223, v223, v119
    v_cvt_pk_bf16_f32 v187, v118, v119
    v_exp_f32 v106, v106
    v_exp_f32 v107, v107
    v_mfma_f32_32x32x16_bf16 a[32:47], a[164:167], v[160:163], a[32:47]
    ds_read_b64_tr_b16 a[180:181], v217 offset:40960
    ds_read_b64_tr_b16 a[182:183], v217 offset:45056
    v_add_f32 v220, v220, v104
    v_add_f32 v221, v221, v105
    v_cvt_pk_bf16_f32 v180, v104, v105
    v_mfma_f32_32x32x16_bf16 a[48:63], a[164:167], v[168:171], a[48:63]
    v_exp_f32 v108, v108
    v_exp_f32 v109, v109
    s_waitcnt lgkmcnt(4)
    v_mfma_f32_32x32x16_bf16 a[64:79], a[168:171], v[160:163], a[64:79]
    ds_read_b64_tr_b16 a[184:185], v218 offset:40960
    ds_read_b64_tr_b16 a[186:187], v218 offset:45056
    v_add_f32 v220, v220, v106
    v_add_f32 v221, v221, v107
    v_cvt_pk_bf16_f32 v181, v106, v107
    v_mfma_f32_32x32x16_bf16 a[80:95], a[168:171], v[168:171], a[80:95]
    v_exp_f32 v110, v110
    v_exp_f32 v111, v111
    v_add_f32 v220, v220, v108
    v_mfma_f32_32x32x16_bf16 a[96:111], a[172:175], v[160:163], a[96:111]
    ds_read_b64_tr_b16 a[188:189], v219 offset:40960
    ds_read_b64_tr_b16 a[190:191], v219 offset:45056
    v_add_f32 v221, v221, v109
    v_cvt_pk_bf16_f32 v182, v108, v109
    v_exp_f32 v120, v120
    v_mfma_f32_32x32x16_bf16 a[112:127], a[172:175], v[168:171], a[112:127]
    s_barrier
    v_exp_f32 v121, v121
    v_add_f32 v220, v220, v110
    s_waitcnt lgkmcnt(4)
    v_mfma_f32_32x32x16_bf16 a[0:15], a[176:179], v[164:167], a[0:15]
    ds_read_b128 a[128:131], v208 offset:49152
    s_add_u32 m0, s72, 114688
    s_add_u32 s71, s71, 4096
    buffer_load_dwordx4 v245, s[32:35], s71 offen offset:0 sc1 lds
    v_mfma_f32_32x32x16_bf16 a[16:31], a[176:179], v[172:175], a[16:31]
    s_nop 0
    buffer_load_dwordx4 v245, s[32:35], s71 offen offset:1024 sc1 lds
    buffer_load_dwordx4 v245, s[32:35], s71 offen offset:2048 sc1 lds
    v_mfma_f32_32x32x16_bf16 a[32:47], a[180:183], v[164:167], a[32:47]
    ds_read_b128 a[132:135], v209 offset:49152
    buffer_load_dwordx4 v245, s[32:35], s71 offen offset:3072 sc1 lds
    v_add_f32 v221, v221, v111
    v_cvt_pk_bf16_f32 v183, v110, v111
    v_mfma_f32_32x32x16_bf16 a[48:63], a[180:183], v[172:175], a[48:63]
    v_exp_f32 v122, v122
    v_exp_f32 v123, v123
    s_waitcnt lgkmcnt(2)
    v_mfma_f32_32x32x16_bf16 a[64:79], a[184:187], v[164:167], a[64:79]
    ds_read_b128 a[136:139], v210 offset:49152
    v_add_f32 v222, v222, v120
    v_add_f32 v223, v223, v121
    v_cvt_pk_bf16_f32 v188, v120, v121
    v_exp_f32 v124, v124
    v_mfma_f32_32x32x16_bf16 a[80:95], a[184:187], v[172:175], a[80:95]
    v_exp_f32 v125, v125
    v_add_f32 v222, v222, v122
    v_add_f32 v223, v223, v123
    v_cvt_pk_bf16_f32 v189, v122, v123
    v_mfma_f32_32x32x16_bf16 a[96:111], a[188:191], v[164:167], a[96:111]
    ds_read_b128 a[140:143], v211 offset:49152
    v_exp_f32 v126, v126
    v_exp_f32 v127, v127
    v_add_f32 v222, v222, v124
    v_mfma_f32_32x32x16_bf16 a[112:127], a[188:191], v[172:175], a[112:127]
    v_add_f32 v223, v223, v125
    v_cvt_pk_bf16_f32 v190, v124, v125
    v_add_f32 v222, v222, v126
    v_add_f32 v223, v223, v127
    v_cvt_pk_bf16_f32 v191, v126, v127
    s_waitcnt lgkmcnt(2)
    v_mfma_f32_32x32x16_bf16 v[96:111], a[128:131], v[0:3], v[128:143]
    ds_read_b128 a[144:147], v212 offset:49152
    v_exp_f32 v64, v64
    v_exp_f32 v65, v65
    v_mfma_f32_32x32x16_bf16 v[112:127], a[128:131], v[8:11], v[144:159]
    v_exp_f32 v66, v66
    v_exp_f32 v67, v67
    v_add_f32 v220, v220, v64
    v_mfma_f32_32x32x16_bf16 v[96:111], a[132:135], v[4:7], v[96:111]
    ds_read_b128 a[148:151], v213 offset:49152
    v_add_f32 v221, v221, v65
    v_cvt_pk_bf16_f32 v160, v64, v65
    v_exp_f32 v68, v68
    v_mfma_f32_32x32x16_bf16 v[112:127], a[132:135], v[12:15], v[112:127]
    v_exp_f32 v69, v69
    v_add_f32 v220, v220, v66
    v_add_f32 v221, v221, v67
    s_waitcnt lgkmcnt(2)
    v_mfma_f32_32x32x16_bf16 v[96:111], a[136:139], v[16:19], v[96:111]
    ds_read_b128 a[152:155], v214 offset:49152
    v_cvt_pk_bf16_f32 v161, v66, v67
    v_exp_f32 v70, v70
    v_exp_f32 v71, v71
    v_mfma_f32_32x32x16_bf16 v[112:127], a[136:139], v[24:27], v[112:127]
    v_add_f32 v220, v220, v68
    v_add_f32 v221, v221, v69
    v_cvt_pk_bf16_f32 v162, v68, v69
    v_exp_f32 v80, v80
    v_mfma_f32_32x32x16_bf16 v[96:111], a[140:143], v[20:23], v[96:111]
    ds_read_b128 a[156:159], v215 offset:49152
    v_exp_f32 v81, v81
    v_add_f32 v220, v220, v70
    v_add_f32 v221, v221, v71
    v_mfma_f32_32x32x16_bf16 v[112:127], a[140:143], v[28:31], v[112:127]
    v_cvt_pk_bf16_f32 v163, v70, v71
    v_exp_f32 v82, v82
    s_waitcnt lgkmcnt(2)
    v_mfma_f32_32x32x16_bf16 v[96:111], a[144:147], v[32:35], v[96:111]
    ds_read_b64_tr_b16 a[160:161], v216 offset:49152
    ds_read_b64_tr_b16 a[162:163], v216 offset:53248
    v_exp_f32 v83, v83
    v_add_f32 v222, v222, v80
    v_mfma_f32_32x32x16_bf16 v[112:127], a[144:147], v[40:43], v[112:127]
    v_add_f32 v223, v223, v81
    v_cvt_pk_bf16_f32 v168, v80, v81
    v_exp_f32 v84, v84
    v_mfma_f32_32x32x16_bf16 v[96:111], a[148:151], v[36:39], v[96:111]
    ds_read_b64_tr_b16 a[164:165], v217 offset:49152
    ds_read_b64_tr_b16 a[166:167], v217 offset:53248
    v_exp_f32 v85, v85
    v_add_f32 v222, v222, v82
    v_mfma_f32_32x32x16_bf16 v[112:127], a[148:151], v[44:47], v[112:127]
    v_add_f32 v223, v223, v83
    v_cvt_pk_bf16_f32 v169, v82, v83
    v_exp_f32 v86, v86
    s_waitcnt lgkmcnt(4)
    v_mfma_f32_32x32x16_bf16 v[96:111], a[152:155], v[48:51], v[96:111]
    ds_read_b64_tr_b16 a[168:169], v218 offset:49152
    ds_read_b64_tr_b16 a[170:171], v218 offset:53248
    v_exp_f32 v87, v87
    v_add_f32 v222, v222, v84
    v_mfma_f32_32x32x16_bf16 v[112:127], a[152:155], v[56:59], v[112:127]
    v_add_f32 v223, v223, v85
    v_cvt_pk_bf16_f32 v170, v84, v85
    v_exp_f32 v72, v72
    v_mfma_f32_32x32x16_bf16 v[96:111], a[156:159], v[52:55], v[96:111]
    ds_read_b64_tr_b16 a[172:173], v219 offset:49152
    ds_read_b64_tr_b16 a[174:175], v219 offset:53248
    v_exp_f32 v73, v73
    v_add_f32 v222, v222, v86
    v_mfma_f32_32x32x16_bf16 v[112:127], a[156:159], v[60:63], v[112:127]
    v_add_f32 v223, v223, v87
    v_cvt_pk_bf16_f32 v171, v86, v87
    v_exp_f32 v74, v74
    s_waitcnt lgkmcnt(4)
    v_mfma_f32_32x32x16_bf16 a[0:15], a[160:163], v[176:179], a[0:15]
    ds_read_b64_tr_b16 a[176:177], v216 offset:57344
    ds_read_b64_tr_b16 a[178:179], v216 offset:61440
    v_exp_f32 v75, v75
    v_add_f32 v220, v220, v72
    v_mfma_f32_32x32x16_bf16 a[16:31], a[160:163], v[184:187], a[16:31]
    v_add_f32 v221, v221, v73
    v_cvt_pk_bf16_f32 v164, v72, v73
    v_exp_f32 v76, v76
    v_exp_f32 v77, v77
    v_mfma_f32_32x32x16_bf16 a[32:47], a[164:167], v[176:179], a[32:47]
    ds_read_b64_tr_b16 a[180:181], v217 offset:57344
    ds_read_b64_tr_b16 a[182:183], v217 offset:61440
    v_add_f32 v220, v220, v74
    v_add_f32 v221, v221, v75
    v_cvt_pk_bf16_f32 v165, v74, v75
    v_mfma_f32_32x32x16_bf16 a[48:63], a[164:167], v[184:187], a[48:63]
    v_exp_f32 v78, v78
    v_exp_f32 v79, v79
    s_waitcnt lgkmcnt(4)
    v_mfma_f32_32x32x16_bf16 a[64:79], a[168:171], v[176:179], a[64:79]
    ds_read_b64_tr_b16 a[184:185], v218 offset:57344
    ds_read_b64_tr_b16 a[186:187], v218 offset:61440
    v_add_f32 v220, v220, v76
    v_mfma_f32_32x32x16_bf16 a[80:95], a[168:171], v[184:187], a[80:95]
    v_mfma_f32_32x32x16_bf16 a[96:111], a[172:175], v[176:179], a[96:111]
    ds_read_b64_tr_b16 a[188:189], v219 offset:57344
    ds_read_b64_tr_b16 a[190:191], v219 offset:61440
    v_add_u32 v216, 0x10000, v216
    v_add_u32 v217, 0x10000, v217
    v_add_u32 v218, 0x10000, v218
    v_add_u32 v219, 0x10000, v219
    v_mfma_f32_32x32x16_bf16 a[112:127], a[172:175], v[184:187], a[112:127]
    s_barrier
    v_add_f32 v221, v221, v77
    v_cvt_pk_bf16_f32 v166, v76, v77
    v_exp_f32 v88, v88
    s_waitcnt lgkmcnt(4)
    v_mfma_f32_32x32x16_bf16 a[0:15], a[176:179], v[180:183], a[0:15]
    ds_read_b64_tr_b16 a[128:129], v216 offset:0
    ds_read_b64_tr_b16 a[130:131], v216 offset:4096
    v_exp_f32 v89, v89
    v_add_f32 v220, v220, v78
    v_add_f32 v221, v221, v79
    v_mfma_f32_32x32x16_bf16 a[16:31], a[176:179], v[188:191], a[16:31]
    s_add_u32 m0, s72, 16384
    s_add_u32 s71, s71, 4096
    buffer_load_dwordx4 v245, s[32:35], s71 offen offset:0 sc1 lds
    v_cvt_pk_bf16_f32 v167, v78, v79
    v_mfma_f32_32x32x16_bf16 a[32:47], a[180:183], v[180:183], a[32:47]
    ds_read_b64_tr_b16 a[132:133], v217 offset:0
    ds_read_b64_tr_b16 a[134:135], v217 offset:4096
    s_nop 0
    buffer_load_dwordx4 v245, s[32:35], s71 offen offset:1024 sc1 lds
    v_mfma_f32_32x32x16_bf16 a[48:63], a[180:183], v[188:191], a[48:63]
    buffer_load_dwordx4 v245, s[32:35], s71 offen offset:2048 sc1 lds
    buffer_load_dwordx4 v245, s[32:35], s71 offen offset:3072 sc1 lds
    s_waitcnt lgkmcnt(4)
    v_mfma_f32_32x32x16_bf16 a[64:79], a[184:187], v[180:183], a[64:79]
    ds_read_b64_tr_b16 a[136:137], v218 offset:0
    ds_read_b64_tr_b16 a[138:139], v218 offset:4096
    v_exp_f32 v90, v90
    v_exp_f32 v91, v91
    v_mfma_f32_32x32x16_bf16 a[80:95], a[184:187], v[188:191], a[80:95]
    v_add_f32 v222, v222, v88
    v_add_f32 v223, v223, v89
    v_cvt_pk_bf16_f32 v172, v88, v89
    v_exp_f32 v92, v92
    v_mfma_f32_32x32x16_bf16 a[96:111], a[188:191], v[180:183], a[96:111]
    ds_read_b64_tr_b16 a[140:141], v219 offset:0
    ds_read_b64_tr_b16 a[142:143], v219 offset:4096
    v_exp_f32 v93, v93
    v_add_f32 v222, v222, v90
    v_add_f32 v223, v223, v91
    v_mfma_f32_32x32x16_bf16 a[112:127], a[188:191], v[188:191], a[112:127]
    v_cvt_pk_bf16_f32 v173, v90, v91
    v_exp_f32 v94, v94
    v_exp_f32 v95, v95
    v_add_f32 v222, v222, v92
    v_add_f32 v223, v223, v93
    v_cvt_pk_bf16_f32 v174, v92, v93
    v_add_f32 v222, v222, v94
    v_add_f32 v223, v223, v95
    v_cvt_pk_bf16_f32 v175, v94, v95
    s_lshl_b32 s81, s64, 5
    s_lshl_b32 s82, s23, 9
    s_add_u32 s82, s82, s81
    s_lshl_b32 s82, s82, 10
    s_add_u32 s44, s82, 33554432
    s_lshl_b32 s83, s22, 7
    s_add_u32 s83, s83, s81
    s_mul_i32 s83, s83, 5120
    s_add_u32 s52, s83, 10485760
    s_add_u32 s53, s83, 10490880
    s_add_u32 s54, s83, 10496000
    s_add_u32 s55, s83, 10501120
    s_add_u32 s56, s83, 10506240
    s_add_u32 s57, s83, 10511360
    s_add_u32 s58, s83, 10516480
    s_add_u32 s59, s83, 10521600
    v_mov_b32 v0, v245
    v_add_u32 v4, 0, v0
    v_add_u32 v5, 4096, v0
    v_add_u32 v248, 40960, v0
    v_add_u32 v249, 45056, v0
    v_add_u32 v250, 81920, v0
    v_add_u32 v251, 86016, v0
    v_add_u32 v252, 122880, v0
    v_add_u32 v253, 126976, v0
    s_mov_b32 s73, 0
    s_bfe_u32 s76, s2, 65539
    s_waitcnt lgkmcnt(4)
    v_mfma_f32_32x32x16_bf16 a[0:15], a[128:131], v[160:163], a[0:15]
    buffer_load_dwordx4 v[128:131], v4, s[32:35], s55 offen offset:1024 sc1
    ds_read_b64_tr_b16 a[144:145], v216 offset:8192
    ds_read_b64_tr_b16 a[146:147], v216 offset:12288
    ds_read_b64_tr_b16 a[148:149], v217 offset:8192
    ds_read_b64_tr_b16 a[150:151], v217 offset:12288
    v_exp_f32 v96, v96
    v_mfma_f32_32x32x16_bf16 a[16:31], a[128:131], v[168:171], a[16:31]
    buffer_load_dwordx4 v[132:135], v4, s[32:35], s55 offen offset:2048 sc1
    ds_read_b64_tr_b16 a[152:153], v218 offset:8192
    ds_read_b64_tr_b16 a[154:155], v218 offset:12288
    ds_read_b64_tr_b16 a[156:157], v219 offset:8192
    ds_read_b64_tr_b16 a[158:159], v219 offset:12288
    v_exp_f32 v97, v97
    v_mfma_f32_32x32x16_bf16 a[32:47], a[132:135], v[160:163], a[32:47]
    s_waitcnt vmcnt(42)
    s_barrier
    v_exp_f32 v98, v98
    buffer_load_dwordx4 v[136:139], v4, s[32:35], s55 offen offset:3072 sc1
    v_exp_f32 v99, v99
    v_add_f32 v220, v220, v96
    v_mfma_f32_32x32x16_bf16 a[48:63], a[132:135], v[168:171], a[48:63]
    ds_read_b64_tr_b16 a[160:161], v216 offset:16384
    ds_read_b64_tr_b16 a[162:163], v216 offset:20480
    v_add_f32 v221, v221, v97
    v_cvt_pk_bf16_f32 v176, v96, v97
    s_waitcnt lgkmcnt(10)
    v_mfma_f32_32x32x16_bf16 a[64:79], a[136:139], v[160:163], a[64:79]
    buffer_load_dwordx4 v[140:143], v5, s[32:35], s55 offen sc1
    ds_read_b64_tr_b16 a[164:165], v217 offset:16384
    ds_read_b64_tr_b16 a[166:167], v217 offset:20480
    v_exp_f32 v100, v100
    v_exp_f32 v101, v101
    v_mfma_f32_32x32x16_bf16 a[80:95], a[136:139], v[168:171], a[80:95]
    buffer_load_dwordx4 v[144:147], v4, s[32:35], s56 offen sc1
    ds_read_b64_tr_b16 a[168:169], v218 offset:16384
    ds_read_b64_tr_b16 a[170:171], v218 offset:20480
    v_add_f32 v220, v220, v98
    v_add_f32 v221, v221, v99
    v_cvt_pk_bf16_f32 v177, v98, v99
    v_mfma_f32_32x32x16_bf16 a[96:111], a[140:143], v[160:163], a[96:111]
    ds_read_b64_tr_b16 a[172:173], v219 offset:16384
    ds_read_b64_tr_b16 a[174:175], v219 offset:20480
    v_exp_f32 v102, v102
    v_exp_f32 v103, v103
    buffer_load_dwordx4 v[148:151], v4, s[32:35], s56 offen offset:1024 sc1
    v_mfma_f32_32x32x16_bf16 a[112:127], a[140:143], v[168:171], a[112:127]
    ds_read_b64_tr_b16 a[176:177], v216 offset:24576
    ds_read_b64_tr_b16 a[178:179], v216 offset:28672
    v_add_f32 v220, v220, v100
    v_add_f32 v221, v221, v101
    v_cvt_pk_bf16_f32 v178, v100, v101
    s_waitcnt lgkmcnt(14)
    v_mfma_f32_32x32x16_bf16 a[0:15], a[144:147], v[164:167], a[0:15]
    buffer_load_dwordx4 v[152:155], v4, s[32:35], s56 offen offset:2048 sc1
    ds_read_b64_tr_b16 a[180:181], v217 offset:24576
    ds_read_b64_tr_b16 a[182:183], v217 offset:28672
    v_exp_f32 v112, v112
    v_exp_f32 v113, v113
    v_mfma_f32_32x32x16_bf16 a[16:31], a[144:147], v[172:175], a[16:31]
    ds_read_b64_tr_b16 a[184:185], v218 offset:24576
    ds_read_b64_tr_b16 a[186:187], v218 offset:28672
    v_add_f32 v220, v220, v102
    buffer_load_dwordx4 v[156:159], v4, s[32:35], s56 offen offset:3072 sc1
    v_add_f32 v221, v221, v103
    v_cvt_pk_bf16_f32 v179, v102, v103
    v_mfma_f32_32x32x16_bf16 a[32:47], a[148:151], v[164:167], a[32:47]
    ds_read_b64_tr_b16 a[188:189], v219 offset:24576
    ds_read_b64_tr_b16 a[190:191], v219 offset:28672
    v_exp_f32 v114, v114
    v_exp_f32 v115, v115
    v_mfma_f32_32x32x16_bf16 a[48:63], a[148:151], v[172:175], a[48:63]
    buffer_load_dwordx4 v[32:35], v5, s[32:35], s56 offen sc1
    v_add_f32 v222, v222, v112
    v_add_f32 v223, v223, v113
    v_cvt_pk_bf16_f32 v184, v112, v113
    v_exp_f32 v116, v116
    s_waitcnt lgkmcnt(15)
    v_mfma_f32_32x32x16_bf16 a[64:79], a[152:155], v[164:167], a[64:79]
    v_exp_f32 v117, v117
    buffer_load_dwordx4 v[36:39], v4, s[32:35], s57 offen sc1
    v_add_f32 v222, v222, v114
    v_add_f32 v223, v223, v115
    v_cvt_pk_bf16_f32 v185, v114, v115
    v_mfma_f32_32x32x16_bf16 a[80:95], a[152:155], v[172:175], a[80:95]
    v_exp_f32 v118, v118
    v_exp_f32 v119, v119
    v_add_f32 v222, v222, v116
    v_add_f32 v223, v223, v117
    v_mfma_f32_32x32x16_bf16 a[96:111], a[156:159], v[164:167], a[96:111]
    buffer_load_dwordx4 v[40:43], v4, s[32:35], s57 offen offset:1024 sc1
    v_cvt_pk_bf16_f32 v186, v116, v117
    v_exp_f32 v104, v104
    v_exp_f32 v105, v105
    v_add_f32 v222, v222, v118
    v_mfma_f32_32x32x16_bf16 a[112:127], a[156:159], v[172:175], a[112:127]
    buffer_load_dwordx4 v[44:47], v4, s[32:35], s57 offen offset:2048 sc1
    v_add_f32 v223, v223, v119
    v_cvt_pk_bf16_f32 v187, v118, v119
    v_exp_f32 v106, v106
    v_exp_f32 v107, v107
    v_add_f32 v220, v220, v104
    v_add_f32 v221, v221, v105
    v_cvt_pk_bf16_f32 v180, v104, v105
    v_exp_f32 v108, v108
    v_exp_f32 v109, v109
    v_add_f32 v220, v220, v106
    v_add_f32 v221, v221, v107
    v_cvt_pk_bf16_f32 v181, v106, v107
    v_exp_f32 v110, v110
    buffer_load_dwordx4 v[48:51], v4, s[32:35], s57 offen offset:3072 sc1
    v_exp_f32 v111, v111
    v_add_f32 v220, v220, v108
    v_add_f32 v221, v221, v109
    v_cvt_pk_bf16_f32 v182, v108, v109
    v_exp_f32 v120, v120
    v_exp_f32 v121, v121
    v_add_f32 v220, v220, v110
    v_add_f32 v221, v221, v111
    v_cvt_pk_bf16_f32 v183, v110, v111
    v_exp_f32 v122, v122
    v_exp_f32 v123, v123
    v_add_f32 v222, v222, v120
    v_add_f32 v223, v223, v121
    buffer_load_dwordx4 v[52:55], v5, s[32:35], s57 offen sc1
    v_cvt_pk_bf16_f32 v188, v120, v121
    v_exp_f32 v124, v124
    v_exp_f32 v125, v125
    v_add_f32 v222, v222, v122
    v_add_f32 v223, v223, v123
    v_cvt_pk_bf16_f32 v189, v122, v123
    v_exp_f32 v126, v126
    v_exp_f32 v127, v127
    v_add_f32 v222, v222, v124
    v_add_f32 v223, v223, v125
    v_cvt_pk_bf16_f32 v190, v124, v125
    v_add_f32 v222, v222, v126
    v_add_f32 v223, v223, v127
    v_cvt_pk_bf16_f32 v191, v126, v127
    s_waitcnt lgkmcnt(12)
    v_mfma_f32_32x32x16_bf16 a[0:15], a[160:163], v[176:179], a[0:15]
    buffer_load_dwordx4 v[56:59], v4, s[32:35], s58 offen sc1
    v_mfma_f32_32x32x16_bf16 a[16:31], a[160:163], v[184:187], a[16:31]
    v_mfma_f32_32x32x16_bf16 a[32:47], a[164:167], v[176:179], a[32:47]
    buffer_load_dwordx4 v[60:63], v4, s[32:35], s58 offen offset:1024 sc1
    v_add_f32 v220, v220, v221
    v_mfma_f32_32x32x16_bf16 a[48:63], a[164:167], v[184:187], a[48:63]
    v_mov_b32 v221, v220
    s_waitcnt lgkmcnt(8)
    v_mfma_f32_32x32x16_bf16 a[64:79], a[168:171], v[176:179], a[64:79]
    buffer_load_dwordx4 v[64:67], v4, s[32:35], s58 offen offset:2048 sc1
    v_accvgpr_read_b32 v224, a204
    v_mfma_f32_32x32x16_bf16 a[80:95], a[168:171], v[184:187], a[80:95]
    s_nop 0
    v_permlane32_swap_b32 v220, v221
    v_mfma_f32_32x32x16_bf16 a[96:111], a[172:175], v[176:179], a[96:111]
    buffer_load_dwordx4 v[68:71], v4, s[32:35], s58 offen offset:3072 sc1
    s_nop 0
    v_mfma_f32_32x32x16_bf16 a[112:127], a[172:175], v[184:187], a[112:127]
    v_add_f32 v220, v220, v221
    s_waitcnt lgkmcnt(4)
    v_mfma_f32_32x32x16_bf16 a[0:15], a[176:179], v[180:183], a[0:15]
    buffer_load_dwordx4 v[72:75], v5, s[32:35], s58 offen sc1
    v_rcp_f32 v221, v220
    v_mfma_f32_32x32x16_bf16 a[16:31], a[176:179], v[188:191], a[16:31]
    s_nop 0
    v_add_f32 v222, v222, v223
    v_mfma_f32_32x32x16_bf16 a[32:47], a[180:183], v[180:183], a[32:47]
    buffer_load_dwordx4 v[76:79], v4, s[32:35], s59 offen sc1
    v_mov_b32 v223, v222
    v_mfma_f32_32x32x16_bf16 a[48:63], a[180:183], v[188:191], a[48:63]
    s_nop 1
    s_waitcnt lgkmcnt(0)
    v_mfma_f32_32x32x16_bf16 a[64:79], a[184:187], v[180:183], a[64:79]
    s_waitcnt vmcnt(44)
    buffer_load_dwordx4 v[80:83], v4, s[32:35], s59 offen offset:1024 sc1
    v_permlane32_swap_b32 v222, v223
    v_mfma_f32_32x32x16_bf16 a[80:95], a[184:187], v[188:191], a[80:95]
    s_nop 0
    v_add_f32 v222, v222, v223
    v_mfma_f32_32x32x16_bf16 a[96:111], a[188:191], v[180:183], a[96:111]
    buffer_load_dwordx4 v[84:87], v4, s[32:35], s59 offen offset:2048 sc1
    v_rcp_f32 v223, v222
    v_mfma_f32_32x32x16_bf16 a[112:127], a[188:191], v[188:191], a[112:127]
    s_nop 0
    v_add_f32 v226, v220, v222
    v_mov_b32 v227, 140544
    v_cmp_nge_f32 vcc, 0x67800000, v226
    s_nop 0
    s_cmp_lg_u64 vcc, 0
    s_cselect_b32 s74, 1, 0
    s_cbranch_scc0 P1_EPI
    ds_write_b32 v227, v227
    s_waitcnt lgkmcnt(0)
P1_EPI:
    s_cmp_eq_u32 s76, 0
    s_cbranch_scc1 P1_EPI2
    buffer_load_dwordx4 v[88:91], v4, s[32:35], s59 offen offset:3072 sc1
    buffer_load_dwordx4 v[92:95], v5, s[32:35], s59 offen sc1
    buffer_load_dwordx4 v[192:195], v248, s[32:35], s52 offen sc1
    buffer_load_dwordx4 v[208:211], v248, s[32:35], s52 offen offset:1024 sc1
    buffer_load_dwordx4 v[212:215], v248, s[32:35], s52 offen offset:2048 sc1
    buffer_load_dwordx4 v[216:219], v248, s[32:35], s52 offen offset:3072 sc1
    buffer_load_dwordx4 v[236:239], v249, s[32:35], s52 offen sc1
    buffer_load_dwordx4 v[244:247], v248, s[32:35], s53 offen sc1
    buffer_load_dwordx4 a[160:163], v248, s[32:35], s53 offen offset:1024 sc1
    buffer_load_dwordx4 a[164:167], v248, s[32:35], s53 offen offset:2048 sc1
    buffer_load_dwordx4 a[168:171], v248, s[32:35], s53 offen offset:3072 sc1
    buffer_load_dwordx4 a[172:175], v249, s[32:35], s53 offen sc1
    buffer_load_dwordx4 a[176:179], v248, s[32:35], s54 offen sc1
    buffer_load_dwordx4 a[180:183], v248, s[32:35], s54 offen offset:1024 sc1
    buffer_load_dwordx4 a[184:187], v248, s[32:35], s54 offen offset:2048 sc1
    buffer_load_dwordx4 a[188:191], v248, s[32:35], s54 offen offset:3072 sc1
    buffer_load_dwordx4 a[128:131], v249, s[32:35], s54 offen sc1
    buffer_load_dwordx4 a[132:135], v248, s[32:35], s55 offen sc1
    buffer_load_dwordx4 a[136:139], v248, s[32:35], s55 offen offset:1024 sc1
    buffer_load_dwordx4 a[140:143], v248, s[32:35], s55 offen offset:2048 sc1
    buffer_load_dwordx4 a[144:147], v248, s[32:35], s55 offen offset:3072 sc1
    buffer_load_dwordx4 a[148:151], v249, s[32:35], s55 offen sc1
    buffer_load_dwordx4 a[152:155], v248, s[32:35], s56 offen sc1
    buffer_load_dwordx4 a[156:159], v248, s[32:35], s56 offen offset:1024 sc1
    buffer_load_dwordx4 a[204:207], v248, s[32:35], s56 offen offset:2048 sc1
    s_add_u32 m0, s72, 32768
    s_add_u32 s71, s71, 4096
    buffer_load_dwordx4 v0, s[32:35], s71 offen offset:0 sc1 lds
    buffer_load_dwordx4 v0, s[32:35], s71 offen offset:1024 sc1 lds
    buffer_load_dwordx4 v0, s[32:35], s71 offen offset:2048 sc1 lds
    buffer_load_dwordx4 v0, s[32:35], s71 offen offset:3072 sc1 lds
    s_add_u32 m0, s72, 49152
    s_add_u32 s71, s71, 4096
    buffer_load_dwordx4 v0, s[32:35], s71 offen offset:0 sc1 lds
    buffer_load_dwordx4 v0, s[32:35], s71 offen offset:1024 sc1 lds
    buffer_load_dwordx4 v0, s[32:35], s71 offen offset:2048 sc1 lds
    buffer_load_dwordx4 v0, s[32:35], s71 offen offset:3072 sc1 lds
P1_EPI2:
    v_accvgpr_read_b32 v96, a0
    v_accvgpr_read_b32 v97, a1
    v_accvgpr_read_b32 v98, a2
    v_accvgpr_read_b32 v99, a3
    v_accvgpr_read_b32 v100, a4
    v_accvgpr_read_b32 v101, a5
    v_accvgpr_read_b32 v102, a6
    v_accvgpr_read_b32 v103, a7
    v_pk_mul_f32 v[96:97], v[96:97], v[220:221] op_sel:[0,1] op_sel_hi:[1,1]
    v_pk_mul_f32 v[98:99], v[98:99], v[220:221] op_sel:[0,1] op_sel_hi:[1,1]
    v_pk_mul_f32 v[100:101], v[100:101], v[220:221] op_sel:[0,1] op_sel_hi:[1,1]
    v_pk_mul_f32 v[102:103], v[102:103], v[220:221] op_sel:[0,1] op_sel_hi:[1,1]
    v_cvt_pk_bf16_f32 v112, v96, v97
    v_cvt_pk_bf16_f32 v113, v98, v99
    v_cvt_pk_bf16_f32 v114, v100, v101
    v_cvt_pk_bf16_f32 v115, v102, v103
    buffer_store_dwordx4 v[112:115], v224, s[32:35], s46 offen offset:0 sc1
    v_accvgpr_read_b32 v104, a8
    v_accvgpr_read_b32 v105, a9
    v_accvgpr_read_b32 v106, a10
    v_accvgpr_read_b32 v107, a11
    v_accvgpr_read_b32 v108, a12
    v_accvgpr_read_b32 v109, a13
    v_accvgpr_read_b32 v110, a14
    v_accvgpr_read_b32 v111, a15
    v_pk_mul_f32 v[104:105], v[104:105], v[220:221] op_sel:[0,1] op_sel_hi:[1,1]
    v_pk_mul_f32 v[106:107], v[106:107], v[220:221] op_sel:[0,1] op_sel_hi:[1,1]
    v_pk_mul_f32 v[108:109], v[108:109], v[220:221] op_sel:[0,1] op_sel_hi:[1,1]
    v_pk_mul_f32 v[110:111], v[110:111], v[220:221] op_sel:[0,1] op_sel_hi:[1,1]
    v_cvt_pk_bf16_f32 v116, v104, v105
    v_cvt_pk_bf16_f32 v117, v106, v107
    v_cvt_pk_bf16_f32 v118, v108, v109
    v_cvt_pk_bf16_f32 v119, v110, v111
    buffer_store_dwordx4 v[116:119], v224, s[32:35], s46 offen offset:512 sc1
    v_accvgpr_read_b32 v96, a16
    v_accvgpr_read_b32 v97, a17
    v_accvgpr_read_b32 v98, a18
    v_accvgpr_read_b32 v99, a19
    v_accvgpr_read_b32 v100, a20
    v_accvgpr_read_b32 v101, a21
    v_accvgpr_read_b32 v102, a22
    v_accvgpr_read_b32 v103, a23
    v_pk_mul_f32 v[96:97], v[96:97], v[222:223] op_sel:[0,1] op_sel_hi:[1,1]
    v_pk_mul_f32 v[98:99], v[98:99], v[222:223] op_sel:[0,1] op_sel_hi:[1,1]
    v_pk_mul_f32 v[100:101], v[100:101], v[222:223] op_sel:[0,1] op_sel_hi:[1,1]
    v_pk_mul_f32 v[102:103], v[102:103], v[222:223] op_sel:[0,1] op_sel_hi:[1,1]
    v_cvt_pk_bf16_f32 v120, v96, v97
    v_cvt_pk_bf16_f32 v121, v98, v99
    v_cvt_pk_bf16_f32 v122, v100, v101
    v_cvt_pk_bf16_f32 v123, v102, v103
    buffer_store_dwordx4 v[120:123], v224, s[32:35], s47 offen offset:0 sc1
    v_accvgpr_read_b32 v104, a24
    v_accvgpr_read_b32 v105, a25
    v_accvgpr_read_b32 v106, a26
    v_accvgpr_read_b32 v107, a27
    v_accvgpr_read_b32 v108, a28
    v_accvgpr_read_b32 v109, a29
    v_accvgpr_read_b32 v110, a30
    v_accvgpr_read_b32 v111, a31
    v_pk_mul_f32 v[104:105], v[104:105], v[222:223] op_sel:[0,1] op_sel_hi:[1,1]
    v_pk_mul_f32 v[106:107], v[106:107], v[222:223] op_sel:[0,1] op_sel_hi:[1,1]
    v_pk_mul_f32 v[108:109], v[108:109], v[222:223] op_sel:[0,1] op_sel_hi:[1,1]
    v_pk_mul_f32 v[110:111], v[110:111], v[222:223] op_sel:[0,1] op_sel_hi:[1,1]
    v_cvt_pk_bf16_f32 v124, v104, v105
    v_cvt_pk_bf16_f32 v125, v106, v107
    v_cvt_pk_bf16_f32 v126, v108, v109
    v_cvt_pk_bf16_f32 v127, v110, v111
    buffer_store_dwordx4 v[124:127], v224, s[32:35], s47 offen offset:512 sc1
    v_accvgpr_read_b32 v96, a32
    v_accvgpr_read_b32 v97, a33
    v_accvgpr_read_b32 v98, a34
    v_accvgpr_read_b32 v99, a35
    v_accvgpr_read_b32 v100, a36
    v_accvgpr_read_b32 v101, a37
    v_accvgpr_read_b32 v102, a38
    v_accvgpr_read_b32 v103, a39
    v_pk_mul_f32 v[96:97], v[96:97], v[220:221] op_sel:[0,1] op_sel_hi:[1,1]
    v_pk_mul_f32 v[98:99], v[98:99], v[220:221] op_sel:[0,1] op_sel_hi:[1,1]
    v_pk_mul_f32 v[100:101], v[100:101], v[220:221] op_sel:[0,1] op_sel_hi:[1,1]
    v_pk_mul_f32 v[102:103], v[102:103], v[220:221] op_sel:[0,1] op_sel_hi:[1,1]
    v_cvt_pk_bf16_f32 v112, v96, v97
    v_cvt_pk_bf16_f32 v113, v98, v99
    v_cvt_pk_bf16_f32 v114, v100, v101
    v_cvt_pk_bf16_f32 v115, v102, v103
    buffer_store_dwordx4 v[112:115], v224, s[32:35], s46 offen offset:1024 sc1
    v_accvgpr_read_b32 v104, a40
    v_accvgpr_read_b32 v105, a41
    v_accvgpr_read_b32 v106, a42
    v_accvgpr_read_b32 v107, a43
    v_accvgpr_read_b32 v108, a44
    v_accvgpr_read_b32 v109, a45
    v_accvgpr_read_b32 v110, a46
    v_accvgpr_read_b32 v111, a47
    v_pk_mul_f32 v[104:105], v[104:105], v[220:221] op_sel:[0,1] op_sel_hi:[1,1]
    v_pk_mul_f32 v[106:107], v[106:107], v[220:221] op_sel:[0,1] op_sel_hi:[1,1]
    v_pk_mul_f32 v[108:109], v[108:109], v[220:221] op_sel:[0,1] op_sel_hi:[1,1]
    v_pk_mul_f32 v[110:111], v[110:111], v[220:221] op_sel:[0,1] op_sel_hi:[1,1]
    v_cvt_pk_bf16_f32 v116, v104, v105
    v_cvt_pk_bf16_f32 v117, v106, v107
    v_cvt_pk_bf16_f32 v118, v108, v109
    v_cvt_pk_bf16_f32 v119, v110, v111
    buffer_store_dwordx4 v[116:119], v224, s[32:35], s46 offen offset:1536 sc1
    v_accvgpr_read_b32 v96, a48
    v_accvgpr_read_b32 v97, a49
    v_accvgpr_read_b32 v98, a50
    v_accvgpr_read_b32 v99, a51
    v_accvgpr_read_b32 v100, a52
    v_accvgpr_read_b32 v101, a53
    v_accvgpr_read_b32 v102, a54
    v_accvgpr_read_b32 v103, a55
    v_pk_mul_f32 v[96:97], v[96:97], v[222:223] op_sel:[0,1] op_sel_hi:[1,1]
    v_pk_mul_f32 v[98:99], v[98:99], v[222:223] op_sel:[0,1] op_sel_hi:[1,1]
    v_pk_mul_f32 v[100:101], v[100:101], v[222:223] op_sel:[0,1] op_sel_hi:[1,1]
    v_pk_mul_f32 v[102:103], v[102:103], v[222:223] op_sel:[0,1] op_sel_hi:[1,1]
    v_cvt_pk_bf16_f32 v120, v96, v97
    v_cvt_pk_bf16_f32 v121, v98, v99
    v_cvt_pk_bf16_f32 v122, v100, v101
    v_cvt_pk_bf16_f32 v123, v102, v103
    buffer_store_dwordx4 v[120:123], v224, s[32:35], s47 offen offset:1024 sc1
    v_accvgpr_read_b32 v104, a56
    v_accvgpr_read_b32 v105, a57
    v_accvgpr_read_b32 v106, a58
    v_accvgpr_read_b32 v107, a59
    v_accvgpr_read_b32 v108, a60
    v_accvgpr_read_b32 v109, a61
    v_accvgpr_read_b32 v110, a62
    v_accvgpr_read_b32 v111, a63
    v_pk_mul_f32 v[104:105], v[104:105], v[222:223] op_sel:[0,1] op_sel_hi:[1,1]
    v_pk_mul_f32 v[106:107], v[106:107], v[222:223] op_sel:[0,1] op_sel_hi:[1,1]
    v_pk_mul_f32 v[108:109], v[108:109], v[222:223] op_sel:[0,1] op_sel_hi:[1,1]
    v_pk_mul_f32 v[110:111], v[110:111], v[222:223] op_sel:[0,1] op_sel_hi:[1,1]
    v_cvt_pk_bf16_f32 v124, v104, v105
    v_cvt_pk_bf16_f32 v125, v106, v107
    v_cvt_pk_bf16_f32 v126, v108, v109
    v_cvt_pk_bf16_f32 v127, v110, v111
    buffer_store_dwordx4 v[124:127], v224, s[32:35], s47 offen offset:1536 sc1
    v_accvgpr_read_b32 v96, a64
    v_accvgpr_read_b32 v97, a65
    v_accvgpr_read_b32 v98, a66
    v_accvgpr_read_b32 v99, a67
    v_accvgpr_read_b32 v100, a68
    v_accvgpr_read_b32 v101, a69
    v_accvgpr_read_b32 v102, a70
    v_accvgpr_read_b32 v103, a71
    v_pk_mul_f32 v[96:97], v[96:97], v[220:221] op_sel:[0,1] op_sel_hi:[1,1]
    v_pk_mul_f32 v[98:99], v[98:99], v[220:221] op_sel:[0,1] op_sel_hi:[1,1]
    v_pk_mul_f32 v[100:101], v[100:101], v[220:221] op_sel:[0,1] op_sel_hi:[1,1]
    v_pk_mul_f32 v[102:103], v[102:103], v[220:221] op_sel:[0,1] op_sel_hi:[1,1]
    v_cvt_pk_bf16_f32 v112, v96, v97
    v_cvt_pk_bf16_f32 v113, v98, v99
    v_cvt_pk_bf16_f32 v114, v100, v101
    v_cvt_pk_bf16_f32 v115, v102, v103
    buffer_store_dwordx4 v[112:115], v224, s[32:35], s46 offen offset:2048 sc1
    v_accvgpr_read_b32 v104, a72
    v_accvgpr_read_b32 v105, a73
    v_accvgpr_read_b32 v106, a74
    v_accvgpr_read_b32 v107, a75
    v_accvgpr_read_b32 v108, a76
    v_accvgpr_read_b32 v109, a77
    v_accvgpr_read_b32 v110, a78
    v_accvgpr_read_b32 v111, a79
    v_pk_mul_f32 v[104:105], v[104:105], v[220:221] op_sel:[0,1] op_sel_hi:[1,1]
    v_pk_mul_f32 v[106:107], v[106:107], v[220:221] op_sel:[0,1] op_sel_hi:[1,1]
    v_pk_mul_f32 v[108:109], v[108:109], v[220:221] op_sel:[0,1] op_sel_hi:[1,1]
    v_pk_mul_f32 v[110:111], v[110:111], v[220:221] op_sel:[0,1] op_sel_hi:[1,1]
    v_cvt_pk_bf16_f32 v116, v104, v105
    v_cvt_pk_bf16_f32 v117, v106, v107
    v_cvt_pk_bf16_f32 v118, v108, v109
    v_cvt_pk_bf16_f32 v119, v110, v111
    buffer_store_dwordx4 v[116:119], v224, s[32:35], s46 offen offset:2560 sc1
    v_accvgpr_read_b32 v96, a80
    v_accvgpr_read_b32 v97, a81
    v_accvgpr_read_b32 v98, a82
    v_accvgpr_read_b32 v99, a83
    v_accvgpr_read_b32 v100, a84
    v_accvgpr_read_b32 v101, a85
    v_accvgpr_read_b32 v102, a86
    v_accvgpr_read_b32 v103, a87
    v_pk_mul_f32 v[96:97], v[96:97], v[222:223] op_sel:[0,1] op_sel_hi:[1,1]
    v_pk_mul_f32 v[98:99], v[98:99], v[222:223] op_sel:[0,1] op_sel_hi:[1,1]
    v_pk_mul_f32 v[100:101], v[100:101], v[222:223] op_sel:[0,1] op_sel_hi:[1,1]
    v_pk_mul_f32 v[102:103], v[102:103], v[222:223] op_sel:[0,1] op_sel_hi:[1,1]
    v_cvt_pk_bf16_f32 v120, v96, v97
    v_cvt_pk_bf16_f32 v121, v98, v99
    v_cvt_pk_bf16_f32 v122, v100, v101
    v_cvt_pk_bf16_f32 v123, v102, v103
    buffer_store_dwordx4 v[120:123], v224, s[32:35], s47 offen offset:2048 sc1
    v_accvgpr_read_b32 v104, a88
    v_accvgpr_read_b32 v105, a89
    v_accvgpr_read_b32 v106, a90
    v_accvgpr_read_b32 v107, a91
    v_accvgpr_read_b32 v108, a92
    v_accvgpr_read_b32 v109, a93
    v_accvgpr_read_b32 v110, a94
    v_accvgpr_read_b32 v111, a95
    v_pk_mul_f32 v[104:105], v[104:105], v[222:223] op_sel:[0,1] op_sel_hi:[1,1]
    v_pk_mul_f32 v[106:107], v[106:107], v[222:223] op_sel:[0,1] op_sel_hi:[1,1]
    v_pk_mul_f32 v[108:109], v[108:109], v[222:223] op_sel:[0,1] op_sel_hi:[1,1]
    v_pk_mul_f32 v[110:111], v[110:111], v[222:223] op_sel:[0,1] op_sel_hi:[1,1]
    v_cvt_pk_bf16_f32 v124, v104, v105
    v_cvt_pk_bf16_f32 v125, v106, v107
    v_cvt_pk_bf16_f32 v126, v108, v109
    v_cvt_pk_bf16_f32 v127, v110, v111
    buffer_store_dwordx4 v[124:127], v224, s[32:35], s47 offen offset:2560 sc1
    v_accvgpr_read_b32 v96, a96
    v_accvgpr_read_b32 v97, a97
    v_accvgpr_read_b32 v98, a98
    v_accvgpr_read_b32 v99, a99
    v_accvgpr_read_b32 v100, a100
    v_accvgpr_read_b32 v101, a101
    v_accvgpr_read_b32 v102, a102
    v_accvgpr_read_b32 v103, a103
    v_pk_mul_f32 v[96:97], v[96:97], v[220:221] op_sel:[0,1] op_sel_hi:[1,1]
    v_pk_mul_f32 v[98:99], v[98:99], v[220:221] op_sel:[0,1] op_sel_hi:[1,1]
    v_pk_mul_f32 v[100:101], v[100:101], v[220:221] op_sel:[0,1] op_sel_hi:[1,1]
    v_pk_mul_f32 v[102:103], v[102:103], v[220:221] op_sel:[0,1] op_sel_hi:[1,1]
    v_cvt_pk_bf16_f32 v112, v96, v97
    v_cvt_pk_bf16_f32 v113, v98, v99
    v_cvt_pk_bf16_f32 v114, v100, v101
    v_cvt_pk_bf16_f32 v115, v102, v103
    buffer_store_dwordx4 v[112:115], v224, s[32:35], s46 offen offset:3072 sc1
    v_accvgpr_read_b32 v104, a104
    v_accvgpr_read_b32 v105, a105
    v_accvgpr_read_b32 v106, a106
    v_accvgpr_read_b32 v107, a107
    v_accvgpr_read_b32 v108, a108
    v_accvgpr_read_b32 v109, a109
    v_accvgpr_read_b32 v110, a110
    v_accvgpr_read_b32 v111, a111
    v_pk_mul_f32 v[104:105], v[104:105], v[220:221] op_sel:[0,1] op_sel_hi:[1,1]
    v_pk_mul_f32 v[106:107], v[106:107], v[220:221] op_sel:[0,1] op_sel_hi:[1,1]
    v_pk_mul_f32 v[108:109], v[108:109], v[220:221] op_sel:[0,1] op_sel_hi:[1,1]
    v_pk_mul_f32 v[110:111], v[110:111], v[220:221] op_sel:[0,1] op_sel_hi:[1,1]
    v_cvt_pk_bf16_f32 v116, v104, v105
    v_cvt_pk_bf16_f32 v117, v106, v107
    v_cvt_pk_bf16_f32 v118, v108, v109
    v_cvt_pk_bf16_f32 v119, v110, v111
    buffer_store_dwordx4 v[116:119], v224, s[32:35], s46 offen offset:3584 sc1
    v_accvgpr_read_b32 v96, a112
    v_accvgpr_read_b32 v97, a113
    v_accvgpr_read_b32 v98, a114
    v_accvgpr_read_b32 v99, a115
    v_accvgpr_read_b32 v100, a116
    v_accvgpr_read_b32 v101, a117
    v_accvgpr_read_b32 v102, a118
    v_accvgpr_read_b32 v103, a119
    v_pk_mul_f32 v[96:97], v[96:97], v[222:223] op_sel:[0,1] op_sel_hi:[1,1]
    v_pk_mul_f32 v[98:99], v[98:99], v[222:223] op_sel:[0,1] op_sel_hi:[1,1]
    v_pk_mul_f32 v[100:101], v[100:101], v[222:223] op_sel:[0,1] op_sel_hi:[1,1]
    v_pk_mul_f32 v[102:103], v[102:103], v[222:223] op_sel:[0,1] op_sel_hi:[1,1]
    v_cvt_pk_bf16_f32 v120, v96, v97
    v_cvt_pk_bf16_f32 v121, v98, v99
    v_cvt_pk_bf16_f32 v122, v100, v101
    v_cvt_pk_bf16_f32 v123, v102, v103
    s_waitcnt vmcnt(44)
    buffer_store_dwordx4 v[120:123], v224, s[32:35], s47 offen offset:3072 sc1
    v_accvgpr_read_b32 v104, a120
    v_accvgpr_read_b32 v105, a121
    v_accvgpr_read_b32 v106, a122
    v_accvgpr_read_b32 v107, a123
    v_accvgpr_read_b32 v108, a124
    v_accvgpr_read_b32 v109, a125
    v_accvgpr_read_b32 v110, a126
    v_accvgpr_read_b32 v111, a127
    v_pk_mul_f32 v[104:105], v[104:105], v[222:223] op_sel:[0,1] op_sel_hi:[1,1]
    v_pk_mul_f32 v[106:107], v[106:107], v[222:223] op_sel:[0,1] op_sel_hi:[1,1]
    v_pk_mul_f32 v[108:109], v[108:109], v[222:223] op_sel:[0,1] op_sel_hi:[1,1]
    v_pk_mul_f32 v[110:111], v[110:111], v[222:223] op_sel:[0,1] op_sel_hi:[1,1]
    v_cvt_pk_bf16_f32 v124, v104, v105
    v_cvt_pk_bf16_f32 v125, v106, v107
    v_cvt_pk_bf16_f32 v126, v108, v109
    v_cvt_pk_bf16_f32 v127, v110, v111
    buffer_store_dwordx4 v[124:127], v224, s[32:35], s47 offen offset:3584 sc1
P1_SKIP:
    s_waitcnt vmcnt(0)
    s_barrier
    ds_read_b32 v226, v227
    s_waitcnt lgkmcnt(0)
    v_readfirstlane_b32 s80, v226
    s_nop 0
    s_min_u32 s80, s80, 1
    s_cmp_gt_u32 s80, s73
    s_cbranch_scc1 P1_SLOW
    s_cmp_lg_u32 s64, 0
    s_cbranch_scc1 SIG_10
    s_mov_b64 exec, 1
    v_mov_b32 v254, s65
    v_mov_b32 v255, 0
    s_lshl_b32 s100, s48, 7
    s_add_u32 s100, s100, 688128
    buffer_store_dword v254, v255, s[32:35], s100 offen sc1
    s_lshl_b32 s100, s48, 2
    s_add_u32 s100, s100, 395264
    buffer_store_dword v254, v255, s[32:35], s100 offen sc1
    s_mov_b64 exec, -1
SIG_10:
    s_cmp_lg_u32 s76, 0
    s_cbranch_scc1 P2_NOX
    buffer_load_dwordx4 v[88:91], v4, s[32:35], s59 offen offset:3072 sc1
    buffer_load_dwordx4 v[92:95], v5, s[32:35], s59 offen sc1
    buffer_load_dwordx4 v[192:195], v248, s[32:35], s52 offen sc1
    buffer_load_dwordx4 v[208:211], v248, s[32:35], s52 offen offset:1024 sc1
    buffer_load_dwordx4 v[212:215], v248, s[32:35], s52 offen offset:2048 sc1
    buffer_load_dwordx4 v[216:219], v248, s[32:35], s52 offen offset:3072 sc1
    buffer_load_dwordx4 v[236:239], v249, s[32:35], s52 offen sc1
    buffer_load_dwordx4 v[244:247], v248, s[32:35], s53 offen sc1
    buffer_load_dwordx4 a[160:163], v248, s[32:35], s53 offen offset:1024 sc1
    buffer_load_dwordx4 a[164:167], v248, s[32:35], s53 offen offset:2048 sc1
    buffer_load_dwordx4 a[168:171], v248, s[32:35], s53 offen offset:3072 sc1
    buffer_load_dwordx4 a[172:175], v249, s[32:35], s53 offen sc1
    buffer_load_dwordx4 a[176:179], v248, s[32:35], s54 offen sc1
    buffer_load_dwordx4 a[180:183], v248, s[32:35], s54 offen offset:1024 sc1
    buffer_load_dwordx4 a[184:187], v248, s[32:35], s54 offen offset:2048 sc1
    buffer_load_dwordx4 a[188:191], v248, s[32:35], s54 offen offset:3072 sc1
    buffer_load_dwordx4 a[128:131], v249, s[32:35], s54 offen sc1
    buffer_load_dwordx4 a[132:135], v248, s[32:35], s55 offen sc1
    buffer_load_dwordx4 a[136:139], v248, s[32:35], s55 offen offset:1024 sc1
    buffer_load_dwordx4 a[140:143], v248, s[32:35], s55 offen offset:2048 sc1
    buffer_load_dwordx4 a[144:147], v248, s[32:35], s55 offen offset:3072 sc1
    buffer_load_dwordx4 a[148:151], v249, s[32:35], s55 offen sc1
    buffer_load_dwordx4 a[152:155], v248, s[32:35], s56 offen sc1
    buffer_load_dwordx4 a[156:159], v248, s[32:35], s56 offen offset:1024 sc1
    buffer_load_dwordx4 a[204:207], v248, s[32:35], s56 offen offset:2048 sc1
    s_add_u32 m0, s72, 32768
    s_add_u32 s71, s71, 4096
    buffer_load_dwordx4 v0, s[32:35], s71 offen offset:0 sc1 lds
    buffer_load_dwordx4 v0, s[32:35], s71 offen offset:1024 sc1 lds
    buffer_load_dwordx4 v0, s[32:35], s71 offen offset:2048 sc1 lds
    buffer_load_dwordx4 v0, s[32:35], s71 offen offset:3072 sc1 lds
    s_add_u32 m0, s72, 49152
    s_add_u32 s71, s71, 4096
    buffer_load_dwordx4 v0, s[32:35], s71 offen offset:0 sc1 lds
    buffer_load_dwordx4 v0, s[32:35], s71 offen offset:1024 sc1 lds
    buffer_load_dwordx4 v0, s[32:35], s71 offen offset:2048 sc1 lds
    buffer_load_dwordx4 v0, s[32:35], s71 offen offset:3072 sc1 lds
P2_NOX:
    s_lshl_b32 s80, s64, 6
    v_lshrrev_b32 v6, 4, v0
    buffer_load_dwordx4 a[124:127], v248, s[32:35], s56 offen offset:3072 sc1
    v_add_u32 v6, s80, v6
    v_add_u32 v1, 131072, v0
    v_add_u32 v2, 262144, v0
    v_add_u32 v3, 393216, v0
    v_bfe_u32 v28, v0, 4, 4
    s_lshl_b32 s80, s64, 4
    v_add_u32 v28, s80, v28
    v_lshrrev_b32 v29, 8, v0
    v_and_b32 v30, 1, v29
    v_lshrrev_b32 v31, 1, v29
    v_mul_u32_u24 v8, 1280, v28
    v_lshl_add_u32 v7, v29, 3, v8
    v_lshlrev_b32 v13, 4, v29
    v_add_u32 v13, 136448, v13
    s_mul_i32 s80, s64, 20480
    v_add_u32 v12, s80, v0
    buffer_load_dwordx4 a[120:123], v249, s[32:35], s56 offen sc1
    s_mul_i32 s80, s64, 5120
    v_add_u32 v14, s80, v0
    v_add_u32 v15, 61440, v14
    v_lshlrev_b32 v11, 6, v28
    v_and_b32 v9, 31, v28
    v_lshlrev_b32 v9, 4, v9
    v_lshl_add_u32 v9, v31, 9, v9
    v_lshrrev_b32 v28, 5, v28
    v_mul_u32_u24 v28, 40960, v28
    v_add_u32 v9, v9, v28
    v_lshl_add_u32 v10, v30, 3, v9
    v_add_u32 v10, 4096, v10
    v_lshl_add_u32 v9, v30, 10, v9
    s_mov_b32 s36, s4
    s_mov_b32 s37, s5
    s_mov_b32 s38, 0x280000
    s_mov_b32 s39, 0x20000
    s_mul_i32 s73, s23, 81920
    s_mul_i32 s74, s22, 160
    s_add_u32 s73, s73, s74
    buffer_load_dwordx2 v[16:17], v7, s[36:39], s73 offen offset:0
    buffer_load_dwordx4 a[116:119], v248, s[32:35], s57 offen sc1
    buffer_load_dwordx2 v[18:19], v7, s[36:39], s73 offen offset:32
    buffer_load_dwordx2 v[20:21], v7, s[36:39], s73 offen offset:64
    buffer_load_dwordx2 v[22:23], v7, s[36:39], s73 offen offset:96
    buffer_load_dwordx2 v[24:25], v7, s[36:39], s73 offen offset:128
    s_lshr_b32 s80, s23, 2
    s_lshl_b32 s80, s80, 12
    s_add_u32 s80, s80, 688128
    v_lshlrev_b32 v28, 3, v0
    buffer_load_dwordx4 a[112:115], v248, s[32:35], s57 offen offset:1024 sc1
    v_and_b32 v28, 0xf80, v28
    v_lshrrev_b32 v96, 3, v6
    v_lshlrev_b32 v96, 2, v96
    v_add_u32 v96, 136448, v96
    ds_read_b32 v100, v96 offset:1024
    ds_read_b32 v105, v96 offset:2048
    ds_read_b32 v101, v96 offset:1152
    ds_read_b32 v106, v96 offset:2176
    ds_read_b32 v102, v96 offset:1280
    ds_read_b32 v107, v96 offset:2304
    ds_read_b32 v103, v96 offset:1408
    ds_read_b32 v108, v96 offset:2432
    ds_read_b32 v104, v96 offset:1536
    ds_read_b32 v109, v96 offset:2560
    buffer_load_dwordx4 a[108:111], v248, s[32:35], s57 offen offset:2048 sc1
    s_waitcnt lgkmcnt(8)
    v_accvgpr_read_b32 v99, a236
    v_lshlrev_b32 v98, 16, v99
    v_and_b32 v99, 0xffff0000, v99
    v_pk_mul_f32 v[112:113], v[100:101], v[98:99] op_sel:[0,0] op_sel_hi:[0,1]
    v_pk_mul_f32 v[120:121], v[104:105], v[98:99] op_sel:[1,0] op_sel_hi:[1,1]
    v_accvgpr_read_b32 v99, a237
    v_lshlrev_b32 v98, 16, v99
    v_and_b32 v99, 0xffff0000, v99
    v_pk_mul_f32 v[114:115], v[100:101], v[98:99] op_sel:[0,0] op_sel_hi:[0,1]
    v_pk_mul_f32 v[122:123], v[104:105], v[98:99] op_sel:[1,0] op_sel_hi:[1,1]
    v_accvgpr_read_b32 v99, a238
    v_lshlrev_b32 v98, 16, v99
    v_and_b32 v99, 0xffff0000, v99
    v_pk_mul_f32 v[116:117], v[100:101], v[98:99] op_sel:[0,0] op_sel_hi:[0,1]
    v_pk_mul_f32 v[124:125], v[104:105], v[98:99] op_sel:[1,0] op_sel_hi:[1,1]
    v_accvgpr_read_b32 v99, a239
    buffer_load_dwordx4 a[104:107], v248, s[32:35], s57 offen offset:3072 sc1
    v_lshlrev_b32 v98, 16, v99
    v_and_b32 v99, 0xffff0000, v99
    v_pk_mul_f32 v[118:119], v[100:101], v[98:99] op_sel:[0,0] op_sel_hi:[0,1]
    v_pk_mul_f32 v[126:127], v[104:105], v[98:99] op_sel:[1,0] op_sel_hi:[1,1]
    s_waitcnt lgkmcnt(6)
    v_accvgpr_read_b32 v99, a240
    v_lshlrev_b32 v98, 16, v99
    v_and_b32 v99, 0xffff0000, v99
    v_pk_fma_f32 v[112:113], v[100:101], v[98:99], v[112:113] op_sel:[1,0,0] op_sel_hi:[1,1,1]
    v_pk_fma_f32 v[120:121], v[106:107], v[98:99], v[120:121] op_sel:[0,0,0] op_sel_hi:[0,1,1]
    v_accvgpr_read_b32 v99, a241
    v_lshlrev_b32 v98, 16, v99
    v_and_b32 v99, 0xffff0000, v99
    v_pk_fma_f32 v[114:115], v[100:101], v[98:99], v[114:115] op_sel:[1,0,0] op_sel_hi:[1,1,1]
    v_pk_fma_f32 v[122:123], v[106:107], v[98:99], v[122:123] op_sel:[0,0,0] op_sel_hi:[0,1,1]
    v_accvgpr_read_b32 v99, a242
    v_lshlrev_b32 v98, 16, v99
    v_and_b32 v99, 0xffff0000, v99
    buffer_load_dwordx4 a[100:103], v249, s[32:35], s57 offen sc1
    v_pk_fma_f32 v[116:117], v[100:101], v[98:99], v[116:117] op_sel:[1,0,0] op_sel_hi:[1,1,1]
    v_pk_fma_f32 v[124:125], v[106:107], v[98:99], v[124:125] op_sel:[0,0,0] op_sel_hi:[0,1,1]
    v_accvgpr_read_b32 v99, a243
    v_lshlrev_b32 v98, 16, v99
    v_and_b32 v99, 0xffff0000, v99
    v_pk_fma_f32 v[118:119], v[100:101], v[98:99], v[118:119] op_sel:[1,0,0] op_sel_hi:[1,1,1]
    v_pk_fma_f32 v[126:127], v[106:107], v[98:99], v[126:127] op_sel:[0,0,0] op_sel_hi:[0,1,1]
    s_waitcnt lgkmcnt(4)
    v_accvgpr_read_b32 v99, a244
    v_lshlrev_b32 v98, 16, v99
    v_and_b32 v99, 0xffff0000, v99
    v_pk_fma_f32 v[112:113], v[102:103], v[98:99], v[112:113] op_sel:[0,0,0] op_sel_hi:[0,1,1]
    v_pk_fma_f32 v[120:121], v[106:107], v[98:99], v[120:121] op_sel:[1,0,0] op_sel_hi:[1,1,1]
    v_accvgpr_read_b32 v99, a245
    v_lshlrev_b32 v98, 16, v99
    v_and_b32 v99, 0xffff0000, v99
    v_pk_fma_f32 v[114:115], v[102:103], v[98:99], v[114:115] op_sel:[0,0,0] op_sel_hi:[0,1,1]
    buffer_load_dwordx4 a[96:99], v248, s[32:35], s58 offen sc1
    v_pk_fma_f32 v[122:123], v[106:107], v[98:99], v[122:123] op_sel:[1,0,0] op_sel_hi:[1,1,1]
    v_accvgpr_read_b32 v99, a246
    v_lshlrev_b32 v98, 16, v99
    v_and_b32 v99, 0xffff0000, v99
    v_pk_fma_f32 v[116:117], v[102:103], v[98:99], v[116:117] op_sel:[0,0,0] op_sel_hi:[0,1,1]
    v_pk_fma_f32 v[124:125], v[106:107], v[98:99], v[124:125] op_sel:[1,0,0] op_sel_hi:[1,1,1]
    v_accvgpr_read_b32 v99, a247
    v_lshlrev_b32 v98, 16, v99
    v_and_b32 v99, 0xffff0000, v99
    v_pk_fma_f32 v[118:119], v[102:103], v[98:99], v[118:119] op_sel:[0,0,0] op_sel_hi:[0,1,1]
    v_pk_fma_f32 v[126:127], v[106:107], v[98:99], v[126:127] op_sel:[1,0,0] op_sel_hi:[1,1,1]
    s_waitcnt lgkmcnt(2)
    v_accvgpr_read_b32 v99, a248
    v_lshlrev_b32 v98, 16, v99
    v_and_b32 v99, 0xffff0000, v99
    v_pk_fma_f32 v[112:113], v[102:103], v[98:99], v[112:113] op_sel:[1,0,0] op_sel_hi:[1,1,1]
    v_pk_fma_f32 v[120:121], v[108:109], v[98:99], v[120:121] op_sel:[0,0,0] op_sel_hi:[0,1,1]
    v_accvgpr_read_b32 v99, a249
    buffer_load_dwordx4 a[92:95], v248, s[32:35], s58 offen offset:1024 sc1
    v_lshlrev_b32 v98, 16, v99
    v_and_b32 v99, 0xffff0000, v99
    v_pk_fma_f32 v[114:115], v[102:103], v[98:99], v[114:115] op_sel:[1,0,0] op_sel_hi:[1,1,1]
    v_pk_fma_f32 v[122:123], v[108:109], v[98:99], v[122:123] op_sel:[0,0,0] op_sel_hi:[0,1,1]
    v_accvgpr_read_b32 v99, a250
    v_lshlrev_b32 v98, 16, v99
    v_and_b32 v99, 0xffff0000, v99
    v_pk_fma_f32 v[116:117], v[102:103], v[98:99], v[116:117] op_sel:[1,0,0] op_sel_hi:[1,1,1]
    v_pk_fma_f32 v[124:125], v[108:109], v[98:99], v[124:125] op_sel:[0,0,0] op_sel_hi:[0,1,1]
    v_accvgpr_read_b32 v99, a251
    v_lshlrev_b32 v98, 16, v99
    v_and_b32 v99, 0xffff0000, v99
    v_pk_fma_f32 v[118:119], v[102:103], v[98:99], v[118:119] op_sel:[1,0,0] op_sel_hi:[1,1,1]
    v_pk_fma_f32 v[126:127], v[108:109], v[98:99], v[126:127] op_sel:[0,0,0] op_sel_hi:[0,1,1]
    s_waitcnt lgkmcnt(0)
    v_accvgpr_read_b32 v99, a252
    v_lshlrev_b32 v98, 16, v99
    v_and_b32 v99, 0xffff0000, v99
    buffer_load_dwordx4 a[88:91], v248, s[32:35], s58 offen offset:2048 sc1
    v_pk_fma_f32 v[112:113], v[104:105], v[98:99], v[112:113] op_sel:[0,0,0] op_sel_hi:[0,1,1]
    v_pk_fma_f32 v[120:121], v[108:109], v[98:99], v[120:121] op_sel:[1,0,0] op_sel_hi:[1,1,1]
    v_accvgpr_read_b32 v99, a253
    v_lshlrev_b32 v98, 16, v99
    v_and_b32 v99, 0xffff0000, v99
    v_pk_fma_f32 v[114:115], v[104:105], v[98:99], v[114:115] op_sel:[0,0,0] op_sel_hi:[0,1,1]
    v_pk_fma_f32 v[122:123], v[108:109], v[98:99], v[122:123] op_sel:[1,0,0] op_sel_hi:[1,1,1]
    v_accvgpr_read_b32 v99, a254
    v_lshlrev_b32 v98, 16, v99
    v_and_b32 v99, 0xffff0000, v99
    v_pk_fma_f32 v[116:117], v[104:105], v[98:99], v[116:117] op_sel:[0,0,0] op_sel_hi:[0,1,1]
    v_pk_fma_f32 v[124:125], v[108:109], v[98:99], v[124:125] op_sel:[1,0,0] op_sel_hi:[1,1,1]
    v_accvgpr_read_b32 v99, a255
    v_lshlrev_b32 v98, 16, v99
    v_and_b32 v99, 0xffff0000, v99
    v_pk_fma_f32 v[118:119], v[104:105], v[98:99], v[118:119] op_sel:[0,0,0] op_sel_hi:[0,1,1]
    buffer_load_dwordx4 a[84:87], v248, s[32:35], s58 offen offset:3072 sc1
    v_pk_fma_f32 v[126:127], v[108:109], v[98:99], v[126:127] op_sel:[1,0,0] op_sel_hi:[1,1,1]
    v_permlane32_swap_b32 v112, v120
    v_permlane32_swap_b32 v113, v121
    v_permlane32_swap_b32 v114, v122
    v_permlane32_swap_b32 v115, v123
    v_permlane32_swap_b32 v116, v124
    v_permlane32_swap_b32 v117, v125
    v_permlane32_swap_b32 v118, v126
    v_permlane32_swap_b32 v119, v127
    v_pk_add_f32 v[112:113], v[112:113], v[120:121]
    v_pk_add_f32 v[114:115], v[114:115], v[122:123]
    v_pk_add_f32 v[116:117], v[116:117], v[124:125]
    v_pk_add_f32 v[118:119], v[118:119], v[126:127]
    s_nop 0
    v_permlane16_swap_b32 v112, v116
    v_permlane16_swap_b32 v113, v117
    v_permlane16_swap_b32 v114, v118
    v_permlane16_swap_b32 v115, v119
    buffer_load_dwordx4 a[80:83], v249, s[32:35], s58 offen sc1
    v_pk_add_f32 v[112:113], v[112:113], v[116:117]
    v_pk_add_f32 v[114:115], v[114:115], v[118:119]
    v_bfe_u32 v96, v0, 9, 1
    v_lshlrev_b32 v96, 8, v96
    v_bfe_u32 v97, v0, 4, 3
    v_lshl_add_u32 v96, v97, 5, v96
    v_bfe_u32 v97, v0, 8, 1
    v_lshl_add_u32 v96, v97, 4, v96
    s_lshl_b32 s81, s64, 9
    s_add_u32 s81, s81, 131072
    v_add_u32 v96, s81, v96
    v_add_f32_dpp v112, v112, v112 row_ror:8 row_mask:0xf bank_mask:0xf
    v_add_f32_dpp v113, v113, v113 row_ror:8 row_mask:0xf bank_mask:0xf
    v_add_f32_dpp v114, v114, v114 row_ror:8 row_mask:0xf bank_mask:0xf
    v_add_f32_dpp v115, v115, v115 row_ror:8 row_mask:0xf bank_mask:0xf
    ds_write_b128 v96, v[112:115]
    buffer_load_dwordx4 a[236:239], v248, s[32:35], s59 offen sc1
    buffer_load_dwordx4 a[240:243], v248, s[32:35], s59 offen offset:1024 sc1
    buffer_load_dwordx4 a[244:247], v248, s[32:35], s59 offen offset:2048 sc1
    buffer_load_dwordx4 a[248:251], v248, s[32:35], s59 offen offset:3072 sc1
    buffer_load_dwordx4 a[252:255], v249, s[32:35], s59 offen sc1
    v_add_u32 v27, s72, v0
    v_add_u32 v26, 0x10000, v27
    s_mul_i32 s81, s64, 5120
    s_add_u32 s81, s81, 140800
    v_add_u32 v31, s81, v0
    s_add_u32 m0, s72, 65536
    s_add_u32 s71, s71, 4096
    buffer_load_dwordx4 v0, s[32:35], s71 offen offset:0 sc1 lds
    buffer_load_dwordx4 v0, s[32:35], s71 offen offset:1024 sc1 lds
    buffer_load_dwordx4 v0, s[32:35], s71 offen offset:2048 sc1 lds
    buffer_load_dwordx4 v0, s[32:35], s71 offen offset:3072 sc1 lds
    s_add_u32 m0, s72, 81920
    s_add_u32 s71, s71, 4096
    buffer_load_dwordx4 v0, s[32:35], s71 offen offset:0 sc1 lds
    s_waitcnt vmcnt(44)
    buffer_load_dwordx4 v0, s[32:35], s71 offen offset:1024 sc1 lds
    s_waitcnt vmcnt(0)
    s_cmp_lg_u32 s64, 0
    s_cbranch_scc1 POLLD_12
    s_mov_b32 s85, 100000
POLL_11:
    buffer_load_dword v29, v28, s[32:35], s80 offen sc1
    s_waitcnt vmcnt(0)
    v_xor_b32 v29, s65, v29
    v_cmp_ne_u32 vcc, 0, v29
    s_nop 1
    s_cbranch_vccz POLLD_12
    s_sub_u32 s85, s85, 1
    s_cbranch_scc1 F_END
    s_sleep 1
    s_branch POLL_11
POLLD_12:
    s_barrier
    buffer_load_dwordx4 v[96:99], v0, s[32:35], s44 offen sc1
    buffer_load_dwordx4 v[100:103], v1, s[32:35], s44 offen sc1
    buffer_load_dwordx4 v[104:107], v2, s[32:35], s44 offen sc1
    buffer_load_dwordx4 v[108:111], v3, s[32:35], s44 offen sc1
    buffer_load_dwordx4 v[112:115], v0, s[32:35], s44 offen offset:1024 sc1
    buffer_load_dwordx4 v[116:119], v1, s[32:35], s44 offen offset:1024 sc1
    buffer_load_dwordx4 v[120:123], v2, s[32:35], s44 offen offset:1024 sc1
    buffer_load_dwordx4 v[124:127], v3, s[32:35], s44 offen offset:1024 sc1
    s_waitcnt vmcnt(4)
    v_mfma_f32_16x16x32_bf16 a[0:3], a[192:195], v[96:99], 0
    v_mfma_f32_16x16x32_bf16 a[4:7], a[192:195], v[100:103], 0
    buffer_load_dwordx4 v[160:163], v0, s[32:35], s44 offen offset:2048 sc1
    v_mfma_f32_16x16x32_bf16 a[8:11], a[192:195], v[104:107], 0
    v_mfma_f32_16x16x32_bf16 a[12:15], a[192:195], v[108:111], 0
    buffer_load_dwordx4 v[164:167], v1, s[32:35], s44 offen offset:2048 sc1
    v_mfma_f32_16x16x32_bf16 a[16:19], a[196:199], v[96:99], 0
    v_mfma_f32_16x16x32_bf16 a[20:23], a[196:199], v[100:103], 0
    buffer_load_dwordx4 v[168:171], v2, s[32:35], s44 offen offset:2048 sc1
    v_mfma_f32_16x16x32_bf16 a[24:27], a[196:199], v[104:107], 0
    v_mfma_f32_16x16x32_bf16 a[28:31], a[196:199], v[108:111], 0
    buffer_load_dwordx4 v[172:175], v3, s[32:35], s44 offen offset:2048 sc1
    v_mfma_f32_16x16x32_bf16 a[32:35], a[200:203], v[96:99], 0
    v_mfma_f32_16x16x32_bf16 a[36:39], a[200:203], v[100:103], 0
    buffer_load_dwordx4 v[176:179], v0, s[32:35], s44 offen offset:3072 sc1
    v_mfma_f32_16x16x32_bf16 a[40:43], a[200:203], v[104:107], 0
    v_mfma_f32_16x16x32_bf16 a[44:47], a[200:203], v[108:111], 0
    buffer_load_dwordx4 v[180:183], v1, s[32:35], s44 offen offset:3072 sc1
    v_mfma_f32_16x16x32_bf16 a[48:51], a[208:211], v[96:99], 0
    v_mfma_f32_16x16x32_bf16 a[52:55], a[208:211], v[100:103], 0
    buffer_load_dwordx4 v[184:187], v2, s[32:35], s44 offen offset:3072 sc1
    v_mfma_f32_16x16x32_bf16 a[56:59], a[208:211], v[104:107], 0
    v_mfma_f32_16x16x32_bf16 a[60:63], a[208:211], v[108:111], 0
    buffer_load_dwordx4 v[188:191], v3, s[32:35], s44 offen offset:3072 sc1
    v_mfma_f32_16x16x32_bf16 a[64:67], a[212:215], v[96:99], 0
    v_mfma_f32_16x16x32_bf16 a[68:71], a[212:215], v[100:103], 0
    s_add_u32 s44, s44, 4096
    v_mfma_f32_16x16x32_bf16 a[72:75], a[212:215], v[104:107], 0
    v_mfma_f32_16x16x32_bf16 a[76:79], a[212:215], v[108:111], 0
    s_waitcnt vmcnt(8)
    v_mfma_f32_16x16x32_bf16 a[0:3], v[200:203], v[112:115], a[0:3]
    v_mfma_f32_16x16x32_bf16 a[4:7], v[200:203], v[116:119], a[4:7]
    buffer_load_dwordx4 v[96:99], v0, s[32:35], s44 offen sc1
    v_mfma_f32_16x16x32_bf16 a[8:11], v[200:203], v[120:123], a[8:11]
    v_mfma_f32_16x16x32_bf16 a[12:15], v[200:203], v[124:127], a[12:15]
    buffer_load_dwordx4 v[100:103], v1, s[32:35], s44 offen sc1
    v_mfma_f32_16x16x32_bf16 a[16:19], v[204:207], v[112:115], a[16:19]
    v_mfma_f32_16x16x32_bf16 a[20:23], v[204:207], v[116:119], a[20:23]
    buffer_load_dwordx4 v[104:107], v2, s[32:35], s44 offen sc1
    v_mfma_f32_16x16x32_bf16 a[24:27], v[204:207], v[120:123], a[24:27]
    v_mfma_f32_16x16x32_bf16 a[28:31], v[204:207], v[124:127], a[28:31]
    buffer_load_dwordx4 v[108:111], v3, s[32:35], s44 offen sc1
    v_mfma_f32_16x16x32_bf16 a[32:35], v[240:243], v[112:115], a[32:35]
    v_mfma_f32_16x16x32_bf16 a[36:39], v[240:243], v[116:119], a[36:39]
    buffer_load_dwordx4 a[192:195], v250, s[32:35], s52 offen sc1
    v_mfma_f32_16x16x32_bf16 a[40:43], v[240:243], v[120:123], a[40:43]
    v_mfma_f32_16x16x32_bf16 a[44:47], v[240:243], v[124:127], a[44:47]
    buffer_load_dwordx4 a[196:199], v250, s[32:35], s52 offen offset:1024 sc1
    v_mfma_f32_16x16x32_bf16 a[48:51], v[228:231], v[112:115], a[48:51]
    v_mfma_f32_16x16x32_bf16 a[52:55], v[228:231], v[116:119], a[52:55]
    buffer_load_dwordx4 a[200:203], v250, s[32:35], s52 offen offset:2048 sc1
    v_mfma_f32_16x16x32_bf16 a[56:59], v[228:231], v[120:123], a[56:59]
    v_mfma_f32_16x16x32_bf16 a[60:63], v[228:231], v[124:127], a[60:63]
    v_mfma_f32_16x16x32_bf16 a[64:67], v[232:235], v[112:115], a[64:67]
    v_mfma_f32_16x16x32_bf16 a[68:71], v[232:235], v[116:119], a[68:71]
    v_mfma_f32_16x16x32_bf16 a[72:75], v[232:235], v[120:123], a[72:75]
    v_mfma_f32_16x16x32_bf16 a[76:79], v[232:235], v[124:127], a[76:79]
    s_waitcnt vmcnt(11)
    v_mfma_f32_16x16x32_bf16 a[0:3], v[196:199], v[160:163], a[0:3]
    v_mfma_f32_16x16x32_bf16 a[4:7], v[196:199], v[164:167], a[4:7]
    buffer_load_dwordx4 v[112:115], v0, s[32:35], s44 offen offset:1024 sc1
    v_mfma_f32_16x16x32_bf16 a[8:11], v[196:199], v[168:171], a[8:11]
    v_mfma_f32_16x16x32_bf16 a[12:15], v[196:199], v[172:175], a[12:15]
    buffer_load_dwordx4 v[116:119], v1, s[32:35], s44 offen offset:1024 sc1
    v_mfma_f32_16x16x32_bf16 a[16:19], a[216:219], v[160:163], a[16:19]
    v_mfma_f32_16x16x32_bf16 a[20:23], a[216:219], v[164:167], a[20:23]
    buffer_load_dwordx4 v[120:123], v2, s[32:35], s44 offen offset:1024 sc1
    v_mfma_f32_16x16x32_bf16 a[24:27], a[216:219], v[168:171], a[24:27]
    v_mfma_f32_16x16x32_bf16 a[28:31], a[216:219], v[172:175], a[28:31]
    buffer_load_dwordx4 v[124:127], v3, s[32:35], s44 offen offset:1024 sc1
    v_mfma_f32_16x16x32_bf16 a[32:35], a[220:223], v[160:163], a[32:35]
    v_mfma_f32_16x16x32_bf16 a[36:39], a[220:223], v[164:167], a[36:39]
    buffer_load_dwordx4 a[208:211], v250, s[32:35], s52 offen offset:3072 sc1
    v_mfma_f32_16x16x32_bf16 a[40:43], a[220:223], v[168:171], a[40:43]
    v_mfma_f32_16x16x32_bf16 a[44:47], a[220:223], v[172:175], a[44:47]
    buffer_load_dwordx4 a[212:215], v251, s[32:35], s52 offen sc1
    v_mfma_f32_16x16x32_bf16 a[48:51], a[224:227], v[160:163], a[48:51]
    v_mfma_f32_16x16x32_bf16 a[52:55], a[224:227], v[164:167], a[52:55]
    buffer_load_dwordx4 v[200:203], v250, s[32:35], s53 offen sc1
    v_mfma_f32_16x16x32_bf16 a[56:59], a[224:227], v[168:171], a[56:59]
    v_mfma_f32_16x16x32_bf16 a[60:63], a[224:227], v[172:175], a[60:63]
    v_mfma_f32_16x16x32_bf16 a[64:67], a[228:231], v[160:163], a[64:67]
    v_mfma_f32_16x16x32_bf16 a[68:71], a[228:231], v[164:167], a[68:71]
    v_mfma_f32_16x16x32_bf16 a[72:75], a[228:231], v[168:171], a[72:75]
    v_mfma_f32_16x16x32_bf16 a[76:79], a[228:231], v[172:175], a[76:79]
    s_waitcnt vmcnt(14)
    v_mfma_f32_16x16x32_bf16 a[0:3], a[232:235], v[176:179], a[0:3]
    v_mfma_f32_16x16x32_bf16 a[4:7], a[232:235], v[180:183], a[4:7]
    buffer_load_dwordx4 v[160:163], v0, s[32:35], s44 offen offset:2048 sc1
    v_mfma_f32_16x16x32_bf16 a[8:11], a[232:235], v[184:187], a[8:11]
    v_mfma_f32_16x16x32_bf16 a[12:15], a[232:235], v[188:191], a[12:15]
    buffer_load_dwordx4 v[164:167], v1, s[32:35], s44 offen offset:2048 sc1
    v_mfma_f32_16x16x32_bf16 a[16:19], v[128:131], v[176:179], a[16:19]
    v_mfma_f32_16x16x32_bf16 a[20:23], v[128:131], v[180:183], a[20:23]
    buffer_load_dwordx4 v[168:171], v2, s[32:35], s44 offen offset:2048 sc1
    v_mfma_f32_16x16x32_bf16 a[24:27], v[128:131], v[184:187], a[24:27]
    v_mfma_f32_16x16x32_bf16 a[28:31], v[128:131], v[188:191], a[28:31]
    buffer_load_dwordx4 v[172:175], v3, s[32:35], s44 offen offset:2048 sc1
    v_mfma_f32_16x16x32_bf16 a[32:35], v[132:135], v[176:179], a[32:35]
    v_mfma_f32_16x16x32_bf16 a[36:39], v[132:135], v[180:183], a[36:39]
    buffer_load_dwordx4 v[204:207], v250, s[32:35], s53 offen offset:1024 sc1
    v_mfma_f32_16x16x32_bf16 a[40:43], v[132:135], v[184:187], a[40:43]
    v_mfma_f32_16x16x32_bf16 a[44:47], v[132:135], v[188:191], a[44:47]
    buffer_load_dwordx4 v[240:243], v250, s[32:35], s53 offen offset:2048 sc1
    v_mfma_f32_16x16x32_bf16 a[48:51], v[136:139], v[176:179], a[48:51]
    v_mfma_f32_16x16x32_bf16 a[52:55], v[136:139], v[180:183], a[52:55]
    buffer_load_dwordx4 v[228:231], v250, s[32:35], s53 offen offset:3072 sc1
    v_mfma_f32_16x16x32_bf16 a[56:59], v[136:139], v[184:187], a[56:59]
    v_mfma_f32_16x16x32_bf16 a[60:63], v[136:139], v[188:191], a[60:63]
    v_mfma_f32_16x16x32_bf16 a[64:67], v[140:143], v[176:179], a[64:67]
    v_mfma_f32_16x16x32_bf16 a[68:71], v[140:143], v[180:183], a[68:71]
    v_mfma_f32_16x16x32_bf16 a[72:75], v[140:143], v[184:187], a[72:75]
    v_mfma_f32_16x16x32_bf16 a[76:79], v[140:143], v[188:191], a[76:79]
    s_waitcnt vmcnt(17)
    v_mfma_f32_16x16x32_bf16 a[0:3], v[144:147], v[96:99], a[0:3]
    v_mfma_f32_16x16x32_bf16 a[4:7], v[144:147], v[100:103], a[4:7]
    buffer_load_dwordx4 v[176:179], v0, s[32:35], s44 offen offset:3072 sc1
    v_mfma_f32_16x16x32_bf16 a[8:11], v[144:147], v[104:107], a[8:11]
    v_mfma_f32_16x16x32_bf16 a[12:15], v[144:147], v[108:111], a[12:15]
    buffer_load_dwordx4 v[180:183], v1, s[32:35], s44 offen offset:3072 sc1
    v_mfma_f32_16x16x32_bf16 a[16:19], v[148:151], v[96:99], a[16:19]
    v_mfma_f32_16x16x32_bf16 a[20:23], v[148:151], v[100:103], a[20:23]
    buffer_load_dwordx4 v[184:187], v2, s[32:35], s44 offen offset:3072 sc1
    v_mfma_f32_16x16x32_bf16 a[24:27], v[148:151], v[104:107], a[24:27]
    v_mfma_f32_16x16x32_bf16 a[28:31], v[148:151], v[108:111], a[28:31]
    buffer_load_dwordx4 v[188:191], v3, s[32:35], s44 offen offset:3072 sc1
    v_mfma_f32_16x16x32_bf16 a[32:35], v[152:155], v[96:99], a[32:35]
    v_mfma_f32_16x16x32_bf16 a[36:39], v[152:155], v[100:103], a[36:39]
    s_add_u32 s44, s44, 4096
    buffer_load_dwordx4 v[232:235], v251, s[32:35], s53 offen sc1
    v_mfma_f32_16x16x32_bf16 a[40:43], v[152:155], v[104:107], a[40:43]
    v_mfma_f32_16x16x32_bf16 a[44:47], v[152:155], v[108:111], a[44:47]
    buffer_load_dwordx4 v[196:199], v250, s[32:35], s54 offen sc1
    v_mfma_f32_16x16x32_bf16 a[48:51], v[156:159], v[96:99], a[48:51]
    v_mfma_f32_16x16x32_bf16 a[52:55], v[156:159], v[100:103], a[52:55]
    buffer_load_dwordx4 a[216:219], v250, s[32:35], s54 offen offset:1024 sc1
    v_mfma_f32_16x16x32_bf16 a[56:59], v[156:159], v[104:107], a[56:59]
    v_mfma_f32_16x16x32_bf16 a[60:63], v[156:159], v[108:111], a[60:63]
    v_mfma_f32_16x16x32_bf16 a[64:67], v[32:35], v[96:99], a[64:67]
    v_mfma_f32_16x16x32_bf16 a[68:71], v[32:35], v[100:103], a[68:71]
    v_mfma_f32_16x16x32_bf16 a[72:75], v[32:35], v[104:107], a[72:75]
    v_mfma_f32_16x16x32_bf16 a[76:79], v[32:35], v[108:111], a[76:79]
    s_waitcnt vmcnt(17)
    v_mfma_f32_16x16x32_bf16 a[0:3], v[36:39], v[112:115], a[0:3]
    v_mfma_f32_16x16x32_bf16 a[4:7], v[36:39], v[116:119], a[4:7]
    buffer_load_dwordx4 v[96:99], v0, s[32:35], s44 offen sc1
    v_mfma_f32_16x16x32_bf16 a[8:11], v[36:39], v[120:123], a[8:11]
    v_mfma_f32_16x16x32_bf16 a[12:15], v[36:39], v[124:127], a[12:15]
    buffer_load_dwordx4 v[100:103], v1, s[32:35], s44 offen sc1
    v_mfma_f32_16x16x32_bf16 a[16:19], v[40:43], v[112:115], a[16:19]
    v_mfma_f32_16x16x32_bf16 a[20:23], v[40:43], v[116:119], a[20:23]
    buffer_load_dwordx4 v[104:107], v2, s[32:35], s44 offen sc1
    v_mfma_f32_16x16x32_bf16 a[24:27], v[40:43], v[120:123], a[24:27]
    v_mfma_f32_16x16x32_bf16 a[28:31], v[40:43], v[124:127], a[28:31]
    buffer_load_dwordx4 v[108:111], v3, s[32:35], s44 offen sc1
    v_mfma_f32_16x16x32_bf16 a[32:35], v[44:47], v[112:115], a[32:35]
    v_mfma_f32_16x16x32_bf16 a[36:39], v[44:47], v[116:119], a[36:39]
    buffer_load_dwordx4 a[220:223], v250, s[32:35], s54 offen offset:2048 sc1
    v_mfma_f32_16x16x32_bf16 a[40:43], v[44:47], v[120:123], a[40:43]
    v_mfma_f32_16x16x32_bf16 a[44:47], v[44:47], v[124:127], a[44:47]
    buffer_load_dwordx4 a[224:227], v250, s[32:35], s54 offen offset:3072 sc1
    v_mfma_f32_16x16x32_bf16 a[48:51], v[48:51], v[112:115], a[48:51]
    v_mfma_f32_16x16x32_bf16 a[52:55], v[48:51], v[116:119], a[52:55]
    buffer_load_dwordx4 a[228:231], v251, s[32:35], s54 offen sc1
    v_mfma_f32_16x16x32_bf16 a[56:59], v[48:51], v[120:123], a[56:59]
    v_mfma_f32_16x16x32_bf16 a[60:63], v[48:51], v[124:127], a[60:63]
    v_mfma_f32_16x16x32_bf16 a[64:67], v[52:55], v[112:115], a[64:67]
    v_mfma_f32_16x16x32_bf16 a[68:71], v[52:55], v[116:119], a[68:71]
    v_mfma_f32_16x16x32_bf16 a[72:75], v[52:55], v[120:123], a[72:75]
    v_mfma_f32_16x16x32_bf16 a[76:79], v[52:55], v[124:127], a[76:79]
    s_waitcnt vmcnt(17)
    v_mfma_f32_16x16x32_bf16 a[0:3], v[56:59], v[160:163], a[0:3]
    v_mfma_f32_16x16x32_bf16 a[4:7], v[56:59], v[164:167], a[4:7]
    buffer_load_dwordx4 v[112:115], v0, s[32:35], s44 offen offset:1024 sc1
    v_mfma_f32_16x16x32_bf16 a[8:11], v[56:59], v[168:171], a[8:11]
    v_mfma_f32_16x16x32_bf16 a[12:15], v[56:59], v[172:175], a[12:15]
    buffer_load_dwordx4 v[116:119], v1, s[32:35], s44 offen offset:1024 sc1
    v_mfma_f32_16x16x32_bf16 a[16:19], v[60:63], v[160:163], a[16:19]
    v_mfma_f32_16x16x32_bf16 a[20:23], v[60:63], v[164:167], a[20:23]
    buffer_load_dwordx4 v[120:123], v2, s[32:35], s44 offen offset:1024 sc1
    v_mfma_f32_16x16x32_bf16 a[24:27], v[60:63], v[168:171], a[24:27]
    v_mfma_f32_16x16x32_bf16 a[28:31], v[60:63], v[172:175], a[28:31]
    buffer_load_dwordx4 v[124:127], v3, s[32:35], s44 offen offset:1024 sc1
    v_mfma_f32_16x16x32_bf16 a[32:35], v[64:67], v[160:163], a[32:35]
    v_mfma_f32_16x16x32_bf16 a[36:39], v[64:67], v[164:167], a[36:39]
    buffer_load_dwordx4 a[232:235], v250, s[32:35], s55 offen sc1
    v_mfma_f32_16x16x32_bf16 a[40:43], v[64:67], v[168:171], a[40:43]
    v_mfma_f32_16x16x32_bf16 a[44:47], v[64:67], v[172:175], a[44:47]
    buffer_load_dwordx4 v[128:131], v250, s[32:35], s55 offen offset:1024 sc1
    v_mfma_f32_16x16x32_bf16 a[48:51], v[68:71], v[160:163], a[48:51]
    v_mfma_f32_16x16x32_bf16 a[52:55], v[68:71], v[164:167], a[52:55]
    buffer_load_dwordx4 v[132:135], v250, s[32:35], s55 offen offset:2048 sc1
    v_mfma_f32_16x16x32_bf16 a[56:59], v[68:71], v[168:171], a[56:59]
    v_mfma_f32_16x16x32_bf16 a[60:63], v[68:71], v[172:175], a[60:63]
    v_mfma_f32_16x16x32_bf16 a[64:67], v[72:75], v[160:163], a[64:67]
    v_mfma_f32_16x16x32_bf16 a[68:71], v[72:75], v[164:167], a[68:71]
    v_mfma_f32_16x16x32_bf16 a[72:75], v[72:75], v[168:171], a[72:75]
    v_mfma_f32_16x16x32_bf16 a[76:79], v[72:75], v[172:175], a[76:79]
    s_waitcnt vmcnt(17)
    v_mfma_f32_16x16x32_bf16 a[0:3], v[76:79], v[176:179], a[0:3]
    v_mfma_f32_16x16x32_bf16 a[4:7], v[76:79], v[180:183], a[4:7]
    buffer_load_dwordx4 v[160:163], v0, s[32:35], s44 offen offset:2048 sc1
    v_mfma_f32_16x16x32_bf16 a[8:11], v[76:79], v[184:187], a[8:11]
    v_mfma_f32_16x16x32_bf16 a[12:15], v[76:79], v[188:191], a[12:15]
    buffer_load_dwordx4 v[164:167], v1, s[32:35], s44 offen offset:2048 sc1
    v_mfma_f32_16x16x32_bf16 a[16:19], v[80:83], v[176:179], a[16:19]
    v_mfma_f32_16x16x32_bf16 a[20:23], v[80:83], v[180:183], a[20:23]
    buffer_load_dwordx4 v[168:171], v2, s[32:35], s44 offen offset:2048 sc1
    v_mfma_f32_16x16x32_bf16 a[24:27], v[80:83], v[184:187], a[24:27]
    v_mfma_f32_16x16x32_bf16 a[28:31], v[80:83], v[188:191], a[28:31]
    buffer_load_dwordx4 v[172:175], v3, s[32:35], s44 offen offset:2048 sc1
    v_mfma_f32_16x16x32_bf16 a[32:35], v[84:87], v[176:179], a[32:35]
    v_mfma_f32_16x16x32_bf16 a[36:39], v[84:87], v[180:183], a[36:39]
    buffer_load_dwordx4 v[136:139], v250, s[32:35], s55 offen offset:3072 sc1
    v_mfma_f32_16x16x32_bf16 a[40:43], v[84:87], v[184:187], a[40:43]
    v_mfma_f32_16x16x32_bf16 a[44:47], v[84:87], v[188:191], a[44:47]
    buffer_load_dwordx4 v[140:143], v251, s[32:35], s55 offen sc1
    v_mfma_f32_16x16x32_bf16 a[48:51], v[88:91], v[176:179], a[48:51]
    v_mfma_f32_16x16x32_bf16 a[52:55], v[88:91], v[180:183], a[52:55]
    buffer_load_dwordx4 v[144:147], v250, s[32:35], s56 offen sc1
    v_mfma_f32_16x16x32_bf16 a[56:59], v[88:91], v[184:187], a[56:59]
    v_mfma_f32_16x16x32_bf16 a[60:63], v[88:91], v[188:191], a[60:63]
    v_mfma_f32_16x16x32_bf16 a[64:67], v[92:95], v[176:179], a[64:67]
    v_mfma_f32_16x16x32_bf16 a[68:71], v[92:95], v[180:183], a[68:71]
    v_mfma_f32_16x16x32_bf16 a[72:75], v[92:95], v[184:187], a[72:75]
    v_mfma_f32_16x16x32_bf16 a[76:79], v[92:95], v[188:191], a[76:79]
    s_waitcnt vmcnt(17)
    v_mfma_f32_16x16x32_bf16 a[0:3], v[192:195], v[96:99], a[0:3]
    v_mfma_f32_16x16x32_bf16 a[4:7], v[192:195], v[100:103], a[4:7]
    buffer_load_dwordx4 v[176:179], v0, s[32:35], s44 offen offset:3072 sc1
    v_mfma_f32_16x16x32_bf16 a[8:11], v[192:195], v[104:107], a[8:11]
    v_mfma_f32_16x16x32_bf16 a[12:15], v[192:195], v[108:111], a[12:15]
    buffer_load_dwordx4 v[180:183], v1, s[32:35], s44 offen offset:3072 sc1
    v_mfma_f32_16x16x32_bf16 a[16:19], v[208:211], v[96:99], a[16:19]
    v_mfma_f32_16x16x32_bf16 a[20:23], v[208:211], v[100:103], a[20:23]
    buffer_load_dwordx4 v[184:187], v2, s[32:35], s44 offen offset:3072 sc1
    v_mfma_f32_16x16x32_bf16 a[24:27], v[208:211], v[104:107], a[24:27]
    v_mfma_f32_16x16x32_bf16 a[28:31], v[208:211], v[108:111], a[28:31]
    buffer_load_dwordx4 v[188:191], v3, s[32:35], s44 offen offset:3072 sc1
    v_mfma_f32_16x16x32_bf16 a[32:35], v[212:215], v[96:99], a[32:35]
    v_mfma_f32_16x16x32_bf16 a[36:39], v[212:215], v[100:103], a[36:39]
    s_add_u32 s44, s44, 4096
    buffer_load_dwordx4 v[148:151], v250, s[32:35], s56 offen offset:1024 sc1
    v_mfma_f32_16x16x32_bf16 a[40:43], v[212:215], v[104:107], a[40:43]
    v_mfma_f32_16x16x32_bf16 a[44:47], v[212:215], v[108:111], a[44:47]
    buffer_load_dwordx4 v[152:155], v250, s[32:35], s56 offen offset:2048 sc1
    v_mfma_f32_16x16x32_bf16 a[48:51], v[216:219], v[96:99], a[48:51]
    v_mfma_f32_16x16x32_bf16 a[52:55], v[216:219], v[100:103], a[52:55]
    buffer_load_dwordx4 v[156:159], v250, s[32:35], s56 offen offset:3072 sc1
    v_mfma_f32_16x16x32_bf16 a[56:59], v[216:219], v[104:107], a[56:59]
    v_mfma_f32_16x16x32_bf16 a[60:63], v[216:219], v[108:111], a[60:63]
    v_mfma_f32_16x16x32_bf16 a[64:67], v[236:239], v[96:99], a[64:67]
    v_mfma_f32_16x16x32_bf16 a[68:71], v[236:239], v[100:103], a[68:71]
    v_mfma_f32_16x16x32_bf16 a[72:75], v[236:239], v[104:107], a[72:75]
    v_mfma_f32_16x16x32_bf16 a[76:79], v[236:239], v[108:111], a[76:79]
    s_waitcnt vmcnt(17)
    v_mfma_f32_16x16x32_bf16 a[0:3], v[244:247], v[112:115], a[0:3]
    v_mfma_f32_16x16x32_bf16 a[4:7], v[244:247], v[116:119], a[4:7]
    buffer_load_dwordx4 v[96:99], v0, s[32:35], s44 offen sc1
    v_mfma_f32_16x16x32_bf16 a[8:11], v[244:247], v[120:123], a[8:11]
    v_mfma_f32_16x16x32_bf16 a[12:15], v[244:247], v[124:127], a[12:15]
    buffer_load_dwordx4 v[100:103], v1, s[32:35], s44 offen sc1
    v_mfma_f32_16x16x32_bf16 a[16:19], a[160:163], v[112:115], a[16:19]
    v_mfma_f32_16x16x32_bf16 a[20:23], a[160:163], v[116:119], a[20:23]
    buffer_load_dwordx4 v[104:107], v2, s[32:35], s44 offen sc1
    v_mfma_f32_16x16x32_bf16 a[24:27], a[160:163], v[120:123], a[24:27]
    v_mfma_f32_16x16x32_bf16 a[28:31], a[160:163], v[124:127], a[28:31]
    buffer_load_dwordx4 v[108:111], v3, s[32:35], s44 offen sc1
    v_mfma_f32_16x16x32_bf16 a[32:35], a[164:167], v[112:115], a[32:35]
    v_mfma_f32_16x16x32_bf16 a[36:39], a[164:167], v[116:119], a[36:39]
    buffer_load_dwordx4 v[32:35], v251, s[32:35], s56 offen sc1
    v_mfma_f32_16x16x32_bf16 a[40:43], a[164:167], v[120:123], a[40:43]
    v_mfma_f32_16x16x32_bf16 a[44:47], a[164:167], v[124:127], a[44:47]
    buffer_load_dwordx4 v[36:39], v250, s[32:35], s57 offen sc1
    v_mfma_f32_16x16x32_bf16 a[48:51], a[168:171], v[112:115], a[48:51]
    v_mfma_f32_16x16x32_bf16 a[52:55], a[168:171], v[116:119], a[52:55]
    buffer_load_dwordx4 v[40:43], v250, s[32:35], s57 offen offset:1024 sc1
    v_mfma_f32_16x16x32_bf16 a[56:59], a[168:171], v[120:123], a[56:59]
    v_mfma_f32_16x16x32_bf16 a[60:63], a[168:171], v[124:127], a[60:63]
    v_mfma_f32_16x16x32_bf16 a[64:67], a[172:175], v[112:115], a[64:67]
    v_mfma_f32_16x16x32_bf16 a[68:71], a[172:175], v[116:119], a[68:71]
    v_mfma_f32_16x16x32_bf16 a[72:75], a[172:175], v[120:123], a[72:75]
    v_mfma_f32_16x16x32_bf16 a[76:79], a[172:175], v[124:127], a[76:79]
    s_waitcnt vmcnt(17)
    v_mfma_f32_16x16x32_bf16 a[0:3], a[176:179], v[160:163], a[0:3]
    v_mfma_f32_16x16x32_bf16 a[4:7], a[176:179], v[164:167], a[4:7]
    buffer_load_dwordx4 v[112:115], v0, s[32:35], s44 offen offset:1024 sc1
    v_mfma_f32_16x16x32_bf16 a[8:11], a[176:179], v[168:171], a[8:11]
    v_mfma_f32_16x16x32_bf16 a[12:15], a[176:179], v[172:175], a[12:15]
    buffer_load_dwordx4 v[116:119], v1, s[32:35], s44 offen offset:1024 sc1
    v_mfma_f32_16x16x32_bf16 a[16:19], a[180:183], v[160:163], a[16:19]
    v_mfma_f32_16x16x32_bf16 a[20:23], a[180:183], v[164:167], a[20:23]
    buffer_load_dwordx4 v[120:123], v2, s[32:35], s44 offen offset:1024 sc1
    v_mfma_f32_16x16x32_bf16 a[24:27], a[180:183], v[168:171], a[24:27]
    v_mfma_f32_16x16x32_bf16 a[28:31], a[180:183], v[172:175], a[28:31]
    buffer_load_dwordx4 v[124:127], v3, s[32:35], s44 offen offset:1024 sc1
    v_mfma_f32_16x16x32_bf16 a[32:35], a[184:187], v[160:163], a[32:35]
    v_mfma_f32_16x16x32_bf16 a[36:39], a[184:187], v[164:167], a[36:39]
    buffer_load_dwordx4 v[44:47], v250, s[32:35], s57 offen offset:2048 sc1
    v_mfma_f32_16x16x32_bf16 a[40:43], a[184:187], v[168:171], a[40:43]
    v_mfma_f32_16x16x32_bf16 a[44:47], a[184:187], v[172:175], a[44:47]
    buffer_load_dwordx4 v[48:51], v250, s[32:35], s57 offen offset:3072 sc1
    v_mfma_f32_16x16x32_bf16 a[48:51], a[188:191], v[160:163], a[48:51]
    v_mfma_f32_16x16x32_bf16 a[52:55], a[188:191], v[164:167], a[52:55]
    buffer_load_dwordx4 v[52:55], v251, s[32:35], s57 offen sc1
    v_mfma_f32_16x16x32_bf16 a[56:59], a[188:191], v[168:171], a[56:59]
    v_mfma_f32_16x16x32_bf16 a[60:63], a[188:191], v[172:175], a[60:63]
    v_mfma_f32_16x16x32_bf16 a[64:67], a[128:131], v[160:163], a[64:67]
    v_mfma_f32_16x16x32_bf16 a[68:71], a[128:131], v[164:167], a[68:71]
    v_mfma_f32_16x16x32_bf16 a[72:75], a[128:131], v[168:171], a[72:75]
    v_mfma_f32_16x16x32_bf16 a[76:79], a[128:131], v[172:175], a[76:79]
    s_waitcnt vmcnt(17)
    v_mfma_f32_16x16x32_bf16 a[0:3], a[132:135], v[176:179], a[0:3]
    v_mfma_f32_16x16x32_bf16 a[4:7], a[132:135], v[180:183], a[4:7]
    buffer_load_dwordx4 v[160:163], v0, s[32:35], s44 offen offset:2048 sc1
    v_mfma_f32_16x16x32_bf16 a[8:11], a[132:135], v[184:187], a[8:11]
    v_mfma_f32_16x16x32_bf16 a[12:15], a[132:135], v[188:191], a[12:15]
    buffer_load_dwordx4 v[164:167], v1, s[32:35], s44 offen offset:2048 sc1
    v_mfma_f32_16x16x32_bf16 a[16:19], a[136:139], v[176:179], a[16:19]
    v_mfma_f32_16x16x32_bf16 a[20:23], a[136:139], v[180:183], a[20:23]
    buffer_load_dwordx4 v[168:171], v2, s[32:35], s44 offen offset:2048 sc1
    v_mfma_f32_16x16x32_bf16 a[24:27], a[136:139], v[184:187], a[24:27]
    v_mfma_f32_16x16x32_bf16 a[28:31], a[136:139], v[188:191], a[28:31]
    buffer_load_dwordx4 v[172:175], v3, s[32:35], s44 offen offset:2048 sc1
    v_mfma_f32_16x16x32_bf16 a[32:35], a[140:143], v[176:179], a[32:35]
    v_mfma_f32_16x16x32_bf16 a[36:39], a[140:143], v[180:183], a[36:39]
    buffer_load_dwordx4 v[56:59], v250, s[32:35], s58 offen sc1
    v_mfma_f32_16x16x32_bf16 a[40:43], a[140:143], v[184:187], a[40:43]
    v_mfma_f32_16x16x32_bf16 a[44:47], a[140:143], v[188:191], a[44:47]
    buffer_load_dwordx4 v[60:63], v250, s[32:35], s58 offen offset:1024 sc1
    v_mfma_f32_16x16x32_bf16 a[48:51], a[144:147], v[176:179], a[48:51]
    v_mfma_f32_16x16x32_bf16 a[52:55], a[144:147], v[180:183], a[52:55]
    buffer_load_dwordx4 v[64:67], v250, s[32:35], s58 offen offset:2048 sc1
    v_mfma_f32_16x16x32_bf16 a[56:59], a[144:147], v[184:187], a[56:59]
    v_mfma_f32_16x16x32_bf16 a[60:63], a[144:147], v[188:191], a[60:63]
    v_mfma_f32_16x16x32_bf16 a[64:67], a[148:151], v[176:179], a[64:67]
    v_mfma_f32_16x16x32_bf16 a[68:71], a[148:151], v[180:183], a[68:71]
    v_mfma_f32_16x16x32_bf16 a[72:75], a[148:151], v[184:187], a[72:75]
    v_mfma_f32_16x16x32_bf16 a[76:79], a[148:151], v[188:191], a[76:79]
    s_waitcnt vmcnt(17)
    v_mfma_f32_16x16x32_bf16 a[0:3], a[152:155], v[96:99], a[0:3]
    v_mfma_f32_16x16x32_bf16 a[4:7], a[152:155], v[100:103], a[4:7]
    buffer_load_dwordx4 v[176:179], v0, s[32:35], s44 offen offset:3072 sc1
    v_mfma_f32_16x16x32_bf16 a[8:11], a[152:155], v[104:107], a[8:11]
    v_mfma_f32_16x16x32_bf16 a[12:15], a[152:155], v[108:111], a[12:15]
    buffer_load_dwordx4 v[180:183], v1, s[32:35], s44 offen offset:3072 sc1
    v_mfma_f32_16x16x32_bf16 a[16:19], a[156:159], v[96:99], a[16:19]
    v_mfma_f32_16x16x32_bf16 a[20:23], a[156:159], v[100:103], a[20:23]
    buffer_load_dwordx4 v[184:187], v2, s[32:35], s44 offen offset:3072 sc1
    v_mfma_f32_16x16x32_bf16 a[24:27], a[156:159], v[104:107], a[24:27]
    v_mfma_f32_16x16x32_bf16 a[28:31], a[156:159], v[108:111], a[28:31]
    buffer_load_dwordx4 v[188:191], v3, s[32:35], s44 offen offset:3072 sc1
    v_mfma_f32_16x16x32_bf16 a[32:35], a[204:207], v[96:99], a[32:35]
    v_mfma_f32_16x16x32_bf16 a[36:39], a[204:207], v[100:103], a[36:39]
    s_add_u32 s44, s44, 4096
    buffer_load_dwordx4 v[68:71], v250, s[32:35], s58 offen offset:3072 sc1
    v_mfma_f32_16x16x32_bf16 a[40:43], a[204:207], v[104:107], a[40:43]
    v_mfma_f32_16x16x32_bf16 a[44:47], a[204:207], v[108:111], a[44:47]
    buffer_load_dwordx4 v[72:75], v251, s[32:35], s58 offen sc1
    v_mfma_f32_16x16x32_bf16 a[48:51], a[124:127], v[96:99], a[48:51]
    v_mfma_f32_16x16x32_bf16 a[52:55], a[124:127], v[100:103], a[52:55]
    buffer_load_dwordx4 v[76:79], v250, s[32:35], s59 offen sc1
    v_mfma_f32_16x16x32_bf16 a[56:59], a[124:127], v[104:107], a[56:59]
    v_mfma_f32_16x16x32_bf16 a[60:63], a[124:127], v[108:111], a[60:63]
    v_mfma_f32_16x16x32_bf16 a[64:67], a[120:123], v[96:99], a[64:67]
    v_mfma_f32_16x16x32_bf16 a[68:71], a[120:123], v[100:103], a[68:71]
    v_mfma_f32_16x16x32_bf16 a[72:75], a[120:123], v[104:107], a[72:75]
    v_mfma_f32_16x16x32_bf16 a[76:79], a[120:123], v[108:111], a[76:79]
    s_waitcnt vmcnt(17)
    v_mfma_f32_16x16x32_bf16 a[0:3], a[116:119], v[112:115], a[0:3]
    v_mfma_f32_16x16x32_bf16 a[4:7], a[116:119], v[116:119], a[4:7]
    buffer_load_dwordx4 v[96:99], v0, s[32:35], s44 offen sc1
    v_mfma_f32_16x16x32_bf16 a[8:11], a[116:119], v[120:123], a[8:11]
    v_mfma_f32_16x16x32_bf16 a[12:15], a[116:119], v[124:127], a[12:15]
    buffer_load_dwordx4 v[100:103], v1, s[32:35], s44 offen sc1
    v_mfma_f32_16x16x32_bf16 a[16:19], a[112:115], v[112:115], a[16:19]
    v_mfma_f32_16x16x32_bf16 a[20:23], a[112:115], v[116:119], a[20:23]
    buffer_load_dwordx4 v[104:107], v2, s[32:35], s44 offen sc1
    v_mfma_f32_16x16x32_bf16 a[24:27], a[112:115], v[120:123], a[24:27]
    v_mfma_f32_16x16x32_bf16 a[28:31], a[112:115], v[124:127], a[28:31]
    buffer_load_dwordx4 v[108:111], v3, s[32:35], s44 offen sc1
    v_mfma_f32_16x16x32_bf16 a[32:35], a[108:111], v[112:115], a[32:35]
    v_mfma_f32_16x16x32_bf16 a[36:39], a[108:111], v[116:119], a[36:39]
    buffer_load_dwordx4 v[80:83], v250, s[32:35], s59 offen offset:1024 sc1
    v_mfma_f32_16x16x32_bf16 a[40:43], a[108:111], v[120:123], a[40:43]
    v_mfma_f32_16x16x32_bf16 a[44:47], a[108:111], v[124:127], a[44:47]
    buffer_load_dwordx4 v[84:87], v250, s[32:35], s59 offen offset:2048 sc1
    v_mfma_f32_16x16x32_bf16 a[48:51], a[104:107], v[112:115], a[48:51]
    v_mfma_f32_16x16x32_bf16 a[52:55], a[104:107], v[116:119], a[52:55]
    buffer_load_dwordx4 v[88:91], v250, s[32:35], s59 offen offset:3072 sc1
    v_mfma_f32_16x16x32_bf16 a[56:59], a[104:107], v[120:123], a[56:59]
    v_mfma_f32_16x16x32_bf16 a[60:63], a[104:107], v[124:127], a[60:63]
    v_mfma_f32_16x16x32_bf16 a[64:67], a[100:103], v[112:115], a[64:67]
    v_mfma_f32_16x16x32_bf16 a[68:71], a[100:103], v[116:119], a[68:71]
    v_mfma_f32_16x16x32_bf16 a[72:75], a[100:103], v[120:123], a[72:75]
    v_mfma_f32_16x16x32_bf16 a[76:79], a[100:103], v[124:127], a[76:79]
    s_waitcnt vmcnt(17)
    v_mfma_f32_16x16x32_bf16 a[0:3], a[96:99], v[160:163], a[0:3]
    v_mfma_f32_16x16x32_bf16 a[4:7], a[96:99], v[164:167], a[4:7]
    buffer_load_dwordx4 v[112:115], v0, s[32:35], s44 offen offset:1024 sc1
    v_mfma_f32_16x16x32_bf16 a[8:11], a[96:99], v[168:171], a[8:11]
    v_mfma_f32_16x16x32_bf16 a[12:15], a[96:99], v[172:175], a[12:15]
    buffer_load_dwordx4 v[116:119], v1, s[32:35], s44 offen offset:1024 sc1
    v_mfma_f32_16x16x32_bf16 a[16:19], a[92:95], v[160:163], a[16:19]
    v_mfma_f32_16x16x32_bf16 a[20:23], a[92:95], v[164:167], a[20:23]
    buffer_load_dwordx4 v[120:123], v2, s[32:35], s44 offen offset:1024 sc1
    v_mfma_f32_16x16x32_bf16 a[24:27], a[92:95], v[168:171], a[24:27]
    v_mfma_f32_16x16x32_bf16 a[28:31], a[92:95], v[172:175], a[28:31]
    buffer_load_dwordx4 v[124:127], v3, s[32:35], s44 offen offset:1024 sc1
    v_mfma_f32_16x16x32_bf16 a[32:35], a[88:91], v[160:163], a[32:35]
    v_mfma_f32_16x16x32_bf16 a[36:39], a[88:91], v[164:167], a[36:39]
    buffer_load_dwordx4 v[92:95], v251, s[32:35], s59 offen sc1
    v_mfma_f32_16x16x32_bf16 a[40:43], a[88:91], v[168:171], a[40:43]
    v_mfma_f32_16x16x32_bf16 a[44:47], a[88:91], v[172:175], a[44:47]
    buffer_load_dwordx4 v[192:195], v252, s[32:35], s52 offen sc1
    v_mfma_f32_16x16x32_bf16 a[48:51], a[84:87], v[160:163], a[48:51]
    v_mfma_f32_16x16x32_bf16 a[52:55], a[84:87], v[164:167], a[52:55]
    buffer_load_dwordx4 v[208:211], v252, s[32:35], s52 offen offset:1024 sc1
    v_mfma_f32_16x16x32_bf16 a[56:59], a[84:87], v[168:171], a[56:59]
    v_mfma_f32_16x16x32_bf16 a[60:63], a[84:87], v[172:175], a[60:63]
    v_mfma_f32_16x16x32_bf16 a[64:67], a[80:83], v[160:163], a[64:67]
    v_mfma_f32_16x16x32_bf16 a[68:71], a[80:83], v[164:167], a[68:71]
    v_mfma_f32_16x16x32_bf16 a[72:75], a[80:83], v[168:171], a[72:75]
    v_mfma_f32_16x16x32_bf16 a[76:79], a[80:83], v[172:175], a[76:79]
    s_waitcnt vmcnt(17)
    v_mfma_f32_16x16x32_bf16 a[0:3], a[236:239], v[176:179], a[0:3]
    v_mfma_f32_16x16x32_bf16 a[4:7], a[236:239], v[180:183], a[4:7]
    buffer_load_dwordx4 v[160:163], v0, s[32:35], s44 offen offset:2048 sc1
    v_mfma_f32_16x16x32_bf16 a[8:11], a[236:239], v[184:187], a[8:11]
    v_mfma_f32_16x16x32_bf16 a[12:15], a[236:239], v[188:191], a[12:15]
    buffer_load_dwordx4 v[164:167], v1, s[32:35], s44 offen offset:2048 sc1
    v_mfma_f32_16x16x32_bf16 a[16:19], a[240:243], v[176:179], a[16:19]
    v_mfma_f32_16x16x32_bf16 a[20:23], a[240:243], v[180:183], a[20:23]
    buffer_load_dwordx4 v[168:171], v2, s[32:35], s44 offen offset:2048 sc1
    v_mfma_f32_16x16x32_bf16 a[24:27], a[240:243], v[184:187], a[24:27]
    v_mfma_f32_16x16x32_bf16 a[28:31], a[240:243], v[188:191], a[28:31]
    buffer_load_dwordx4 v[172:175], v3, s[32:35], s44 offen offset:2048 sc1
    v_mfma_f32_16x16x32_bf16 a[32:35], a[244:247], v[176:179], a[32:35]
    v_mfma_f32_16x16x32_bf16 a[36:39], a[244:247], v[180:183], a[36:39]
    buffer_load_dwordx4 v[212:215], v252, s[32:35], s52 offen offset:2048 sc1
    v_mfma_f32_16x16x32_bf16 a[40:43], a[244:247], v[184:187], a[40:43]
    v_mfma_f32_16x16x32_bf16 a[44:47], a[244:247], v[188:191], a[44:47]
    buffer_load_dwordx4 v[216:219], v252, s[32:35], s52 offen offset:3072 sc1
    v_mfma_f32_16x16x32_bf16 a[48:51], a[248:251], v[176:179], a[48:51]
    v_mfma_f32_16x16x32_bf16 a[52:55], a[248:251], v[180:183], a[52:55]
    buffer_load_dwordx4 v[236:239], v253, s[32:35], s52 offen sc1
    v_mfma_f32_16x16x32_bf16 a[56:59], a[248:251], v[184:187], a[56:59]
    v_mfma_f32_16x16x32_bf16 a[60:63], a[248:251], v[188:191], a[60:63]
    v_mfma_f32_16x16x32_bf16 a[64:67], a[252:255], v[176:179], a[64:67]
    v_mfma_f32_16x16x32_bf16 a[68:71], a[252:255], v[180:183], a[68:71]
    v_mfma_f32_16x16x32_bf16 a[72:75], a[252:255], v[184:187], a[72:75]
    v_mfma_f32_16x16x32_bf16 a[76:79], a[252:255], v[188:191], a[76:79]
    s_waitcnt vmcnt(17)
    v_mfma_f32_16x16x32_bf16 a[0:3], a[192:195], v[96:99], a[0:3]
    v_mfma_f32_16x16x32_bf16 a[4:7], a[192:195], v[100:103], a[4:7]
    buffer_load_dwordx4 v[176:179], v0, s[32:35], s44 offen offset:3072 sc1
    v_mfma_f32_16x16x32_bf16 a[8:11], a[192:195], v[104:107], a[8:11]
    v_mfma_f32_16x16x32_bf16 a[12:15], a[192:195], v[108:111], a[12:15]
    buffer_load_dwordx4 v[180:183], v1, s[32:35], s44 offen offset:3072 sc1
    v_mfma_f32_16x16x32_bf16 a[16:19], a[196:199], v[96:99], a[16:19]
    v_mfma_f32_16x16x32_bf16 a[20:23], a[196:199], v[100:103], a[20:23]
    buffer_load_dwordx4 v[184:187], v2, s[32:35], s44 offen offset:3072 sc1
    v_mfma_f32_16x16x32_bf16 a[24:27], a[196:199], v[104:107], a[24:27]
    v_mfma_f32_16x16x32_bf16 a[28:31], a[196:199], v[108:111], a[28:31]
    buffer_load_dwordx4 v[188:191], v3, s[32:35], s44 offen offset:3072 sc1
    v_mfma_f32_16x16x32_bf16 a[32:35], a[200:203], v[96:99], a[32:35]
    v_mfma_f32_16x16x32_bf16 a[36:39], a[200:203], v[100:103], a[36:39]
    s_add_u32 s44, s44, 4096
    v_mfma_f32_16x16x32_bf16 a[40:43], a[200:203], v[104:107], a[40:43]
    v_mfma_f32_16x16x32_bf16 a[44:47], a[200:203], v[108:111], a[44:47]
    v_mfma_f32_16x16x32_bf16 a[48:51], a[208:211], v[96:99], a[48:51]
    v_mfma_f32_16x16x32_bf16 a[52:55], a[208:211], v[100:103], a[52:55]
    v_mfma_f32_16x16x32_bf16 a[56:59], a[208:211], v[104:107], a[56:59]
    v_mfma_f32_16x16x32_bf16 a[60:63], a[208:211], v[108:111], a[60:63]
    v_mfma_f32_16x16x32_bf16 a[64:67], a[212:215], v[96:99], a[64:67]
    v_mfma_f32_16x16x32_bf16 a[68:71], a[212:215], v[100:103], a[68:71]
    v_mfma_f32_16x16x32_bf16 a[72:75], a[212:215], v[104:107], a[72:75]
    v_mfma_f32_16x16x32_bf16 a[76:79], a[212:215], v[108:111], a[76:79]
    s_waitcnt vmcnt(14)
    v_mfma_f32_16x16x32_bf16 a[0:3], v[200:203], v[112:115], a[0:3]
    v_mfma_f32_16x16x32_bf16 a[4:7], v[200:203], v[116:119], a[4:7]
    buffer_load_dwordx4 v[96:99], v0, s[32:35], s44 offen sc1
    v_mfma_f32_16x16x32_bf16 a[8:11], v[200:203], v[120:123], a[8:11]
    v_mfma_f32_16x16x32_bf16 a[12:15], v[200:203], v[124:127], a[12:15]
    buffer_load_dwordx4 v[100:103], v1, s[32:35], s44 offen sc1
    v_mfma_f32_16x16x32_bf16 a[16:19], v[204:207], v[112:115], a[16:19]
    v_mfma_f32_16x16x32_bf16 a[20:23], v[204:207], v[116:119], a[20:23]
    buffer_load_dwordx4 v[104:107], v2, s[32:35], s44 offen sc1
    v_mfma_f32_16x16x32_bf16 a[24:27], v[204:207], v[120:123], a[24:27]
    v_mfma_f32_16x16x32_bf16 a[28:31], v[204:207], v[124:127], a[28:31]
    buffer_load_dwordx4 v[108:111], v3, s[32:35], s44 offen sc1
    v_mfma_f32_16x16x32_bf16 a[32:35], v[240:243], v[112:115], a[32:35]
    v_mfma_f32_16x16x32_bf16 a[36:39], v[240:243], v[116:119], a[36:39]
    v_mfma_f32_16x16x32_bf16 a[40:43], v[240:243], v[120:123], a[40:43]
    v_mfma_f32_16x16x32_bf16 a[44:47], v[240:243], v[124:127], a[44:47]
    v_mfma_f32_16x16x32_bf16 a[48:51], v[228:231], v[112:115], a[48:51]
    v_mfma_f32_16x16x32_bf16 a[52:55], v[228:231], v[116:119], a[52:55]
    v_mfma_f32_16x16x32_bf16 a[56:59], v[228:231], v[120:123], a[56:59]
    v_mfma_f32_16x16x32_bf16 a[60:63], v[228:231], v[124:127], a[60:63]
    v_mfma_f32_16x16x32_bf16 a[64:67], v[232:235], v[112:115], a[64:67]
    v_mfma_f32_16x16x32_bf16 a[68:71], v[232:235], v[116:119], a[68:71]
    v_mfma_f32_16x16x32_bf16 a[72:75], v[232:235], v[120:123], a[72:75]
    v_mfma_f32_16x16x32_bf16 a[76:79], v[232:235], v[124:127], a[76:79]
    s_waitcnt vmcnt(11)
    v_mfma_f32_16x16x32_bf16 a[0:3], v[196:199], v[160:163], a[0:3]
    v_mfma_f32_16x16x32_bf16 a[4:7], v[196:199], v[164:167], a[4:7]
    buffer_load_dwordx4 v[112:115], v0, s[32:35], s44 offen offset:1024 sc1
    v_mfma_f32_16x16x32_bf16 a[8:11], v[196:199], v[168:171], a[8:11]
    v_mfma_f32_16x16x32_bf16 a[12:15], v[196:199], v[172:175], a[12:15]
    buffer_load_dwordx4 v[116:119], v1, s[32:35], s44 offen offset:1024 sc1
    v_mfma_f32_16x16x32_bf16 a[16:19], a[216:219], v[160:163], a[16:19]
    v_mfma_f32_16x16x32_bf16 a[20:23], a[216:219], v[164:167], a[20:23]
    buffer_load_dwordx4 v[120:123], v2, s[32:35], s44 offen offset:1024 sc1
    v_mfma_f32_16x16x32_bf16 a[24:27], a[216:219], v[168:171], a[24:27]
    v_mfma_f32_16x16x32_bf16 a[28:31], a[216:219], v[172:175], a[28:31]
    buffer_load_dwordx4 v[124:127], v3, s[32:35], s44 offen offset:1024 sc1
    v_mfma_f32_16x16x32_bf16 a[32:35], a[220:223], v[160:163], a[32:35]
    v_mfma_f32_16x16x32_bf16 a[36:39], a[220:223], v[164:167], a[36:39]
    v_mfma_f32_16x16x32_bf16 a[40:43], a[220:223], v[168:171], a[40:43]
    v_mfma_f32_16x16x32_bf16 a[44:47], a[220:223], v[172:175], a[44:47]
    v_mfma_f32_16x16x32_bf16 a[48:51], a[224:227], v[160:163], a[48:51]
    v_mfma_f32_16x16x32_bf16 a[52:55], a[224:227], v[164:167], a[52:55]
    v_mfma_f32_16x16x32_bf16 a[56:59], a[224:227], v[168:171], a[56:59]
    v_mfma_f32_16x16x32_bf16 a[60:63], a[224:227], v[172:175], a[60:63]
    v_mfma_f32_16x16x32_bf16 a[64:67], a[228:231], v[160:163], a[64:67]
    v_mfma_f32_16x16x32_bf16 a[68:71], a[228:231], v[164:167], a[68:71]
    v_mfma_f32_16x16x32_bf16 a[72:75], a[228:231], v[168:171], a[72:75]
    v_mfma_f32_16x16x32_bf16 a[76:79], a[228:231], v[172:175], a[76:79]
    s_waitcnt vmcnt(8)
    v_mfma_f32_16x16x32_bf16 a[0:3], a[232:235], v[176:179], a[0:3]
    v_mfma_f32_16x16x32_bf16 a[4:7], a[232:235], v[180:183], a[4:7]
    buffer_load_dwordx4 v[160:163], v0, s[32:35], s44 offen offset:2048 sc1
    v_mfma_f32_16x16x32_bf16 a[8:11], a[232:235], v[184:187], a[8:11]
    v_mfma_f32_16x16x32_bf16 a[12:15], a[232:235], v[188:191], a[12:15]
    buffer_load_dwordx4 v[164:167], v1, s[32:35], s44 offen offset:2048 sc1
    v_mfma_f32_16x16x32_bf16 a[16:19], v[128:131], v[176:179], a[16:19]
    v_mfma_f32_16x16x32_bf16 a[20:23], v[128:131], v[180:183], a[20:23]
    buffer_load_dwordx4 v[168:171], v2, s[32:35], s44 offen offset:2048 sc1
    v_mfma_f32_16x16x32_bf16 a[24:27], v[128:131], v[184:187], a[24:27]
    v_mfma_f32_16x16x32_bf16 a[28:31], v[128:131], v[188:191], a[28:31]
    buffer_load_dwordx4 v[172:175], v3, s[32:35], s44 offen offset:2048 sc1
    v_mfma_f32_16x16x32_bf16 a[32:35], v[132:135], v[176:179], a[32:35]
    v_mfma_f32_16x16x32_bf16 a[36:39], v[132:135], v[180:183], a[36:39]
    v_mfma_f32_16x16x32_bf16 a[40:43], v[132:135], v[184:187], a[40:43]
    v_mfma_f32_16x16x32_bf16 a[44:47], v[132:135], v[188:191], a[44:47]
    v_mfma_f32_16x16x32_bf16 a[48:51], v[136:139], v[176:179], a[48:51]
    v_mfma_f32_16x16x32_bf16 a[52:55], v[136:139], v[180:183], a[52:55]
    v_mfma_f32_16x16x32_bf16 a[56:59], v[136:139], v[184:187], a[56:59]
    v_mfma_f32_16x16x32_bf16 a[60:63], v[136:139], v[188:191], a[60:63]
    v_mfma_f32_16x16x32_bf16 a[64:67], v[140:143], v[176:179], a[64:67]
    v_mfma_f32_16x16x32_bf16 a[68:71], v[140:143], v[180:183], a[68:71]
    v_mfma_f32_16x16x32_bf16 a[72:75], v[140:143], v[184:187], a[72:75]
    v_mfma_f32_16x16x32_bf16 a[76:79], v[140:143], v[188:191], a[76:79]
    s_waitcnt vmcnt(8)
    v_mfma_f32_16x16x32_bf16 a[0:3], v[144:147], v[96:99], a[0:3]
    v_mfma_f32_16x16x32_bf16 a[4:7], v[144:147], v[100:103], a[4:7]
    buffer_load_dwordx4 v[176:179], v0, s[32:35], s44 offen offset:3072 sc1
    v_mfma_f32_16x16x32_bf16 a[8:11], v[144:147], v[104:107], a[8:11]
    v_mfma_f32_16x16x32_bf16 a[12:15], v[144:147], v[108:111], a[12:15]
    buffer_load_dwordx4 v[180:183], v1, s[32:35], s44 offen offset:3072 sc1
    v_mfma_f32_16x16x32_bf16 a[16:19], v[148:151], v[96:99], a[16:19]
    v_mfma_f32_16x16x32_bf16 a[20:23], v[148:151], v[100:103], a[20:23]
    buffer_load_dwordx4 v[184:187], v2, s[32:35], s44 offen offset:3072 sc1
    v_mfma_f32_16x16x32_bf16 a[24:27], v[148:151], v[104:107], a[24:27]
    v_mfma_f32_16x16x32_bf16 a[28:31], v[148:151], v[108:111], a[28:31]
    buffer_load_dwordx4 v[188:191], v3, s[32:35], s44 offen offset:3072 sc1
    v_mfma_f32_16x16x32_bf16 a[32:35], v[152:155], v[96:99], a[32:35]
    v_mfma_f32_16x16x32_bf16 a[36:39], v[152:155], v[100:103], a[36:39]
    s_add_u32 s44, s44, 4096
    v_mfma_f32_16x16x32_bf16 a[40:43], v[152:155], v[104:107], a[40:43]
    v_mfma_f32_16x16x32_bf16 a[44:47], v[152:155], v[108:111], a[44:47]
    v_mfma_f32_16x16x32_bf16 a[48:51], v[156:159], v[96:99], a[48:51]
    v_mfma_f32_16x16x32_bf16 a[52:55], v[156:159], v[100:103], a[52:55]
    v_mfma_f32_16x16x32_bf16 a[56:59], v[156:159], v[104:107], a[56:59]
    v_mfma_f32_16x16x32_bf16 a[60:63], v[156:159], v[108:111], a[60:63]
    v_mfma_f32_16x16x32_bf16 a[64:67], v[32:35], v[96:99], a[64:67]
    v_mfma_f32_16x16x32_bf16 a[68:71], v[32:35], v[100:103], a[68:71]
    v_mfma_f32_16x16x32_bf16 a[72:75], v[32:35], v[104:107], a[72:75]
    v_mfma_f32_16x16x32_bf16 a[76:79], v[32:35], v[108:111], a[76:79]
    s_waitcnt vmcnt(8)
    v_mfma_f32_16x16x32_bf16 a[0:3], v[36:39], v[112:115], a[0:3]
    v_mfma_f32_16x16x32_bf16 a[4:7], v[36:39], v[116:119], a[4:7]
    buffer_load_dwordx4 v[96:99], v0, s[32:35], s44 offen sc1
    v_mfma_f32_16x16x32_bf16 a[8:11], v[36:39], v[120:123], a[8:11]
    v_mfma_f32_16x16x32_bf16 a[12:15], v[36:39], v[124:127], a[12:15]
    buffer_load_dwordx4 v[100:103], v1, s[32:35], s44 offen sc1
    v_mfma_f32_16x16x32_bf16 a[16:19], v[40:43], v[112:115], a[16:19]
    v_mfma_f32_16x16x32_bf16 a[20:23], v[40:43], v[116:119], a[20:23]
    buffer_load_dwordx4 v[104:107], v2, s[32:35], s44 offen sc1
    v_mfma_f32_16x16x32_bf16 a[24:27], v[40:43], v[120:123], a[24:27]
    v_mfma_f32_16x16x32_bf16 a[28:31], v[40:43], v[124:127], a[28:31]
    buffer_load_dwordx4 v[108:111], v3, s[32:35], s44 offen sc1
    v_mfma_f32_16x16x32_bf16 a[32:35], v[44:47], v[112:115], a[32:35]
    v_mfma_f32_16x16x32_bf16 a[36:39], v[44:47], v[116:119], a[36:39]
    v_mfma_f32_16x16x32_bf16 a[40:43], v[44:47], v[120:123], a[40:43]
    v_mfma_f32_16x16x32_bf16 a[44:47], v[44:47], v[124:127], a[44:47]
    v_mfma_f32_16x16x32_bf16 a[48:51], v[48:51], v[112:115], a[48:51]
    v_mfma_f32_16x16x32_bf16 a[52:55], v[48:51], v[116:119], a[52:55]
    v_mfma_f32_16x16x32_bf16 a[56:59], v[48:51], v[120:123], a[56:59]
    v_mfma_f32_16x16x32_bf16 a[60:63], v[48:51], v[124:127], a[60:63]
    v_mfma_f32_16x16x32_bf16 a[64:67], v[52:55], v[112:115], a[64:67]
    v_mfma_f32_16x16x32_bf16 a[68:71], v[52:55], v[116:119], a[68:71]
    v_mfma_f32_16x16x32_bf16 a[72:75], v[52:55], v[120:123], a[72:75]
    v_mfma_f32_16x16x32_bf16 a[76:79], v[52:55], v[124:127], a[76:79]
    s_waitcnt vmcnt(8)
    v_mfma_f32_16x16x32_bf16 a[0:3], v[56:59], v[160:163], a[0:3]
    v_mfma_f32_16x16x32_bf16 a[4:7], v[56:59], v[164:167], a[4:7]
    buffer_load_dwordx4 v[112:115], v0, s[32:35], s44 offen offset:1024 sc1
    v_mfma_f32_16x16x32_bf16 a[8:11], v[56:59], v[168:171], a[8:11]
    v_mfma_f32_16x16x32_bf16 a[12:15], v[56:59], v[172:175], a[12:15]
    buffer_load_dwordx4 v[116:119], v1, s[32:35], s44 offen offset:1024 sc1
    v_mfma_f32_16x16x32_bf16 a[16:19], v[60:63], v[160:163], a[16:19]
    v_mfma_f32_16x16x32_bf16 a[20:23], v[60:63], v[164:167], a[20:23]
    buffer_load_dwordx4 v[120:123], v2, s[32:35], s44 offen offset:1024 sc1
    v_mfma_f32_16x16x32_bf16 a[24:27], v[60:63], v[168:171], a[24:27]
    v_mfma_f32_16x16x32_bf16 a[28:31], v[60:63], v[172:175], a[28:31]
    buffer_load_dwordx4 v[124:127], v3, s[32:35], s44 offen offset:1024 sc1
    v_mfma_f32_16x16x32_bf16 a[32:35], v[64:67], v[160:163], a[32:35]
    v_mfma_f32_16x16x32_bf16 a[36:39], v[64:67], v[164:167], a[36:39]
    v_mfma_f32_16x16x32_bf16 a[40:43], v[64:67], v[168:171], a[40:43]
    v_mfma_f32_16x16x32_bf16 a[44:47], v[64:67], v[172:175], a[44:47]
    v_mfma_f32_16x16x32_bf16 a[48:51], v[68:71], v[160:163], a[48:51]
    v_mfma_f32_16x16x32_bf16 a[52:55], v[68:71], v[164:167], a[52:55]
    v_mfma_f32_16x16x32_bf16 a[56:59], v[68:71], v[168:171], a[56:59]
    v_mfma_f32_16x16x32_bf16 a[60:63], v[68:71], v[172:175], a[60:63]
    v_mfma_f32_16x16x32_bf16 a[64:67], v[72:75], v[160:163], a[64:67]
    v_mfma_f32_16x16x32_bf16 a[68:71], v[72:75], v[164:167], a[68:71]
    v_mfma_f32_16x16x32_bf16 a[72:75], v[72:75], v[168:171], a[72:75]
    v_mfma_f32_16x16x32_bf16 a[76:79], v[72:75], v[172:175], a[76:79]
    s_waitcnt vmcnt(8)
    v_mfma_f32_16x16x32_bf16 a[0:3], v[76:79], v[176:179], a[0:3]
    v_mfma_f32_16x16x32_bf16 a[4:7], v[76:79], v[180:183], a[4:7]
    buffer_load_dwordx4 v[160:163], v0, s[32:35], s44 offen offset:2048 sc1
    v_mfma_f32_16x16x32_bf16 a[8:11], v[76:79], v[184:187], a[8:11]
    v_mfma_f32_16x16x32_bf16 a[12:15], v[76:79], v[188:191], a[12:15]
    buffer_load_dwordx4 v[164:167], v1, s[32:35], s44 offen offset:2048 sc1
    v_mfma_f32_16x16x32_bf16 a[16:19], v[80:83], v[176:179], a[16:19]
    v_mfma_f32_16x16x32_bf16 a[20:23], v[80:83], v[180:183], a[20:23]
    buffer_load_dwordx4 v[168:171], v2, s[32:35], s44 offen offset:2048 sc1
    v_mfma_f32_16x16x32_bf16 a[24:27], v[80:83], v[184:187], a[24:27]
    v_mfma_f32_16x16x32_bf16 a[28:31], v[80:83], v[188:191], a[28:31]
    buffer_load_dwordx4 v[172:175], v3, s[32:35], s44 offen offset:2048 sc1
    v_mfma_f32_16x16x32_bf16 a[32:35], v[84:87], v[176:179], a[32:35]
    v_mfma_f32_16x16x32_bf16 a[36:39], v[84:87], v[180:183], a[36:39]
    ds_read_b128 v[244:247], v31 offset:0
    v_mfma_f32_16x16x32_bf16 a[40:43], v[84:87], v[184:187], a[40:43]
    ds_read_b128 a[160:163], v31 offset:1024
    v_mfma_f32_16x16x32_bf16 a[44:47], v[84:87], v[188:191], a[44:47]
    ds_read_b128 a[164:167], v31 offset:2048
    v_mfma_f32_16x16x32_bf16 a[48:51], v[88:91], v[176:179], a[48:51]
    ds_read_b128 a[168:171], v31 offset:3072
    v_mfma_f32_16x16x32_bf16 a[52:55], v[88:91], v[180:183], a[52:55]
    ds_read_b128 a[172:175], v31 offset:4096
    v_mfma_f32_16x16x32_bf16 a[56:59], v[88:91], v[184:187], a[56:59]
    v_mfma_f32_16x16x32_bf16 a[60:63], v[88:91], v[188:191], a[60:63]
    v_mfma_f32_16x16x32_bf16 a[64:67], v[92:95], v[176:179], a[64:67]
    v_mfma_f32_16x16x32_bf16 a[68:71], v[92:95], v[180:183], a[68:71]
    v_mfma_f32_16x16x32_bf16 a[72:75], v[92:95], v[184:187], a[72:75]
    v_mfma_f32_16x16x32_bf16 a[76:79], v[92:95], v[188:191], a[76:79]
    s_waitcnt vmcnt(8)
    v_mfma_f32_16x16x32_bf16 a[0:3], v[192:195], v[96:99], a[0:3]
    v_mfma_f32_16x16x32_bf16 a[4:7], v[192:195], v[100:103], a[4:7]
    buffer_load_dwordx4 v[176:179], v0, s[32:35], s44 offen offset:3072 sc1
    v_mfma_f32_16x16x32_bf16 a[8:11], v[192:195], v[104:107], a[8:11]
    v_mfma_f32_16x16x32_bf16 a[12:15], v[192:195], v[108:111], a[12:15]
    buffer_load_dwordx4 v[180:183], v1, s[32:35], s44 offen offset:3072 sc1
    v_mfma_f32_16x16x32_bf16 a[16:19], v[208:211], v[96:99], a[16:19]
    v_mfma_f32_16x16x32_bf16 a[20:23], v[208:211], v[100:103], a[20:23]
    buffer_load_dwordx4 v[184:187], v2, s[32:35], s44 offen offset:3072 sc1
    v_mfma_f32_16x16x32_bf16 a[24:27], v[208:211], v[104:107], a[24:27]
    v_mfma_f32_16x16x32_bf16 a[28:31], v[208:211], v[108:111], a[28:31]
    buffer_load_dwordx4 v[188:191], v3, s[32:35], s44 offen offset:3072 sc1
    v_mfma_f32_16x16x32_bf16 a[32:35], v[212:215], v[96:99], a[32:35]
    v_mfma_f32_16x16x32_bf16 a[36:39], v[212:215], v[100:103], a[36:39]
    s_add_u32 s44, s44, 4096
    ds_read_b128 a[176:179], v27 offset:0
    v_mfma_f32_16x16x32_bf16 a[40:43], v[212:215], v[104:107], a[40:43]
    ds_read_b128 a[180:183], v27 offset:1024
    v_mfma_f32_16x16x32_bf16 a[44:47], v[212:215], v[108:111], a[44:47]
    ds_read_b128 a[184:187], v27 offset:2048
    v_mfma_f32_16x16x32_bf16 a[48:51], v[216:219], v[96:99], a[48:51]
    ds_read_b128 a[188:191], v27 offset:3072
    v_mfma_f32_16x16x32_bf16 a[52:55], v[216:219], v[100:103], a[52:55]
    ds_read_b128 a[128:131], v26 offset:32768
    v_mfma_f32_16x16x32_bf16 a[56:59], v[216:219], v[104:107], a[56:59]
    v_mfma_f32_16x16x32_bf16 a[60:63], v[216:219], v[108:111], a[60:63]
    v_mfma_f32_16x16x32_bf16 a[64:67], v[236:239], v[96:99], a[64:67]
    v_mfma_f32_16x16x32_bf16 a[68:71], v[236:239], v[100:103], a[68:71]
    v_mfma_f32_16x16x32_bf16 a[72:75], v[236:239], v[104:107], a[72:75]
    v_mfma_f32_16x16x32_bf16 a[76:79], v[236:239], v[108:111], a[76:79]
    s_waitcnt vmcnt(8) lgkmcnt(9)
    v_mfma_f32_16x16x32_bf16 a[0:3], v[244:247], v[112:115], a[0:3]
    v_mfma_f32_16x16x32_bf16 a[4:7], v[244:247], v[116:119], a[4:7]
    buffer_load_dwordx4 v[96:99], v0, s[32:35], s44 offen sc1
    v_mfma_f32_16x16x32_bf16 a[8:11], v[244:247], v[120:123], a[8:11]
    v_mfma_f32_16x16x32_bf16 a[12:15], v[244:247], v[124:127], a[12:15]
    buffer_load_dwordx4 v[100:103], v1, s[32:35], s44 offen sc1
    s_waitcnt lgkmcnt(8)
    v_mfma_f32_16x16x32_bf16 a[16:19], a[160:163], v[112:115], a[16:19]
    v_mfma_f32_16x16x32_bf16 a[20:23], a[160:163], v[116:119], a[20:23]
    buffer_load_dwordx4 v[104:107], v2, s[32:35], s44 offen sc1
    v_mfma_f32_16x16x32_bf16 a[24:27], a[160:163], v[120:123], a[24:27]
    v_mfma_f32_16x16x32_bf16 a[28:31], a[160:163], v[124:127], a[28:31]
    buffer_load_dwordx4 v[108:111], v3, s[32:35], s44 offen sc1
    s_waitcnt lgkmcnt(7)
    v_mfma_f32_16x16x32_bf16 a[32:35], a[164:167], v[112:115], a[32:35]
    v_mfma_f32_16x16x32_bf16 a[36:39], a[164:167], v[116:119], a[36:39]
    ds_read_b128 a[132:135], v26 offset:33792
    v_mfma_f32_16x16x32_bf16 a[40:43], a[164:167], v[120:123], a[40:43]
    ds_read_b128 a[136:139], v26 offset:34816
    v_mfma_f32_16x16x32_bf16 a[44:47], a[164:167], v[124:127], a[44:47]
    ds_read_b128 a[140:143], v26 offset:35840
    s_waitcnt lgkmcnt(9)
    v_mfma_f32_16x16x32_bf16 a[48:51], a[168:171], v[112:115], a[48:51]
    ds_read_b128 a[144:147], v26 offset:49152
    v_mfma_f32_16x16x32_bf16 a[52:55], a[168:171], v[116:119], a[52:55]
    ds_read_b128 a[148:151], v26 offset:50176
    v_mfma_f32_16x16x32_bf16 a[56:59], a[168:171], v[120:123], a[56:59]
    s_and_b32 s80, s2, 7
    s_lshr_b32 s81, s2, 3
    s_and_b32 s82, s80, 1
    s_lshl_b32 s82, s82, 2
    s_and_b32 s83, s81, 3
    s_add_u32 s69, s82, s83
    s_lshr_b32 s82, s80, 1
    s_mul_i32 s82, s82, 7
    s_lshr_b32 s83, s81, 2
    s_add_u32 s68, s82, s83
    s_mov_b32 s77, 0
    s_cmp_ge_u32 s83, 7
    s_cselect_b32 s77, 1, s77
    s_cmp_ge_u32 s68, 27
    s_cselect_b32 s77, 1, s77
    v_mov_b32 v194, v0
    v_lshrrev_b32 v197, 7, v0
    s_lshl_b32 s80, s64, 4
    v_add_u32 v197, s80, v197
    v_mul_u32_u24 v197, 3456, v197
    v_bfe_u32 v198, v0, 8, 1
    v_lshlrev_b32 v198, 2, v198
    v_bfe_u32 v199, v0, 4, 3
    v_xor_b32 v198, v198, v199
    v_lshl_add_u32 v195, v198, 4, v197
    v_add_u32 v196, 26624, v195
    s_lshl_b32 s80, s68, 7
    s_sub_u32 s81, 2211840, s80
    s_cmp_lg_u32 s77, 0
    s_cselect_b32 s81, 0, s81
    s_cselect_b32 s80, 0, s80
    s_add_u32 s36, s16, s80
    s_addc_u32 s37, s17, 0
    s_mov_b32 s38, s81
    s_mov_b32 s39, 0x20000
    s_add_u32 s81, s81, 2048
    s_add_u32 s40, s18, s80
    s_addc_u32 s41, s19, 0
    s_mov_b32 s42, s81
    s_mov_b32 s43, 0x20000
    s_sub_u32 s40, s40, 2048
    s_subb_u32 s41, s41, 0
    s_mov_b32 s62, 0
    s_mov_b32 s63, 4096
    v_mfma_f32_16x16x32_bf16 a[60:63], a[168:171], v[124:127], a[60:63]
    s_waitcnt lgkmcnt(10)
    v_mfma_f32_16x16x32_bf16 a[64:67], a[172:175], v[112:115], a[64:67]
    v_mfma_f32_16x16x32_bf16 a[68:71], a[172:175], v[116:119], a[68:71]
    v_mfma_f32_16x16x32_bf16 a[72:75], a[172:175], v[120:123], a[72:75]
    v_mfma_f32_16x16x32_bf16 a[76:79], a[172:175], v[124:127], a[76:79]
    s_waitcnt vmcnt(8) lgkmcnt(9)
    v_mfma_f32_16x16x32_bf16 a[0:3], a[176:179], v[160:163], a[0:3]
    v_mfma_f32_16x16x32_bf16 a[4:7], a[176:179], v[164:167], a[4:7]
    buffer_load_dwordx4 v[112:115], v0, s[32:35], s44 offen offset:1024 sc1
    v_mfma_f32_16x16x32_bf16 a[8:11], a[176:179], v[168:171], a[8:11]
    v_mfma_f32_16x16x32_bf16 a[12:15], a[176:179], v[172:175], a[12:15]
    buffer_load_dwordx4 v[116:119], v1, s[32:35], s44 offen offset:1024 sc1
    s_waitcnt lgkmcnt(8)
    v_mfma_f32_16x16x32_bf16 a[16:19], a[180:183], v[160:163], a[16:19]
    v_mfma_f32_16x16x32_bf16 a[20:23], a[180:183], v[164:167], a[20:23]
    buffer_load_dwordx4 v[120:123], v2, s[32:35], s44 offen offset:1024 sc1
    v_mfma_f32_16x16x32_bf16 a[24:27], a[180:183], v[168:171], a[24:27]
    v_mfma_f32_16x16x32_bf16 a[28:31], a[180:183], v[172:175], a[28:31]
    buffer_load_dwordx4 v[124:127], v3, s[32:35], s44 offen offset:1024 sc1
    s_waitcnt lgkmcnt(7)
    v_mfma_f32_16x16x32_bf16 a[32:35], a[184:187], v[160:163], a[32:35]
    v_mfma_f32_16x16x32_bf16 a[36:39], a[184:187], v[164:167], a[36:39]
    ds_read_b128 a[152:155], v26 offset:51200
    v_mfma_f32_16x16x32_bf16 a[40:43], a[184:187], v[168:171], a[40:43]
    ds_read_b128 a[156:159], v26 offset:52224
    v_mfma_f32_16x16x32_bf16 a[44:47], a[184:187], v[172:175], a[44:47]
    ds_read_b128 a[204:207], v27 offset:16384
    s_waitcnt lgkmcnt(9)
    v_mfma_f32_16x16x32_bf16 a[48:51], a[188:191], v[160:163], a[48:51]
    ds_read_b128 a[124:127], v27 offset:17408
    v_mfma_f32_16x16x32_bf16 a[52:55], a[188:191], v[164:167], a[52:55]
    ds_read_b128 a[120:123], v27 offset:18432
    v_mfma_f32_16x16x32_bf16 a[56:59], a[188:191], v[168:171], a[56:59]
    v_mfma_f32_16x16x32_bf16 a[60:63], a[188:191], v[172:175], a[60:63]
    s_waitcnt lgkmcnt(10)
    v_mfma_f32_16x16x32_bf16 a[64:67], a[128:131], v[160:163], a[64:67]
    v_mfma_f32_16x16x32_bf16 a[68:71], a[128:131], v[164:167], a[68:71]
    v_mfma_f32_16x16x32_bf16 a[72:75], a[128:131], v[168:171], a[72:75]
    v_mfma_f32_16x16x32_bf16 a[76:79], a[128:131], v[172:175], a[76:79]
    s_waitcnt vmcnt(8) lgkmcnt(9)
    v_mfma_f32_16x16x32_bf16 a[0:3], a[132:135], v[176:179], a[0:3]
    v_mfma_f32_16x16x32_bf16 a[4:7], a[132:135], v[180:183], a[4:7]
    buffer_load_dwordx4 v[160:163], v0, s[32:35], s44 offen offset:2048 sc1
    v_mfma_f32_16x16x32_bf16 a[8:11], a[132:135], v[184:187], a[8:11]
    v_mfma_f32_16x16x32_bf16 a[12:15], a[132:135], v[188:191], a[12:15]
    buffer_load_dwordx4 v[164:167], v1, s[32:35], s44 offen offset:2048 sc1
    s_waitcnt lgkmcnt(8)
    v_mfma_f32_16x16x32_bf16 a[16:19], a[136:139], v[176:179], a[16:19]
    v_mfma_f32_16x16x32_bf16 a[20:23], a[136:139], v[180:183], a[20:23]
    buffer_load_dwordx4 v[168:171], v2, s[32:35], s44 offen offset:2048 sc1
    v_mfma_f32_16x16x32_bf16 a[24:27], a[136:139], v[184:187], a[24:27]
    v_mfma_f32_16x16x32_bf16 a[28:31], a[136:139], v[188:191], a[28:31]
    buffer_load_dwordx4 v[172:175], v3, s[32:35], s44 offen offset:2048 sc1
    s_waitcnt lgkmcnt(7)
    v_mfma_f32_16x16x32_bf16 a[32:35], a[140:143], v[176:179], a[32:35]
    v_mfma_f32_16x16x32_bf16 a[36:39], a[140:143], v[180:183], a[36:39]
    ds_read_b128 a[116:119], v27 offset:19456
    v_mfma_f32_16x16x32_bf16 a[40:43], a[140:143], v[184:187], a[40:43]
    ds_read_b128 a[112:115], v27 offset:32768
    v_mfma_f32_16x16x32_bf16 a[44:47], a[140:143], v[188:191], a[44:47]
    ds_read_b128 a[108:111], v27 offset:33792
    s_waitcnt lgkmcnt(9)
    v_mfma_f32_16x16x32_bf16 a[48:51], a[144:147], v[176:179], a[48:51]
    ds_read_b128 a[104:107], v27 offset:34816
    v_mfma_f32_16x16x32_bf16 a[52:55], a[144:147], v[180:183], a[52:55]
    ds_read_b128 a[100:103], v27 offset:35840
    v_mfma_f32_16x16x32_bf16 a[56:59], a[144:147], v[184:187], a[56:59]
    v_mfma_f32_16x16x32_bf16 a[60:63], a[144:147], v[188:191], a[60:63]
    s_waitcnt lgkmcnt(10)
    v_mfma_f32_16x16x32_bf16 a[64:67], a[148:151], v[176:179], a[64:67]
    v_mfma_f32_16x16x32_bf16 a[68:71], a[148:151], v[180:183], a[68:71]
    v_mfma_f32_16x16x32_bf16 a[72:75], a[148:151], v[184:187], a[72:75]
    v_mfma_f32_16x16x32_bf16 a[76:79], a[148:151], v[188:191], a[76:79]
    s_waitcnt vmcnt(8) lgkmcnt(9)
    v_mfma_f32_16x16x32_bf16 a[0:3], a[152:155], v[96:99], a[0:3]
    v_mfma_f32_16x16x32_bf16 a[4:7], a[152:155], v[100:103], a[4:7]
    buffer_load_dwordx4 v[176:179], v0, s[32:35], s44 offen offset:3072 sc1
    v_mfma_f32_16x16x32_bf16 a[8:11], a[152:155], v[104:107], a[8:11]
    v_mfma_f32_16x16x32_bf16 a[12:15], a[152:155], v[108:111], a[12:15]
    buffer_load_dwordx4 v[180:183], v1, s[32:35], s44 offen offset:3072 sc1
    s_waitcnt lgkmcnt(8)
    v_mfma_f32_16x16x32_bf16 a[16:19], a[156:159], v[96:99], a[16:19]
    v_mfma_f32_16x16x32_bf16 a[20:23], a[156:159], v[100:103], a[20:23]
    buffer_load_dwordx4 v[184:187], v2, s[32:35], s44 offen offset:3072 sc1
    v_mfma_f32_16x16x32_bf16 a[24:27], a[156:159], v[104:107], a[24:27]
    v_mfma_f32_16x16x32_bf16 a[28:31], a[156:159], v[108:111], a[28:31]
    buffer_load_dwordx4 v[188:191], v3, s[32:35], s44 offen offset:3072 sc1
    s_waitcnt lgkmcnt(7)
    v_mfma_f32_16x16x32_bf16 a[32:35], a[204:207], v[96:99], a[32:35]
    v_mfma_f32_16x16x32_bf16 a[36:39], a[204:207], v[100:103], a[36:39]
    s_add_u32 s44, s44, 4096
    ds_read_b128 a[96:99], v27 offset:49152
    v_mfma_f32_16x16x32_bf16 a[40:43], a[204:207], v[104:107], a[40:43]
    ds_read_b128 a[92:95], v27 offset:50176
    v_mfma_f32_16x16x32_bf16 a[44:47], a[204:207], v[108:111], a[44:47]
    ds_read_b128 a[88:91], v27 offset:51200
    s_waitcnt lgkmcnt(9)
    v_mfma_f32_16x16x32_bf16 a[48:51], a[124:127], v[96:99], a[48:51]
    ds_read_b128 a[84:87], v27 offset:52224
    v_mfma_f32_16x16x32_bf16 a[52:55], a[124:127], v[100:103], a[52:55]
    ds_read_b128 a[80:83], v26 offset:0
    v_mfma_f32_16x16x32_bf16 a[56:59], a[124:127], v[104:107], a[56:59]
    v_mfma_f32_16x16x32_bf16 a[60:63], a[124:127], v[108:111], a[60:63]
    s_waitcnt lgkmcnt(10)
    v_mfma_f32_16x16x32_bf16 a[64:67], a[120:123], v[96:99], a[64:67]
    v_mfma_f32_16x16x32_bf16 a[68:71], a[120:123], v[100:103], a[68:71]
    v_mfma_f32_16x16x32_bf16 a[72:75], a[120:123], v[104:107], a[72:75]
    v_mfma_f32_16x16x32_bf16 a[76:79], a[120:123], v[108:111], a[76:79]
    s_waitcnt vmcnt(8) lgkmcnt(9)
    v_mfma_f32_16x16x32_bf16 a[0:3], a[116:119], v[112:115], a[0:3]
    v_mfma_f32_16x16x32_bf16 a[4:7], a[116:119], v[116:119], a[4:7]
    ds_read_b128 a[236:239], v26 offset:1024
    v_mfma_f32_16x16x32_bf16 a[8:11], a[116:119], v[120:123], a[8:11]
    ds_read_b128 a[240:243], v26 offset:2048
    v_mfma_f32_16x16x32_bf16 a[12:15], a[116:119], v[124:127], a[12:15]
    ds_read_b128 a[244:247], v26 offset:3072
    s_waitcnt lgkmcnt(11)
    v_mfma_f32_16x16x32_bf16 a[16:19], a[112:115], v[112:115], a[16:19]
    ds_read_b128 a[248:251], v26 offset:16384
    v_mfma_f32_16x16x32_bf16 a[20:23], a[112:115], v[116:119], a[20:23]
    ds_read_b128 a[252:255], v26 offset:17408
    v_mfma_f32_16x16x32_bf16 a[24:27], a[112:115], v[120:123], a[24:27]
    v_mfma_f32_16x16x32_bf16 a[28:31], a[112:115], v[124:127], a[28:31]
    s_waitcnt lgkmcnt(12)
    v_mfma_f32_16x16x32_bf16 a[32:35], a[108:111], v[112:115], a[32:35]
    v_mfma_f32_16x16x32_bf16 a[36:39], a[108:111], v[116:119], a[36:39]
    v_mfma_f32_16x16x32_bf16 a[40:43], a[108:111], v[120:123], a[40:43]
    v_mfma_f32_16x16x32_bf16 a[44:47], a[108:111], v[124:127], a[44:47]
    s_waitcnt lgkmcnt(11)
    v_mfma_f32_16x16x32_bf16 a[48:51], a[104:107], v[112:115], a[48:51]
    v_mfma_f32_16x16x32_bf16 a[52:55], a[104:107], v[116:119], a[52:55]
    v_mfma_f32_16x16x32_bf16 a[56:59], a[104:107], v[120:123], a[56:59]
    v_mfma_f32_16x16x32_bf16 a[60:63], a[104:107], v[124:127], a[60:63]
    s_waitcnt lgkmcnt(10)
    v_mfma_f32_16x16x32_bf16 a[64:67], a[100:103], v[112:115], a[64:67]
    v_mfma_f32_16x16x32_bf16 a[68:71], a[100:103], v[116:119], a[68:71]
    v_mfma_f32_16x16x32_bf16 a[72:75], a[100:103], v[120:123], a[72:75]
    v_mfma_f32_16x16x32_bf16 a[76:79], a[100:103], v[124:127], a[76:79]
    s_waitcnt vmcnt(4) lgkmcnt(9)
    v_mfma_f32_16x16x32_bf16 a[0:3], a[96:99], v[160:163], a[0:3]
    v_mfma_f32_16x16x32_bf16 a[4:7], a[96:99], v[164:167], a[4:7]
    s_waitcnt lgkmcnt(0)
    s_barrier
    s_add_u32 m0, s72, 98304
    s_mul_i32 s70, s62, 54
    buffer_load_dwordx4 v195, s[36:39], s70 offen lds
    v_mfma_f32_16x16x32_bf16 a[8:11], a[96:99], v[168:171], a[8:11]
    v_mfma_f32_16x16x32_bf16 a[12:15], a[96:99], v[172:175], a[12:15]
    buffer_load_dwordx4 v196, s[36:39], s70 offen offset:1024 lds
    v_mfma_f32_16x16x32_bf16 a[16:19], a[92:95], v[160:163], a[16:19]
    v_mfma_f32_16x16x32_bf16 a[20:23], a[92:95], v[164:167], a[20:23]
    buffer_load_dwordx4 v195, s[40:43], s70 offen offset:2048 lds
    v_mfma_f32_16x16x32_bf16 a[24:27], a[92:95], v[168:171], a[24:27]
    v_mfma_f32_16x16x32_bf16 a[28:31], a[92:95], v[172:175], a[28:31]
    buffer_load_dwordx4 v196, s[40:43], s70 offen offset:3072 lds
    v_mfma_f32_16x16x32_bf16 a[32:35], a[88:91], v[160:163], a[32:35]
    v_mfma_f32_16x16x32_bf16 a[36:39], a[88:91], v[164:167], a[36:39]
    v_mfma_f32_16x16x32_bf16 a[40:43], a[88:91], v[168:171], a[40:43]
    v_mfma_f32_16x16x32_bf16 a[44:47], a[88:91], v[172:175], a[44:47]
    v_mfma_f32_16x16x32_bf16 a[48:51], a[84:87], v[160:163], a[48:51]
    v_mfma_f32_16x16x32_bf16 a[52:55], a[84:87], v[164:167], a[52:55]
    v_mfma_f32_16x16x32_bf16 a[56:59], a[84:87], v[168:171], a[56:59]
    v_mfma_f32_16x16x32_bf16 a[60:63], a[84:87], v[172:175], a[60:63]
    v_mfma_f32_16x16x32_bf16 a[64:67], a[80:83], v[160:163], a[64:67]
    v_mfma_f32_16x16x32_bf16 a[68:71], a[80:83], v[164:167], a[68:71]
    v_mfma_f32_16x16x32_bf16 a[72:75], a[80:83], v[168:171], a[72:75]
    v_mfma_f32_16x16x32_bf16 a[76:79], a[80:83], v[172:175], a[76:79]
    s_waitcnt vmcnt(4)
    v_mfma_f32_16x16x32_bf16 a[0:3], a[236:239], v[176:179], a[0:3]
    v_mfma_f32_16x16x32_bf16 a[16:19], a[240:243], v[176:179], a[16:19]
    s_add_u32 m0, s72, 114688
    s_mul_i32 s70, s63, 54
    buffer_load_dwordx4 v195, s[36:39], s70 offen lds
    v_mfma_f32_16x16x32_bf16 a[32:35], a[244:247], v[176:179], a[32:35]
    v_mfma_f32_16x16x32_bf16 a[48:51], a[248:251], v[176:179], a[48:51]
    buffer_load_dwordx4 v196, s[36:39], s70 offen offset:1024 lds
    v_mfma_f32_16x16x32_bf16 a[64:67], a[252:255], v[176:179], a[64:67]
    v_mfma_f32_16x16x32_bf16 a[4:7], a[236:239], v[180:183], a[4:7]
    buffer_load_dwordx4 v195, s[40:43], s70 offen offset:2048 lds
    v_mfma_f32_16x16x32_bf16 a[20:23], a[240:243], v[180:183], a[20:23]
    v_mfma_f32_16x16x32_bf16 a[36:39], a[244:247], v[180:183], a[36:39]
    buffer_load_dwordx4 v196, s[40:43], s70 offen offset:3072 lds
    v_mfma_f32_16x16x32_bf16 a[52:55], a[248:251], v[180:183], a[52:55]
    ds_write_b128 v14, a[0:3] offset:0
    v_mfma_f32_16x16x32_bf16 a[68:71], a[252:255], v[180:183], a[68:71]
    ds_write_b128 v14, a[16:19] offset:1024
    v_mfma_f32_16x16x32_bf16 a[8:11], a[236:239], v[184:187], a[8:11]
    ds_write_b128 v14, a[32:35] offset:2048
    v_mfma_f32_16x16x32_bf16 a[24:27], a[240:243], v[184:187], a[24:27]
    ds_write_b128 v14, a[48:51] offset:3072
    v_mfma_f32_16x16x32_bf16 a[40:43], a[244:247], v[184:187], a[40:43]
    ds_write_b128 v14, a[64:67] offset:4096
    v_mfma_f32_16x16x32_bf16 a[56:59], a[248:251], v[184:187], a[56:59]
    ds_write_b128 v14, a[4:7] offset:20480
    v_mfma_f32_16x16x32_bf16 a[72:75], a[252:255], v[184:187], a[72:75]
    ds_write_b128 v14, a[20:23] offset:21504
    v_mfma_f32_16x16x32_bf16 a[12:15], a[236:239], v[188:191], a[12:15]
    ds_write_b128 v14, a[36:39] offset:22528
    v_mfma_f32_16x16x32_bf16 a[28:31], a[240:243], v[188:191], a[28:31]
    ds_write_b128 v14, a[52:55] offset:23552
    v_mfma_f32_16x16x32_bf16 a[44:47], a[244:247], v[188:191], a[44:47]
    ds_write_b128 v14, a[68:71] offset:24576
    v_mfma_f32_16x16x32_bf16 a[60:63], a[248:251], v[188:191], a[60:63]
    ds_write_b128 v14, a[8:11] offset:40960
    v_mfma_f32_16x16x32_bf16 a[76:79], a[252:255], v[188:191], a[76:79]
    ds_write_b128 v14, a[24:27] offset:41984
    s_mul_i32 s80, s23, 81920
    s_mul_i32 s81, s22, 5120
    s_add_u32 s80, s80, s81
    s_add_u32 s80, s80, 4194304
    s_lshl_b32 s82, s23, 12
    s_lshl_b32 s81, s22, 3
    s_add_u32 s82, s82, s81
    s_add_u32 s82, s82, 196608
    ds_read_b128 v[172:175], v13 offset:320
    ds_read_b128 v[176:179], v13 offset:384
    ds_read_b128 v[180:183], v13 offset:448
    ds_read_b128 v[184:187], v13 offset:512
    ds_read_b128 v[188:191], v13 offset:576
    v_lshlrev_b32 v128, 16, v16
    v_and_b32 v129, 0xffff0000, v16
    v_lshlrev_b32 v130, 16, v17
    v_and_b32 v131, 0xffff0000, v17
    v_lshlrev_b32 v132, 16, v18
    v_and_b32 v133, 0xffff0000, v18
    ds_write_b128 v14, a[40:43] offset:43008
    v_lshlrev_b32 v134, 16, v19
    v_and_b32 v135, 0xffff0000, v19
    ds_write_b128 v14, a[56:59] offset:44032
    v_lshlrev_b32 v136, 16, v20
    v_and_b32 v137, 0xffff0000, v20
    ds_write_b128 v14, a[72:75] offset:45056
    v_lshlrev_b32 v138, 16, v21
    v_and_b32 v139, 0xffff0000, v21
    ds_write_b128 v15, a[12:15] offset:0
    v_lshlrev_b32 v140, 16, v22
    v_and_b32 v141, 0xffff0000, v22
    ds_write_b128 v15, a[28:31] offset:1024
    v_lshlrev_b32 v142, 16, v23
    v_and_b32 v143, 0xffff0000, v23
    ds_write_b128 v15, a[44:47] offset:2048
    v_lshlrev_b32 v144, 16, v24
    v_and_b32 v145, 0xffff0000, v24
    ds_write_b128 v15, a[60:63] offset:3072
    v_lshlrev_b32 v146, 16, v25
    v_and_b32 v147, 0xffff0000, v25
    ds_write_b128 v15, a[76:79] offset:4096
    ds_read_b128 v[152:155], v13 offset:0
    ds_read_b128 v[156:159], v13 offset:64
    ds_read_b128 v[160:163], v13 offset:128
    ds_read_b128 v[164:167], v13 offset:192
    ds_read_b128 v[168:171], v13 offset:256
    s_waitcnt lgkmcnt(0)
    s_barrier
    ds_read_b128 v[32:35], v12 offset:0
    ds_read_b128 v[52:55], v12 offset:5120
    ds_read_b128 v[72:75], v12 offset:10240
    ds_read_b128 v[92:95], v12 offset:15360
    ds_read_b128 v[36:39], v12 offset:1024
    ds_read_b128 v[56:59], v12 offset:6144
    ds_read_b128 v[76:79], v12 offset:11264
    ds_read_b128 v[96:99], v12 offset:16384
    ds_read_b128 v[40:43], v12 offset:2048
    ds_read_b128 v[60:63], v12 offset:7168
    ds_read_b128 v[80:83], v12 offset:12288
    ds_read_b128 v[100:103], v12 offset:17408
    ds_read_b128 v[44:47], v12 offset:3072
    ds_read_b128 v[64:67], v12 offset:8192
    ds_read_b128 v[84:87], v12 offset:13312
    ds_read_b128 v[104:107], v12 offset:18432
    ds_read_b128 v[48:51], v12 offset:4096
    ds_read_b128 v[68:71], v12 offset:9216
    ds_read_b128 v[88:91], v12 offset:14336
    ds_read_b128 v[108:111], v12 offset:19456
    s_waitcnt lgkmcnt(15)
    v_pk_add_f32 v[32:33], v[32:33], v[52:53]
    v_pk_add_f32 v[72:73], v[72:73], v[92:93]
    v_pk_add_f32 v[34:35], v[34:35], v[54:55]
    v_pk_add_f32 v[74:75], v[74:75], v[94:95]
    v_pk_add_f32 v[32:33], v[32:33], v[72:73]
    v_pk_add_f32 v[34:35], v[34:35], v[74:75]
    v_pk_fma_f32 v[128:129], v[32:33], v[152:153], v[128:129]
    v_pk_fma_f32 v[130:131], v[34:35], v[154:155], v[130:131]
    v_cvt_pk_bf16_f32 v16, v128, v129
    v_cvt_pk_bf16_f32 v17, v130, v131
    s_waitcnt lgkmcnt(12)
    v_pk_add_f32 v[36:37], v[36:37], v[56:57]
    v_pk_add_f32 v[76:77], v[76:77], v[96:97]
    v_pk_add_f32 v[38:39], v[38:39], v[58:59]
    v_pk_add_f32 v[78:79], v[78:79], v[98:99]
    v_pk_add_f32 v[36:37], v[36:37], v[76:77]
    v_pk_add_f32 v[38:39], v[38:39], v[78:79]
    v_pk_fma_f32 v[132:133], v[36:37], v[156:157], v[132:133]
    v_pk_fma_f32 v[134:135], v[38:39], v[158:159], v[134:135]
    v_cvt_pk_bf16_f32 v18, v132, v133
    v_cvt_pk_bf16_f32 v19, v134, v135
    s_waitcnt lgkmcnt(8)
    v_pk_add_f32 v[40:41], v[40:41], v[60:61]
    v_pk_add_f32 v[80:81], v[80:81], v[100:101]
    v_pk_add_f32 v[42:43], v[42:43], v[62:63]
    v_pk_add_f32 v[82:83], v[82:83], v[102:103]
    v_pk_add_f32 v[40:41], v[40:41], v[80:81]
    v_pk_add_f32 v[42:43], v[42:43], v[82:83]
    v_pk_fma_f32 v[136:137], v[40:41], v[160:161], v[136:137]
    v_pk_fma_f32 v[138:139], v[42:43], v[162:163], v[138:139]
    v_cvt_pk_bf16_f32 v20, v136, v137
    v_cvt_pk_bf16_f32 v21, v138, v139
    s_waitcnt lgkmcnt(4)
    v_pk_add_f32 v[44:45], v[44:45], v[64:65]
    v_pk_add_f32 v[84:85], v[84:85], v[104:105]
    v_pk_add_f32 v[46:47], v[46:47], v[66:67]
    v_pk_add_f32 v[86:87], v[86:87], v[106:107]
    v_pk_add_f32 v[44:45], v[44:45], v[84:85]
    v_pk_add_f32 v[46:47], v[46:47], v[86:87]
    v_pk_fma_f32 v[140:141], v[44:45], v[164:165], v[140:141]
    v_pk_fma_f32 v[142:143], v[46:47], v[166:167], v[142:143]
    v_cvt_pk_bf16_f32 v22, v140, v141
    v_cvt_pk_bf16_f32 v23, v142, v143
    s_waitcnt lgkmcnt(0)
    v_pk_add_f32 v[48:49], v[48:49], v[68:69]
    v_pk_add_f32 v[88:89], v[88:89], v[108:109]
    v_pk_add_f32 v[50:51], v[50:51], v[70:71]
    v_pk_add_f32 v[90:91], v[90:91], v[110:111]
    v_pk_add_f32 v[48:49], v[48:49], v[88:89]
    v_pk_add_f32 v[50:51], v[50:51], v[90:91]
    v_pk_fma_f32 v[144:145], v[48:49], v[168:169], v[144:145]
    v_pk_fma_f32 v[146:147], v[50:51], v[170:171], v[146:147]
    v_cvt_pk_bf16_f32 v24, v144, v145
    v_cvt_pk_bf16_f32 v25, v146, v147
    v_lshlrev_b32 v128, 16, v16
    v_and_b32 v129, 0xffff0000, v16
    v_lshlrev_b32 v130, 16, v17
    v_and_b32 v131, 0xffff0000, v17
    v_lshlrev_b32 v132, 16, v18
    v_and_b32 v133, 0xffff0000, v18
    v_lshlrev_b32 v134, 16, v19
    v_and_b32 v135, 0xffff0000, v19
    v_lshlrev_b32 v136, 16, v20
    v_and_b32 v137, 0xffff0000, v20
    v_lshlrev_b32 v138, 16, v21
    v_and_b32 v139, 0xffff0000, v21
    v_lshlrev_b32 v140, 16, v22
    v_and_b32 v141, 0xffff0000, v22
    v_lshlrev_b32 v142, 16, v23
    v_and_b32 v143, 0xffff0000, v23
    v_lshlrev_b32 v144, 16, v24
    v_and_b32 v145, 0xffff0000, v24
    v_lshlrev_b32 v146, 16, v25
    v_and_b32 v147, 0xffff0000, v25
    v_pk_mul_f32 v[32:33], v[128:129], v[172:173]
    v_pk_mul_f32 v[34:35], v[130:131], v[174:175]
    v_pk_mul_f32 v[36:37], v[132:133], v[176:177]
    v_pk_mul_f32 v[38:39], v[134:135], v[178:179]
    v_pk_mul_f32 v[40:41], v[136:137], v[180:181]
    v_pk_mul_f32 v[42:43], v[138:139], v[182:183]
    v_pk_mul_f32 v[44:45], v[140:141], v[184:185]
    v_pk_mul_f32 v[46:47], v[142:143], v[186:187]
    v_pk_mul_f32 v[48:49], v[144:145], v[188:189]
    v_pk_mul_f32 v[50:51], v[146:147], v[190:191]
    v_cvt_pk_bf16_f32 v56, v32, v33
    v_cvt_pk_bf16_f32 v57, v34, v35
    v_cvt_pk_bf16_f32 v58, v36, v37
    v_cvt_pk_bf16_f32 v59, v38, v39
    v_cvt_pk_bf16_f32 v60, v40, v41
    v_cvt_pk_bf16_f32 v61, v42, v43
    v_cvt_pk_bf16_f32 v62, v44, v45
    v_cvt_pk_bf16_f32 v63, v46, v47
    v_cvt_pk_bf16_f32 v64, v48, v49
    v_cvt_pk_bf16_f32 v65, v50, v51
    v_permlane16_swap_b32 v56, v58
    v_permlane16_swap_b32 v57, v59
    v_permlane16_swap_b32 v60, v62
    v_permlane16_swap_b32 v61, v63
    buffer_store_dwordx2 v[64:65], v10, s[32:35], s80 offen sc1
    buffer_store_dwordx4 v[56:59], v9, s[32:35], s80 offen sc1
    buffer_store_dwordx4 v[60:63], v9, s[32:35], s80 offen offset:2048 sc1
    v_pk_add_f32 v[72:73], v[128:129], v[132:133]
    v_pk_add_f32 v[74:75], v[130:131], v[134:135]
    v_pk_add_f32 v[72:73], v[72:73], v[136:137]
    v_pk_add_f32 v[74:75], v[74:75], v[138:139]
    v_pk_add_f32 v[72:73], v[72:73], v[140:141]
    v_pk_add_f32 v[74:75], v[74:75], v[142:143]
    v_pk_add_f32 v[72:73], v[72:73], v[144:145]
    v_pk_add_f32 v[74:75], v[74:75], v[146:147]
    v_add_f32 v72, v72, v73
    v_add_f32 v74, v74, v75
    v_add_f32 v72, v72, v74
    v_mov_b32 v73, v72
    s_nop 1
    v_permlane16_swap_b32 v72, v73
    v_add_f32 v72, v72, v73
    v_mov_b32 v73, v72
    s_nop 1
    v_permlane32_swap_b32 v72, v73
    v_add_f32 v72, v72, v73
    v_mul_f32 v76, 0x3c4ccccd, v72
    v_pk_add_f32 v[128:129], v[128:129], v[76:77] op_sel:[0,0] op_sel_hi:[1,0] neg_lo:[0,1] neg_hi:[0,1]
    v_pk_add_f32 v[130:131], v[130:131], v[76:77] op_sel:[0,0] op_sel_hi:[1,0] neg_lo:[0,1] neg_hi:[0,1]
    v_pk_add_f32 v[132:133], v[132:133], v[76:77] op_sel:[0,0] op_sel_hi:[1,0] neg_lo:[0,1] neg_hi:[0,1]
    v_pk_add_f32 v[134:135], v[134:135], v[76:77] op_sel:[0,0] op_sel_hi:[1,0] neg_lo:[0,1] neg_hi:[0,1]
    v_pk_add_f32 v[136:137], v[136:137], v[76:77] op_sel:[0,0] op_sel_hi:[1,0] neg_lo:[0,1] neg_hi:[0,1]
    v_pk_add_f32 v[138:139], v[138:139], v[76:77] op_sel:[0,0] op_sel_hi:[1,0] neg_lo:[0,1] neg_hi:[0,1]
    v_pk_add_f32 v[140:141], v[140:141], v[76:77] op_sel:[0,0] op_sel_hi:[1,0] neg_lo:[0,1] neg_hi:[0,1]
    v_pk_add_f32 v[142:143], v[142:143], v[76:77] op_sel:[0,0] op_sel_hi:[1,0] neg_lo:[0,1] neg_hi:[0,1]
    v_pk_add_f32 v[144:145], v[144:145], v[76:77] op_sel:[0,0] op_sel_hi:[1,0] neg_lo:[0,1] neg_hi:[0,1]
    v_pk_add_f32 v[146:147], v[146:147], v[76:77] op_sel:[0,0] op_sel_hi:[1,0] neg_lo:[0,1] neg_hi:[0,1]
    v_pk_mul_f32 v[72:73], v[128:129], v[128:129]
    v_pk_mul_f32 v[74:75], v[130:131], v[130:131]
    v_pk_fma_f32 v[72:73], v[132:133], v[132:133], v[72:73]
    v_pk_fma_f32 v[74:75], v[134:135], v[134:135], v[74:75]
    v_pk_fma_f32 v[72:73], v[136:137], v[136:137], v[72:73]
    v_pk_fma_f32 v[74:75], v[138:139], v[138:139], v[74:75]
    v_pk_fma_f32 v[72:73], v[140:141], v[140:141], v[72:73]
    v_pk_fma_f32 v[74:75], v[142:143], v[142:143], v[74:75]
    v_pk_fma_f32 v[72:73], v[144:145], v[144:145], v[72:73]
    v_pk_fma_f32 v[74:75], v[146:147], v[146:147], v[74:75]
    v_add_f32 v72, v72, v73
    v_add_f32 v74, v74, v75
    v_add_f32 v72, v72, v74
    v_mov_b32 v73, v72
    s_nop 1
    v_permlane16_swap_b32 v72, v73
    v_add_f32 v72, v72, v73
    v_mov_b32 v73, v72
    s_nop 1
    v_permlane32_swap_b32 v72, v73
    v_add_f32 v72, v72, v73
    v_mov_b32 v77, v72
    buffer_store_dwordx2 v[76:77], v11, s[32:35], s82 offen sc1
    v_accvgpr_write_b32 a240, v16
    v_accvgpr_write_b32 a241, v17
    v_accvgpr_write_b32 a242, v18
    v_accvgpr_write_b32 a243, v19
    v_accvgpr_write_b32 a244, v20
    v_accvgpr_write_b32 a245, v21
    v_accvgpr_write_b32 a246, v22
    v_accvgpr_write_b32 a247, v23
    v_accvgpr_write_b32 a248, v24
    v_accvgpr_write_b32 a249, v25
    s_lshl_b32 s84, s23, 3
    s_add_u32 s84, s84, s22
    s_waitcnt vmcnt(0)
    s_barrier
    s_cmp_lg_u32 s64, 0
    s_cbranch_scc1 SIG_13
    s_mov_b64 exec, 1
    v_mov_b32 v254, s65
    v_mov_b32 v255, 0
    s_lshl_b32 s100, s84, 7
    s_add_u32 s100, s100, 720896
    buffer_store_dword v254, v255, s[32:35], s100 offen sc1
    s_mov_b64 exec, -1
SIG_13:
    v_and_b32 v36, 127, v6
    v_lshlrev_b32 v36, 2, v36
    v_add_u32 v36, 131072, v36
    ds_read_b32 v32, v36 offset:0
    ds_read_b32 v33, v36 offset:512
    ds_read_b32 v34, v36 offset:1024
    ds_read_b32 v35, v36 offset:1536
    v_bfe_u32 v37, v6, 6, 1
    v_mul_u32_u24 v37, 13824, v37
    v_lshrrev_b32 v36, 2, v0
    v_add_u32 v37, v37, v36
    s_waitcnt lgkmcnt(0)
    v_add_f32 v32, v32, v33
    v_add_f32 v34, v34, v35
    v_add_f32 v32, v32, v34
    buffer_store_dword v32, v37, s[32:35], s24 offen sc1
    s_cmp_lg_u32 s77, 0
    s_cbranch_scc1 P3_IDLE
    s_mov_b32 s52, 8192
    s_mov_b32 s53, 12288
    s_mov_b32 s54, 16384
    s_mov_b32 s55, 20480
    s_mov_b32 s56, 24576
    s_mov_b32 s57, 28672
    s_mov_b32 s58, 32768
    s_mov_b32 s59, 36864
    s_lshl_b32 s80, s69, 3
    s_lshl_b32 s81, s64, 1
    s_add_u32 s76, s80, s81
    s_mul_i32 s80, s76, 40960
    s_add_u32 s80, s80, 4194304
    s_add_u32 s44, s30, s80
    s_addc_u32 s45, s31, 0
    s_mov_b32 s46, 0xa000
    s_mov_b32 s47, 0x20000
    s_add_u32 s80, s80, 40960
    s_add_u32 s48, s30, s80
    s_addc_u32 s49, s31, 0
    s_mov_b32 s50, 0xa000
    s_mov_b32 s51, 0x20000
    v_lshrrev_b32 v2, 4, v194
    s_add_u32 m0, s72, 0
    s_mul_i32 s70, s52, 54
    buffer_load_dwordx4 v195, s[36:39], s70 offen lds
    buffer_load_dwordx4 v196, s[36:39], s70 offen offset:1024 lds
    buffer_load_dwordx4 v195, s[40:43], s70 offen offset:2048 lds
    buffer_load_dwordx4 v196, s[40:43], s70 offen offset:3072 lds
    v_lshrrev_b32 v50, 5, v2
    v_bfe_u32 v51, v2, 2, 2
    v_and_b32 v52, 3, v2
    s_add_u32 m0, s72, 16384
    v_and_b32 v53, 1, v52
    v_lshrrev_b32 v54, 1, v52
    v_lshl_or_b32 v53, v53, 1, v54
    s_mul_i32 s70, s53, 54
    v_lshlrev_b32 v53, 3, v53
    v_bfe_u32 v54, v2, 4, 1
    buffer_load_dwordx4 v195, s[36:39], s70 offen lds
    v_lshl_add_u32 v53, v54, 5, v53
    v_lshl_add_u32 v55, v50, 3, v51
    v_lshl_add_u32 v53, v55, 7, v53
    buffer_load_dwordx4 v196, s[36:39], s70 offen offset:1024 lds
    v_add_u32 v53, 0x10000, v53
    v_lshrrev_b32 v55, 1, v51
    v_lshl_add_u32 v192, v55, 6, v53
    buffer_load_dwordx4 v195, s[40:43], s70 offen offset:2048 lds
    v_xor_b32 v55, 1, v55
    v_lshl_add_u32 v193, v55, 6, v53
    v_mul_u32_u24 v202, 55296, v54
    buffer_load_dwordx4 v196, s[40:43], s70 offen offset:3072 lds
    v_lshl_add_u32 v202, v50, 8, v202
    v_and_b32 v55, 15, v2
    v_lshl_add_u32 v202, v55, 4, v202
    v_lshlrev_b32 v203, 5, v50
    v_add_u32 v203, 139520, v203
    v_lshlrev_b32 v204, 2, v2
    v_and_b32 v205, 31, v2
    v_lshlrev_b32 v206, 7, v205
    v_lshlrev_b32 v205, 6, v205
    v_lshlrev_b32 v207, 2, v6
    v_add_u32 v207, 139520, v207
    ds_read_b64_tr_b16 a[0:1], v192 offset:32768
    ds_read_b64_tr_b16 a[2:3], v192 offset:33280
    ds_read_b64_tr_b16 a[4:5], v193 offset:32768
    ds_read_b64_tr_b16 a[6:7], v193 offset:33280
    ds_read_b64_tr_b16 a[8:9], v192 offset:34816
    ds_read_b64_tr_b16 a[10:11], v192 offset:35328
    ds_read_b64_tr_b16 a[12:13], v193 offset:34816
    ds_read_b64_tr_b16 a[14:15], v193 offset:35328
    ds_read_b64_tr_b16 a[16:17], v192 offset:36864
    ds_read_b64_tr_b16 a[18:19], v192 offset:37376
    ds_read_b64_tr_b16 a[20:21], v193 offset:36864
    ds_read_b64_tr_b16 a[22:23], v193 offset:37376
    ds_read_b64_tr_b16 a[24:25], v192 offset:38912
    ds_read_b64_tr_b16 a[26:27], v192 offset:39424
    ds_read_b64_tr_b16 a[28:29], v193 offset:38912
    ds_read_b64_tr_b16 a[30:31], v193 offset:39424
    s_lshl_b32 s80, s69, 12
    s_add_u32 s80, s80, 720896
    s_mov_b32 s82, 395264
    s_cmp_lg_u32 s64, 1
    s_cbranch_scc1 POLLD_15
    s_mov_b32 s85, 100000
POLL_14:
    buffer_load_dwordx4 v[208:211], v194, s[32:35], s82 offen sc1
    buffer_load_dword v212, v206, s[32:35], s80 offen sc1
    s_waitcnt vmcnt(0)
    v_xor_b32 v208, s65, v208
    v_xor_b32 v209, s65, v209
    v_xor_b32 v210, s65, v210
    v_xor_b32 v211, s65, v211
    v_xor_b32 v212, s65, v212
    v_or_b32 v208, v208, v209
    v_or_b32 v208, v208, v210
    v_or_b32 v208, v208, v211
    v_or_b32 v208, v208, v212
    v_cmp_ne_u32 vcc, 0, v208
    s_nop 1
    s_cbranch_vccz POLLD_15
    s_sub_u32 s85, s85, 1
    s_cbranch_scc1 F_END
    s_sleep 1
    s_branch POLL_14
POLLD_15:
    s_barrier
    buffer_load_dwordx4 v[128:131], v194, s[44:47], s62 offen sc1
    buffer_load_dwordx4 v[132:135], v194, s[48:51], s62 offen sc1
    buffer_load_dwordx4 v[136:139], v194, s[44:47], s62 offen offset:1024 sc1
    buffer_load_dwordx4 v[140:143], v194, s[48:51], s62 offen offset:1024 sc1
    buffer_load_dwordx4 v[144:147], v194, s[44:47], s62 offen offset:2048 sc1
    buffer_load_dwordx4 v[148:151], v194, s[48:51], s62 offen offset:2048 sc1
    buffer_load_dwordx4 v[152:155], v194, s[44:47], s62 offen offset:3072 sc1
    buffer_load_dwordx4 v[156:159], v194, s[48:51], s62 offen offset:3072 sc1
    s_waitcnt vmcnt(6) lgkmcnt(8)
    v_mfma_f32_32x32x16_bf16 v[0:15], a[0:3], v[128:131], 0
    s_barrier
    s_add_u32 m0, s72, 32768
    s_mul_i32 s70, s54, 54
    buffer_load_dwordx4 v[160:163], v194, s[44:47], s63 offen sc1
    v_mfma_f32_32x32x16_bf16 v[16:31], a[0:3], v[132:135], 0
    buffer_load_dwordx4 v[164:167], v194, s[48:51], s63 offen sc1
    s_lshl_b32 s80, s76, 11
    s_add_u32 s80, s80, 196608
    v_mfma_f32_32x32x16_bf16 v[32:47], a[4:7], v[128:131], 0
    ds_read_b64_tr_b16 a[32:33], v192 offset:40960
    ds_read_b64_tr_b16 a[34:35], v192 offset:41472
    buffer_load_dwordx4 v[212:215], v205, s[32:35], s80 offen offset:0 sc1
    v_mfma_f32_32x32x16_bf16 v[48:63], a[4:7], v[132:135], 0
    ds_read_b64_tr_b16 a[36:37], v193 offset:40960
    ds_read_b64_tr_b16 a[38:39], v193 offset:41472
    v_mfma_f32_32x32x16_bf16 v[64:79], a[8:11], v[128:131], 0
    ds_read_b64_tr_b16 a[40:41], v192 offset:43008
    ds_read_b64_tr_b16 a[42:43], v192 offset:43520
    v_mfma_f32_32x32x16_bf16 v[80:95], a[8:11], v[132:135], 0
    ds_read_b64_tr_b16 a[44:45], v193 offset:43008
    ds_read_b64_tr_b16 a[46:47], v193 offset:43520
    v_mfma_f32_32x32x16_bf16 v[96:111], a[12:15], v[128:131], 0
    buffer_load_dwordx4 v[168:171], v194, s[44:47], s63 offen offset:1024 sc1
    buffer_load_dwordx4 v195, s[36:39], s70 offen lds
    v_mfma_f32_32x32x16_bf16 v[112:127], a[12:15], v[132:135], 0
    buffer_load_dwordx4 v[172:175], v194, s[48:51], s63 offen offset:1024 sc1
    s_waitcnt vmcnt(10) lgkmcnt(8)
    v_mfma_f32_32x32x16_bf16 v[0:15], a[16:19], v[136:139], v[0:15]
    buffer_load_dwordx4 v[176:179], v194, s[44:47], s63 offen offset:2048 sc1
    v_mfma_f32_32x32x16_bf16 v[16:31], a[16:19], v[140:143], v[16:31]
    buffer_load_dwordx4 v[180:183], v194, s[48:51], s63 offen offset:2048 sc1
    v_mfma_f32_32x32x16_bf16 v[32:47], a[20:23], v[136:139], v[32:47]
    ds_read_b64_tr_b16 a[48:49], v192 offset:45056
    ds_read_b64_tr_b16 a[50:51], v192 offset:45568
    v_mfma_f32_32x32x16_bf16 v[48:63], a[20:23], v[140:143], v[48:63]
    ds_read_b64_tr_b16 a[52:53], v193 offset:45056
    ds_read_b64_tr_b16 a[54:55], v193 offset:45568
    v_mfma_f32_32x32x16_bf16 v[64:79], a[24:27], v[136:139], v[64:79]
    ds_read_b64_tr_b16 a[56:57], v192 offset:47104
    ds_read_b64_tr_b16 a[58:59], v192 offset:47616
    v_mfma_f32_32x32x16_bf16 v[80:95], a[24:27], v[140:143], v[80:95]
    ds_read_b64_tr_b16 a[60:61], v193 offset:47104
    ds_read_b64_tr_b16 a[62:63], v193 offset:47616
    v_mfma_f32_32x32x16_bf16 v[96:111], a[28:31], v[136:139], v[96:111]
    buffer_load_dwordx4 v[184:187], v194, s[44:47], s63 offen offset:3072 sc1
    buffer_load_dwordx4 v196, s[36:39], s70 offen offset:1024 lds
    v_mfma_f32_32x32x16_bf16 v[112:127], a[28:31], v[140:143], v[112:127]
    buffer_load_dwordx4 v[188:191], v194, s[48:51], s63 offen offset:3072 sc1
    s_waitcnt vmcnt(13) lgkmcnt(8)
    v_mfma_f32_32x32x16_bf16 v[0:15], a[32:35], v[144:147], v[0:15]
    buffer_load_dwordx4 v[128:131], v194, s[44:47], s52 offen sc1
    buffer_load_dwordx4 v[216:219], v205, s[32:35], s80 offen offset:16 sc1
    v_mfma_f32_32x32x16_bf16 v[16:31], a[32:35], v[148:151], v[16:31]
    buffer_load_dwordx4 v[132:135], v194, s[48:51], s52 offen sc1
    v_mfma_f32_32x32x16_bf16 v[32:47], a[36:39], v[144:147], v[32:47]
    ds_read_b64_tr_b16 a[0:1], v192 offset:49152
    ds_read_b64_tr_b16 a[2:3], v192 offset:49664
    v_mfma_f32_32x32x16_bf16 v[48:63], a[36:39], v[148:151], v[48:63]
    ds_read_b64_tr_b16 a[4:5], v193 offset:49152
    ds_read_b64_tr_b16 a[6:7], v193 offset:49664
    v_mfma_f32_32x32x16_bf16 v[64:79], a[40:43], v[144:147], v[64:79]
    ds_read_b64_tr_b16 a[8:9], v192 offset:51200
    ds_read_b64_tr_b16 a[10:11], v192 offset:51712
    v_mfma_f32_32x32x16_bf16 v[80:95], a[40:43], v[148:151], v[80:95]
    ds_read_b64_tr_b16 a[12:13], v193 offset:51200
    ds_read_b64_tr_b16 a[14:15], v193 offset:51712
    v_mfma_f32_32x32x16_bf16 v[96:111], a[44:47], v[144:147], v[96:111]
    buffer_load_dwordx4 v[136:139], v194, s[44:47], s52 offen offset:1024 sc1
    buffer_load_dwordx4 v195, s[40:43], s70 offen offset:2048 lds
    v_mfma_f32_32x32x16_bf16 v[112:127], a[44:47], v[148:151], v[112:127]
    buffer_load_dwordx4 v[140:143], v194, s[48:51], s52 offen offset:1024 sc1
    s_waitcnt vmcnt(17) lgkmcnt(8)
    v_mfma_f32_32x32x16_bf16 v[0:15], a[48:51], v[152:155], v[0:15]
    buffer_load_dwordx4 v[144:147], v194, s[44:47], s52 offen offset:2048 sc1
    v_mfma_f32_32x32x16_bf16 v[16:31], a[48:51], v[156:159], v[16:31]
    buffer_load_dwordx4 v[148:151], v194, s[48:51], s52 offen offset:2048 sc1
    v_mfma_f32_32x32x16_bf16 v[32:47], a[52:55], v[152:155], v[32:47]
    ds_read_b64_tr_b16 a[16:17], v192 offset:53248
    ds_read_b64_tr_b16 a[18:19], v192 offset:53760
    v_mfma_f32_32x32x16_bf16 v[48:63], a[52:55], v[156:159], v[48:63]
    ds_read_b64_tr_b16 a[20:21], v193 offset:53248
    ds_read_b64_tr_b16 a[22:23], v193 offset:53760
    v_mfma_f32_32x32x16_bf16 v[64:79], a[56:59], v[152:155], v[64:79]
    ds_read_b64_tr_b16 a[24:25], v192 offset:55296
    ds_read_b64_tr_b16 a[26:27], v192 offset:55808
    v_mfma_f32_32x32x16_bf16 v[80:95], a[56:59], v[156:159], v[80:95]
    ds_read_b64_tr_b16 a[28:29], v193 offset:55296
    ds_read_b64_tr_b16 a[30:31], v193 offset:55808
    v_mfma_f32_32x32x16_bf16 v[96:111], a[60:63], v[152:155], v[96:111]
    buffer_load_dwordx4 v196, s[40:43], s70 offen offset:3072 lds
    v_mfma_f32_32x32x16_bf16 v[112:127], a[60:63], v[156:159], v[112:127]
    s_waitcnt vmcnt(18) lgkmcnt(8)
    v_mfma_f32_32x32x16_bf16 v[0:15], a[0:3], v[160:163], v[0:15]
    s_barrier
    s_add_u32 m0, s72, 49152
    s_mul_i32 s70, s55, 54
    buffer_load_dwordx4 v[152:155], v194, s[44:47], s52 offen offset:3072 sc1
    v_mfma_f32_32x32x16_bf16 v[16:31], a[0:3], v[164:167], v[16:31]
    buffer_load_dwordx4 v[156:159], v194, s[48:51], s52 offen offset:3072 sc1
    s_cmp_lg_u32 s64, 0
    s_cbranch_scc1 SIG_16
    s_mov_b64 exec, 1
    v_mov_b32 v250, s65
    v_mov_b32 v251, 0
    s_lshl_b32 s100, s2, 2
    s_add_u32 s100, s100, 396288
    buffer_store_dword v250, v251, s[32:35], s100 offen sc1
    s_mov_b64 exec, -1
SIG_16:
    v_mfma_f32_32x32x16_bf16 v[32:47], a[4:7], v[160:163], v[32:47]
    ds_read_b64_tr_b16 a[32:33], v192 offset:57344
    ds_read_b64_tr_b16 a[34:35], v192 offset:57856
    buffer_load_dwordx4 v[220:223], v205, s[32:35], s80 offen offset:32 sc1
    v_mfma_f32_32x32x16_bf16 v[48:63], a[4:7], v[164:167], v[48:63]
    ds_read_b64_tr_b16 a[36:37], v193 offset:57344
    ds_read_b64_tr_b16 a[38:39], v193 offset:57856
    v_mfma_f32_32x32x16_bf16 v[64:79], a[8:11], v[160:163], v[64:79]
    ds_read_b64_tr_b16 a[40:41], v192 offset:59392
    ds_read_b64_tr_b16 a[42:43], v192 offset:59904
    v_mfma_f32_32x32x16_bf16 v[80:95], a[8:11], v[164:167], v[80:95]
    ds_read_b64_tr_b16 a[44:45], v193 offset:59392
    ds_read_b64_tr_b16 a[46:47], v193 offset:59904
    v_mfma_f32_32x32x16_bf16 v[96:111], a[12:15], v[160:163], v[96:111]
    buffer_load_dwordx4 v195, s[36:39], s70 offen lds
    v_mfma_f32_32x32x16_bf16 v[112:127], a[12:15], v[164:167], v[112:127]
    s_waitcnt vmcnt(18) lgkmcnt(8)
    v_mfma_f32_32x32x16_bf16 v[0:15], a[16:19], v[168:171], v[0:15]
    buffer_load_dwordx4 v[160:163], v194, s[44:47], s53 offen sc1
    v_mfma_f32_32x32x16_bf16 v[16:31], a[16:19], v[172:175], v[16:31]
    buffer_load_dwordx4 v[164:167], v194, s[48:51], s53 offen sc1
    v_mfma_f32_32x32x16_bf16 v[32:47], a[20:23], v[168:171], v[32:47]
    ds_read_b64_tr_b16 a[48:49], v192 offset:61440
    ds_read_b64_tr_b16 a[50:51], v192 offset:61952
    v_mfma_f32_32x32x16_bf16 v[48:63], a[20:23], v[172:175], v[48:63]
    ds_read_b64_tr_b16 a[52:53], v193 offset:61440
    ds_read_b64_tr_b16 a[54:55], v193 offset:61952
    v_mfma_f32_32x32x16_bf16 v[64:79], a[24:27], v[168:171], v[64:79]
    ds_read_b64_tr_b16 a[56:57], v192 offset:63488
    ds_read_b64_tr_b16 a[58:59], v192 offset:64000
    v_mfma_f32_32x32x16_bf16 v[80:95], a[24:27], v[172:175], v[80:95]
    ds_read_b64_tr_b16 a[60:61], v193 offset:63488
    ds_read_b64_tr_b16 a[62:63], v193 offset:64000
    v_mfma_f32_32x32x16_bf16 v[96:111], a[28:31], v[168:171], v[96:111]
    buffer_load_dwordx4 v196, s[36:39], s70 offen offset:1024 lds
    v_mfma_f32_32x32x16_bf16 v[112:127], a[28:31], v[172:175], v[112:127]
    v_subrev_u32 v192, 0x10000, v192
    v_subrev_u32 v193, 0x10000, v193
    s_waitcnt vmcnt(19) lgkmcnt(8)
    v_mfma_f32_32x32x16_bf16 v[0:15], a[32:35], v[176:179], v[0:15]
    buffer_load_dwordx4 v[168:171], v194, s[44:47], s53 offen offset:1024 sc1
    buffer_load_dwordx4 v[224:227], v205, s[32:35], s80 offen offset:48 sc1
    v_mfma_f32_32x32x16_bf16 v[16:31], a[32:35], v[180:183], v[16:31]
    buffer_load_dwordx4 v[172:175], v194, s[48:51], s53 offen offset:1024 sc1
    v_mfma_f32_32x32x16_bf16 v[32:47], a[36:39], v[176:179], v[32:47]
    ds_read_b64_tr_b16 a[0:1], v192 offset:0
    ds_read_b64_tr_b16 a[2:3], v192 offset:512
    v_mfma_f32_32x32x16_bf16 v[48:63], a[36:39], v[180:183], v[48:63]
    ds_read_b64_tr_b16 a[4:5], v193 offset:0
    ds_read_b64_tr_b16 a[6:7], v193 offset:512
    v_mfma_f32_32x32x16_bf16 v[64:79], a[40:43], v[176:179], v[64:79]
    ds_read_b64_tr_b16 a[8:9], v192 offset:2048
    ds_read_b64_tr_b16 a[10:11], v192 offset:2560
    v_mfma_f32_32x32x16_bf16 v[80:95], a[40:43], v[180:183], v[80:95]
    ds_read_b64_tr_b16 a[12:13], v193 offset:2048
    ds_read_b64_tr_b16 a[14:15], v193 offset:2560
    v_mfma_f32_32x32x16_bf16 v[96:111], a[44:47], v[176:179], v[96:111]
    buffer_load_dwordx4 v195, s[40:43], s70 offen offset:2048 lds
    v_mfma_f32_32x32x16_bf16 v[112:127], a[44:47], v[180:183], v[112:127]
    s_waitcnt vmcnt(20) lgkmcnt(8)
    v_mfma_f32_32x32x16_bf16 v[0:15], a[48:51], v[184:187], v[0:15]
    buffer_load_dwordx4 v[176:179], v194, s[44:47], s53 offen offset:2048 sc1
    v_mfma_f32_32x32x16_bf16 v[16:31], a[48:51], v[188:191], v[16:31]
    buffer_load_dwordx4 v[180:183], v194, s[48:51], s53 offen offset:2048 sc1
    v_mfma_f32_32x32x16_bf16 v[32:47], a[52:55], v[184:187], v[32:47]
    ds_read_b64_tr_b16 a[16:17], v192 offset:4096
    ds_read_b64_tr_b16 a[18:19], v192 offset:4608
    v_mfma_f32_32x32x16_bf16 v[48:63], a[52:55], v[188:191], v[48:63]
    ds_read_b64_tr_b16 a[20:21], v193 offset:4096
    ds_read_b64_tr_b16 a[22:23], v193 offset:4608
    v_mfma_f32_32x32x16_bf16 v[64:79], a[56:59], v[184:187], v[64:79]
    ds_read_b64_tr_b16 a[24:25], v192 offset:6144
    ds_read_b64_tr_b16 a[26:27], v192 offset:6656
    v_mfma_f32_32x32x16_bf16 v[80:95], a[56:59], v[188:191], v[80:95]
    ds_read_b64_tr_b16 a[28:29], v193 offset:6144
    ds_read_b64_tr_b16 a[30:31], v193 offset:6656
    v_mfma_f32_32x32x16_bf16 v[96:111], a[60:63], v[184:187], v[96:111]
    buffer_load_dwordx4 v196, s[40:43], s70 offen offset:3072 lds
    v_mfma_f32_32x32x16_bf16 v[112:127], a[60:63], v[188:191], v[112:127]
    s_waitcnt vmcnt(20) lgkmcnt(8)
    v_mfma_f32_32x32x16_bf16 v[0:15], a[0:3], v[128:131], v[0:15]
    s_barrier
    s_add_u32 m0, s72, 65536
    s_mul_i32 s70, s56, 54
    buffer_load_dwordx4 v[184:187], v194, s[44:47], s53 offen offset:3072 sc1
    v_mfma_f32_32x32x16_bf16 v[16:31], a[0:3], v[132:135], v[16:31]
    buffer_load_dwordx4 v[188:191], v194, s[48:51], s53 offen offset:3072 sc1
    buffer_load_dwordx4 v[228:231], v205, s[32:35], s80 offen offset:2048 sc1
    v_mfma_f32_32x32x16_bf16 v[32:47], a[4:7], v[128:131], v[32:47]
    ds_read_b64_tr_b16 a[32:33], v192 offset:8192
    ds_read_b64_tr_b16 a[34:35], v192 offset:8704
    v_mfma_f32_32x32x16_bf16 v[48:63], a[4:7], v[132:135], v[48:63]
    ds_read_b64_tr_b16 a[36:37], v193 offset:8192
    ds_read_b64_tr_b16 a[38:39], v193 offset:8704
    v_mfma_f32_32x32x16_bf16 v[64:79], a[8:11], v[128:131], v[64:79]
    ds_read_b64_tr_b16 a[40:41], v192 offset:10240
    ds_read_b64_tr_b16 a[42:43], v192 offset:10752
    v_mfma_f32_32x32x16_bf16 v[80:95], a[8:11], v[132:135], v[80:95]
    ds_read_b64_tr_b16 a[44:45], v193 offset:10240
    ds_read_b64_tr_b16 a[46:47], v193 offset:10752
    v_mfma_f32_32x32x16_bf16 v[96:111], a[12:15], v[128:131], v[96:111]
    buffer_load_dwordx4 v195, s[36:39], s70 offen lds
    v_mfma_f32_32x32x16_bf16 v[112:127], a[12:15], v[132:135], v[112:127]
    s_waitcnt vmcnt(21) lgkmcnt(8)
    v_mfma_f32_32x32x16_bf16 v[0:15], a[16:19], v[136:139], v[0:15]
    buffer_load_dwordx4 v[128:131], v194, s[44:47], s54 offen sc1
    v_mfma_f32_32x32x16_bf16 v[16:31], a[16:19], v[140:143], v[16:31]
    buffer_load_dwordx4 v[132:135], v194, s[48:51], s54 offen sc1
    v_mfma_f32_32x32x16_bf16 v[32:47], a[20:23], v[136:139], v[32:47]
    ds_read_b64_tr_b16 a[48:49], v192 offset:12288
    ds_read_b64_tr_b16 a[50:51], v192 offset:12800
    v_mfma_f32_32x32x16_bf16 v[48:63], a[20:23], v[140:143], v[48:63]
    ds_read_b64_tr_b16 a[52:53], v193 offset:12288
    ds_read_b64_tr_b16 a[54:55], v193 offset:12800
    v_mfma_f32_32x32x16_bf16 v[64:79], a[24:27], v[136:139], v[64:79]
    ds_read_b64_tr_b16 a[56:57], v192 offset:14336
    ds_read_b64_tr_b16 a[58:59], v192 offset:14848
    v_mfma_f32_32x32x16_bf16 v[80:95], a[24:27], v[140:143], v[80:95]
    ds_read_b64_tr_b16 a[60:61], v193 offset:14336
    ds_read_b64_tr_b16 a[62:63], v193 offset:14848
    v_mfma_f32_32x32x16_bf16 v[96:111], a[28:31], v[136:139], v[96:111]
    buffer_load_dwordx4 v196, s[36:39], s70 offen offset:1024 lds
    v_mfma_f32_32x32x16_bf16 v[112:127], a[28:31], v[140:143], v[112:127]
    s_waitcnt vmcnt(22) lgkmcnt(8)
    v_mfma_f32_32x32x16_bf16 v[0:15], a[32:35], v[144:147], v[0:15]
    buffer_load_dwordx4 v[136:139], v194, s[44:47], s54 offen offset:1024 sc1
    buffer_load_dwordx4 v[232:235], v205, s[32:35], s80 offen offset:2064 sc1
    v_mfma_f32_32x32x16_bf16 v[16:31], a[32:35], v[148:151], v[16:31]
    buffer_load_dwordx4 v[140:143], v194, s[48:51], s54 offen offset:1024 sc1
    v_mfma_f32_32x32x16_bf16 v[32:47], a[36:39], v[144:147], v[32:47]
    ds_read_b64_tr_b16 a[0:1], v192 offset:16384
    ds_read_b64_tr_b16 a[2:3], v192 offset:16896
    v_mfma_f32_32x32x16_bf16 v[48:63], a[36:39], v[148:151], v[48:63]
    ds_read_b64_tr_b16 a[4:5], v193 offset:16384
    ds_read_b64_tr_b16 a[6:7], v193 offset:16896
    v_mfma_f32_32x32x16_bf16 v[64:79], a[40:43], v[144:147], v[64:79]
    ds_read_b64_tr_b16 a[8:9], v192 offset:18432
    ds_read_b64_tr_b16 a[10:11], v192 offset:18944
    v_mfma_f32_32x32x16_bf16 v[80:95], a[40:43], v[148:151], v[80:95]
    ds_read_b64_tr_b16 a[12:13], v193 offset:18432
    ds_read_b64_tr_b16 a[14:15], v193 offset:18944
    v_mfma_f32_32x32x16_bf16 v[96:111], a[44:47], v[144:147], v[96:111]
    buffer_load_dwordx4 v195, s[40:43], s70 offen offset:2048 lds
    v_mfma_f32_32x32x16_bf16 v[112:127], a[44:47], v[148:151], v[112:127]
    s_waitcnt vmcnt(23) lgkmcnt(8)
    v_mfma_f32_32x32x16_bf16 v[0:15], a[48:51], v[152:155], v[0:15]
    buffer_load_dwordx4 v[144:147], v194, s[44:47], s54 offen offset:2048 sc1
    v_mfma_f32_32x32x16_bf16 v[16:31], a[48:51], v[156:159], v[16:31]
    buffer_load_dwordx4 v[148:151], v194, s[48:51], s54 offen offset:2048 sc1
    v_mfma_f32_32x32x16_bf16 v[32:47], a[52:55], v[152:155], v[32:47]
    ds_read_b64_tr_b16 a[16:17], v192 offset:20480
    ds_read_b64_tr_b16 a[18:19], v192 offset:20992
    v_mfma_f32_32x32x16_bf16 v[48:63], a[52:55], v[156:159], v[48:63]
    ds_read_b64_tr_b16 a[20:21], v193 offset:20480
    ds_read_b64_tr_b16 a[22:23], v193 offset:20992
    v_mfma_f32_32x32x16_bf16 v[64:79], a[56:59], v[152:155], v[64:79]
    ds_read_b64_tr_b16 a[24:25], v192 offset:22528
    ds_read_b64_tr_b16 a[26:27], v192 offset:23040
    v_mfma_f32_32x32x16_bf16 v[80:95], a[56:59], v[156:159], v[80:95]
    ds_read_b64_tr_b16 a[28:29], v193 offset:22528
    ds_read_b64_tr_b16 a[30:31], v193 offset:23040
    v_mfma_f32_32x32x16_bf16 v[96:111], a[60:63], v[152:155], v[96:111]
    buffer_load_dwordx4 v196, s[40:43], s70 offen offset:3072 lds
    v_mfma_f32_32x32x16_bf16 v[112:127], a[60:63], v[156:159], v[112:127]
    s_waitcnt vmcnt(22) lgkmcnt(8)
    v_mfma_f32_32x32x16_bf16 v[0:15], a[0:3], v[160:163], v[0:15]
    s_barrier
    s_add_u32 m0, s72, 81920
    s_mul_i32 s70, s57, 54
    buffer_load_dwordx4 v[152:155], v194, s[44:47], s54 offen offset:3072 sc1
    v_mfma_f32_32x32x16_bf16 v[16:31], a[0:3], v[164:167], v[16:31]
    buffer_load_dwordx4 v[156:159], v194, s[48:51], s54 offen offset:3072 sc1
    buffer_load_dwordx4 v[236:239], v205, s[32:35], s80 offen offset:2080 sc1
    v_mfma_f32_32x32x16_bf16 v[32:47], a[4:7], v[160:163], v[32:47]
    ds_read_b64_tr_b16 a[32:33], v192 offset:24576
    ds_read_b64_tr_b16 a[34:35], v192 offset:25088
    v_mfma_f32_32x32x16_bf16 v[48:63], a[4:7], v[164:167], v[48:63]
    ds_read_b64_tr_b16 a[36:37], v193 offset:24576
    ds_read_b64_tr_b16 a[38:39], v193 offset:25088
    v_mfma_f32_32x32x16_bf16 v[64:79], a[8:11], v[160:163], v[64:79]
    ds_read_b64_tr_b16 a[40:41], v192 offset:26624
    ds_read_b64_tr_b16 a[42:43], v192 offset:27136
    v_mfma_f32_32x32x16_bf16 v[80:95], a[8:11], v[164:167], v[80:95]
    ds_read_b64_tr_b16 a[44:45], v193 offset:26624
    ds_read_b64_tr_b16 a[46:47], v193 offset:27136
    v_mfma_f32_32x32x16_bf16 v[96:111], a[12:15], v[160:163], v[96:111]
    buffer_load_dwordx4 v195, s[36:39], s70 offen lds
    v_mfma_f32_32x32x16_bf16 v[112:127], a[12:15], v[164:167], v[112:127]
    s_waitcnt vmcnt(22) lgkmcnt(8)
    v_mfma_f32_32x32x16_bf16 v[0:15], a[16:19], v[168:171], v[0:15]
    buffer_load_dwordx4 v[160:163], v194, s[44:47], s55 offen sc1
    v_mfma_f32_32x32x16_bf16 v[16:31], a[16:19], v[172:175], v[16:31]
    buffer_load_dwordx4 v[164:167], v194, s[48:51], s55 offen sc1
    v_mfma_f32_32x32x16_bf16 v[32:47], a[20:23], v[168:171], v[32:47]
    ds_read_b64_tr_b16 a[48:49], v192 offset:28672
    ds_read_b64_tr_b16 a[50:51], v192 offset:29184
    v_mfma_f32_32x32x16_bf16 v[48:63], a[20:23], v[172:175], v[48:63]
    ds_read_b64_tr_b16 a[52:53], v193 offset:28672
    ds_read_b64_tr_b16 a[54:55], v193 offset:29184
    v_mfma_f32_32x32x16_bf16 v[64:79], a[24:27], v[168:171], v[64:79]
    ds_read_b64_tr_b16 a[56:57], v192 offset:30720
    ds_read_b64_tr_b16 a[58:59], v192 offset:31232
    v_mfma_f32_32x32x16_bf16 v[80:95], a[24:27], v[172:175], v[80:95]
    ds_read_b64_tr_b16 a[60:61], v193 offset:30720
    ds_read_b64_tr_b16 a[62:63], v193 offset:31232
    v_mfma_f32_32x32x16_bf16 v[96:111], a[28:31], v[168:171], v[96:111]
    buffer_load_dwordx4 v196, s[36:39], s70 offen offset:1024 lds
    v_mfma_f32_32x32x16_bf16 v[112:127], a[28:31], v[172:175], v[112:127]
    s_waitcnt vmcnt(22) lgkmcnt(8)
    v_mfma_f32_32x32x16_bf16 v[0:15], a[32:35], v[176:179], v[0:15]
    buffer_load_dwordx4 v[168:171], v194, s[44:47], s55 offen offset:1024 sc1
    buffer_load_dwordx4 v[240:243], v205, s[32:35], s80 offen offset:2096 sc1
    s_mul_i32 s74, s64, 14
    v_mfma_f32_32x32x16_bf16 v[16:31], a[32:35], v[180:183], v[16:31]
    buffer_load_dwordx4 v[172:175], v194, s[48:51], s55 offen offset:1024 sc1
    s_mul_i32 s78, s22, 54
    s_add_u32 s78, s78, s74
    s_mul_i32 s78, s78, 5120
    v_mfma_f32_32x32x16_bf16 v[32:47], a[36:39], v[176:179], v[32:47]
    ds_read_b64_tr_b16 a[0:1], v192 offset:32768
    ds_read_b64_tr_b16 a[2:3], v192 offset:33280
    s_add_u32 s78, s78, 15728640
    v_add_u32 v248, 0x1000, v194
    v_mfma_f32_32x32x16_bf16 v[48:63], a[36:39], v[180:183], v[48:63]
    ds_read_b64_tr_b16 a[4:5], v193 offset:32768
    ds_read_b64_tr_b16 a[6:7], v193 offset:33280
    v_mfma_f32_32x32x16_bf16 v[64:79], a[40:43], v[176:179], v[64:79]
    ds_read_b64_tr_b16 a[8:9], v192 offset:34816
    ds_read_b64_tr_b16 a[10:11], v192 offset:35328
    v_mfma_f32_32x32x16_bf16 v[80:95], a[40:43], v[180:183], v[80:95]
    ds_read_b64_tr_b16 a[12:13], v193 offset:34816
    ds_read_b64_tr_b16 a[14:15], v193 offset:35328
    v_mfma_f32_32x32x16_bf16 v[96:111], a[44:47], v[176:179], v[96:111]
    buffer_load_dwordx4 v195, s[40:43], s70 offen offset:2048 lds
    v_mfma_f32_32x32x16_bf16 v[112:127], a[44:47], v[180:183], v[112:127]
    s_waitcnt vmcnt(23) lgkmcnt(8)
    v_mfma_f32_32x32x16_bf16 v[0:15], a[48:51], v[184:187], v[0:15]
    buffer_load_dwordx4 v[176:179], v194, s[44:47], s55 offen offset:2048 sc1
    v_mfma_f32_32x32x16_bf16 v[16:31], a[48:51], v[188:191], v[16:31]
    buffer_load_dwordx4 v[180:183], v194, s[48:51], s55 offen offset:2048 sc1
    v_mfma_f32_32x32x16_bf16 v[32:47], a[52:55], v[184:187], v[32:47]
    ds_read_b64_tr_b16 a[16:17], v192 offset:36864
    ds_read_b64_tr_b16 a[18:19], v192 offset:37376
    v_mfma_f32_32x32x16_bf16 v[48:63], a[52:55], v[188:191], v[48:63]
    ds_read_b64_tr_b16 a[20:21], v193 offset:36864
    ds_read_b64_tr_b16 a[22:23], v193 offset:37376
    v_mfma_f32_32x32x16_bf16 v[64:79], a[56:59], v[184:187], v[64:79]
    ds_read_b64_tr_b16 a[24:25], v192 offset:38912
    ds_read_b64_tr_b16 a[26:27], v192 offset:39424
    v_mfma_f32_32x32x16_bf16 v[80:95], a[56:59], v[188:191], v[80:95]
    ds_read_b64_tr_b16 a[28:29], v193 offset:38912
    ds_read_b64_tr_b16 a[30:31], v193 offset:39424
    v_mfma_f32_32x32x16_bf16 v[96:111], a[60:63], v[184:187], v[96:111]
    buffer_load_dwordx4 v196, s[40:43], s70 offen offset:3072 lds
    v_mfma_f32_32x32x16_bf16 v[112:127], a[60:63], v[188:191], v[112:127]
    s_waitcnt vmcnt(22) lgkmcnt(8)
    v_mfma_f32_32x32x16_bf16 v[0:15], a[0:3], v[128:131], v[0:15]
    s_barrier
    s_add_u32 m0, s72, 98304
    s_mul_i32 s70, s58, 54
    buffer_load_dwordx4 v[184:187], v194, s[44:47], s55 offen offset:3072 sc1
    v_mfma_f32_32x32x16_bf16 v[16:31], a[0:3], v[132:135], v[16:31]
    buffer_load_dwordx4 v[188:191], v194, s[48:51], s55 offen offset:3072 sc1
    buffer_load_dwordx4 a[80:83], v194, s[32:35], s78 offen sc1
    v_mfma_f32_32x32x16_bf16 v[32:47], a[4:7], v[128:131], v[32:47]
    ds_read_b64_tr_b16 a[32:33], v192 offset:40960
    ds_read_b64_tr_b16 a[34:35], v192 offset:41472
    v_mfma_f32_32x32x16_bf16 v[48:63], a[4:7], v[132:135], v[48:63]
    ds_read_b64_tr_b16 a[36:37], v193 offset:40960
    ds_read_b64_tr_b16 a[38:39], v193 offset:41472
    v_mfma_f32_32x32x16_bf16 v[64:79], a[8:11], v[128:131], v[64:79]
    ds_read_b64_tr_b16 a[40:41], v192 offset:43008
    ds_read_b64_tr_b16 a[42:43], v192 offset:43520
    v_mfma_f32_32x32x16_bf16 v[80:95], a[8:11], v[132:135], v[80:95]
    ds_read_b64_tr_b16 a[44:45], v193 offset:43008
    ds_read_b64_tr_b16 a[46:47], v193 offset:43520
    v_mfma_f32_32x32x16_bf16 v[96:111], a[12:15], v[128:131], v[96:111]
    buffer_load_dwordx4 v195, s[36:39], s70 offen lds
    v_mfma_f32_32x32x16_bf16 v[112:127], a[12:15], v[132:135], v[112:127]
    s_waitcnt vmcnt(22) lgkmcnt(8)
    v_mfma_f32_32x32x16_bf16 v[0:15], a[16:19], v[136:139], v[0:15]
    buffer_load_dwordx4 v[128:131], v194, s[44:47], s56 offen sc1
    v_mfma_f32_32x32x16_bf16 v[16:31], a[16:19], v[140:143], v[16:31]
    buffer_load_dwordx4 v[132:135], v194, s[48:51], s56 offen sc1
    v_mfma_f32_32x32x16_bf16 v[32:47], a[20:23], v[136:139], v[32:47]
    ds_read_b64_tr_b16 a[48:49], v192 offset:45056
    ds_read_b64_tr_b16 a[50:51], v192 offset:45568
    v_mfma_f32_32x32x16_bf16 v[48:63], a[20:23], v[140:143], v[48:63]
    ds_read_b64_tr_b16 a[52:53], v193 offset:45056
    ds_read_b64_tr_b16 a[54:55], v193 offset:45568
    v_mfma_f32_32x32x16_bf16 v[64:79], a[24:27], v[136:139], v[64:79]
    ds_read_b64_tr_b16 a[56:57], v192 offset:47104
    ds_read_b64_tr_b16 a[58:59], v192 offset:47616
    v_mfma_f32_32x32x16_bf16 v[80:95], a[24:27], v[140:143], v[80:95]
    ds_read_b64_tr_b16 a[60:61], v193 offset:47104
    ds_read_b64_tr_b16 a[62:63], v193 offset:47616
    v_mfma_f32_32x32x16_bf16 v[96:111], a[28:31], v[136:139], v[96:111]
    buffer_load_dwordx4 v196, s[36:39], s70 offen offset:1024 lds
    v_mfma_f32_32x32x16_bf16 v[112:127], a[28:31], v[140:143], v[112:127]
    s_waitcnt vmcnt(22) lgkmcnt(8)
    v_mfma_f32_32x32x16_bf16 v[0:15], a[32:35], v[144:147], v[0:15]
    buffer_load_dwordx4 v[136:139], v194, s[44:47], s56 offen offset:1024 sc1
    buffer_load_dwordx4 a[84:87], v194, s[32:35], s78 offen offset:1024 sc1
    v_mfma_f32_32x32x16_bf16 v[16:31], a[32:35], v[148:151], v[16:31]
    buffer_load_dwordx4 v[140:143], v194, s[48:51], s56 offen offset:1024 sc1
    v_mfma_f32_32x32x16_bf16 v[32:47], a[36:39], v[144:147], v[32:47]
    ds_read_b64_tr_b16 a[0:1], v192 offset:49152
    ds_read_b64_tr_b16 a[2:3], v192 offset:49664
    v_mfma_f32_32x32x16_bf16 v[48:63], a[36:39], v[148:151], v[48:63]
    ds_read_b64_tr_b16 a[4:5], v193 offset:49152
    ds_read_b64_tr_b16 a[6:7], v193 offset:49664
    v_mfma_f32_32x32x16_bf16 v[64:79], a[40:43], v[144:147], v[64:79]
    ds_read_b64_tr_b16 a[8:9], v192 offset:51200
    ds_read_b64_tr_b16 a[10:11], v192 offset:51712
    v_mfma_f32_32x32x16_bf16 v[80:95], a[40:43], v[148:151], v[80:95]
    ds_read_b64_tr_b16 a[12:13], v193 offset:51200
    ds_read_b64_tr_b16 a[14:15], v193 offset:51712
    v_mfma_f32_32x32x16_bf16 v[96:111], a[44:47], v[144:147], v[96:111]
    buffer_load_dwordx4 v195, s[40:43], s70 offen offset:2048 lds
    v_mfma_f32_32x32x16_bf16 v[112:127], a[44:47], v[148:151], v[112:127]
    s_waitcnt vmcnt(23) lgkmcnt(8)
    v_mfma_f32_32x32x16_bf16 v[0:15], a[48:51], v[152:155], v[0:15]
    buffer_load_dwordx4 v[144:147], v194, s[44:47], s56 offen offset:2048 sc1
    v_mfma_f32_32x32x16_bf16 v[16:31], a[48:51], v[156:159], v[16:31]
    buffer_load_dwordx4 v[148:151], v194, s[48:51], s56 offen offset:2048 sc1
    v_mfma_f32_32x32x16_bf16 v[32:47], a[52:55], v[152:155], v[32:47]
    ds_read_b64_tr_b16 a[16:17], v192 offset:53248
    ds_read_b64_tr_b16 a[18:19], v192 offset:53760
    v_mfma_f32_32x32x16_bf16 v[48:63], a[52:55], v[156:159], v[48:63]
    ds_read_b64_tr_b16 a[20:21], v193 offset:53248
    ds_read_b64_tr_b16 a[22:23], v193 offset:53760
    v_mfma_f32_32x32x16_bf16 v[64:79], a[56:59], v[152:155], v[64:79]
    ds_read_b64_tr_b16 a[24:25], v192 offset:55296
    ds_read_b64_tr_b16 a[26:27], v192 offset:55808
    v_mfma_f32_32x32x16_bf16 v[80:95], a[56:59], v[156:159], v[80:95]
    ds_read_b64_tr_b16 a[28:29], v193 offset:55296
    ds_read_b64_tr_b16 a[30:31], v193 offset:55808
    v_mfma_f32_32x32x16_bf16 v[96:111], a[60:63], v[152:155], v[96:111]
    buffer_load_dwordx4 v196, s[40:43], s70 offen offset:3072 lds
    v_mfma_f32_32x32x16_bf16 v[112:127], a[60:63], v[156:159], v[112:127]
    s_waitcnt vmcnt(22) lgkmcnt(8)
    v_mfma_f32_32x32x16_bf16 v[0:15], a[0:3], v[160:163], v[0:15]
    s_barrier
    s_add_u32 m0, s72, 114688
    s_mul_i32 s70, s59, 54
    buffer_load_dwordx4 v[152:155], v194, s[44:47], s56 offen offset:3072 sc1
    v_mfma_f32_32x32x16_bf16 v[16:31], a[0:3], v[164:167], v[16:31]
    buffer_load_dwordx4 v[156:159], v194, s[48:51], s56 offen offset:3072 sc1
    buffer_load_dwordx4 a[88:91], v194, s[32:35], s78 offen offset:2048 sc1
    v_mfma_f32_32x32x16_bf16 v[32:47], a[4:7], v[160:163], v[32:47]
    ds_read_b64_tr_b16 a[32:33], v192 offset:57344
    ds_read_b64_tr_b16 a[34:35], v192 offset:57856
    v_mfma_f32_32x32x16_bf16 v[48:63], a[4:7], v[164:167], v[48:63]
    ds_read_b64_tr_b16 a[36:37], v193 offset:57344
    ds_read_b64_tr_b16 a[38:39], v193 offset:57856
    v_mfma_f32_32x32x16_bf16 v[64:79], a[8:11], v[160:163], v[64:79]
    ds_read_b64_tr_b16 a[40:41], v192 offset:59392
    ds_read_b64_tr_b16 a[42:43], v192 offset:59904
    v_mfma_f32_32x32x16_bf16 v[80:95], a[8:11], v[164:167], v[80:95]
    ds_read_b64_tr_b16 a[44:45], v193 offset:59392
    ds_read_b64_tr_b16 a[46:47], v193 offset:59904
    v_mfma_f32_32x32x16_bf16 v[96:111], a[12:15], v[160:163], v[96:111]
    buffer_load_dwordx4 v195, s[36:39], s70 offen lds
    v_mfma_f32_32x32x16_bf16 v[112:127], a[12:15], v[164:167], v[112:127]
    s_waitcnt vmcnt(22) lgkmcnt(8)
    v_mfma_f32_32x32x16_bf16 v[0:15], a[16:19], v[168:171], v[0:15]
    buffer_load_dwordx4 v[160:163], v194, s[44:47], s57 offen sc1
    v_mfma_f32_32x32x16_bf16 v[16:31], a[16:19], v[172:175], v[16:31]
    buffer_load_dwordx4 v[164:167], v194, s[48:51], s57 offen sc1
    v_mfma_f32_32x32x16_bf16 v[32:47], a[20:23], v[168:171], v[32:47]
    ds_read_b64_tr_b16 a[48:49], v192 offset:61440
    ds_read_b64_tr_b16 a[50:51], v192 offset:61952
    v_mfma_f32_32x32x16_bf16 v[48:63], a[20:23], v[172:175], v[48:63]
    ds_read_b64_tr_b16 a[52:53], v193 offset:61440
    ds_read_b64_tr_b16 a[54:55], v193 offset:61952
    v_mfma_f32_32x32x16_bf16 v[64:79], a[24:27], v[168:171], v[64:79]
    ds_read_b64_tr_b16 a[56:57], v192 offset:63488
    ds_read_b64_tr_b16 a[58:59], v192 offset:64000
    v_mfma_f32_32x32x16_bf16 v[80:95], a[24:27], v[172:175], v[80:95]
    ds_read_b64_tr_b16 a[60:61], v193 offset:63488
    ds_read_b64_tr_b16 a[62:63], v193 offset:64000
    v_mfma_f32_32x32x16_bf16 v[96:111], a[28:31], v[168:171], v[96:111]
    buffer_load_dwordx4 v196, s[36:39], s70 offen offset:1024 lds
    v_mfma_f32_32x32x16_bf16 v[112:127], a[28:31], v[172:175], v[112:127]
    v_add_u32 v192, 0x10000, v192
    v_add_u32 v193, 0x10000, v193
    s_waitcnt vmcnt(22) lgkmcnt(8)
    v_mfma_f32_32x32x16_bf16 v[0:15], a[32:35], v[176:179], v[0:15]
    buffer_load_dwordx4 v[168:171], v194, s[44:47], s57 offen offset:1024 sc1
    buffer_load_dwordx4 a[92:95], v194, s[32:35], s78 offen offset:3072 sc1
    v_mfma_f32_32x32x16_bf16 v[16:31], a[32:35], v[180:183], v[16:31]
    buffer_load_dwordx4 v[172:175], v194, s[48:51], s57 offen offset:1024 sc1
    v_mfma_f32_32x32x16_bf16 v[32:47], a[36:39], v[176:179], v[32:47]
    ds_read_b64_tr_b16 a[0:1], v192 offset:0
    ds_read_b64_tr_b16 a[2:3], v192 offset:512
    v_mfma_f32_32x32x16_bf16 v[48:63], a[36:39], v[180:183], v[48:63]
    ds_read_b64_tr_b16 a[4:5], v193 offset:0
    ds_read_b64_tr_b16 a[6:7], v193 offset:512
    v_mfma_f32_32x32x16_bf16 v[64:79], a[40:43], v[176:179], v[64:79]
    ds_read_b64_tr_b16 a[8:9], v192 offset:2048
    ds_read_b64_tr_b16 a[10:11], v192 offset:2560
    v_mfma_f32_32x32x16_bf16 v[80:95], a[40:43], v[180:183], v[80:95]
    ds_read_b64_tr_b16 a[12:13], v193 offset:2048
    ds_read_b64_tr_b16 a[14:15], v193 offset:2560
    v_mfma_f32_32x32x16_bf16 v[96:111], a[44:47], v[176:179], v[96:111]
    buffer_load_dwordx4 v195, s[40:43], s70 offen offset:2048 lds
    v_mfma_f32_32x32x16_bf16 v[112:127], a[44:47], v[180:183], v[112:127]
    s_waitcnt vmcnt(23) lgkmcnt(8)
    v_mfma_f32_32x32x16_bf16 v[0:15], a[48:51], v[184:187], v[0:15]
    buffer_load_dwordx4 v[176:179], v194, s[44:47], s57 offen offset:2048 sc1
    v_mfma_f32_32x32x16_bf16 v[16:31], a[48:51], v[188:191], v[16:31]
    buffer_load_dwordx4 v[180:183], v194, s[48:51], s57 offen offset:2048 sc1
    v_mfma_f32_32x32x16_bf16 v[32:47], a[52:55], v[184:187], v[32:47]
    ds_read_b64_tr_b16 a[16:17], v192 offset:4096
    ds_read_b64_tr_b16 a[18:19], v192 offset:4608
    v_mfma_f32_32x32x16_bf16 v[48:63], a[52:55], v[188:191], v[48:63]
    ds_read_b64_tr_b16 a[20:21], v193 offset:4096
    ds_read_b64_tr_b16 a[22:23], v193 offset:4608
    v_mfma_f32_32x32x16_bf16 v[64:79], a[56:59], v[184:187], v[64:79]
    ds_read_b64_tr_b16 a[24:25], v192 offset:6144
    ds_read_b64_tr_b16 a[26:27], v192 offset:6656
    v_mfma_f32_32x32x16_bf16 v[80:95], a[56:59], v[188:191], v[80:95]
    ds_read_b64_tr_b16 a[28:29], v193 offset:6144
    ds_read_b64_tr_b16 a[30:31], v193 offset:6656
    v_mfma_f32_32x32x16_bf16 v[96:111], a[60:63], v[184:187], v[96:111]
    buffer_load_dwordx4 v196, s[40:43], s70 offen offset:3072 lds
    v_mfma_f32_32x32x16_bf16 v[112:127], a[60:63], v[188:191], v[112:127]
    s_waitcnt vmcnt(22) lgkmcnt(8)
    v_mfma_f32_32x32x16_bf16 v[0:15], a[0:3], v[128:131], v[0:15]
    s_barrier
    buffer_load_dwordx4 v[184:187], v194, s[44:47], s57 offen offset:3072 sc1
    v_add_f32 v244, v212, v214
    v_mfma_f32_32x32x16_bf16 v[16:31], a[0:3], v[132:135], v[16:31]
    buffer_load_dwordx4 v[188:191], v194, s[48:51], s57 offen offset:3072 sc1
    v_add_f32 v245, v213, v215
    v_add_f32 v244, v244, v216
    v_add_f32 v245, v245, v217
    v_mfma_f32_32x32x16_bf16 v[32:47], a[4:7], v[128:131], v[32:47]
    ds_read_b64_tr_b16 a[32:33], v192 offset:8192
    ds_read_b64_tr_b16 a[34:35], v192 offset:8704
    v_add_f32 v244, v244, v218
    v_add_f32 v245, v245, v219
    v_add_f32 v244, v244, v220
    v_add_f32 v245, v245, v221
    v_mfma_f32_32x32x16_bf16 v[48:63], a[4:7], v[132:135], v[48:63]
    ds_read_b64_tr_b16 a[36:37], v193 offset:8192
    ds_read_b64_tr_b16 a[38:39], v193 offset:8704
    v_add_f32 v244, v244, v222
    v_add_f32 v245, v245, v223
    v_add_f32 v244, v244, v224
    v_add_f32 v245, v245, v225
    v_mfma_f32_32x32x16_bf16 v[64:79], a[8:11], v[128:131], v[64:79]
    ds_read_b64_tr_b16 a[40:41], v192 offset:10240
    ds_read_b64_tr_b16 a[42:43], v192 offset:10752
    v_add_f32 v244, v244, v226
    v_add_f32 v245, v245, v227
    v_mul_f32 v244, 0x3e000000, v244
    v_mov_b32 v246, 0
    v_mfma_f32_32x32x16_bf16 v[80:95], a[8:11], v[132:135], v[80:95]
    ds_read_b64_tr_b16 a[44:45], v193 offset:10240
    ds_read_b64_tr_b16 a[46:47], v193 offset:10752
    v_sub_f32 v247, v212, v244
    v_fmac_f32 v246, v247, v247
    v_sub_f32 v247, v214, v244
    v_fmac_f32 v246, v247, v247
    v_mfma_f32_32x32x16_bf16 v[96:111], a[12:15], v[128:131], v[96:111]
    v_sub_f32 v247, v216, v244
    v_fmac_f32 v246, v247, v247
    v_sub_f32 v247, v218, v244
    v_fmac_f32 v246, v247, v247
    v_sub_f32 v247, v220, v244
    v_fmac_f32 v246, v247, v247
    v_mfma_f32_32x32x16_bf16 v[112:127], a[12:15], v[132:135], v[112:127]
    v_sub_f32 v247, v222, v244
    v_fmac_f32 v246, v247, v247
    v_sub_f32 v247, v224, v244
    v_fmac_f32 v246, v247, v247
    v_sub_f32 v247, v226, v244
    s_waitcnt vmcnt(20) lgkmcnt(8)
    v_mfma_f32_32x32x16_bf16 v[0:15], a[16:19], v[136:139], v[0:15]
    buffer_load_dwordx4 v[128:131], v194, s[44:47], s58 offen sc1
    v_fmac_f32 v246, v247, v247
    v_mul_f32 v246, 0x42a00000, v246
    v_add_f32 v245, v245, v246
    v_mfma_f32_32x32x16_bf16 v[16:31], a[16:19], v[140:143], v[16:31]
    buffer_load_dwordx4 v[132:135], v194, s[48:51], s58 offen sc1
    v_mul_f32 v245, 0x3acccccd, v245
    v_add_f32 v245, 0x3727c5ac, v245
    v_mfma_f32_32x32x16_bf16 v[32:47], a[20:23], v[136:139], v[32:47]
    ds_read_b64_tr_b16 a[48:49], v192 offset:12288
    ds_read_b64_tr_b16 a[50:51], v192 offset:12800
    v_rsq_f32 v198, v245
    s_nop 0
    v_mul_f32 v199, v244, v198
    v_mfma_f32_32x32x16_bf16 v[48:63], a[20:23], v[140:143], v[48:63]
    ds_read_b64_tr_b16 a[52:53], v193 offset:12288
    ds_read_b64_tr_b16 a[54:55], v193 offset:12800
    v_sub_f32 v199, 0, v199
    v_add_f32 v244, v228, v230
    v_add_f32 v245, v229, v231
    v_mfma_f32_32x32x16_bf16 v[64:79], a[24:27], v[136:139], v[64:79]
    ds_read_b64_tr_b16 a[56:57], v192 offset:14336
    ds_read_b64_tr_b16 a[58:59], v192 offset:14848
    v_add_f32 v244, v244, v232
    v_add_f32 v245, v245, v233
    v_add_f32 v244, v244, v234
    v_add_f32 v245, v245, v235
    v_mfma_f32_32x32x16_bf16 v[80:95], a[24:27], v[140:143], v[80:95]
    ds_read_b64_tr_b16 a[60:61], v193 offset:14336
    ds_read_b64_tr_b16 a[62:63], v193 offset:14848
    v_add_f32 v244, v244, v236
    v_add_f32 v245, v245, v237
    v_add_f32 v244, v244, v238
    v_add_f32 v245, v245, v239
    v_mfma_f32_32x32x16_bf16 v[96:111], a[28:31], v[136:139], v[96:111]
    v_add_f32 v244, v244, v240
    v_add_f32 v245, v245, v241
    v_add_f32 v244, v244, v242
    v_add_f32 v245, v245, v243
    v_mul_f32 v244, 0x3e000000, v244
    v_mov_b32 v246, 0
    v_mfma_f32_32x32x16_bf16 v[112:127], a[28:31], v[140:143], v[112:127]
    v_sub_f32 v247, v228, v244
    v_fmac_f32 v246, v247, v247
    v_sub_f32 v247, v230, v244
    v_fmac_f32 v246, v247, v247
    v_sub_f32 v247, v232, v244
    s_waitcnt vmcnt(19) lgkmcnt(8)
    v_mfma_f32_32x32x16_bf16 v[0:15], a[32:35], v[144:147], v[0:15]
    buffer_load_dwordx4 v[136:139], v194, s[44:47], s58 offen offset:1024 sc1
    v_fmac_f32 v246, v247, v247
    v_sub_f32 v247, v234, v244
    v_fmac_f32 v246, v247, v247
    v_mfma_f32_32x32x16_bf16 v[16:31], a[32:35], v[148:151], v[16:31]
    buffer_load_dwordx4 v[140:143], v194, s[48:51], s58 offen offset:1024 sc1
    v_sub_f32 v247, v236, v244
    v_fmac_f32 v246, v247, v247
    v_sub_f32 v247, v238, v244
    v_mfma_f32_32x32x16_bf16 v[32:47], a[36:39], v[144:147], v[32:47]
    ds_read_b64_tr_b16 a[0:1], v192 offset:16384
    ds_read_b64_tr_b16 a[2:3], v192 offset:16896
    v_fmac_f32 v246, v247, v247
    v_sub_f32 v247, v240, v244
    v_fmac_f32 v246, v247, v247
    v_sub_f32 v247, v242, v244
    v_mfma_f32_32x32x16_bf16 v[48:63], a[36:39], v[148:151], v[48:63]
    ds_read_b64_tr_b16 a[4:5], v193 offset:16384
    ds_read_b64_tr_b16 a[6:7], v193 offset:16896
    v_fmac_f32 v246, v247, v247
    v_mul_f32 v246, 0x42a00000, v246
    v_add_f32 v245, v245, v246
    v_mul_f32 v245, 0x3acccccd, v245
    v_mfma_f32_32x32x16_bf16 v[64:79], a[40:43], v[144:147], v[64:79]
    ds_read_b64_tr_b16 a[8:9], v192 offset:18432
    ds_read_b64_tr_b16 a[10:11], v192 offset:18944
    v_add_f32 v245, 0x3727c5ac, v245
    v_rsq_f32 v200, v245
    s_nop 0
    v_mfma_f32_32x32x16_bf16 v[80:95], a[40:43], v[148:151], v[80:95]
    ds_read_b64_tr_b16 a[12:13], v193 offset:18432
    ds_read_b64_tr_b16 a[14:15], v193 offset:18944
    v_mul_f32 v201, v244, v200
    v_sub_f32 v201, 0, v201
    s_mov_b32 s83, 396288
    s_and_b32 s81, s64, 1
    v_mfma_f32_32x32x16_bf16 v[96:111], a[44:47], v[144:147], v[96:111]
    s_mul_i32 s81, s81, 13824
    s_lshr_b32 s82, s64, 1
    s_mul_i32 s82, s82, 6912
    s_add_u32 s81, s81, s82
    s_lshl_b32 s82, s68, 8
    s_add_u32 s81, s81, s82
    v_mfma_f32_32x32x16_bf16 v[112:127], a[44:47], v[148:151], v[112:127]
    s_add_u32 s81, s81, 81920
    s_waitcnt vmcnt(18) lgkmcnt(8)
    v_mfma_f32_32x32x16_bf16 v[0:15], a[48:51], v[152:155], v[0:15]
    buffer_load_dwordx4 v[144:147], v194, s[44:47], s58 offen offset:2048 sc1
    buffer_load_dwordx4 v[208:211], v194, s[32:35], s83 offen sc1
    v_mfma_f32_32x32x16_bf16 v[16:31], a[48:51], v[156:159], v[16:31]
    buffer_load_dwordx4 v[148:151], v194, s[48:51], s58 offen offset:2048 sc1
    buffer_load_dwordx4 a[96:99], v248, s[32:35], s78 offen sc1
    s_add_u32 s78, s78, 5120
    v_mfma_f32_32x32x16_bf16 v[32:47], a[52:55], v[152:155], v[32:47]
    ds_read_b64_tr_b16 a[16:17], v192 offset:20480
    ds_read_b64_tr_b16 a[18:19], v192 offset:20992
    buffer_load_dwordx4 a[100:103], v194, s[32:35], s78 offen sc1
    v_mfma_f32_32x32x16_bf16 v[48:63], a[52:55], v[156:159], v[48:63]
    ds_read_b64_tr_b16 a[20:21], v193 offset:20480
    ds_read_b64_tr_b16 a[22:23], v193 offset:20992
    buffer_load_dwordx4 a[104:107], v194, s[32:35], s78 offen offset:1024 sc1
    v_mfma_f32_32x32x16_bf16 v[64:79], a[56:59], v[152:155], v[64:79]
    ds_read_b64_tr_b16 a[24:25], v192 offset:22528
    ds_read_b64_tr_b16 a[26:27], v192 offset:23040
    buffer_load_dwordx4 a[108:111], v194, s[32:35], s78 offen offset:2048 sc1
    v_mfma_f32_32x32x16_bf16 v[80:95], a[56:59], v[156:159], v[80:95]
    ds_read_b64_tr_b16 a[28:29], v193 offset:22528
    ds_read_b64_tr_b16 a[30:31], v193 offset:23040
    buffer_load_dwordx4 a[112:115], v194, s[32:35], s78 offen offset:3072 sc1
    v_mfma_f32_32x32x16_bf16 v[96:111], a[60:63], v[152:155], v[96:111]
    buffer_load_dwordx4 a[116:119], v248, s[32:35], s78 offen sc1
    s_add_u32 s78, s78, 5120
    v_mfma_f32_32x32x16_bf16 v[112:127], a[60:63], v[156:159], v[112:127]
    s_waitcnt vmcnt(23) lgkmcnt(8)
    v_mfma_f32_32x32x16_bf16 v[0:15], a[0:3], v[160:163], v[0:15]
    s_barrier
    buffer_load_dwordx4 v[152:155], v194, s[44:47], s58 offen offset:3072 sc1
    s_waitcnt vmcnt(8)
    v_xor_b32 v208, s65, v208
    v_mfma_f32_32x32x16_bf16 v[16:31], a[0:3], v[164:167], v[16:31]
    buffer_load_dwordx4 v[156:159], v194, s[48:51], s58 offen offset:3072 sc1
    v_xor_b32 v209, s65, v209
    v_mfma_f32_32x32x16_bf16 v[32:47], a[4:7], v[160:163], v[32:47]
    ds_read_b64_tr_b16 a[32:33], v192 offset:24576
    ds_read_b64_tr_b16 a[34:35], v192 offset:25088
    v_xor_b32 v210, s65, v210
    v_xor_b32 v211, s65, v211
    v_mfma_f32_32x32x16_bf16 v[48:63], a[4:7], v[164:167], v[48:63]
    ds_read_b64_tr_b16 a[36:37], v193 offset:24576
    ds_read_b64_tr_b16 a[38:39], v193 offset:25088
    v_or_b32 v208, v208, v209
    v_or3_b32 v208, v208, v210, v211
    v_mfma_f32_32x32x16_bf16 v[64:79], a[8:11], v[160:163], v[64:79]
    ds_read_b64_tr_b16 a[40:41], v192 offset:26624
    ds_read_b64_tr_b16 a[42:43], v192 offset:27136
    v_cmp_ne_u32 vcc, 0, v208
    s_nop 1
    s_cbranch_vccz P3_FUOK
    s_mov_b32 s85, 100000
POLL_17:
    buffer_load_dwordx4 v[208:211], v194, s[32:35], s83 offen sc1
    s_waitcnt vmcnt(0)
    v_xor_b32 v208, s65, v208
    v_xor_b32 v209, s65, v209
    v_xor_b32 v210, s65, v210
    v_xor_b32 v211, s65, v211
    v_or_b32 v208, v208, v209
    v_or_b32 v208, v208, v210
    v_or_b32 v208, v208, v211
    v_cmp_ne_u32 vcc, 0, v208
    s_nop 1
    s_cbranch_vccz POLLD_18
    s_sub_u32 s85, s85, 1
    s_cbranch_scc1 F_END
    s_sleep 1
    s_branch POLL_17
POLLD_18:
P3_FUOK:
    v_mfma_f32_32x32x16_bf16 v[80:95], a[8:11], v[164:167], v[80:95]
    ds_read_b64_tr_b16 a[44:45], v193 offset:26624
    ds_read_b64_tr_b16 a[46:47], v193 offset:27136
    buffer_load_dword v208, v204, s[32:35], s81 offen sc1
    s_add_u32 s81, s81, 27648
    v_mfma_f32_32x32x16_bf16 v[96:111], a[12:15], v[160:163], v[96:111]
    buffer_load_dword v209, v204, s[32:35], s81 offen sc1
    s_add_u32 s81, s81, 27648
    v_mfma_f32_32x32x16_bf16 v[112:127], a[12:15], v[164:167], v[112:127]
    buffer_load_dword v210, v204, s[32:35], s81 offen sc1
    s_add_u32 s81, s81, 27648
    s_waitcnt lgkmcnt(8)
    v_mfma_f32_32x32x16_bf16 v[0:15], a[16:19], v[168:171], v[0:15]
    buffer_load_dwordx4 v[160:163], v194, s[44:47], s59 offen sc1
    buffer_load_dword v211, v204, s[32:35], s81 offen sc1
    s_add_u32 s81, s81, 27648
    v_mfma_f32_32x32x16_bf16 v[16:31], a[16:19], v[172:175], v[16:31]
    buffer_load_dwordx4 v[164:167], v194, s[48:51], s59 offen sc1
    buffer_load_dwordx4 a[120:123], v194, s[32:35], s78 offen sc1
    v_mfma_f32_32x32x16_bf16 v[32:47], a[20:23], v[168:171], v[32:47]
    ds_read_b64_tr_b16 a[48:49], v192 offset:28672
    ds_read_b64_tr_b16 a[50:51], v192 offset:29184
    buffer_load_dwordx4 a[124:127], v194, s[32:35], s78 offen offset:1024 sc1
    v_mfma_f32_32x32x16_bf16 v[48:63], a[20:23], v[172:175], v[48:63]
    ds_read_b64_tr_b16 a[52:53], v193 offset:28672
    ds_read_b64_tr_b16 a[54:55], v193 offset:29184
    buffer_load_dwordx4 a[128:131], v194, s[32:35], s78 offen offset:2048 sc1
    v_mfma_f32_32x32x16_bf16 v[64:79], a[24:27], v[168:171], v[64:79]
    ds_read_b64_tr_b16 a[56:57], v192 offset:30720
    ds_read_b64_tr_b16 a[58:59], v192 offset:31232
    v_mfma_f32_32x32x16_bf16 v[80:95], a[24:27], v[172:175], v[80:95]
    ds_read_b64_tr_b16 a[60:61], v193 offset:30720
    ds_read_b64_tr_b16 a[62:63], v193 offset:31232
    buffer_load_dwordx4 a[132:135], v194, s[32:35], s78 offen offset:3072 sc1
    v_mfma_f32_32x32x16_bf16 v[96:111], a[28:31], v[168:171], v[96:111]
    v_mfma_f32_32x32x16_bf16 v[112:127], a[28:31], v[172:175], v[112:127]
    s_waitcnt lgkmcnt(8)
    v_mfma_f32_32x32x16_bf16 v[0:15], a[32:35], v[176:179], v[0:15]
    buffer_load_dwordx4 v[168:171], v194, s[44:47], s59 offen offset:1024 sc1
    v_mfma_f32_32x32x16_bf16 v[16:31], a[32:35], v[180:183], v[16:31]
    buffer_load_dwordx4 v[172:175], v194, s[48:51], s59 offen offset:1024 sc1
    v_mfma_f32_32x32x16_bf16 v[32:47], a[36:39], v[176:179], v[32:47]
    ds_read_b64_tr_b16 a[0:1], v192 offset:32768
    ds_read_b64_tr_b16 a[2:3], v192 offset:33280
    buffer_load_dwordx4 a[136:139], v248, s[32:35], s78 offen sc1
    s_add_u32 s78, s78, 5120
    v_mfma_f32_32x32x16_bf16 v[48:63], a[36:39], v[180:183], v[48:63]
    ds_read_b64_tr_b16 a[4:5], v193 offset:32768
    ds_read_b64_tr_b16 a[6:7], v193 offset:33280
    v_mfma_f32_32x32x16_bf16 v[64:79], a[40:43], v[176:179], v[64:79]
    ds_read_b64_tr_b16 a[8:9], v192 offset:34816
    ds_read_b64_tr_b16 a[10:11], v192 offset:35328
    v_mfma_f32_32x32x16_bf16 v[80:95], a[40:43], v[180:183], v[80:95]
    ds_read_b64_tr_b16 a[12:13], v193 offset:34816
    ds_read_b64_tr_b16 a[14:15], v193 offset:35328
    v_mfma_f32_32x32x16_bf16 v[96:111], a[44:47], v[176:179], v[96:111]
    buffer_load_dwordx4 a[140:143], v194, s[32:35], s78 offen sc1
    v_mfma_f32_32x32x16_bf16 v[112:127], a[44:47], v[180:183], v[112:127]
    s_waitcnt lgkmcnt(8)
    v_mfma_f32_32x32x16_bf16 v[0:15], a[48:51], v[184:187], v[0:15]
    buffer_load_dwordx4 v[176:179], v194, s[44:47], s59 offen offset:2048 sc1
    v_mfma_f32_32x32x16_bf16 v[16:31], a[48:51], v[188:191], v[16:31]
    buffer_load_dwordx4 v[180:183], v194, s[48:51], s59 offen offset:2048 sc1
    v_mfma_f32_32x32x16_bf16 v[32:47], a[52:55], v[184:187], v[32:47]
    ds_read_b64_tr_b16 a[16:17], v192 offset:36864
    ds_read_b64_tr_b16 a[18:19], v192 offset:37376
    v_mfma_f32_32x32x16_bf16 v[48:63], a[52:55], v[188:191], v[48:63]
    ds_read_b64_tr_b16 a[20:21], v193 offset:36864
    ds_read_b64_tr_b16 a[22:23], v193 offset:37376
    buffer_load_dwordx4 a[144:147], v194, s[32:35], s78 offen offset:1024 sc1
    v_mfma_f32_32x32x16_bf16 v[64:79], a[56:59], v[184:187], v[64:79]
    ds_read_b64_tr_b16 a[24:25], v192 offset:38912
    ds_read_b64_tr_b16 a[26:27], v192 offset:39424
    v_mfma_f32_32x32x16_bf16 v[80:95], a[56:59], v[188:191], v[80:95]
    ds_read_b64_tr_b16 a[28:29], v193 offset:38912
    ds_read_b64_tr_b16 a[30:31], v193 offset:39424
    v_mfma_f32_32x32x16_bf16 v[96:111], a[60:63], v[184:187], v[96:111]
    v_mfma_f32_32x32x16_bf16 v[112:127], a[60:63], v[188:191], v[112:127]
    s_waitcnt lgkmcnt(8)
    v_mfma_f32_32x32x16_bf16 v[0:15], a[0:3], v[128:131], v[0:15]
    s_barrier
    buffer_load_dwordx4 v[184:187], v194, s[44:47], s59 offen offset:3072 sc1
    s_waitcnt vmcnt(13)
    v_add_f32 v208, v208, v209
    v_mfma_f32_32x32x16_bf16 v[16:31], a[0:3], v[132:135], v[16:31]
    buffer_load_dwordx4 v[188:191], v194, s[48:51], s59 offen offset:3072 sc1
    v_add_f32 v210, v210, v211
    v_add_f32 v208, v208, v210
    v_mfma_f32_32x32x16_bf16 v[32:47], a[4:7], v[128:131], v[32:47]
    ds_read_b64_tr_b16 a[32:33], v192 offset:40960
    ds_read_b64_tr_b16 a[34:35], v192 offset:41472
    ds_write_b32 v207, v208
    buffer_load_dwordx4 a[148:151], v194, s[32:35], s78 offen offset:2048 sc1
    v_mfma_f32_32x32x16_bf16 v[48:63], a[4:7], v[132:135], v[48:63]
    ds_read_b64_tr_b16 a[36:37], v193 offset:40960
    ds_read_b64_tr_b16 a[38:39], v193 offset:41472
    v_mfma_f32_32x32x16_bf16 v[64:79], a[8:11], v[128:131], v[64:79]
    ds_read_b64_tr_b16 a[40:41], v192 offset:43008
    ds_read_b64_tr_b16 a[42:43], v192 offset:43520
    buffer_load_dwordx4 a[152:155], v194, s[32:35], s78 offen offset:3072 sc1
    v_mfma_f32_32x32x16_bf16 v[80:95], a[8:11], v[132:135], v[80:95]
    ds_read_b64_tr_b16 a[44:45], v193 offset:43008
    ds_read_b64_tr_b16 a[46:47], v193 offset:43520
    v_mfma_f32_32x32x16_bf16 v[96:111], a[12:15], v[128:131], v[96:111]
    v_mfma_f32_32x32x16_bf16 v[112:127], a[12:15], v[132:135], v[112:127]
    s_waitcnt lgkmcnt(9)
    v_mfma_f32_32x32x16_bf16 v[0:15], a[16:19], v[136:139], v[0:15]
    v_mfma_f32_32x32x16_bf16 v[16:31], a[16:19], v[140:143], v[16:31]
    buffer_load_dwordx4 a[156:159], v248, s[32:35], s78 offen sc1
    s_add_u32 s78, s78, 5120
    v_mfma_f32_32x32x16_bf16 v[32:47], a[20:23], v[136:139], v[32:47]
    ds_read_b64_tr_b16 a[48:49], v192 offset:45056
    ds_read_b64_tr_b16 a[50:51], v192 offset:45568
    v_mfma_f32_32x32x16_bf16 v[48:63], a[20:23], v[140:143], v[48:63]
    ds_read_b64_tr_b16 a[52:53], v193 offset:45056
    ds_read_b64_tr_b16 a[54:55], v193 offset:45568
    v_mfma_f32_32x32x16_bf16 v[64:79], a[24:27], v[136:139], v[64:79]
    ds_read_b64_tr_b16 a[56:57], v192 offset:47104
    ds_read_b64_tr_b16 a[58:59], v192 offset:47616
    v_mfma_f32_32x32x16_bf16 v[80:95], a[24:27], v[140:143], v[80:95]
    ds_read_b64_tr_b16 a[60:61], v193 offset:47104
    ds_read_b64_tr_b16 a[62:63], v193 offset:47616
    buffer_load_dwordx4 a[160:163], v194, s[32:35], s78 offen sc1
    v_mfma_f32_32x32x16_bf16 v[96:111], a[28:31], v[136:139], v[96:111]
    v_mfma_f32_32x32x16_bf16 v[112:127], a[28:31], v[140:143], v[112:127]
    s_waitcnt lgkmcnt(8)
    v_mfma_f32_32x32x16_bf16 v[0:15], a[32:35], v[144:147], v[0:15]
    v_mfma_f32_32x32x16_bf16 v[16:31], a[32:35], v[148:151], v[16:31]
    v_mfma_f32_32x32x16_bf16 v[32:47], a[36:39], v[144:147], v[32:47]
    ds_read_b64_tr_b16 a[0:1], v192 offset:49152
    ds_read_b64_tr_b16 a[2:3], v192 offset:49664
    buffer_load_dwordx4 a[164:167], v194, s[32:35], s78 offen offset:1024 sc1
    v_mfma_f32_32x32x16_bf16 v[48:63], a[36:39], v[148:151], v[48:63]
    ds_read_b64_tr_b16 a[4:5], v193 offset:49152
    ds_read_b64_tr_b16 a[6:7], v193 offset:49664
    v_mfma_f32_32x32x16_bf16 v[64:79], a[40:43], v[144:147], v[64:79]
    ds_read_b64_tr_b16 a[8:9], v192 offset:51200
    ds_read_b64_tr_b16 a[10:11], v192 offset:51712
    v_mfma_f32_32x32x16_bf16 v[80:95], a[40:43], v[148:151], v[80:95]
    ds_read_b64_tr_b16 a[12:13], v193 offset:51200
    ds_read_b64_tr_b16 a[14:15], v193 offset:51712
    v_mfma_f32_32x32x16_bf16 v[96:111], a[44:47], v[144:147], v[96:111]
    buffer_load_dwordx4 a[168:171], v194, s[32:35], s78 offen offset:2048 sc1
    v_mfma_f32_32x32x16_bf16 v[112:127], a[44:47], v[148:151], v[112:127]
    s_waitcnt lgkmcnt(8)
    v_mfma_f32_32x32x16_bf16 v[0:15], a[48:51], v[152:155], v[0:15]
    v_mfma_f32_32x32x16_bf16 v[16:31], a[48:51], v[156:159], v[16:31]
    v_mfma_f32_32x32x16_bf16 v[32:47], a[52:55], v[152:155], v[32:47]
    ds_read_b64_tr_b16 a[16:17], v192 offset:53248
    ds_read_b64_tr_b16 a[18:19], v192 offset:53760
    v_mfma_f32_32x32x16_bf16 v[48:63], a[52:55], v[156:159], v[48:63]
    ds_read_b64_tr_b16 a[20:21], v193 offset:53248
    ds_read_b64_tr_b16 a[22:23], v193 offset:53760
    buffer_load_dwordx4 a[172:175], v194, s[32:35], s78 offen offset:3072 sc1
    v_mfma_f32_32x32x16_bf16 v[64:79], a[56:59], v[152:155], v[64:79]
    ds_read_b64_tr_b16 a[24:25], v192 offset:55296
    ds_read_b64_tr_b16 a[26:27], v192 offset:55808
    v_mfma_f32_32x32x16_bf16 v[80:95], a[56:59], v[156:159], v[80:95]
    ds_read_b64_tr_b16 a[28:29], v193 offset:55296
    ds_read_b64_tr_b16 a[30:31], v193 offset:55808
    v_mfma_f32_32x32x16_bf16 v[96:111], a[60:63], v[152:155], v[96:111]
    v_mfma_f32_32x32x16_bf16 v[112:127], a[60:63], v[156:159], v[112:127]
    s_waitcnt vmcnt(20) lgkmcnt(8)
    v_mfma_f32_32x32x16_bf16 v[0:15], a[0:3], v[160:163], v[0:15]
    s_barrier
    s_mul_i32 s80, s76, 108
    s_lshl_b32 s81, s68, 1
    s_add_u32 s80, s80, s81
    s_lshl_b32 s80, s80, 10
    s_add_u32 s80, s80, 18874368
    v_mfma_f32_32x32x16_bf16 v[16:31], a[0:3], v[164:167], v[16:31]
    s_add_u32 s81, s80, 110592
    s_lshl_b32 s84, s69, 5
    s_add_u32 s84, s84, s68
    v_mfma_f32_32x32x16_bf16 v[32:47], a[4:7], v[160:163], v[32:47]
    ds_read_b64_tr_b16 a[32:33], v192 offset:57344
    ds_read_b64_tr_b16 a[34:35], v192 offset:57856
    buffer_load_dwordx4 a[176:179], v248, s[32:35], s78 offen sc1
    s_add_u32 s78, s78, 5120
    v_mfma_f32_32x32x16_bf16 v[48:63], a[4:7], v[164:167], v[48:63]
    ds_read_b64_tr_b16 a[36:37], v193 offset:57344
    ds_read_b64_tr_b16 a[38:39], v193 offset:57856
    v_mfma_f32_32x32x16_bf16 v[64:79], a[8:11], v[160:163], v[64:79]
    ds_read_b64_tr_b16 a[40:41], v192 offset:59392
    ds_read_b64_tr_b16 a[42:43], v192 offset:59904
    buffer_load_dwordx4 a[180:183], v194, s[32:35], s78 offen sc1
    v_mfma_f32_32x32x16_bf16 v[80:95], a[8:11], v[164:167], v[80:95]
    ds_read_b64_tr_b16 a[44:45], v193 offset:59392
    ds_read_b64_tr_b16 a[46:47], v193 offset:59904
    v_mfma_f32_32x32x16_bf16 v[96:111], a[12:15], v[160:163], v[96:111]
    v_mfma_f32_32x32x16_bf16 v[112:127], a[12:15], v[164:167], v[112:127]
    s_waitcnt vmcnt(16) lgkmcnt(8)
    v_mfma_f32_32x32x16_bf16 v[0:15], a[16:19], v[168:171], v[0:15]
    v_mfma_f32_32x32x16_bf16 v[16:31], a[16:19], v[172:175], v[16:31]
    buffer_load_dwordx4 a[184:187], v194, s[32:35], s78 offen offset:1024 sc1
    v_mfma_f32_32x32x16_bf16 v[32:47], a[20:23], v[168:171], v[32:47]
    ds_read_b64_tr_b16 a[48:49], v192 offset:61440
    ds_read_b64_tr_b16 a[50:51], v192 offset:61952
    v_mfma_f32_32x32x16_bf16 v[48:63], a[20:23], v[172:175], v[48:63]
    ds_read_b64_tr_b16 a[52:53], v193 offset:61440
    ds_read_b64_tr_b16 a[54:55], v193 offset:61952
    v_mfma_f32_32x32x16_bf16 v[64:79], a[24:27], v[168:171], v[64:79]
    ds_read_b64_tr_b16 a[56:57], v192 offset:63488
    ds_read_b64_tr_b16 a[58:59], v192 offset:64000
    v_mfma_f32_32x32x16_bf16 v[80:95], a[24:27], v[172:175], v[80:95]
    ds_read_b64_tr_b16 a[60:61], v193 offset:63488
    ds_read_b64_tr_b16 a[62:63], v193 offset:64000
    buffer_load_dwordx4 a[188:191], v194, s[32:35], s78 offen offset:2048 sc1
    v_mfma_f32_32x32x16_bf16 v[96:111], a[28:31], v[168:171], v[96:111]
    v_mfma_f32_32x32x16_bf16 v[112:127], a[28:31], v[172:175], v[112:127]
    s_waitcnt vmcnt(14) lgkmcnt(8)
    v_mfma_f32_32x32x16_bf16 v[0:15], a[32:35], v[176:179], v[0:15]
    v_mfma_f32_32x32x16_bf16 v[16:31], a[32:35], v[180:183], v[16:31]
    v_mfma_f32_32x32x16_bf16 v[32:47], a[36:39], v[176:179], v[32:47]
    buffer_load_dwordx4 a[192:195], v194, s[32:35], s78 offen offset:3072 sc1
    v_mfma_f32_32x32x16_bf16 v[48:63], a[36:39], v[180:183], v[48:63]
    v_mfma_f32_32x32x16_bf16 v[64:79], a[40:43], v[176:179], v[64:79]
    v_mfma_f32_32x32x16_bf16 v[80:95], a[40:43], v[180:183], v[80:95]
    v_mfma_f32_32x32x16_bf16 v[96:111], a[44:47], v[176:179], v[96:111]
    buffer_load_dwordx4 a[196:199], v248, s[32:35], s78 offen sc1
    s_add_u32 s78, s78, 5120
    v_mfma_f32_32x32x16_bf16 v[112:127], a[44:47], v[180:183], v[112:127]
    s_waitcnt vmcnt(13) lgkmcnt(0)
    v_mfma_f32_32x32x16_bf16 v[0:15], a[48:51], v[184:187], v[0:15]
    v_mfma_f32_32x32x16_bf16 v[16:31], a[48:51], v[188:191], v[16:31]
    v_mfma_f32_32x32x16_bf16 v[32:47], a[52:55], v[184:187], v[32:47]
    v_mfma_f32_32x32x16_bf16 v[48:63], a[52:55], v[188:191], v[48:63]
    buffer_load_dwordx4 a[200:203], v194, s[32:35], s78 offen sc1
    v_mfma_f32_32x32x16_bf16 v[64:79], a[56:59], v[184:187], v[64:79]
    v_mfma_f32_32x32x16_bf16 v[80:95], a[56:59], v[188:191], v[80:95]
    v_mfma_f32_32x32x16_bf16 v[96:111], a[60:63], v[184:187], v[96:111]
    v_mfma_f32_32x32x16_bf16 v[112:127], a[60:63], v[188:191], v[112:127]
    ds_read_b128 v[128:131], v203 offset:0
    buffer_load_dwordx4 a[204:207], v194, s[32:35], s78 offen offset:1024 sc1
    ds_read_b128 v[132:135], v203 offset:16
    ds_read_b128 v[136:139], v203 offset:256
    ds_read_b128 v[140:143], v203 offset:272
    ds_read_b128 v[144:147], v203 offset:512
    ds_read_b128 v[148:151], v203 offset:528
    ds_read_b128 v[152:155], v203 offset:768
    ds_read_b128 v[156:159], v203 offset:784
    ds_read_b128 v[160:163], v203 offset:64
    ds_read_b128 v[164:167], v203 offset:80
    ds_read_b128 v[168:171], v203 offset:320
    ds_read_b128 v[172:175], v203 offset:336
    ds_read_b128 v[176:179], v203 offset:576
    ds_read_b128 v[180:183], v203 offset:592
    buffer_load_dwordx4 a[208:211], v194, s[32:35], s78 offen offset:2048 sc1
    ds_read_b128 v[184:187], v203 offset:832
    ds_read_b128 v[188:191], v203 offset:848
    s_waitcnt lgkmcnt(8)
    v_pk_fma_f32 v[204:205], v[198:199], v[128:129], v[136:137] op_sel:[1,0,0] op_sel_hi:[1,1,1]
    v_pk_fma_f32 v[212:213], v[198:199], v[144:145], v[152:153] op_sel:[1,0,0] op_sel_hi:[1,1,1]
    v_pk_fma_f32 v[206:207], v[198:199], v[130:131], v[138:139] op_sel:[1,0,0] op_sel_hi:[1,1,1]
    v_pk_fma_f32 v[214:215], v[198:199], v[146:147], v[154:155] op_sel:[1,0,0] op_sel_hi:[1,1,1]
    v_pk_fma_f32 v[208:209], v[198:199], v[132:133], v[140:141] op_sel:[1,0,0] op_sel_hi:[1,1,1]
    v_pk_fma_f32 v[216:217], v[198:199], v[148:149], v[156:157] op_sel:[1,0,0] op_sel_hi:[1,1,1]
    v_pk_fma_f32 v[210:211], v[198:199], v[134:135], v[142:143] op_sel:[1,0,0] op_sel_hi:[1,1,1]
    v_pk_fma_f32 v[218:219], v[198:199], v[150:151], v[158:159] op_sel:[1,0,0] op_sel_hi:[1,1,1]
    v_pk_fma_f32 v[204:205], v[198:199], v[0:1], v[204:205] op_sel:[0,0,0] op_sel_hi:[0,1,1]
    v_pk_fma_f32 v[212:213], v[198:199], v[64:65], v[212:213] op_sel:[0,0,0] op_sel_hi:[0,1,1]
    v_pk_fma_f32 v[206:207], v[198:199], v[2:3], v[206:207] op_sel:[0,0,0] op_sel_hi:[0,1,1]
    v_pk_fma_f32 v[214:215], v[198:199], v[66:67], v[214:215] op_sel:[0,0,0] op_sel_hi:[0,1,1]
    buffer_load_dwordx4 a[212:215], v194, s[32:35], s78 offen offset:3072 sc1
    v_pk_fma_f32 v[208:209], v[198:199], v[4:5], v[208:209] op_sel:[0,0,0] op_sel_hi:[0,1,1]
    v_pk_fma_f32 v[216:217], v[198:199], v[68:69], v[216:217] op_sel:[0,0,0] op_sel_hi:[0,1,1]
    v_pk_fma_f32 v[210:211], v[198:199], v[6:7], v[210:211] op_sel:[0,0,0] op_sel_hi:[0,1,1]
    v_pk_fma_f32 v[218:219], v[198:199], v[70:71], v[218:219] op_sel:[0,0,0] op_sel_hi:[0,1,1]
    v_max_f32 v204, 0, v204
    v_max_f32 v205, 0, v205
    v_max_f32 v206, 0, v206
    v_max_f32 v207, 0, v207
    v_max_f32 v208, 0, v208
    v_max_f32 v209, 0, v209
    v_max_f32 v210, 0, v210
    v_max_f32 v211, 0, v211
    v_pk_mul_f32 v[204:205], v[204:205], v[212:213]
    v_pk_mul_f32 v[206:207], v[206:207], v[214:215]
    buffer_load_dwordx4 a[216:219], v248, s[32:35], s78 offen sc1
    v_pk_mul_f32 v[208:209], v[208:209], v[216:217]
    v_pk_mul_f32 v[210:211], v[210:211], v[218:219]
    v_cvt_pk_bf16_f32 v0, v204, v205
    v_cvt_pk_bf16_f32 v1, v206, v207
    v_cvt_pk_bf16_f32 v2, v208, v209
    v_cvt_pk_bf16_f32 v3, v210, v211
    buffer_store_dwordx4 v[0:3], v202, s[32:35], s80 offen offset:0 sc1
    v_pk_fma_f32 v[220:221], v[200:201], v[128:129], v[136:137] op_sel:[1,0,0] op_sel_hi:[1,1,1]
    v_pk_fma_f32 v[228:229], v[200:201], v[144:145], v[152:153] op_sel:[1,0,0] op_sel_hi:[1,1,1]
    v_pk_fma_f32 v[222:223], v[200:201], v[130:131], v[138:139] op_sel:[1,0,0] op_sel_hi:[1,1,1]
    v_pk_fma_f32 v[230:231], v[200:201], v[146:147], v[154:155] op_sel:[1,0,0] op_sel_hi:[1,1,1]
    v_pk_fma_f32 v[224:225], v[200:201], v[132:133], v[140:141] op_sel:[1,0,0] op_sel_hi:[1,1,1]
    v_pk_fma_f32 v[232:233], v[200:201], v[148:149], v[156:157] op_sel:[1,0,0] op_sel_hi:[1,1,1]
    s_add_u32 s78, s78, 5120
    v_pk_fma_f32 v[226:227], v[200:201], v[134:135], v[142:143] op_sel:[1,0,0] op_sel_hi:[1,1,1]
    v_pk_fma_f32 v[234:235], v[200:201], v[150:151], v[158:159] op_sel:[1,0,0] op_sel_hi:[1,1,1]
    v_pk_fma_f32 v[220:221], v[200:201], v[16:17], v[220:221] op_sel:[0,0,0] op_sel_hi:[0,1,1]
    v_pk_fma_f32 v[228:229], v[200:201], v[80:81], v[228:229] op_sel:[0,0,0] op_sel_hi:[0,1,1]
    v_pk_fma_f32 v[222:223], v[200:201], v[18:19], v[222:223] op_sel:[0,0,0] op_sel_hi:[0,1,1]
    v_pk_fma_f32 v[230:231], v[200:201], v[82:83], v[230:231] op_sel:[0,0,0] op_sel_hi:[0,1,1]
    v_pk_fma_f32 v[224:225], v[200:201], v[20:21], v[224:225] op_sel:[0,0,0] op_sel_hi:[0,1,1]
    v_pk_fma_f32 v[232:233], v[200:201], v[84:85], v[232:233] op_sel:[0,0,0] op_sel_hi:[0,1,1]
    v_pk_fma_f32 v[226:227], v[200:201], v[22:23], v[226:227] op_sel:[0,0,0] op_sel_hi:[0,1,1]
    v_pk_fma_f32 v[234:235], v[200:201], v[86:87], v[234:235] op_sel:[0,0,0] op_sel_hi:[0,1,1]
    v_max_f32 v220, 0, v220
    v_max_f32 v221, 0, v221
    v_max_f32 v222, 0, v222
    v_max_f32 v223, 0, v223
    buffer_load_dwordx4 a[220:223], v194, s[32:35], s78 offen sc1
    v_max_f32 v224, 0, v224
    v_max_f32 v225, 0, v225
    v_max_f32 v226, 0, v226
    v_max_f32 v227, 0, v227
    v_pk_mul_f32 v[220:221], v[220:221], v[228:229]
    v_pk_mul_f32 v[222:223], v[222:223], v[230:231]
    v_pk_mul_f32 v[224:225], v[224:225], v[232:233]
    v_pk_mul_f32 v[226:227], v[226:227], v[234:235]
    v_cvt_pk_bf16_f32 v16, v220, v221
    v_cvt_pk_bf16_f32 v17, v222, v223
    v_cvt_pk_bf16_f32 v18, v224, v225
    v_cvt_pk_bf16_f32 v19, v226, v227
    buffer_store_dwordx4 v[16:19], v202, s[32:35], s81 offen offset:0 sc1
    buffer_load_dwordx4 a[224:227], v194, s[32:35], s78 offen offset:1024 sc1
    ds_read_b128 v[128:131], v203 offset:128
    ds_read_b128 v[132:135], v203 offset:144
    ds_read_b128 v[136:139], v203 offset:384
    ds_read_b128 v[140:143], v203 offset:400
    ds_read_b128 v[144:147], v203 offset:640
    ds_read_b128 v[148:151], v203 offset:656
    ds_read_b128 v[152:155], v203 offset:896
    ds_read_b128 v[156:159], v203 offset:912
    s_waitcnt lgkmcnt(8)
    v_pk_fma_f32 v[204:205], v[198:199], v[160:161], v[168:169] op_sel:[1,0,0] op_sel_hi:[1,1,1]
    v_pk_fma_f32 v[212:213], v[198:199], v[176:177], v[184:185] op_sel:[1,0,0] op_sel_hi:[1,1,1]
    v_pk_fma_f32 v[206:207], v[198:199], v[162:163], v[170:171] op_sel:[1,0,0] op_sel_hi:[1,1,1]
    v_pk_fma_f32 v[214:215], v[198:199], v[178:179], v[186:187] op_sel:[1,0,0] op_sel_hi:[1,1,1]
    v_pk_fma_f32 v[208:209], v[198:199], v[164:165], v[172:173] op_sel:[1,0,0] op_sel_hi:[1,1,1]
    buffer_load_dwordx4 a[228:231], v194, s[32:35], s78 offen offset:2048 sc1
    v_pk_fma_f32 v[216:217], v[198:199], v[180:181], v[188:189] op_sel:[1,0,0] op_sel_hi:[1,1,1]
    v_pk_fma_f32 v[210:211], v[198:199], v[166:167], v[174:175] op_sel:[1,0,0] op_sel_hi:[1,1,1]
    v_pk_fma_f32 v[218:219], v[198:199], v[182:183], v[190:191] op_sel:[1,0,0] op_sel_hi:[1,1,1]
    v_pk_fma_f32 v[204:205], v[198:199], v[8:9], v[204:205] op_sel:[0,0,0] op_sel_hi:[0,1,1]
    v_pk_fma_f32 v[212:213], v[198:199], v[72:73], v[212:213] op_sel:[0,0,0] op_sel_hi:[0,1,1]
    v_pk_fma_f32 v[206:207], v[198:199], v[10:11], v[206:207] op_sel:[0,0,0] op_sel_hi:[0,1,1]
    v_pk_fma_f32 v[214:215], v[198:199], v[74:75], v[214:215] op_sel:[0,0,0] op_sel_hi:[0,1,1]
    v_pk_fma_f32 v[208:209], v[198:199], v[12:13], v[208:209] op_sel:[0,0,0] op_sel_hi:[0,1,1]
    v_pk_fma_f32 v[216:217], v[198:199], v[76:77], v[216:217] op_sel:[0,0,0] op_sel_hi:[0,1,1]
    v_pk_fma_f32 v[210:211], v[198:199], v[14:15], v[210:211] op_sel:[0,0,0] op_sel_hi:[0,1,1]
    v_pk_fma_f32 v[218:219], v[198:199], v[78:79], v[218:219] op_sel:[0,0,0] op_sel_hi:[0,1,1]
    v_max_f32 v204, 0, v204
    v_max_f32 v205, 0, v205
    v_max_f32 v206, 0, v206
    buffer_load_dwordx4 a[232:235], v194, s[32:35], s78 offen offset:3072 sc1
    v_max_f32 v207, 0, v207
    v_max_f32 v208, 0, v208
    v_max_f32 v209, 0, v209
    v_max_f32 v210, 0, v210
    v_max_f32 v211, 0, v211
    v_pk_mul_f32 v[204:205], v[204:205], v[212:213]
    v_pk_mul_f32 v[206:207], v[206:207], v[214:215]
    v_pk_mul_f32 v[208:209], v[208:209], v[216:217]
    v_pk_mul_f32 v[210:211], v[210:211], v[218:219]
    v_cvt_pk_bf16_f32 v8, v204, v205
    v_cvt_pk_bf16_f32 v9, v206, v207
    v_cvt_pk_bf16_f32 v10, v208, v209
    v_cvt_pk_bf16_f32 v11, v210, v211
    buffer_store_dwordx4 v[8:11], v202, s[32:35], s80 offen offset:512 sc1
    buffer_load_dwordx4 a[236:239], v248, s[32:35], s78 offen sc1
    v_pk_fma_f32 v[220:221], v[200:201], v[160:161], v[168:169] op_sel:[1,0,0] op_sel_hi:[1,1,1]
    v_pk_fma_f32 v[228:229], v[200:201], v[176:177], v[184:185] op_sel:[1,0,0] op_sel_hi:[1,1,1]
    v_pk_fma_f32 v[222:223], v[200:201], v[162:163], v[170:171] op_sel:[1,0,0] op_sel_hi:[1,1,1]
    v_pk_fma_f32 v[230:231], v[200:201], v[178:179], v[186:187] op_sel:[1,0,0] op_sel_hi:[1,1,1]
    v_pk_fma_f32 v[224:225], v[200:201], v[164:165], v[172:173] op_sel:[1,0,0] op_sel_hi:[1,1,1]
    v_pk_fma_f32 v[232:233], v[200:201], v[180:181], v[188:189] op_sel:[1,0,0] op_sel_hi:[1,1,1]
    v_pk_fma_f32 v[226:227], v[200:201], v[166:167], v[174:175] op_sel:[1,0,0] op_sel_hi:[1,1,1]
    v_pk_fma_f32 v[234:235], v[200:201], v[182:183], v[190:191] op_sel:[1,0,0] op_sel_hi:[1,1,1]
    v_pk_fma_f32 v[220:221], v[200:201], v[24:25], v[220:221] op_sel:[0,0,0] op_sel_hi:[0,1,1]
    v_pk_fma_f32 v[228:229], v[200:201], v[88:89], v[228:229] op_sel:[0,0,0] op_sel_hi:[0,1,1]
    v_pk_fma_f32 v[222:223], v[200:201], v[26:27], v[222:223] op_sel:[0,0,0] op_sel_hi:[0,1,1]
    v_pk_fma_f32 v[230:231], v[200:201], v[90:91], v[230:231] op_sel:[0,0,0] op_sel_hi:[0,1,1]
    v_pk_fma_f32 v[224:225], v[200:201], v[28:29], v[224:225] op_sel:[0,0,0] op_sel_hi:[0,1,1]
    s_add_u32 s78, s78, 5120
    v_pk_fma_f32 v[232:233], v[200:201], v[92:93], v[232:233] op_sel:[0,0,0] op_sel_hi:[0,1,1]
    v_pk_fma_f32 v[226:227], v[200:201], v[30:31], v[226:227] op_sel:[0,0,0] op_sel_hi:[0,1,1]
    v_pk_fma_f32 v[234:235], v[200:201], v[94:95], v[234:235] op_sel:[0,0,0] op_sel_hi:[0,1,1]
    v_max_f32 v220, 0, v220
    v_max_f32 v221, 0, v221
    v_max_f32 v222, 0, v222
    v_max_f32 v223, 0, v223
    v_max_f32 v224, 0, v224
    v_max_f32 v225, 0, v225
    v_max_f32 v226, 0, v226
    v_max_f32 v227, 0, v227
    v_pk_mul_f32 v[220:221], v[220:221], v[228:229]
    v_pk_mul_f32 v[222:223], v[222:223], v[230:231]
    v_pk_mul_f32 v[224:225], v[224:225], v[232:233]
    v_pk_mul_f32 v[226:227], v[226:227], v[234:235]
    v_cvt_pk_bf16_f32 v24, v220, v221
    v_cvt_pk_bf16_f32 v25, v222, v223
    v_cvt_pk_bf16_f32 v26, v224, v225
    v_cvt_pk_bf16_f32 v27, v226, v227
    buffer_store_dwordx4 v[24:27], v202, s[32:35], s81 offen offset:512 sc1
    ds_read_b128 v[160:163], v203 offset:192
    ds_read_b128 v[164:167], v203 offset:208
    ds_read_b128 v[168:171], v203 offset:448
    ds_read_b128 v[172:175], v203 offset:464
    ds_read_b128 v[176:179], v203 offset:704
    ds_read_b128 v[180:183], v203 offset:720
    ds_read_b128 v[184:187], v203 offset:960
    ds_read_b128 v[188:191], v203 offset:976
    s_waitcnt lgkmcnt(8)
    v_pk_fma_f32 v[204:205], v[198:199], v[128:129], v[136:137] op_sel:[1,0,0] op_sel_hi:[1,1,1]
    v_pk_fma_f32 v[212:213], v[198:199], v[144:145], v[152:153] op_sel:[1,0,0] op_sel_hi:[1,1,1]
    v_pk_fma_f32 v[206:207], v[198:199], v[130:131], v[138:139] op_sel:[1,0,0] op_sel_hi:[1,1,1]
    v_pk_fma_f32 v[214:215], v[198:199], v[146:147], v[154:155] op_sel:[1,0,0] op_sel_hi:[1,1,1]
    v_pk_fma_f32 v[208:209], v[198:199], v[132:133], v[140:141] op_sel:[1,0,0] op_sel_hi:[1,1,1]
    v_pk_fma_f32 v[216:217], v[198:199], v[148:149], v[156:157] op_sel:[1,0,0] op_sel_hi:[1,1,1]
    v_pk_fma_f32 v[210:211], v[198:199], v[134:135], v[142:143] op_sel:[1,0,0] op_sel_hi:[1,1,1]
    v_pk_fma_f32 v[218:219], v[198:199], v[150:151], v[158:159] op_sel:[1,0,0] op_sel_hi:[1,1,1]
    v_pk_fma_f32 v[204:205], v[198:199], v[32:33], v[204:205] op_sel:[0,0,0] op_sel_hi:[0,1,1]
    v_pk_fma_f32 v[212:213], v[198:199], v[96:97], v[212:213] op_sel:[0,0,0] op_sel_hi:[0,1,1]
    v_pk_fma_f32 v[206:207], v[198:199], v[34:35], v[206:207] op_sel:[0,0,0] op_sel_hi:[0,1,1]
    v_pk_fma_f32 v[214:215], v[198:199], v[98:99], v[214:215] op_sel:[0,0,0] op_sel_hi:[0,1,1]
    v_pk_fma_f32 v[208:209], v[198:199], v[36:37], v[208:209] op_sel:[0,0,0] op_sel_hi:[0,1,1]
    v_pk_fma_f32 v[216:217], v[198:199], v[100:101], v[216:217] op_sel:[0,0,0] op_sel_hi:[0,1,1]
    v_pk_fma_f32 v[210:211], v[198:199], v[38:39], v[210:211] op_sel:[0,0,0] op_sel_hi:[0,1,1]
    v_pk_fma_f32 v[218:219], v[198:199], v[102:103], v[218:219] op_sel:[0,0,0] op_sel_hi:[0,1,1]
    v_max_f32 v204, 0, v204
    v_max_f32 v205, 0, v205
    v_max_f32 v206, 0, v206
    v_max_f32 v207, 0, v207
    v_max_f32 v208, 0, v208
    v_max_f32 v209, 0, v209
    v_max_f32 v210, 0, v210
    v_max_f32 v211, 0, v211
    v_pk_mul_f32 v[204:205], v[204:205], v[212:213]
    v_pk_mul_f32 v[206:207], v[206:207], v[214:215]
    v_pk_mul_f32 v[208:209], v[208:209], v[216:217]
    v_pk_mul_f32 v[210:211], v[210:211], v[218:219]
    v_cvt_pk_bf16_f32 v32, v204, v205
    v_cvt_pk_bf16_f32 v33, v206, v207
    v_cvt_pk_bf16_f32 v34, v208, v209
    v_cvt_pk_bf16_f32 v35, v210, v211
    buffer_store_dwordx4 v[32:35], v202, s[32:35], s80 offen offset:1024 sc1
    v_pk_fma_f32 v[220:221], v[200:201], v[128:129], v[136:137] op_sel:[1,0,0] op_sel_hi:[1,1,1]
    v_pk_fma_f32 v[228:229], v[200:201], v[144:145], v[152:153] op_sel:[1,0,0] op_sel_hi:[1,1,1]
    v_pk_fma_f32 v[222:223], v[200:201], v[130:131], v[138:139] op_sel:[1,0,0] op_sel_hi:[1,1,1]
    v_pk_fma_f32 v[230:231], v[200:201], v[146:147], v[154:155] op_sel:[1,0,0] op_sel_hi:[1,1,1]
    v_pk_fma_f32 v[224:225], v[200:201], v[132:133], v[140:141] op_sel:[1,0,0] op_sel_hi:[1,1,1]
    v_pk_fma_f32 v[232:233], v[200:201], v[148:149], v[156:157] op_sel:[1,0,0] op_sel_hi:[1,1,1]
    v_pk_fma_f32 v[226:227], v[200:201], v[134:135], v[142:143] op_sel:[1,0,0] op_sel_hi:[1,1,1]
    v_pk_fma_f32 v[234:235], v[200:201], v[150:151], v[158:159] op_sel:[1,0,0] op_sel_hi:[1,1,1]
    v_pk_fma_f32 v[220:221], v[200:201], v[48:49], v[220:221] op_sel:[0,0,0] op_sel_hi:[0,1,1]
    v_pk_fma_f32 v[228:229], v[200:201], v[112:113], v[228:229] op_sel:[0,0,0] op_sel_hi:[0,1,1]
    v_pk_fma_f32 v[222:223], v[200:201], v[50:51], v[222:223] op_sel:[0,0,0] op_sel_hi:[0,1,1]
    v_pk_fma_f32 v[230:231], v[200:201], v[114:115], v[230:231] op_sel:[0,0,0] op_sel_hi:[0,1,1]
    v_pk_fma_f32 v[224:225], v[200:201], v[52:53], v[224:225] op_sel:[0,0,0] op_sel_hi:[0,1,1]
    v_pk_fma_f32 v[232:233], v[200:201], v[116:117], v[232:233] op_sel:[0,0,0] op_sel_hi:[0,1,1]
    v_pk_fma_f32 v[226:227], v[200:201], v[54:55], v[226:227] op_sel:[0,0,0] op_sel_hi:[0,1,1]
    v_pk_fma_f32 v[234:235], v[200:201], v[118:119], v[234:235] op_sel:[0,0,0] op_sel_hi:[0,1,1]
    v_max_f32 v220, 0, v220
    v_max_f32 v221, 0, v221
    v_max_f32 v222, 0, v222
    v_max_f32 v223, 0, v223
    v_max_f32 v224, 0, v224
    v_max_f32 v225, 0, v225
    v_max_f32 v226, 0, v226
    v_max_f32 v227, 0, v227
    v_pk_mul_f32 v[220:221], v[220:221], v[228:229]
    v_pk_mul_f32 v[222:223], v[222:223], v[230:231]
    v_pk_mul_f32 v[224:225], v[224:225], v[232:233]
    v_pk_mul_f32 v[226:227], v[226:227], v[234:235]
    v_cvt_pk_bf16_f32 v48, v220, v221
    v_cvt_pk_bf16_f32 v49, v222, v223
    v_cvt_pk_bf16_f32 v50, v224, v225
    v_cvt_pk_bf16_f32 v51, v226, v227
    buffer_store_dwordx4 v[48:51], v202, s[32:35], s81 offen offset:1024 sc1
    s_waitcnt lgkmcnt(0)
    v_pk_fma_f32 v[204:205], v[198:199], v[160:161], v[168:169] op_sel:[1,0,0] op_sel_hi:[1,1,1]
    v_pk_fma_f32 v[212:213], v[198:199], v[176:177], v[184:185] op_sel:[1,0,0] op_sel_hi:[1,1,1]
    v_pk_fma_f32 v[206:207], v[198:199], v[162:163], v[170:171] op_sel:[1,0,0] op_sel_hi:[1,1,1]
    v_pk_fma_f32 v[214:215], v[198:199], v[178:179], v[186:187] op_sel:[1,0,0] op_sel_hi:[1,1,1]
    v_pk_fma_f32 v[208:209], v[198:199], v[164:165], v[172:173] op_sel:[1,0,0] op_sel_hi:[1,1,1]
    v_pk_fma_f32 v[216:217], v[198:199], v[180:181], v[188:189] op_sel:[1,0,0] op_sel_hi:[1,1,1]
    v_pk_fma_f32 v[210:211], v[198:199], v[166:167], v[174:175] op_sel:[1,0,0] op_sel_hi:[1,1,1]
    v_pk_fma_f32 v[218:219], v[198:199], v[182:183], v[190:191] op_sel:[1,0,0] op_sel_hi:[1,1,1]
    v_pk_fma_f32 v[204:205], v[198:199], v[40:41], v[204:205] op_sel:[0,0,0] op_sel_hi:[0,1,1]
    v_pk_fma_f32 v[212:213], v[198:199], v[104:105], v[212:213] op_sel:[0,0,0] op_sel_hi:[0,1,1]
    v_pk_fma_f32 v[206:207], v[198:199], v[42:43], v[206:207] op_sel:[0,0,0] op_sel_hi:[0,1,1]
    v_pk_fma_f32 v[214:215], v[198:199], v[106:107], v[214:215] op_sel:[0,0,0] op_sel_hi:[0,1,1]
    v_pk_fma_f32 v[208:209], v[198:199], v[44:45], v[208:209] op_sel:[0,0,0] op_sel_hi:[0,1,1]
    v_pk_fma_f32 v[216:217], v[198:199], v[108:109], v[216:217] op_sel:[0,0,0] op_sel_hi:[0,1,1]
    v_pk_fma_f32 v[210:211], v[198:199], v[46:47], v[210:211] op_sel:[0,0,0] op_sel_hi:[0,1,1]
    v_pk_fma_f32 v[218:219], v[198:199], v[110:111], v[218:219] op_sel:[0,0,0] op_sel_hi:[0,1,1]
    v_max_f32 v204, 0, v204
    v_max_f32 v205, 0, v205
    v_max_f32 v206, 0, v206
    v_max_f32 v207, 0, v207
    v_max_f32 v208, 0, v208
    v_max_f32 v209, 0, v209
    v_max_f32 v210, 0, v210
    v_max_f32 v211, 0, v211
    v_pk_mul_f32 v[204:205], v[204:205], v[212:213]
    v_pk_mul_f32 v[206:207], v[206:207], v[214:215]
    v_pk_mul_f32 v[208:209], v[208:209], v[216:217]
    v_pk_mul_f32 v[210:211], v[210:211], v[218:219]
    v_cvt_pk_bf16_f32 v40, v204, v205
    v_cvt_pk_bf16_f32 v41, v206, v207
    v_cvt_pk_bf16_f32 v42, v208, v209
    v_cvt_pk_bf16_f32 v43, v210, v211
    buffer_store_dwordx4 v[40:43], v202, s[32:35], s80 offen offset:1536 sc1
    v_pk_fma_f32 v[220:221], v[200:201], v[160:161], v[168:169] op_sel:[1,0,0] op_sel_hi:[1,1,1]
    v_pk_fma_f32 v[228:229], v[200:201], v[176:177], v[184:185] op_sel:[1,0,0] op_sel_hi:[1,1,1]
    v_pk_fma_f32 v[222:223], v[200:201], v[162:163], v[170:171] op_sel:[1,0,0] op_sel_hi:[1,1,1]
    v_pk_fma_f32 v[230:231], v[200:201], v[178:179], v[186:187] op_sel:[1,0,0] op_sel_hi:[1,1,1]
    v_pk_fma_f32 v[224:225], v[200:201], v[164:165], v[172:173] op_sel:[1,0,0] op_sel_hi:[1,1,1]
    v_pk_fma_f32 v[232:233], v[200:201], v[180:181], v[188:189] op_sel:[1,0,0] op_sel_hi:[1,1,1]
    v_pk_fma_f32 v[226:227], v[200:201], v[166:167], v[174:175] op_sel:[1,0,0] op_sel_hi:[1,1,1]
    v_pk_fma_f32 v[234:235], v[200:201], v[182:183], v[190:191] op_sel:[1,0,0] op_sel_hi:[1,1,1]
    v_pk_fma_f32 v[220:221], v[200:201], v[56:57], v[220:221] op_sel:[0,0,0] op_sel_hi:[0,1,1]
    v_pk_fma_f32 v[228:229], v[200:201], v[120:121], v[228:229] op_sel:[0,0,0] op_sel_hi:[0,1,1]
    v_pk_fma_f32 v[222:223], v[200:201], v[58:59], v[222:223] op_sel:[0,0,0] op_sel_hi:[0,1,1]
    v_pk_fma_f32 v[230:231], v[200:201], v[122:123], v[230:231] op_sel:[0,0,0] op_sel_hi:[0,1,1]
    v_pk_fma_f32 v[224:225], v[200:201], v[60:61], v[224:225] op_sel:[0,0,0] op_sel_hi:[0,1,1]
    v_pk_fma_f32 v[232:233], v[200:201], v[124:125], v[232:233] op_sel:[0,0,0] op_sel_hi:[0,1,1]
    v_pk_fma_f32 v[226:227], v[200:201], v[62:63], v[226:227] op_sel:[0,0,0] op_sel_hi:[0,1,1]
    v_pk_fma_f32 v[234:235], v[200:201], v[126:127], v[234:235] op_sel:[0,0,0] op_sel_hi:[0,1,1]
    v_max_f32 v220, 0, v220
    v_max_f32 v221, 0, v221
    v_max_f32 v222, 0, v222
    v_max_f32 v223, 0, v223
    v_max_f32 v224, 0, v224
    v_max_f32 v225, 0, v225
    v_max_f32 v226, 0, v226
    v_max_f32 v227, 0, v227
    v_pk_mul_f32 v[220:221], v[220:221], v[228:229]
    v_pk_mul_f32 v[222:223], v[222:223], v[230:231]
    v_pk_mul_f32 v[224:225], v[224:225], v[232:233]
    v_pk_mul_f32 v[226:227], v[226:227], v[234:235]
    v_cvt_pk_bf16_f32 v56, v220, v221
    v_cvt_pk_bf16_f32 v57, v222, v223
    v_cvt_pk_bf16_f32 v58, v224, v225
    v_cvt_pk_bf16_f32 v59, v226, v227
    buffer_store_dwordx4 v[56:59], v202, s[32:35], s81 offen offset:1536 sc1
    v_mov_b32 v252, v194
    v_mov_b32 v253, v248
    buffer_load_dwordx4 v[128:131], v252, s[32:35], s78 offen sc1
    buffer_load_dwordx4 v[132:135], v252, s[32:35], s78 offen offset:1024 sc1
    buffer_load_dwordx4 v[136:139], v252, s[32:35], s78 offen offset:2048 sc1
    buffer_load_dwordx4 v[140:143], v252, s[32:35], s78 offen offset:3072 sc1
    buffer_load_dwordx4 v[144:147], v253, s[32:35], s78 offen sc1
    s_add_u32 s78, s78, 5120
    s_waitcnt vmcnt(5)
    s_barrier
    s_cmp_lg_u32 s64, 0
    s_cbranch_scc1 SIG_19
    s_mov_b64 exec, 1
    v_mov_b32 v250, s65
    v_mov_b32 v251, 0
    s_lshl_b32 s100, s84, 7
    s_add_u32 s100, s100, 753664
    buffer_store_dword v250, v251, s[32:35], s100 offen sc1
    s_mov_b64 exec, -1
SIG_19:
    s_branch P3_J2
P3_J1:
    s_mov_b32 s82, 395264
    s_mov_b32 s85, 100000
POLL_20:
    buffer_load_dwordx4 v[208:211], v194, s[32:35], s82 offen sc1
    s_waitcnt vmcnt(0)
    v_xor_b32 v208, s65, v208
    v_xor_b32 v209, s65, v209
    v_xor_b32 v210, s65, v210
    v_xor_b32 v211, s65, v211
    v_or_b32 v208, v208, v209
    v_or_b32 v208, v208, v210
    v_or_b32 v208, v208, v211
    v_cmp_ne_u32 vcc, 0, v208
    s_nop 1
    s_cbranch_vccz POLLD_21
    s_sub_u32 s85, s85, 1
    s_cbranch_scc1 F_END
    s_sleep 1
    s_branch POLL_20
POLLD_21:
    s_mul_i32 s74, s64, 14
    s_mul_i32 s78, s22, 54
    s_add_u32 s78, s78, s74
    s_mul_i32 s78, s78, 5120
    s_add_u32 s78, s78, 15728640
    v_add_u32 v248, 0x1000, v194
    buffer_load_dwordx4 a[80:83], v194, s[32:35], s78 offen sc1
    buffer_load_dwordx4 a[84:87], v194, s[32:35], s78 offen offset:1024 sc1
    buffer_load_dwordx4 a[88:91], v194, s[32:35], s78 offen offset:2048 sc1
    buffer_load_dwordx4 a[92:95], v194, s[32:35], s78 offen offset:3072 sc1
    buffer_load_dwordx4 a[96:99], v248, s[32:35], s78 offen sc1
    s_add_u32 s78, s78, 5120
    buffer_load_dwordx4 a[100:103], v194, s[32:35], s78 offen sc1
    buffer_load_dwordx4 a[104:107], v194, s[32:35], s78 offen offset:1024 sc1
    buffer_load_dwordx4 a[108:111], v194, s[32:35], s78 offen offset:2048 sc1
    buffer_load_dwordx4 a[112:115], v194, s[32:35], s78 offen offset:3072 sc1
    buffer_load_dwordx4 a[116:119], v248, s[32:35], s78 offen sc1
    s_add_u32 s78, s78, 5120
    buffer_load_dwordx4 a[120:123], v194, s[32:35], s78 offen sc1
    buffer_load_dwordx4 a[124:127], v194, s[32:35], s78 offen offset:1024 sc1
    buffer_load_dwordx4 a[128:131], v194, s[32:35], s78 offen offset:2048 sc1
    buffer_load_dwordx4 a[132:135], v194, s[32:35], s78 offen offset:3072 sc1
    buffer_load_dwordx4 a[136:139], v248, s[32:35], s78 offen sc1
    s_add_u32 s78, s78, 5120
    buffer_load_dwordx4 a[140:143], v194, s[32:35], s78 offen sc1
    buffer_load_dwordx4 a[144:147], v194, s[32:35], s78 offen offset:1024 sc1
    buffer_load_dwordx4 a[148:151], v194, s[32:35], s78 offen offset:2048 sc1
    buffer_load_dwordx4 a[152:155], v194, s[32:35], s78 offen offset:3072 sc1
    buffer_load_dwordx4 a[156:159], v248, s[32:35], s78 offen sc1
    s_add_u32 s78, s78, 5120
    buffer_load_dwordx4 a[160:163], v194, s[32:35], s78 offen sc1
    buffer_load_dwordx4 a[164:167], v194, s[32:35], s78 offen offset:1024 sc1
    buffer_load_dwordx4 a[168:171], v194, s[32:35], s78 offen offset:2048 sc1
    buffer_load_dwordx4 a[172:175], v194, s[32:35], s78 offen offset:3072 sc1
    buffer_load_dwordx4 a[176:179], v248, s[32:35], s78 offen sc1
    s_add_u32 s78, s78, 5120
    buffer_load_dwordx4 a[180:183], v194, s[32:35], s78 offen sc1
    buffer_load_dwordx4 a[184:187], v194, s[32:35], s78 offen offset:1024 sc1
    buffer_load_dwordx4 a[188:191], v194, s[32:35], s78 offen offset:2048 sc1
    buffer_load_dwordx4 a[192:195], v194, s[32:35], s78 offen offset:3072 sc1
    buffer_load_dwordx4 a[196:199], v248, s[32:35], s78 offen sc1
    s_add_u32 s78, s78, 5120
    buffer_load_dwordx4 a[200:203], v194, s[32:35], s78 offen sc1
    buffer_load_dwordx4 a[204:207], v194, s[32:35], s78 offen offset:1024 sc1
    buffer_load_dwordx4 a[208:211], v194, s[32:35], s78 offen offset:2048 sc1
    buffer_load_dwordx4 a[212:215], v194, s[32:35], s78 offen offset:3072 sc1
    buffer_load_dwordx4 a[216:219], v248, s[32:35], s78 offen sc1
    s_add_u32 s78, s78, 5120
    buffer_load_dwordx4 a[220:223], v194, s[32:35], s78 offen sc1
    buffer_load_dwordx4 a[224:227], v194, s[32:35], s78 offen offset:1024 sc1
    buffer_load_dwordx4 a[228:231], v194, s[32:35], s78 offen offset:2048 sc1
    buffer_load_dwordx4 a[232:235], v194, s[32:35], s78 offen offset:3072 sc1
    buffer_load_dwordx4 a[236:239], v248, s[32:35], s78 offen sc1
    s_add_u32 s78, s78, 5120
    v_mov_b32 v252, v194
    v_mov_b32 v253, v248
    buffer_load_dwordx4 v[128:131], v252, s[32:35], s78 offen sc1
    buffer_load_dwordx4 v[132:135], v252, s[32:35], s78 offen offset:1024 sc1
    buffer_load_dwordx4 v[136:139], v252, s[32:35], s78 offen offset:2048 sc1
    buffer_load_dwordx4 v[140:143], v252, s[32:35], s78 offen offset:3072 sc1
    buffer_load_dwordx4 v[144:147], v253, s[32:35], s78 offen sc1
    s_add_u32 s78, s78, 5120
P3_J2:
    buffer_load_dwordx4 v[148:151], v252, s[32:35], s78 offen sc1
    buffer_load_dwordx4 v[152:155], v252, s[32:35], s78 offen offset:1024 sc1
    buffer_load_dwordx4 v[156:159], v252, s[32:35], s78 offen offset:2048 sc1
    buffer_load_dwordx4 v[160:163], v252, s[32:35], s78 offen offset:3072 sc1
    buffer_load_dwordx4 v[164:167], v253, s[32:35], s78 offen sc1
    s_add_u32 s78, s78, 5120
    buffer_load_dwordx4 v[168:171], v252, s[32:35], s78 offen sc1
    buffer_load_dwordx4 v[172:175], v252, s[32:35], s78 offen offset:1024 sc1
    buffer_load_dwordx4 v[176:179], v252, s[32:35], s78 offen offset:2048 sc1
    buffer_load_dwordx4 v[180:183], v252, s[32:35], s78 offen offset:3072 sc1
    buffer_load_dwordx4 v[184:187], v253, s[32:35], s78 offen sc1
    s_add_u32 s78, s78, 5120
    buffer_load_dwordx4 v[188:191], v252, s[32:35], s78 offen sc1
    buffer_load_dwordx4 v[192:195], v252, s[32:35], s78 offen offset:1024 sc1
    buffer_load_dwordx4 v[196:199], v252, s[32:35], s78 offen offset:2048 sc1
    buffer_load_dwordx4 v[200:203], v252, s[32:35], s78 offen offset:3072 sc1
    buffer_load_dwordx4 v[204:207], v253, s[32:35], s78 offen sc1
    s_add_u32 s78, s78, 5120
    s_cmp_eq_u32 s64, 3
    s_cselect_b32 s79, 0x7fff0000, s78
    buffer_load_dwordx4 v[208:211], v252, s[32:35], s79 offen sc1
    buffer_load_dwordx4 v[212:215], v252, s[32:35], s79 offen offset:1024 sc1
    buffer_load_dwordx4 v[216:219], v252, s[32:35], s79 offen offset:2048 sc1
    buffer_load_dwordx4 v[220:223], v252, s[32:35], s79 offen offset:3072 sc1
    buffer_load_dwordx4 v[224:227], v253, s[32:35], s79 offen sc1
    s_add_u32 s79, s79, 5120
    buffer_load_dwordx4 v[228:231], v252, s[32:35], s79 offen sc1
    buffer_load_dwordx4 v[232:235], v252, s[32:35], s79 offen offset:1024 sc1
    buffer_load_dwordx4 v[236:239], v252, s[32:35], s79 offen offset:2048 sc1
    buffer_load_dwordx4 v[240:243], v252, s[32:35], s79 offen offset:3072 sc1
    buffer_load_dwordx4 v[244:247], v253, s[32:35], s79 offen sc1
    s_add_u32 s79, s79, 5120
    v_mov_b32 v0, v252
    v_add_u32 v1, 55296, v0
    v_add_u32 v2, 110592, v0
    v_add_u32 v3, 165888, v0
    s_lshl_b32 s80, s64, 6
    v_lshrrev_b32 v6, 4, v0
    v_add_u32 v6, s80, v6
    v_bfe_u32 v28, v0, 4, 4
    s_lshl_b32 s80, s64, 4
    v_add_u32 v28, s80, v28
    v_lshrrev_b32 v29, 8, v0
    v_and_b32 v30, 1, v29
    v_lshrrev_b32 v31, 1, v29
    v_mul_u32_u24 v8, 1280, v28
    v_lshl_add_u32 v7, v29, 3, v8
    v_lshlrev_b32 v13, 4, v29
    v_add_u32 v13, 136448, v13
    s_mul_i32 s80, s64, 20480
    v_add_u32 v12, s80, v0
    s_mul_i32 s80, s64, 5120
    v_add_u32 v14, s80, v0
    v_add_u32 v15, 61440, v14
    v_lshl_add_u32 v8, v30, 5, v8
    v_lshl_add_u32 v8, v31, 4, v8
    v_accvgpr_read_b32 v16, a240
    v_accvgpr_read_b32 v17, a241
    v_accvgpr_read_b32 v18, a242
    v_accvgpr_read_b32 v19, a243
    v_accvgpr_read_b32 v20, a244
    v_accvgpr_read_b32 v21, a245
    v_accvgpr_read_b32 v22, a246
    v_accvgpr_read_b32 v23, a247
    v_accvgpr_read_b32 v24, a248
    v_accvgpr_read_b32 v25, a249
    s_mov_b32 s36, s26
    s_mov_b32 s37, s27
    s_mov_b32 s38, 0x280000
    s_mov_b32 s39, 0x20000
    s_mul_i32 s73, s23, 81920
    s_mul_i32 s74, s22, 160
    s_add_u32 s73, s73, s74
    s_mul_i32 s80, s64, 14
    s_mul_i32 s68, s23, 216
    s_add_u32 s68, s68, s80
    s_lshl_b32 s68, s68, 10
    s_add_u32 s68, s68, 18874368
    s_add_u32 s69, s68, 12288
    s_cmp_eq_u32 s64, 3
    s_cselect_b32 s69, 0x7fff0000, s69
    s_lshr_b32 s80, s23, 2
    s_lshl_b32 s80, s80, 12
    s_add_u32 s80, s80, 753664
    v_lshlrev_b32 v28, 3, v0
    v_min_u32 v28, 3328, v28
    s_waitcnt vmcnt(0)
    s_cmp_lg_u32 s64, 0
    s_cbranch_scc1 POLLD_23
    s_mov_b32 s85, 100000
POLL_22:
    buffer_load_dword v29, v28, s[32:35], s80 offen sc1
    s_waitcnt vmcnt(0)
    v_xor_b32 v29, s65, v29
    v_cmp_ne_u32 vcc, 0, v29
    s_nop 1
    s_cbranch_vccz POLLD_23
    s_sub_u32 s85, s85, 1
    s_cbranch_scc1 F_END
    s_sleep 1
    s_branch POLL_22
POLLD_23:
    s_barrier
    buffer_load_dwordx4 v[32:35], v0, s[32:35], s68 offen sc1
    buffer_load_dwordx4 v[36:39], v1, s[32:35], s68 offen sc1
    buffer_load_dwordx4 v[40:43], v2, s[32:35], s68 offen sc1
    buffer_load_dwordx4 v[44:47], v3, s[32:35], s68 offen sc1
    buffer_load_dwordx4 v[48:51], v0, s[32:35], s68 offen offset:1024 sc1
    buffer_load_dwordx4 v[52:55], v1, s[32:35], s68 offen offset:1024 sc1
    buffer_load_dwordx4 v[56:59], v2, s[32:35], s68 offen offset:1024 sc1
    buffer_load_dwordx4 v[60:63], v3, s[32:35], s68 offen offset:1024 sc1
    s_waitcnt vmcnt(4)
    v_mfma_f32_16x16x32_bf16 a[0:3], a[80:83], v[32:35], 0
    v_mfma_f32_16x16x32_bf16 a[4:7], a[80:83], v[36:39], 0
    buffer_load_dwordx4 v[64:67], v0, s[32:35], s68 offen offset:2048 sc1
    v_mfma_f32_16x16x32_bf16 a[8:11], a[80:83], v[40:43], 0
    v_mfma_f32_16x16x32_bf16 a[12:15], a[80:83], v[44:47], 0
    buffer_load_dwordx4 v[68:71], v1, s[32:35], s68 offen offset:2048 sc1
    v_mfma_f32_16x16x32_bf16 a[16:19], a[84:87], v[32:35], 0
    v_mfma_f32_16x16x32_bf16 a[20:23], a[84:87], v[36:39], 0
    buffer_load_dwordx4 v[72:75], v2, s[32:35], s68 offen offset:2048 sc1
    v_mfma_f32_16x16x32_bf16 a[24:27], a[84:87], v[40:43], 0
    v_mfma_f32_16x16x32_bf16 a[28:31], a[84:87], v[44:47], 0
    buffer_load_dwordx4 v[76:79], v3, s[32:35], s68 offen offset:2048 sc1
    v_mfma_f32_16x16x32_bf16 a[32:35], a[88:91], v[32:35], 0
    v_mfma_f32_16x16x32_bf16 a[36:39], a[88:91], v[36:39], 0
    buffer_load_dwordx4 v[80:83], v0, s[32:35], s68 offen offset:3072 sc1
    v_mfma_f32_16x16x32_bf16 a[40:43], a[88:91], v[40:43], 0
    v_mfma_f32_16x16x32_bf16 a[44:47], a[88:91], v[44:47], 0
    buffer_load_dwordx4 v[84:87], v1, s[32:35], s68 offen offset:3072 sc1
    v_mfma_f32_16x16x32_bf16 a[48:51], a[92:95], v[32:35], 0
    v_mfma_f32_16x16x32_bf16 a[52:55], a[92:95], v[36:39], 0
    buffer_load_dwordx4 v[88:91], v2, s[32:35], s68 offen offset:3072 sc1
    v_mfma_f32_16x16x32_bf16 a[56:59], a[92:95], v[40:43], 0
    v_mfma_f32_16x16x32_bf16 a[60:63], a[92:95], v[44:47], 0
    buffer_load_dwordx4 v[92:95], v3, s[32:35], s68 offen offset:3072 sc1
    v_mfma_f32_16x16x32_bf16 a[64:67], a[96:99], v[32:35], 0
    v_mfma_f32_16x16x32_bf16 a[68:71], a[96:99], v[36:39], 0
    s_add_u32 s68, s68, 4096
    v_mfma_f32_16x16x32_bf16 a[72:75], a[96:99], v[40:43], 0
    v_mfma_f32_16x16x32_bf16 a[76:79], a[96:99], v[44:47], 0
    s_waitcnt vmcnt(8)
    v_mfma_f32_16x16x32_bf16 a[0:3], a[100:103], v[48:51], a[0:3]
    v_mfma_f32_16x16x32_bf16 a[4:7], a[100:103], v[52:55], a[4:7]
    buffer_load_dwordx4 v[96:99], v0, s[32:35], s68 offen sc1
    v_mfma_f32_16x16x32_bf16 a[8:11], a[100:103], v[56:59], a[8:11]
    v_mfma_f32_16x16x32_bf16 a[12:15], a[100:103], v[60:63], a[12:15]
    buffer_load_dwordx4 v[100:103], v1, s[32:35], s68 offen sc1
    v_mfma_f32_16x16x32_bf16 a[16:19], a[104:107], v[48:51], a[16:19]
    v_mfma_f32_16x16x32_bf16 a[20:23], a[104:107], v[52:55], a[20:23]
    buffer_load_dwordx4 v[104:107], v2, s[32:35], s68 offen sc1
    v_mfma_f32_16x16x32_bf16 a[24:27], a[104:107], v[56:59], a[24:27]
    v_mfma_f32_16x16x32_bf16 a[28:31], a[104:107], v[60:63], a[28:31]
    buffer_load_dwordx4 v[108:111], v3, s[32:35], s68 offen sc1
    v_mfma_f32_16x16x32_bf16 a[32:35], a[108:111], v[48:51], a[32:35]
    v_mfma_f32_16x16x32_bf16 a[36:39], a[108:111], v[52:55], a[36:39]
    buffer_load_dwordx4 v[112:115], v0, s[32:35], s68 offen offset:1024 sc1
    v_mfma_f32_16x16x32_bf16 a[40:43], a[108:111], v[56:59], a[40:43]
    v_mfma_f32_16x16x32_bf16 a[44:47], a[108:111], v[60:63], a[44:47]
    buffer_load_dwordx4 v[116:119], v1, s[32:35], s68 offen offset:1024 sc1
    v_mfma_f32_16x16x32_bf16 a[48:51], a[112:115], v[48:51], a[48:51]
    v_mfma_f32_16x16x32_bf16 a[52:55], a[112:115], v[52:55], a[52:55]
    buffer_load_dwordx4 v[120:123], v2, s[32:35], s68 offen offset:1024 sc1
    v_mfma_f32_16x16x32_bf16 a[56:59], a[112:115], v[56:59], a[56:59]
    v_mfma_f32_16x16x32_bf16 a[60:63], a[112:115], v[60:63], a[60:63]
    buffer_load_dwordx4 v[124:127], v3, s[32:35], s68 offen offset:1024 sc1
    v_mfma_f32_16x16x32_bf16 a[64:67], a[116:119], v[48:51], a[64:67]
    v_mfma_f32_16x16x32_bf16 a[68:71], a[116:119], v[52:55], a[68:71]
    v_mfma_f32_16x16x32_bf16 a[72:75], a[116:119], v[56:59], a[72:75]
    v_mfma_f32_16x16x32_bf16 a[76:79], a[116:119], v[60:63], a[76:79]
    s_waitcnt vmcnt(12)
    v_mfma_f32_16x16x32_bf16 a[0:3], a[120:123], v[64:67], a[0:3]
    v_mfma_f32_16x16x32_bf16 a[4:7], a[120:123], v[68:71], a[4:7]
    buffer_load_dwordx4 v[32:35], v0, s[32:35], s68 offen offset:2048 sc1
    v_mfma_f32_16x16x32_bf16 a[8:11], a[120:123], v[72:75], a[8:11]
    v_mfma_f32_16x16x32_bf16 a[12:15], a[120:123], v[76:79], a[12:15]
    buffer_load_dwordx4 v[36:39], v1, s[32:35], s68 offen offset:2048 sc1
    v_mfma_f32_16x16x32_bf16 a[16:19], a[124:127], v[64:67], a[16:19]
    v_mfma_f32_16x16x32_bf16 a[20:23], a[124:127], v[68:71], a[20:23]
    buffer_load_dwordx4 v[40:43], v2, s[32:35], s68 offen offset:2048 sc1
    v_mfma_f32_16x16x32_bf16 a[24:27], a[124:127], v[72:75], a[24:27]
    v_mfma_f32_16x16x32_bf16 a[28:31], a[124:127], v[76:79], a[28:31]
    buffer_load_dwordx4 v[44:47], v3, s[32:35], s68 offen offset:2048 sc1
    v_mfma_f32_16x16x32_bf16 a[32:35], a[128:131], v[64:67], a[32:35]
    v_mfma_f32_16x16x32_bf16 a[36:39], a[128:131], v[68:71], a[36:39]
    v_mfma_f32_16x16x32_bf16 a[40:43], a[128:131], v[72:75], a[40:43]
    v_mfma_f32_16x16x32_bf16 a[44:47], a[128:131], v[76:79], a[44:47]
    v_mfma_f32_16x16x32_bf16 a[48:51], a[132:135], v[64:67], a[48:51]
    v_mfma_f32_16x16x32_bf16 a[52:55], a[132:135], v[68:71], a[52:55]
    v_mfma_f32_16x16x32_bf16 a[56:59], a[132:135], v[72:75], a[56:59]
    v_mfma_f32_16x16x32_bf16 a[60:63], a[132:135], v[76:79], a[60:63]
    v_mfma_f32_16x16x32_bf16 a[64:67], a[136:139], v[64:67], a[64:67]
    v_mfma_f32_16x16x32_bf16 a[68:71], a[136:139], v[68:71], a[68:71]
    v_mfma_f32_16x16x32_bf16 a[72:75], a[136:139], v[72:75], a[72:75]
    v_mfma_f32_16x16x32_bf16 a[76:79], a[136:139], v[76:79], a[76:79]
    s_waitcnt vmcnt(12)
    v_mfma_f32_16x16x32_bf16 a[0:3], a[140:143], v[80:83], a[0:3]
    v_mfma_f32_16x16x32_bf16 a[4:7], a[140:143], v[84:87], a[4:7]
    buffer_load_dwordx4 v[48:51], v0, s[32:35], s68 offen offset:3072 sc1
    v_mfma_f32_16x16x32_bf16 a[8:11], a[140:143], v[88:91], a[8:11]
    v_mfma_f32_16x16x32_bf16 a[12:15], a[140:143], v[92:95], a[12:15]
    buffer_load_dwordx4 v[52:55], v1, s[32:35], s68 offen offset:3072 sc1
    v_mfma_f32_16x16x32_bf16 a[16:19], a[144:147], v[80:83], a[16:19]
    v_mfma_f32_16x16x32_bf16 a[20:23], a[144:147], v[84:87], a[20:23]
    buffer_load_dwordx4 v[56:59], v2, s[32:35], s68 offen offset:3072 sc1
    v_mfma_f32_16x16x32_bf16 a[24:27], a[144:147], v[88:91], a[24:27]
    v_mfma_f32_16x16x32_bf16 a[28:31], a[144:147], v[92:95], a[28:31]
    buffer_load_dwordx4 v[60:63], v3, s[32:35], s68 offen offset:3072 sc1
    v_mfma_f32_16x16x32_bf16 a[32:35], a[148:151], v[80:83], a[32:35]
    v_mfma_f32_16x16x32_bf16 a[36:39], a[148:151], v[84:87], a[36:39]
    s_add_u32 s68, s68, 4096
    v_mfma_f32_16x16x32_bf16 a[40:43], a[148:151], v[88:91], a[40:43]
    v_mfma_f32_16x16x32_bf16 a[44:47], a[148:151], v[92:95], a[44:47]
    v_mfma_f32_16x16x32_bf16 a[48:51], a[152:155], v[80:83], a[48:51]
    v_mfma_f32_16x16x32_bf16 a[52:55], a[152:155], v[84:87], a[52:55]
    v_mfma_f32_16x16x32_bf16 a[56:59], a[152:155], v[88:91], a[56:59]
    v_mfma_f32_16x16x32_bf16 a[60:63], a[152:155], v[92:95], a[60:63]
    v_mfma_f32_16x16x32_bf16 a[64:67], a[156:159], v[80:83], a[64:67]
    v_mfma_f32_16x16x32_bf16 a[68:71], a[156:159], v[84:87], a[68:71]
    v_mfma_f32_16x16x32_bf16 a[72:75], a[156:159], v[88:91], a[72:75]
    v_mfma_f32_16x16x32_bf16 a[76:79], a[156:159], v[92:95], a[76:79]
    s_waitcnt vmcnt(12)
    v_mfma_f32_16x16x32_bf16 a[0:3], a[160:163], v[96:99], a[0:3]
    v_mfma_f32_16x16x32_bf16 a[4:7], a[160:163], v[100:103], a[4:7]
    buffer_load_dwordx4 v[64:67], v0, s[32:35], s68 offen sc1
    v_mfma_f32_16x16x32_bf16 a[8:11], a[160:163], v[104:107], a[8:11]
    v_mfma_f32_16x16x32_bf16 a[12:15], a[160:163], v[108:111], a[12:15]
    buffer_load_dwordx4 v[68:71], v1, s[32:35], s68 offen sc1
    v_mfma_f32_16x16x32_bf16 a[16:19], a[164:167], v[96:99], a[16:19]
    v_mfma_f32_16x16x32_bf16 a[20:23], a[164:167], v[100:103], a[20:23]
    buffer_load_dwordx4 v[72:75], v2, s[32:35], s68 offen sc1
    v_mfma_f32_16x16x32_bf16 a[24:27], a[164:167], v[104:107], a[24:27]
    v_mfma_f32_16x16x32_bf16 a[28:31], a[164:167], v[108:111], a[28:31]
    buffer_load_dwordx4 v[76:79], v3, s[32:35], s68 offen sc1
    v_mfma_f32_16x16x32_bf16 a[32:35], a[168:171], v[96:99], a[32:35]
    v_mfma_f32_16x16x32_bf16 a[36:39], a[168:171], v[100:103], a[36:39]
    v_mfma_f32_16x16x32_bf16 a[40:43], a[168:171], v[104:107], a[40:43]
    v_mfma_f32_16x16x32_bf16 a[44:47], a[168:171], v[108:111], a[44:47]
    v_mfma_f32_16x16x32_bf16 a[48:51], a[172:175], v[96:99], a[48:51]
    v_mfma_f32_16x16x32_bf16 a[52:55], a[172:175], v[100:103], a[52:55]
    v_mfma_f32_16x16x32_bf16 a[56:59], a[172:175], v[104:107], a[56:59]
    v_mfma_f32_16x16x32_bf16 a[60:63], a[172:175], v[108:111], a[60:63]
    v_mfma_f32_16x16x32_bf16 a[64:67], a[176:179], v[96:99], a[64:67]
    v_mfma_f32_16x16x32_bf16 a[68:71], a[176:179], v[100:103], a[68:71]
    v_mfma_f32_16x16x32_bf16 a[72:75], a[176:179], v[104:107], a[72:75]
    v_mfma_f32_16x16x32_bf16 a[76:79], a[176:179], v[108:111], a[76:79]
    s_waitcnt vmcnt(12)
    v_mfma_f32_16x16x32_bf16 a[0:3], a[180:183], v[112:115], a[0:3]
    v_mfma_f32_16x16x32_bf16 a[4:7], a[180:183], v[116:119], a[4:7]
    buffer_load_dwordx4 v[80:83], v0, s[32:35], s68 offen offset:1024 sc1
    v_mfma_f32_16x16x32_bf16 a[8:11], a[180:183], v[120:123], a[8:11]
    v_mfma_f32_16x16x32_bf16 a[12:15], a[180:183], v[124:127], a[12:15]
    buffer_load_dwordx4 v[84:87], v1, s[32:35], s68 offen offset:1024 sc1
    v_mfma_f32_16x16x32_bf16 a[16:19], a[184:187], v[112:115], a[16:19]
    v_mfma_f32_16x16x32_bf16 a[20:23], a[184:187], v[116:119], a[20:23]
    buffer_load_dwordx4 v[88:91], v2, s[32:35], s68 offen offset:1024 sc1
    v_mfma_f32_16x16x32_bf16 a[24:27], a[184:187], v[120:123], a[24:27]
    v_mfma_f32_16x16x32_bf16 a[28:31], a[184:187], v[124:127], a[28:31]
    buffer_load_dwordx4 v[92:95], v3, s[32:35], s68 offen offset:1024 sc1
    v_mfma_f32_16x16x32_bf16 a[32:35], a[188:191], v[112:115], a[32:35]
    v_mfma_f32_16x16x32_bf16 a[36:39], a[188:191], v[116:119], a[36:39]
    v_mfma_f32_16x16x32_bf16 a[40:43], a[188:191], v[120:123], a[40:43]
    v_mfma_f32_16x16x32_bf16 a[44:47], a[188:191], v[124:127], a[44:47]
    v_mfma_f32_16x16x32_bf16 a[48:51], a[192:195], v[112:115], a[48:51]
    v_mfma_f32_16x16x32_bf16 a[52:55], a[192:195], v[116:119], a[52:55]
    v_mfma_f32_16x16x32_bf16 a[56:59], a[192:195], v[120:123], a[56:59]
    v_mfma_f32_16x16x32_bf16 a[60:63], a[192:195], v[124:127], a[60:63]
    v_mfma_f32_16x16x32_bf16 a[64:67], a[196:199], v[112:115], a[64:67]
    v_mfma_f32_16x16x32_bf16 a[68:71], a[196:199], v[116:119], a[68:71]
    v_mfma_f32_16x16x32_bf16 a[72:75], a[196:199], v[120:123], a[72:75]
    v_mfma_f32_16x16x32_bf16 a[76:79], a[196:199], v[124:127], a[76:79]
    s_waitcnt vmcnt(12)
    v_mfma_f32_16x16x32_bf16 a[0:3], a[200:203], v[32:35], a[0:3]
    v_mfma_f32_16x16x32_bf16 a[4:7], a[200:203], v[36:39], a[4:7]
    buffer_load_dwordx4 v[96:99], v0, s[32:35], s68 offen offset:2048 sc1
    v_mfma_f32_16x16x32_bf16 a[8:11], a[200:203], v[40:43], a[8:11]
    v_mfma_f32_16x16x32_bf16 a[12:15], a[200:203], v[44:47], a[12:15]
    buffer_load_dwordx4 v[100:103], v1, s[32:35], s68 offen offset:2048 sc1
    v_mfma_f32_16x16x32_bf16 a[16:19], a[204:207], v[32:35], a[16:19]
    v_mfma_f32_16x16x32_bf16 a[20:23], a[204:207], v[36:39], a[20:23]
    buffer_load_dwordx4 v[104:107], v2, s[32:35], s68 offen offset:2048 sc1
    v_mfma_f32_16x16x32_bf16 a[24:27], a[204:207], v[40:43], a[24:27]
    v_mfma_f32_16x16x32_bf16 a[28:31], a[204:207], v[44:47], a[28:31]
    buffer_load_dwordx4 v[108:111], v3, s[32:35], s68 offen offset:2048 sc1
    v_mfma_f32_16x16x32_bf16 a[32:35], a[208:211], v[32:35], a[32:35]
    v_mfma_f32_16x16x32_bf16 a[36:39], a[208:211], v[36:39], a[36:39]
    v_mfma_f32_16x16x32_bf16 a[40:43], a[208:211], v[40:43], a[40:43]
    v_mfma_f32_16x16x32_bf16 a[44:47], a[208:211], v[44:47], a[44:47]
    v_mfma_f32_16x16x32_bf16 a[48:51], a[212:215], v[32:35], a[48:51]
    v_mfma_f32_16x16x32_bf16 a[52:55], a[212:215], v[36:39], a[52:55]
    v_mfma_f32_16x16x32_bf16 a[56:59], a[212:215], v[40:43], a[56:59]
    v_mfma_f32_16x16x32_bf16 a[60:63], a[212:215], v[44:47], a[60:63]
    v_mfma_f32_16x16x32_bf16 a[64:67], a[216:219], v[32:35], a[64:67]
    v_mfma_f32_16x16x32_bf16 a[68:71], a[216:219], v[36:39], a[68:71]
    v_mfma_f32_16x16x32_bf16 a[72:75], a[216:219], v[40:43], a[72:75]
    v_mfma_f32_16x16x32_bf16 a[76:79], a[216:219], v[44:47], a[76:79]
    s_waitcnt vmcnt(12)
    v_mfma_f32_16x16x32_bf16 a[0:3], a[220:223], v[48:51], a[0:3]
    v_mfma_f32_16x16x32_bf16 a[4:7], a[220:223], v[52:55], a[4:7]
    buffer_load_dwordx4 v[112:115], v0, s[32:35], s68 offen offset:3072 sc1
    v_mfma_f32_16x16x32_bf16 a[8:11], a[220:223], v[56:59], a[8:11]
    v_mfma_f32_16x16x32_bf16 a[12:15], a[220:223], v[60:63], a[12:15]
    buffer_load_dwordx4 v[116:119], v1, s[32:35], s68 offen offset:3072 sc1
    v_mfma_f32_16x16x32_bf16 a[16:19], a[224:227], v[48:51], a[16:19]
    v_mfma_f32_16x16x32_bf16 a[20:23], a[224:227], v[52:55], a[20:23]
    buffer_load_dwordx4 v[120:123], v2, s[32:35], s68 offen offset:3072 sc1
    v_mfma_f32_16x16x32_bf16 a[24:27], a[224:227], v[56:59], a[24:27]
    v_mfma_f32_16x16x32_bf16 a[28:31], a[224:227], v[60:63], a[28:31]
    buffer_load_dwordx4 v[124:127], v3, s[32:35], s68 offen offset:3072 sc1
    v_mfma_f32_16x16x32_bf16 a[32:35], a[228:231], v[48:51], a[32:35]
    v_mfma_f32_16x16x32_bf16 a[36:39], a[228:231], v[52:55], a[36:39]
    s_add_u32 s68, s68, 4096
    v_mfma_f32_16x16x32_bf16 a[40:43], a[228:231], v[56:59], a[40:43]
    v_mfma_f32_16x16x32_bf16 a[44:47], a[228:231], v[60:63], a[44:47]
    v_mfma_f32_16x16x32_bf16 a[48:51], a[232:235], v[48:51], a[48:51]
    v_mfma_f32_16x16x32_bf16 a[52:55], a[232:235], v[52:55], a[52:55]
    v_mfma_f32_16x16x32_bf16 a[56:59], a[232:235], v[56:59], a[56:59]
    v_mfma_f32_16x16x32_bf16 a[60:63], a[232:235], v[60:63], a[60:63]
    v_mfma_f32_16x16x32_bf16 a[64:67], a[236:239], v[48:51], a[64:67]
    v_mfma_f32_16x16x32_bf16 a[68:71], a[236:239], v[52:55], a[68:71]
    v_mfma_f32_16x16x32_bf16 a[72:75], a[236:239], v[56:59], a[72:75]
    v_mfma_f32_16x16x32_bf16 a[76:79], a[236:239], v[60:63], a[76:79]
    s_waitcnt vmcnt(12)
    v_mfma_f32_16x16x32_bf16 a[0:3], v[128:131], v[64:67], a[0:3]
    v_mfma_f32_16x16x32_bf16 a[4:7], v[128:131], v[68:71], a[4:7]
    buffer_load_dwordx4 v[32:35], v0, s[32:35], s69 offen sc1
    v_mfma_f32_16x16x32_bf16 a[8:11], v[128:131], v[72:75], a[8:11]
    v_mfma_f32_16x16x32_bf16 a[12:15], v[128:131], v[76:79], a[12:15]
    buffer_load_dwordx4 v[36:39], v1, s[32:35], s69 offen sc1
    v_mfma_f32_16x16x32_bf16 a[16:19], v[132:135], v[64:67], a[16:19]
    v_mfma_f32_16x16x32_bf16 a[20:23], v[132:135], v[68:71], a[20:23]
    buffer_load_dwordx4 v[40:43], v2, s[32:35], s69 offen sc1
    v_mfma_f32_16x16x32_bf16 a[24:27], v[132:135], v[72:75], a[24:27]
    v_mfma_f32_16x16x32_bf16 a[28:31], v[132:135], v[76:79], a[28:31]
    buffer_load_dwordx4 v[44:47], v3, s[32:35], s69 offen sc1
    v_mfma_f32_16x16x32_bf16 a[32:35], v[136:139], v[64:67], a[32:35]
    v_mfma_f32_16x16x32_bf16 a[36:39], v[136:139], v[68:71], a[36:39]
    v_mfma_f32_16x16x32_bf16 a[40:43], v[136:139], v[72:75], a[40:43]
    v_mfma_f32_16x16x32_bf16 a[44:47], v[136:139], v[76:79], a[44:47]
    v_mfma_f32_16x16x32_bf16 a[48:51], v[140:143], v[64:67], a[48:51]
    v_mfma_f32_16x16x32_bf16 a[52:55], v[140:143], v[68:71], a[52:55]
    v_mfma_f32_16x16x32_bf16 a[56:59], v[140:143], v[72:75], a[56:59]
    v_mfma_f32_16x16x32_bf16 a[60:63], v[140:143], v[76:79], a[60:63]
    v_mfma_f32_16x16x32_bf16 a[64:67], v[144:147], v[64:67], a[64:67]
    v_mfma_f32_16x16x32_bf16 a[68:71], v[144:147], v[68:71], a[68:71]
    v_mfma_f32_16x16x32_bf16 a[72:75], v[144:147], v[72:75], a[72:75]
    v_mfma_f32_16x16x32_bf16 a[76:79], v[144:147], v[76:79], a[76:79]
    s_waitcnt vmcnt(12)
    v_mfma_f32_16x16x32_bf16 a[0:3], v[148:151], v[80:83], a[0:3]
    v_mfma_f32_16x16x32_bf16 a[4:7], v[148:151], v[84:87], a[4:7]
    buffer_load_dwordx4 v[48:51], v0, s[32:35], s69 offen offset:1024 sc1
    v_mfma_f32_16x16x32_bf16 a[8:11], v[148:151], v[88:91], a[8:11]
    v_mfma_f32_16x16x32_bf16 a[12:15], v[148:151], v[92:95], a[12:15]
    buffer_load_dwordx4 v[52:55], v1, s[32:35], s69 offen offset:1024 sc1
    v_mfma_f32_16x16x32_bf16 a[16:19], v[152:155], v[80:83], a[16:19]
    v_mfma_f32_16x16x32_bf16 a[20:23], v[152:155], v[84:87], a[20:23]
    buffer_load_dwordx4 v[56:59], v2, s[32:35], s69 offen offset:1024 sc1
    v_mfma_f32_16x16x32_bf16 a[24:27], v[152:155], v[88:91], a[24:27]
    v_mfma_f32_16x16x32_bf16 a[28:31], v[152:155], v[92:95], a[28:31]
    buffer_load_dwordx4 v[60:63], v3, s[32:35], s69 offen offset:1024 sc1
    v_mfma_f32_16x16x32_bf16 a[32:35], v[156:159], v[80:83], a[32:35]
    v_mfma_f32_16x16x32_bf16 a[36:39], v[156:159], v[84:87], a[36:39]
    v_mfma_f32_16x16x32_bf16 a[40:43], v[156:159], v[88:91], a[40:43]
    v_mfma_f32_16x16x32_bf16 a[44:47], v[156:159], v[92:95], a[44:47]
    v_mfma_f32_16x16x32_bf16 a[48:51], v[160:163], v[80:83], a[48:51]
    v_mfma_f32_16x16x32_bf16 a[52:55], v[160:163], v[84:87], a[52:55]
    v_mfma_f32_16x16x32_bf16 a[56:59], v[160:163], v[88:91], a[56:59]
    v_mfma_f32_16x16x32_bf16 a[60:63], v[160:163], v[92:95], a[60:63]
    v_mfma_f32_16x16x32_bf16 a[64:67], v[164:167], v[80:83], a[64:67]
    v_mfma_f32_16x16x32_bf16 a[68:71], v[164:167], v[84:87], a[68:71]
    v_mfma_f32_16x16x32_bf16 a[72:75], v[164:167], v[88:91], a[72:75]
    v_mfma_f32_16x16x32_bf16 a[76:79], v[164:167], v[92:95], a[76:79]
    s_waitcnt vmcnt(12)
    v_mfma_f32_16x16x32_bf16 a[0:3], v[168:171], v[96:99], a[0:3]
    v_mfma_f32_16x16x32_bf16 a[4:7], v[168:171], v[100:103], a[4:7]
    v_mfma_f32_16x16x32_bf16 a[8:11], v[168:171], v[104:107], a[8:11]
    v_mfma_f32_16x16x32_bf16 a[12:15], v[168:171], v[108:111], a[12:15]
    v_mfma_f32_16x16x32_bf16 a[16:19], v[172:175], v[96:99], a[16:19]
    v_mfma_f32_16x16x32_bf16 a[20:23], v[172:175], v[100:103], a[20:23]
    v_mfma_f32_16x16x32_bf16 a[24:27], v[172:175], v[104:107], a[24:27]
    v_mfma_f32_16x16x32_bf16 a[28:31], v[172:175], v[108:111], a[28:31]
    v_mfma_f32_16x16x32_bf16 a[32:35], v[176:179], v[96:99], a[32:35]
    v_mfma_f32_16x16x32_bf16 a[36:39], v[176:179], v[100:103], a[36:39]
    v_mfma_f32_16x16x32_bf16 a[40:43], v[176:179], v[104:107], a[40:43]
    v_mfma_f32_16x16x32_bf16 a[44:47], v[176:179], v[108:111], a[44:47]
    v_mfma_f32_16x16x32_bf16 a[48:51], v[180:183], v[96:99], a[48:51]
    v_mfma_f32_16x16x32_bf16 a[52:55], v[180:183], v[100:103], a[52:55]
    v_mfma_f32_16x16x32_bf16 a[56:59], v[180:183], v[104:107], a[56:59]
    v_mfma_f32_16x16x32_bf16 a[60:63], v[180:183], v[108:111], a[60:63]
    v_mfma_f32_16x16x32_bf16 a[64:67], v[184:187], v[96:99], a[64:67]
    v_mfma_f32_16x16x32_bf16 a[68:71], v[184:187], v[100:103], a[68:71]
    v_mfma_f32_16x16x32_bf16 a[72:75], v[184:187], v[104:107], a[72:75]
    v_mfma_f32_16x16x32_bf16 a[76:79], v[184:187], v[108:111], a[76:79]
    s_waitcnt vmcnt(8)
    v_mfma_f32_16x16x32_bf16 a[0:3], v[188:191], v[112:115], a[0:3]
    v_mfma_f32_16x16x32_bf16 a[4:7], v[188:191], v[116:119], a[4:7]
    v_mfma_f32_16x16x32_bf16 a[8:11], v[188:191], v[120:123], a[8:11]
    v_mfma_f32_16x16x32_bf16 a[12:15], v[188:191], v[124:127], a[12:15]
    v_mfma_f32_16x16x32_bf16 a[16:19], v[192:195], v[112:115], a[16:19]
    v_mfma_f32_16x16x32_bf16 a[20:23], v[192:195], v[116:119], a[20:23]
    v_mfma_f32_16x16x32_bf16 a[24:27], v[192:195], v[120:123], a[24:27]
    v_mfma_f32_16x16x32_bf16 a[28:31], v[192:195], v[124:127], a[28:31]
    v_mfma_f32_16x16x32_bf16 a[32:35], v[196:199], v[112:115], a[32:35]
    v_mfma_f32_16x16x32_bf16 a[36:39], v[196:199], v[116:119], a[36:39]
    v_mfma_f32_16x16x32_bf16 a[40:43], v[196:199], v[120:123], a[40:43]
    v_mfma_f32_16x16x32_bf16 a[44:47], v[196:199], v[124:127], a[44:47]
    v_mfma_f32_16x16x32_bf16 a[48:51], v[200:203], v[112:115], a[48:51]
    v_mfma_f32_16x16x32_bf16 a[52:55], v[200:203], v[116:119], a[52:55]
    v_mfma_f32_16x16x32_bf16 a[56:59], v[200:203], v[120:123], a[56:59]
    v_mfma_f32_16x16x32_bf16 a[60:63], v[200:203], v[124:127], a[60:63]
    v_mfma_f32_16x16x32_bf16 a[64:67], v[204:207], v[112:115], a[64:67]
    v_mfma_f32_16x16x32_bf16 a[68:71], v[204:207], v[116:119], a[68:71]
    v_mfma_f32_16x16x32_bf16 a[72:75], v[204:207], v[120:123], a[72:75]
    v_mfma_f32_16x16x32_bf16 a[76:79], v[204:207], v[124:127], a[76:79]
    s_waitcnt vmcnt(4)
    v_mfma_f32_16x16x32_bf16 a[0:3], v[208:211], v[32:35], a[0:3]
    v_mfma_f32_16x16x32_bf16 a[4:7], v[208:211], v[36:39], a[4:7]
    v_mfma_f32_16x16x32_bf16 a[8:11], v[208:211], v[40:43], a[8:11]
    v_mfma_f32_16x16x32_bf16 a[12:15], v[208:211], v[44:47], a[12:15]
    v_mfma_f32_16x16x32_bf16 a[16:19], v[212:215], v[32:35], a[16:19]
    v_mfma_f32_16x16x32_bf16 a[20:23], v[212:215], v[36:39], a[20:23]
    v_mfma_f32_16x16x32_bf16 a[24:27], v[212:215], v[40:43], a[24:27]
    v_mfma_f32_16x16x32_bf16 a[28:31], v[212:215], v[44:47], a[28:31]
    v_mfma_f32_16x16x32_bf16 a[32:35], v[216:219], v[32:35], a[32:35]
    v_mfma_f32_16x16x32_bf16 a[36:39], v[216:219], v[36:39], a[36:39]
    v_mfma_f32_16x16x32_bf16 a[40:43], v[216:219], v[40:43], a[40:43]
    v_mfma_f32_16x16x32_bf16 a[44:47], v[216:219], v[44:47], a[44:47]
    v_mfma_f32_16x16x32_bf16 a[48:51], v[220:223], v[32:35], a[48:51]
    v_mfma_f32_16x16x32_bf16 a[52:55], v[220:223], v[36:39], a[52:55]
    v_mfma_f32_16x16x32_bf16 a[56:59], v[220:223], v[40:43], a[56:59]
    v_mfma_f32_16x16x32_bf16 a[60:63], v[220:223], v[44:47], a[60:63]
    v_mfma_f32_16x16x32_bf16 a[64:67], v[224:227], v[32:35], a[64:67]
    v_mfma_f32_16x16x32_bf16 a[68:71], v[224:227], v[36:39], a[68:71]
    v_mfma_f32_16x16x32_bf16 a[72:75], v[224:227], v[40:43], a[72:75]
    v_mfma_f32_16x16x32_bf16 a[76:79], v[224:227], v[44:47], a[76:79]
    s_waitcnt vmcnt(0)
    v_mfma_f32_16x16x32_bf16 a[0:3], v[228:231], v[48:51], a[0:3]
    v_mfma_f32_16x16x32_bf16 a[16:19], v[232:235], v[48:51], a[16:19]
    v_mfma_f32_16x16x32_bf16 a[32:35], v[236:239], v[48:51], a[32:35]
    v_mfma_f32_16x16x32_bf16 a[48:51], v[240:243], v[48:51], a[48:51]
    v_mfma_f32_16x16x32_bf16 a[64:67], v[244:247], v[48:51], a[64:67]
    v_mfma_f32_16x16x32_bf16 a[4:7], v[228:231], v[52:55], a[4:7]
    v_mfma_f32_16x16x32_bf16 a[20:23], v[232:235], v[52:55], a[20:23]
    v_mfma_f32_16x16x32_bf16 a[36:39], v[236:239], v[52:55], a[36:39]
    v_mfma_f32_16x16x32_bf16 a[52:55], v[240:243], v[52:55], a[52:55]
    ds_write_b128 v14, a[0:3] offset:0
    v_mfma_f32_16x16x32_bf16 a[68:71], v[244:247], v[52:55], a[68:71]
    ds_write_b128 v14, a[16:19] offset:1024
    v_mfma_f32_16x16x32_bf16 a[8:11], v[228:231], v[56:59], a[8:11]
    ds_write_b128 v14, a[32:35] offset:2048
    v_mfma_f32_16x16x32_bf16 a[24:27], v[232:235], v[56:59], a[24:27]
    ds_write_b128 v14, a[48:51] offset:3072
    v_mfma_f32_16x16x32_bf16 a[40:43], v[236:239], v[56:59], a[40:43]
    ds_write_b128 v14, a[64:67] offset:4096
    v_mfma_f32_16x16x32_bf16 a[56:59], v[240:243], v[56:59], a[56:59]
    ds_write_b128 v14, a[4:7] offset:20480
    v_mfma_f32_16x16x32_bf16 a[72:75], v[244:247], v[56:59], a[72:75]
    ds_write_b128 v14, a[20:23] offset:21504
    v_mfma_f32_16x16x32_bf16 a[12:15], v[228:231], v[60:63], a[12:15]
    ds_write_b128 v14, a[36:39] offset:22528
    v_mfma_f32_16x16x32_bf16 a[28:31], v[232:235], v[60:63], a[28:31]
    ds_write_b128 v14, a[52:55] offset:23552
    v_mfma_f32_16x16x32_bf16 a[44:47], v[236:239], v[60:63], a[44:47]
    ds_write_b128 v14, a[68:71] offset:24576
    v_mfma_f32_16x16x32_bf16 a[60:63], v[240:243], v[60:63], a[60:63]
    ds_write_b128 v14, a[8:11] offset:40960
    v_mfma_f32_16x16x32_bf16 a[76:79], v[244:247], v[60:63], a[76:79]
    ds_write_b128 v14, a[24:27] offset:41984
    v_lshlrev_b32 v128, 16, v16
    v_and_b32 v129, 0xffff0000, v16
    v_lshlrev_b32 v130, 16, v17
    v_and_b32 v131, 0xffff0000, v17
    v_lshlrev_b32 v132, 16, v18
    v_and_b32 v133, 0xffff0000, v18
    ds_write_b128 v14, a[40:43] offset:43008
    v_lshlrev_b32 v134, 16, v19
    v_and_b32 v135, 0xffff0000, v19
    ds_write_b128 v14, a[56:59] offset:44032
    v_lshlrev_b32 v136, 16, v20
    v_and_b32 v137, 0xffff0000, v20
    ds_write_b128 v14, a[72:75] offset:45056
    v_lshlrev_b32 v138, 16, v21
    v_and_b32 v139, 0xffff0000, v21
    ds_write_b128 v15, a[12:15] offset:0
    v_lshlrev_b32 v140, 16, v22
    v_and_b32 v141, 0xffff0000, v22
    ds_write_b128 v15, a[28:31] offset:1024
    v_lshlrev_b32 v142, 16, v23
    v_and_b32 v143, 0xffff0000, v23
    ds_write_b128 v15, a[44:47] offset:2048
    v_lshlrev_b32 v144, 16, v24
    v_and_b32 v145, 0xffff0000, v24
    ds_write_b128 v15, a[60:63] offset:3072
    v_lshlrev_b32 v146, 16, v25
    v_and_b32 v147, 0xffff0000, v25
    ds_write_b128 v15, a[76:79] offset:4096
    ds_read_b128 v[152:155], v13 offset:640
    ds_read_b128 v[156:159], v13 offset:704
    ds_read_b128 v[160:163], v13 offset:768
    ds_read_b128 v[164:167], v13 offset:832
    ds_read_b128 v[168:171], v13 offset:896
    s_waitcnt lgkmcnt(0)
    s_barrier
    ds_read_b128 v[32:35], v12 offset:0
    ds_read_b128 v[52:55], v12 offset:5120
    ds_read_b128 v[72:75], v12 offset:10240
    ds_read_b128 v[92:95], v12 offset:15360
    ds_read_b128 v[36:39], v12 offset:1024
    ds_read_b128 v[56:59], v12 offset:6144
    ds_read_b128 v[76:79], v12 offset:11264
    ds_read_b128 v[96:99], v12 offset:16384
    ds_read_b128 v[40:43], v12 offset:2048
    ds_read_b128 v[60:63], v12 offset:7168
    ds_read_b128 v[80:83], v12 offset:12288
    ds_read_b128 v[100:103], v12 offset:17408
    ds_read_b128 v[44:47], v12 offset:3072
    ds_read_b128 v[64:67], v12 offset:8192
    ds_read_b128 v[84:87], v12 offset:13312
    ds_read_b128 v[104:107], v12 offset:18432
    ds_read_b128 v[48:51], v12 offset:4096
    ds_read_b128 v[68:71], v12 offset:9216
    ds_read_b128 v[88:91], v12 offset:14336
    ds_read_b128 v[108:111], v12 offset:19456
    s_waitcnt lgkmcnt(15)
    v_pk_add_f32 v[32:33], v[32:33], v[52:53]
    v_pk_add_f32 v[72:73], v[72:73], v[92:93]
    v_pk_add_f32 v[34:35], v[34:35], v[54:55]
    v_pk_add_f32 v[74:75], v[74:75], v[94:95]
    v_pk_add_f32 v[32:33], v[32:33], v[72:73]
    v_pk_add_f32 v[34:35], v[34:35], v[74:75]
    v_pk_fma_f32 v[128:129], v[32:33], v[152:153], v[128:129]
    v_pk_fma_f32 v[130:131], v[34:35], v[154:155], v[130:131]
    v_cvt_pk_bf16_f32 v16, v128, v129
    v_cvt_pk_bf16_f32 v17, v130, v131
    s_waitcnt lgkmcnt(12)
    v_pk_add_f32 v[36:37], v[36:37], v[56:57]
    v_pk_add_f32 v[76:77], v[76:77], v[96:97]
    v_pk_add_f32 v[38:39], v[38:39], v[58:59]
    v_pk_add_f32 v[78:79], v[78:79], v[98:99]
    v_pk_add_f32 v[36:37], v[36:37], v[76:77]
    v_pk_add_f32 v[38:39], v[38:39], v[78:79]
    v_pk_fma_f32 v[132:133], v[36:37], v[156:157], v[132:133]
    v_pk_fma_f32 v[134:135], v[38:39], v[158:159], v[134:135]
    v_cvt_pk_bf16_f32 v18, v132, v133
    v_cvt_pk_bf16_f32 v19, v134, v135
    s_waitcnt lgkmcnt(8)
    v_pk_add_f32 v[40:41], v[40:41], v[60:61]
    v_pk_add_f32 v[80:81], v[80:81], v[100:101]
    v_pk_add_f32 v[42:43], v[42:43], v[62:63]
    v_pk_add_f32 v[82:83], v[82:83], v[102:103]
    v_pk_add_f32 v[40:41], v[40:41], v[80:81]
    v_pk_add_f32 v[42:43], v[42:43], v[82:83]
    v_pk_fma_f32 v[136:137], v[40:41], v[160:161], v[136:137]
    v_pk_fma_f32 v[138:139], v[42:43], v[162:163], v[138:139]
    v_cvt_pk_bf16_f32 v20, v136, v137
    v_cvt_pk_bf16_f32 v21, v138, v139
    s_waitcnt lgkmcnt(4)
    v_pk_add_f32 v[44:45], v[44:45], v[64:65]
    v_pk_add_f32 v[84:85], v[84:85], v[104:105]
    v_pk_add_f32 v[46:47], v[46:47], v[66:67]
    v_pk_add_f32 v[86:87], v[86:87], v[106:107]
    v_pk_add_f32 v[44:45], v[44:45], v[84:85]
    v_pk_add_f32 v[46:47], v[46:47], v[86:87]
    v_pk_fma_f32 v[140:141], v[44:45], v[164:165], v[140:141]
    v_pk_fma_f32 v[142:143], v[46:47], v[166:167], v[142:143]
    v_cvt_pk_bf16_f32 v22, v140, v141
    v_cvt_pk_bf16_f32 v23, v142, v143
    s_waitcnt lgkmcnt(0)
    v_pk_add_f32 v[48:49], v[48:49], v[68:69]
    v_pk_add_f32 v[88:89], v[88:89], v[108:109]
    v_pk_add_f32 v[50:51], v[50:51], v[70:71]
    v_pk_add_f32 v[90:91], v[90:91], v[110:111]
    v_pk_add_f32 v[48:49], v[48:49], v[88:89]
    v_pk_add_f32 v[50:51], v[50:51], v[90:91]
    v_pk_fma_f32 v[144:145], v[48:49], v[168:169], v[144:145]
    v_pk_fma_f32 v[146:147], v[50:51], v[170:171], v[146:147]
    v_cvt_pk_bf16_f32 v24, v144, v145
    v_cvt_pk_bf16_f32 v25, v146, v147
    v_permlane16_swap_b32 v16, v18
    v_permlane16_swap_b32 v17, v19
    v_permlane16_swap_b32 v20, v22
    v_permlane16_swap_b32 v21, v23
    buffer_store_dwordx2 v[24:25], v7, s[36:39], s73 offen offset:128
    buffer_store_dwordx4 v[16:19], v8, s[36:39], s73 offen
    buffer_store_dwordx4 v[20:23], v8, s[36:39], s73 offen offset:64
F_END:
    s_endpgm
P3_IDLE:
    s_waitcnt vmcnt(0)
    s_barrier
    s_cmp_lg_u32 s64, 0
    s_cbranch_scc1 SIG_24
    s_mov_b64 exec, 1
    v_mov_b32 v32, s65
    v_mov_b32 v33, 0
    s_lshl_b32 s100, s2, 2
    s_add_u32 s100, s100, 396288
    buffer_store_dword v32, v33, s[32:35], s100 offen sc1
    s_mov_b64 exec, -1
SIG_24:
    s_branch P3_J1
P1_SLOW:
    s_waitcnt vmcnt(0) lgkmcnt(0)
    s_mov_b32 s73, 1
    s_mov_b32 s76, 0
    v_mov_b32 v129, s64
    v_mbcnt_lo_u32_b32 v130, -1, 0
    v_mbcnt_hi_u32_b32 v130, -1, v130
    v_mov_b32 v1, v129
    v_mov_b32 v2, v130
    s_and_b32 s80, s2, 7
    s_lshr_b32 s81, s2, 3
    s_and_b32 s82, s80, 3
    s_lshl_b32 s82, s82, 3
    s_and_b32 s83, s81, 7
    s_add_u32 s66, s82, s83
    s_lshr_b32 s82, s80, 2
    s_lshl_b32 s82, s82, 2
    s_lshr_b32 s83, s81, 3
    s_add_u32 s67, s82, s83
    v_lshlrev_b32 v245, 4, v2
    v_lshrrev_b32 v3, 4, v2
    v_and_b32 v4, 15, v2
    v_lshlrev_b32 v5, 2, v3
    v_xor_b32 v5, v4, v5
    v_lshlrev_b32 v5, 4, v5
    v_lshl_add_u32 v6, v1, 4, v3
    v_lshl_add_u32 v246, v6, 13, v5
    v_add_u32 v247, 31744, v246
    v_add_u32 v248, 63488, v246
    v_add_u32 v249, 95232, v246
    s_lshl_b32 s80, s66, 8
    s_sub_u32 s81, 5242880, s80
    s_add_u32 s60, s10, s80
    s_addc_u32 s61, s11, 0
    s_mov_b32 s62, s81
    s_mov_b32 s63, 0x20000
    s_lshl_b32 s72, s64, 12
    s_lshl_b32 s80, s66, 19
    s_add_u32 s80, s80, 393216
    s_add_u32 s52, s6, s80
    s_addc_u32 s53, s7, 0
    s_mov_b32 s54, 0x20000
    s_mov_b32 s55, 0x20000
    s_sub_u32 s80, s80, 2048
    s_add_u32 s56, s8, s80
    s_addc_u32 s57, s9, 0
    s_mov_b32 s58, 0x20800
    s_mov_b32 s59, 0x20000
    v_lshl_add_u32 v6, v1, 3, v3
    v_lshlrev_b32 v6, 8, v6
    v_add_u32 v255, v6, v5
    v_lshl_add_u32 v40, v1, 2, v3
    v_xor_b32 v40, v4, v40
    v_lshl_add_u32 v254, v40, 4, v6
    v_lshrrev_b32 v41, 5, v2
    v_bfe_u32 v42, v2, 2, 2
    v_and_b32 v43, 3, v2
    v_and_b32 v44, 1, v43
    v_lshrrev_b32 v45, 1, v43
    v_lshl_or_b32 v44, v44, 1, v45
    v_lshlrev_b32 v44, 3, v44
    v_and_b32 v45, 1, v3
    v_lshl_add_u32 v44, v45, 5, v44
    v_lshl_add_u32 v45, v41, 3, v42
    v_lshl_add_u32 v45, v45, 8, v44
    v_lshl_add_u32 v46, v41, 2, v42
    v_lshl_add_u32 v46, v46, 8, v44
    v_add_u32 v46, 2048, v46
    v_xor_b32 v47, 0, v42
    v_lshl_add_u32 v240, v47, 6, v45
    v_lshl_add_u32 v47, v47, 6, v46
    v_accvgpr_write_b32 a200, v47
    v_xor_b32 v47, 1, v42
    v_lshl_add_u32 v241, v47, 6, v45
    v_lshl_add_u32 v47, v47, 6, v46
    v_accvgpr_write_b32 a201, v47
    v_xor_b32 v47, 2, v42
    v_lshl_add_u32 v242, v47, 6, v45
    v_lshl_add_u32 v47, v47, 6, v46
    v_accvgpr_write_b32 a202, v47
    v_xor_b32 v47, 3, v42
    v_lshl_add_u32 v243, v47, 6, v45
    v_lshl_add_u32 v47, v47, 6, v46
    v_accvgpr_write_b32 a203, v47
    v_bfe_u32 v44, v2, 3, 2
    v_and_b32 v45, 7, v2
    v_lshlrev_b32 v46, 12, v44
    v_lshl_add_u32 v46, v45, 8, v46
    v_lshl_add_u32 v44, v44, 2, v43
    v_xor_b32 v44, v44, v41
    v_xor_b32 v47, 0, v44
    v_lshl_add_u32 v47, v47, 4, v46
    v_accvgpr_write_b32 a192, v47
    v_xor_b32 v47, 2, v44
    v_lshl_add_u32 v47, v47, 4, v46
    v_accvgpr_write_b32 a193, v47
    v_xor_b32 v47, 4, v44
    v_lshl_add_u32 v47, v47, 4, v46
    v_accvgpr_write_b32 a194, v47
    v_xor_b32 v47, 6, v44
    v_lshl_add_u32 v47, v47, 4, v46
    v_accvgpr_write_b32 a195, v47
    v_xor_b32 v47, 8, v44
    v_lshl_add_u32 v47, v47, 4, v46
    v_accvgpr_write_b32 a196, v47
    v_xor_b32 v47, 10, v44
    v_lshl_add_u32 v47, v47, 4, v46
    v_accvgpr_write_b32 a197, v47
    v_xor_b32 v47, 12, v44
    v_lshl_add_u32 v47, v47, 4, v46
    v_accvgpr_write_b32 a198, v47
    v_xor_b32 v47, 14, v44
    v_lshl_add_u32 v47, v47, 4, v46
    v_accvgpr_write_b32 a199, v47
    v_bfe_u32 v44, v2, 4, 1
    v_lshlrev_b32 v44, 17, v44
    v_lshl_add_u32 v44, v41, 8, v44
    v_lshl_add_u32 v44, v4, 4, v44
    v_accvgpr_write_b32 a204, v44
    v_lshlrev_b32 v244, 6, v41
    v_add_u32 v244, 131072, v244
    s_lshl_b32 s80, s67, 3
    s_lshl_b32 s81, s64, 1
    s_add_u32 s80, s80, s81
    s_mul_i32 s80, s80, 40960
    s_add_u32 s80, s80, 1048576
    s_add_u32 s44, s30, s80
    s_addc_u32 s45, s31, 0
    s_mov_b32 s46, 0xa000
    s_mov_b32 s47, 0x20000
    s_add_u32 s80, s80, 40960
    s_add_u32 s48, s30, s80
    s_addc_u32 s49, s31, 0
    s_mov_b32 s50, 0xa000
    s_mov_b32 s51, 0x20000
    v_mov_b32 v0, 0
    v_mov_b32 v1, 0
    v_mov_b32 v2, 0
    v_mov_b32 v3, 0
    v_mov_b32 v4, 0
    v_mov_b32 v5, 0
    v_mov_b32 v6, 0
    v_mov_b32 v7, 0
    v_mov_b32 v8, 0
    v_mov_b32 v9, 0
    v_mov_b32 v10, 0
    v_mov_b32 v11, 0
    v_mov_b32 v12, 0
    v_mov_b32 v13, 0
    v_mov_b32 v14, 0
    v_mov_b32 v15, 0
    v_mov_b32 v16, 0
    v_mov_b32 v17, 0
    v_mov_b32 v18, 0
    v_mov_b32 v19, 0
    v_mov_b32 v20, 0
    v_mov_b32 v21, 0
    v_mov_b32 v22, 0
    v_mov_b32 v23, 0
    v_mov_b32 v24, 0
    v_mov_b32 v25, 0
    v_mov_b32 v26, 0
    v_mov_b32 v27, 0
    v_mov_b32 v28, 0
    v_mov_b32 v29, 0
    v_mov_b32 v30, 0
    v_mov_b32 v31, 0
    v_mov_b32 v32, 0
    v_mov_b32 v33, 0
    v_mov_b32 v34, 0
    v_mov_b32 v35, 0
    v_mov_b32 v36, 0
    v_mov_b32 v37, 0
    v_mov_b32 v38, 0
    v_mov_b32 v39, 0
    v_mov_b32 v40, 0
    v_mov_b32 v41, 0
    v_mov_b32 v42, 0
    v_mov_b32 v43, 0
    v_mov_b32 v44, 0
    v_mov_b32 v45, 0
    v_mov_b32 v46, 0
    v_mov_b32 v47, 0
    v_mov_b32 v48, 0
    v_mov_b32 v49, 0
    v_mov_b32 v50, 0
    v_mov_b32 v51, 0
    v_mov_b32 v52, 0
    v_mov_b32 v53, 0
    v_mov_b32 v54, 0
    v_mov_b32 v55, 0
    v_mov_b32 v56, 0
    v_mov_b32 v57, 0
    v_mov_b32 v58, 0
    v_mov_b32 v59, 0
    v_mov_b32 v60, 0
    v_mov_b32 v61, 0
    v_mov_b32 v62, 0
    v_mov_b32 v63, 0
    v_mov_b32 v64, 0
    v_mov_b32 v65, 0
    v_mov_b32 v66, 0
    v_mov_b32 v67, 0
    v_mov_b32 v68, 0
    v_mov_b32 v69, 0
    v_mov_b32 v70, 0
    v_mov_b32 v71, 0
    v_mov_b32 v72, 0
    v_mov_b32 v73, 0
    v_mov_b32 v74, 0
    v_mov_b32 v75, 0
    v_mov_b32 v76, 0
    v_mov_b32 v77, 0
    v_mov_b32 v78, 0
    v_mov_b32 v79, 0
    v_mov_b32 v80, 0
    v_mov_b32 v81, 0
    v_mov_b32 v82, 0
    v_mov_b32 v83, 0
    v_mov_b32 v84, 0
    v_mov_b32 v85, 0
    v_mov_b32 v86, 0
    v_mov_b32 v87, 0
    v_mov_b32 v88, 0
    v_mov_b32 v89, 0
    v_mov_b32 v90, 0
    v_mov_b32 v91, 0
    v_mov_b32 v92, 0
    v_mov_b32 v93, 0
    v_mov_b32 v94, 0
    v_mov_b32 v95, 0
    v_mov_b32 v96, 0
    v_mov_b32 v97, 0
    v_mov_b32 v98, 0
    v_mov_b32 v99, 0
    v_mov_b32 v100, 0
    v_mov_b32 v101, 0
    v_mov_b32 v102, 0
    v_mov_b32 v103, 0
    v_mov_b32 v104, 0
    v_mov_b32 v105, 0
    v_mov_b32 v106, 0
    v_mov_b32 v107, 0
    v_mov_b32 v108, 0
    v_mov_b32 v109, 0
    v_mov_b32 v110, 0
    v_mov_b32 v111, 0
    v_mov_b32 v112, 0
    v_mov_b32 v113, 0
    v_mov_b32 v114, 0
    v_mov_b32 v115, 0
    v_mov_b32 v116, 0
    v_mov_b32 v117, 0
    v_mov_b32 v118, 0
    v_mov_b32 v119, 0
    v_mov_b32 v120, 0
    v_mov_b32 v121, 0
    v_mov_b32 v122, 0
    v_mov_b32 v123, 0
    v_mov_b32 v124, 0
    v_mov_b32 v125, 0
    v_mov_b32 v126, 0
    v_mov_b32 v127, 0
    s_mov_b32 s36, 0
SLOW_Q:
    s_barrier
    s_add_u32 m0, s72, 0
    s_lshl_b32 s68, s36, 7
    buffer_load_dwordx4 v246, s[60:63], s68 offen lds
    buffer_load_dwordx4 v247, s[60:63], s68 offen offset:1024 lds
    buffer_load_dwordx4 v248, s[60:63], s68 offen offset:2048 lds
    buffer_load_dwordx4 v249, s[60:63], s68 offen offset:3072 lds
    buffer_load_dwordx4 v[128:131], v245, s[44:47], s36 offen sc1
    buffer_load_dwordx4 v[132:135], v245, s[48:51], s36 offen sc1
    buffer_load_dwordx4 v[136:139], v245, s[44:47], s36 offen offset:1024 sc1
    buffer_load_dwordx4 v[140:143], v245, s[48:51], s36 offen offset:1024 sc1
    buffer_load_dwordx4 v[144:147], v245, s[44:47], s36 offen offset:2048 sc1
    buffer_load_dwordx4 v[148:151], v245, s[48:51], s36 offen offset:2048 sc1
    buffer_load_dwordx4 v[152:155], v245, s[44:47], s36 offen offset:3072 sc1
    buffer_load_dwordx4 v[156:159], v245, s[48:51], s36 offen offset:3072 sc1
    s_waitcnt vmcnt(0)
    s_barrier
    ds_read_b128 v[208:211], v244 offset:0
    ds_read_b128 v[212:215], v244 offset:16
    ds_read_b128 v[216:219], v244 offset:32
    ds_read_b128 v[220:223], v244 offset:48
    ds_read_b64_tr_b16 a[128:129], v240 offset:0
    ds_read_b64_tr_b16 a[130:131], v240 offset:1024
    ds_read_b64_tr_b16 a[132:133], v241 offset:0
    ds_read_b64_tr_b16 a[134:135], v241 offset:1024
    ds_read_b64_tr_b16 a[136:137], v242 offset:0
    ds_read_b64_tr_b16 a[138:139], v242 offset:1024
    ds_read_b64_tr_b16 a[140:141], v243 offset:0
    ds_read_b64_tr_b16 a[142:143], v243 offset:1024
    s_waitcnt lgkmcnt(0)
    v_fma_mix_f32 v250, v128, v208, v216 op_sel_hi:[1,0,0]
    v_fma_mix_f32 v251, v128, v209, v217 op_sel:[1,0,0] op_sel_hi:[1,0,0]
    v_cvt_pk_bf16_f32 v192, v250, v251
    v_fma_mix_f32 v252, v129, v210, v218 op_sel_hi:[1,0,0]
    v_fma_mix_f32 v253, v129, v211, v219 op_sel:[1,0,0] op_sel_hi:[1,0,0]
    v_cvt_pk_bf16_f32 v193, v252, v253
    v_fma_mix_f32 v250, v130, v212, v220 op_sel_hi:[1,0,0]
    v_fma_mix_f32 v251, v130, v213, v221 op_sel:[1,0,0] op_sel_hi:[1,0,0]
    v_cvt_pk_bf16_f32 v194, v250, v251
    v_fma_mix_f32 v252, v131, v214, v222 op_sel_hi:[1,0,0]
    v_fma_mix_f32 v253, v131, v215, v223 op_sel:[1,0,0] op_sel_hi:[1,0,0]
    v_cvt_pk_bf16_f32 v195, v252, v253
    v_fma_mix_f32 v250, v132, v208, v216 op_sel_hi:[1,0,0]
    v_fma_mix_f32 v251, v132, v209, v217 op_sel:[1,0,0] op_sel_hi:[1,0,0]
    v_cvt_pk_bf16_f32 v196, v250, v251
    v_fma_mix_f32 v252, v133, v210, v218 op_sel_hi:[1,0,0]
    v_fma_mix_f32 v253, v133, v211, v219 op_sel:[1,0,0] op_sel_hi:[1,0,0]
    v_cvt_pk_bf16_f32 v197, v252, v253
    v_fma_mix_f32 v250, v134, v212, v220 op_sel_hi:[1,0,0]
    v_fma_mix_f32 v251, v134, v213, v221 op_sel:[1,0,0] op_sel_hi:[1,0,0]
    v_cvt_pk_bf16_f32 v198, v250, v251
    v_fma_mix_f32 v252, v135, v214, v222 op_sel_hi:[1,0,0]
    v_fma_mix_f32 v253, v135, v215, v223 op_sel:[1,0,0] op_sel_hi:[1,0,0]
    v_cvt_pk_bf16_f32 v199, v252, v253
    v_mfma_f32_32x32x16_bf16 v[0:15], a[128:131], v[192:195], v[0:15]
    s_nop 0
    v_mfma_f32_32x32x16_bf16 v[16:31], a[128:131], v[196:199], v[16:31]
    v_mfma_f32_32x32x16_bf16 v[32:47], a[132:135], v[192:195], v[32:47]
    v_mfma_f32_32x32x16_bf16 v[48:63], a[132:135], v[196:199], v[48:63]
    v_mfma_f32_32x32x16_bf16 v[64:79], a[136:139], v[192:195], v[64:79]
    v_mfma_f32_32x32x16_bf16 v[80:95], a[136:139], v[196:199], v[80:95]
    v_mfma_f32_32x32x16_bf16 v[96:111], a[140:143], v[192:195], v[96:111]
    v_mfma_f32_32x32x16_bf16 v[112:127], a[140:143], v[196:199], v[112:127]
    ds_read_b128 v[224:227], v244 offset:128
    ds_read_b128 v[228:231], v244 offset:144
    ds_read_b128 v[232:235], v244 offset:160
    ds_read_b128 v[236:239], v244 offset:176
    ds_read_b64_tr_b16 a[144:145], v240 offset:4096
    ds_read_b64_tr_b16 a[146:147], v240 offset:5120
    ds_read_b64_tr_b16 a[148:149], v241 offset:4096
    ds_read_b64_tr_b16 a[150:151], v241 offset:5120
    ds_read_b64_tr_b16 a[152:153], v242 offset:4096
    ds_read_b64_tr_b16 a[154:155], v242 offset:5120
    ds_read_b64_tr_b16 a[156:157], v243 offset:4096
    ds_read_b64_tr_b16 a[158:159], v243 offset:5120
    s_waitcnt lgkmcnt(0)
    v_fma_mix_f32 v250, v136, v224, v232 op_sel_hi:[1,0,0]
    v_fma_mix_f32 v251, v136, v225, v233 op_sel:[1,0,0] op_sel_hi:[1,0,0]
    v_cvt_pk_bf16_f32 v200, v250, v251
    v_fma_mix_f32 v252, v137, v226, v234 op_sel_hi:[1,0,0]
    v_fma_mix_f32 v253, v137, v227, v235 op_sel:[1,0,0] op_sel_hi:[1,0,0]
    v_cvt_pk_bf16_f32 v201, v252, v253
    v_fma_mix_f32 v250, v138, v228, v236 op_sel_hi:[1,0,0]
    v_fma_mix_f32 v251, v138, v229, v237 op_sel:[1,0,0] op_sel_hi:[1,0,0]
    v_cvt_pk_bf16_f32 v202, v250, v251
    v_fma_mix_f32 v252, v139, v230, v238 op_sel_hi:[1,0,0]
    v_fma_mix_f32 v253, v139, v231, v239 op_sel:[1,0,0] op_sel_hi:[1,0,0]
    v_cvt_pk_bf16_f32 v203, v252, v253
    v_fma_mix_f32 v250, v140, v224, v232 op_sel_hi:[1,0,0]
    v_fma_mix_f32 v251, v140, v225, v233 op_sel:[1,0,0] op_sel_hi:[1,0,0]
    v_cvt_pk_bf16_f32 v204, v250, v251
    v_fma_mix_f32 v252, v141, v226, v234 op_sel_hi:[1,0,0]
    v_fma_mix_f32 v253, v141, v227, v235 op_sel:[1,0,0] op_sel_hi:[1,0,0]
    v_cvt_pk_bf16_f32 v205, v252, v253
    v_fma_mix_f32 v250, v142, v228, v236 op_sel_hi:[1,0,0]
    v_fma_mix_f32 v251, v142, v229, v237 op_sel:[1,0,0] op_sel_hi:[1,0,0]
    v_cvt_pk_bf16_f32 v206, v250, v251
    v_fma_mix_f32 v252, v143, v230, v238 op_sel_hi:[1,0,0]
    v_fma_mix_f32 v253, v143, v231, v239 op_sel:[1,0,0] op_sel_hi:[1,0,0]
    v_cvt_pk_bf16_f32 v207, v252, v253
    v_mfma_f32_32x32x16_bf16 v[0:15], a[144:147], v[200:203], v[0:15]
    s_nop 0
    v_mfma_f32_32x32x16_bf16 v[16:31], a[144:147], v[204:207], v[16:31]
    v_mfma_f32_32x32x16_bf16 v[32:47], a[148:151], v[200:203], v[32:47]
    v_mfma_f32_32x32x16_bf16 v[48:63], a[148:151], v[204:207], v[48:63]
    v_mfma_f32_32x32x16_bf16 v[64:79], a[152:155], v[200:203], v[64:79]
    v_mfma_f32_32x32x16_bf16 v[80:95], a[152:155], v[204:207], v[80:95]
    v_mfma_f32_32x32x16_bf16 v[96:111], a[156:159], v[200:203], v[96:111]
    v_mfma_f32_32x32x16_bf16 v[112:127], a[156:159], v[204:207], v[112:127]
    ds_read_b128 v[208:211], v244 offset:256
    ds_read_b128 v[212:215], v244 offset:272
    ds_read_b128 v[216:219], v244 offset:288
    ds_read_b128 v[220:223], v244 offset:304
    ds_read_b64_tr_b16 a[160:161], v240 offset:8192
    ds_read_b64_tr_b16 a[162:163], v240 offset:9216
    ds_read_b64_tr_b16 a[164:165], v241 offset:8192
    ds_read_b64_tr_b16 a[166:167], v241 offset:9216
    ds_read_b64_tr_b16 a[168:169], v242 offset:8192
    ds_read_b64_tr_b16 a[170:171], v242 offset:9216
    ds_read_b64_tr_b16 a[172:173], v243 offset:8192
    ds_read_b64_tr_b16 a[174:175], v243 offset:9216
    s_waitcnt lgkmcnt(0)
    v_fma_mix_f32 v250, v144, v208, v216 op_sel_hi:[1,0,0]
    v_fma_mix_f32 v251, v144, v209, v217 op_sel:[1,0,0] op_sel_hi:[1,0,0]
    v_cvt_pk_bf16_f32 v192, v250, v251
    v_fma_mix_f32 v252, v145, v210, v218 op_sel_hi:[1,0,0]
    v_fma_mix_f32 v253, v145, v211, v219 op_sel:[1,0,0] op_sel_hi:[1,0,0]
    v_cvt_pk_bf16_f32 v193, v252, v253
    v_fma_mix_f32 v250, v146, v212, v220 op_sel_hi:[1,0,0]
    v_fma_mix_f32 v251, v146, v213, v221 op_sel:[1,0,0] op_sel_hi:[1,0,0]
    v_cvt_pk_bf16_f32 v194, v250, v251
    v_fma_mix_f32 v252, v147, v214, v222 op_sel_hi:[1,0,0]
    v_fma_mix_f32 v253, v147, v215, v223 op_sel:[1,0,0] op_sel_hi:[1,0,0]
    v_cvt_pk_bf16_f32 v195, v252, v253
    v_fma_mix_f32 v250, v148, v208, v216 op_sel_hi:[1,0,0]
    v_fma_mix_f32 v251, v148, v209, v217 op_sel:[1,0,0] op_sel_hi:[1,0,0]
    v_cvt_pk_bf16_f32 v196, v250, v251
    v_fma_mix_f32 v252, v149, v210, v218 op_sel_hi:[1,0,0]
    v_fma_mix_f32 v253, v149, v211, v219 op_sel:[1,0,0] op_sel_hi:[1,0,0]
    v_cvt_pk_bf16_f32 v197, v252, v253
    v_fma_mix_f32 v250, v150, v212, v220 op_sel_hi:[1,0,0]
    v_fma_mix_f32 v251, v150, v213, v221 op_sel:[1,0,0] op_sel_hi:[1,0,0]
    v_cvt_pk_bf16_f32 v198, v250, v251
    v_fma_mix_f32 v252, v151, v214, v222 op_sel_hi:[1,0,0]
    v_fma_mix_f32 v253, v151, v215, v223 op_sel:[1,0,0] op_sel_hi:[1,0,0]
    v_cvt_pk_bf16_f32 v199, v252, v253
    v_mfma_f32_32x32x16_bf16 v[0:15], a[160:163], v[192:195], v[0:15]
    s_nop 0
    v_mfma_f32_32x32x16_bf16 v[16:31], a[160:163], v[196:199], v[16:31]
    v_mfma_f32_32x32x16_bf16 v[32:47], a[164:167], v[192:195], v[32:47]
    v_mfma_f32_32x32x16_bf16 v[48:63], a[164:167], v[196:199], v[48:63]
    v_mfma_f32_32x32x16_bf16 v[64:79], a[168:171], v[192:195], v[64:79]
    v_mfma_f32_32x32x16_bf16 v[80:95], a[168:171], v[196:199], v[80:95]
    v_mfma_f32_32x32x16_bf16 v[96:111], a[172:175], v[192:195], v[96:111]
    v_mfma_f32_32x32x16_bf16 v[112:127], a[172:175], v[196:199], v[112:127]
    ds_read_b128 v[224:227], v244 offset:384
    ds_read_b128 v[228:231], v244 offset:400
    ds_read_b128 v[232:235], v244 offset:416
    ds_read_b128 v[236:239], v244 offset:432
    ds_read_b64_tr_b16 a[176:177], v240 offset:12288
    ds_read_b64_tr_b16 a[178:179], v240 offset:13312
    ds_read_b64_tr_b16 a[180:181], v241 offset:12288
    ds_read_b64_tr_b16 a[182:183], v241 offset:13312
    ds_read_b64_tr_b16 a[184:185], v242 offset:12288
    ds_read_b64_tr_b16 a[186:187], v242 offset:13312
    ds_read_b64_tr_b16 a[188:189], v243 offset:12288
    ds_read_b64_tr_b16 a[190:191], v243 offset:13312
    s_waitcnt lgkmcnt(0)
    v_fma_mix_f32 v250, v152, v224, v232 op_sel_hi:[1,0,0]
    v_fma_mix_f32 v251, v152, v225, v233 op_sel:[1,0,0] op_sel_hi:[1,0,0]
    v_cvt_pk_bf16_f32 v200, v250, v251
    v_fma_mix_f32 v252, v153, v226, v234 op_sel_hi:[1,0,0]
    v_fma_mix_f32 v253, v153, v227, v235 op_sel:[1,0,0] op_sel_hi:[1,0,0]
    v_cvt_pk_bf16_f32 v201, v252, v253
    v_fma_mix_f32 v250, v154, v228, v236 op_sel_hi:[1,0,0]
    v_fma_mix_f32 v251, v154, v229, v237 op_sel:[1,0,0] op_sel_hi:[1,0,0]
    v_cvt_pk_bf16_f32 v202, v250, v251
    v_fma_mix_f32 v252, v155, v230, v238 op_sel_hi:[1,0,0]
    v_fma_mix_f32 v253, v155, v231, v239 op_sel:[1,0,0] op_sel_hi:[1,0,0]
    v_cvt_pk_bf16_f32 v203, v252, v253
    v_fma_mix_f32 v250, v156, v224, v232 op_sel_hi:[1,0,0]
    v_fma_mix_f32 v251, v156, v225, v233 op_sel:[1,0,0] op_sel_hi:[1,0,0]
    v_cvt_pk_bf16_f32 v204, v250, v251
    v_fma_mix_f32 v252, v157, v226, v234 op_sel_hi:[1,0,0]
    v_fma_mix_f32 v253, v157, v227, v235 op_sel:[1,0,0] op_sel_hi:[1,0,0]
    v_cvt_pk_bf16_f32 v205, v252, v253
    v_fma_mix_f32 v250, v158, v228, v236 op_sel_hi:[1,0,0]
    v_fma_mix_f32 v251, v158, v229, v237 op_sel:[1,0,0] op_sel_hi:[1,0,0]
    v_cvt_pk_bf16_f32 v206, v250, v251
    v_fma_mix_f32 v252, v159, v230, v238 op_sel_hi:[1,0,0]
    v_fma_mix_f32 v253, v159, v231, v239 op_sel:[1,0,0] op_sel_hi:[1,0,0]
    v_cvt_pk_bf16_f32 v207, v252, v253
    v_mfma_f32_32x32x16_bf16 v[0:15], a[176:179], v[200:203], v[0:15]
    s_nop 0
    v_mfma_f32_32x32x16_bf16 v[16:31], a[176:179], v[204:207], v[16:31]
    v_mfma_f32_32x32x16_bf16 v[32:47], a[180:183], v[200:203], v[32:47]
    v_mfma_f32_32x32x16_bf16 v[48:63], a[180:183], v[204:207], v[48:63]
    v_mfma_f32_32x32x16_bf16 v[64:79], a[184:187], v[200:203], v[64:79]
    v_mfma_f32_32x32x16_bf16 v[80:95], a[184:187], v[204:207], v[80:95]
    v_mfma_f32_32x32x16_bf16 v[96:111], a[188:191], v[200:203], v[96:111]
    v_mfma_f32_32x32x16_bf16 v[112:127], a[188:191], v[204:207], v[112:127]
    v_add_u32 v244, 512, v244
    s_add_u32 s36, s36, 4096
    s_cmp_lt_u32 s36, 40960
    s_cbranch_scc1 SLOW_Q
    v_cvt_pk_bf16_f32 v0, v0, v1
    v_cvt_pk_bf16_f32 v1, v2, v3
    v_cvt_pk_bf16_f32 v2, v4, v5
    v_cvt_pk_bf16_f32 v3, v6, v7
    v_cvt_pk_bf16_f32 v4, v8, v9
    v_cvt_pk_bf16_f32 v5, v10, v11
    v_cvt_pk_bf16_f32 v6, v12, v13
    v_cvt_pk_bf16_f32 v7, v14, v15
    v_cvt_pk_bf16_f32 v8, v16, v17
    v_cvt_pk_bf16_f32 v9, v18, v19
    v_cvt_pk_bf16_f32 v10, v20, v21
    v_cvt_pk_bf16_f32 v11, v22, v23
    v_cvt_pk_bf16_f32 v12, v24, v25
    v_cvt_pk_bf16_f32 v13, v26, v27
    v_cvt_pk_bf16_f32 v14, v28, v29
    v_cvt_pk_bf16_f32 v15, v30, v31
    v_cvt_pk_bf16_f32 v16, v32, v33
    v_cvt_pk_bf16_f32 v17, v34, v35
    v_cvt_pk_bf16_f32 v18, v36, v37
    v_cvt_pk_bf16_f32 v19, v38, v39
    v_cvt_pk_bf16_f32 v20, v40, v41
    v_cvt_pk_bf16_f32 v21, v42, v43
    v_cvt_pk_bf16_f32 v22, v44, v45
    v_cvt_pk_bf16_f32 v23, v46, v47
    v_cvt_pk_bf16_f32 v24, v48, v49
    v_cvt_pk_bf16_f32 v25, v50, v51
    v_cvt_pk_bf16_f32 v26, v52, v53
    v_cvt_pk_bf16_f32 v27, v54, v55
    v_cvt_pk_bf16_f32 v28, v56, v57
    v_cvt_pk_bf16_f32 v29, v58, v59
    v_cvt_pk_bf16_f32 v30, v60, v61
    v_cvt_pk_bf16_f32 v31, v62, v63
    v_cvt_pk_bf16_f32 v32, v64, v65
    v_cvt_pk_bf16_f32 v33, v66, v67
    v_cvt_pk_bf16_f32 v34, v68, v69
    v_cvt_pk_bf16_f32 v35, v70, v71
    v_cvt_pk_bf16_f32 v36, v72, v73
    v_cvt_pk_bf16_f32 v37, v74, v75
    v_cvt_pk_bf16_f32 v38, v76, v77
    v_cvt_pk_bf16_f32 v39, v78, v79
    v_cvt_pk_bf16_f32 v40, v80, v81
    v_cvt_pk_bf16_f32 v41, v82, v83
    v_cvt_pk_bf16_f32 v42, v84, v85
    v_cvt_pk_bf16_f32 v43, v86, v87
    v_cvt_pk_bf16_f32 v44, v88, v89
    v_cvt_pk_bf16_f32 v45, v90, v91
    v_cvt_pk_bf16_f32 v46, v92, v93
    v_cvt_pk_bf16_f32 v47, v94, v95
    v_cvt_pk_bf16_f32 v48, v96, v97
    v_cvt_pk_bf16_f32 v49, v98, v99
    v_cvt_pk_bf16_f32 v50, v100, v101
    v_cvt_pk_bf16_f32 v51, v102, v103
    v_cvt_pk_bf16_f32 v52, v104, v105
    v_cvt_pk_bf16_f32 v53, v106, v107
    v_cvt_pk_bf16_f32 v54, v108, v109
    v_cvt_pk_bf16_f32 v55, v110, v111
    v_cvt_pk_bf16_f32 v56, v112, v113
    v_cvt_pk_bf16_f32 v57, v114, v115
    v_cvt_pk_bf16_f32 v58, v116, v117
    v_cvt_pk_bf16_f32 v59, v118, v119
    v_cvt_pk_bf16_f32 v60, v120, v121
    v_cvt_pk_bf16_f32 v61, v122, v123
    v_cvt_pk_bf16_f32 v62, v124, v125
    v_cvt_pk_bf16_f32 v63, v126, v127
    v_accvgpr_read_b32 v208, a192
    v_accvgpr_read_b32 v209, a193
    v_accvgpr_read_b32 v210, a194
    v_accvgpr_read_b32 v211, a195
    v_accvgpr_read_b32 v212, a196
    v_accvgpr_read_b32 v213, a197
    v_accvgpr_read_b32 v214, a198
    v_accvgpr_read_b32 v215, a199
    v_accvgpr_read_b32 v216, a200
    v_accvgpr_read_b32 v217, a201
    v_accvgpr_read_b32 v218, a202
    v_accvgpr_read_b32 v219, a203
    v_mov_b32 v220, 0
    v_mov_b32 v221, 0
    v_mov_b32 v222, 0
    v_mov_b32 v223, 0
    v_mov_b32 v192, 0xff800000
    v_mov_b32 v193, 0xff800000
    v_accvgpr_write_b32 a0, 0
    v_accvgpr_write_b32 a1, 0
    v_accvgpr_write_b32 a2, 0
    v_accvgpr_write_b32 a3, 0
    v_accvgpr_write_b32 a4, 0
    v_accvgpr_write_b32 a5, 0
    v_accvgpr_write_b32 a6, 0
    v_accvgpr_write_b32 a7, 0
    v_accvgpr_write_b32 a8, 0
    v_accvgpr_write_b32 a9, 0
    v_accvgpr_write_b32 a10, 0
    v_accvgpr_write_b32 a11, 0
    v_accvgpr_write_b32 a12, 0
    v_accvgpr_write_b32 a13, 0
    v_accvgpr_write_b32 a14, 0
    v_accvgpr_write_b32 a15, 0
    v_accvgpr_write_b32 a16, 0
    v_accvgpr_write_b32 a17, 0
    v_accvgpr_write_b32 a18, 0
    v_accvgpr_write_b32 a19, 0
    v_accvgpr_write_b32 a20, 0
    v_accvgpr_write_b32 a21, 0
    v_accvgpr_write_b32 a22, 0
    v_accvgpr_write_b32 a23, 0
    v_accvgpr_write_b32 a24, 0
    v_accvgpr_write_b32 a25, 0
    v_accvgpr_write_b32 a26, 0
    v_accvgpr_write_b32 a27, 0
    v_accvgpr_write_b32 a28, 0
    v_accvgpr_write_b32 a29, 0
    v_accvgpr_write_b32 a30, 0
    v_accvgpr_write_b32 a31, 0
    v_accvgpr_write_b32 a32, 0
    v_accvgpr_write_b32 a33, 0
    v_accvgpr_write_b32 a34, 0
    v_accvgpr_write_b32 a35, 0
    v_accvgpr_write_b32 a36, 0
    v_accvgpr_write_b32 a37, 0
    v_accvgpr_write_b32 a38, 0
    v_accvgpr_write_b32 a39, 0
    v_accvgpr_write_b32 a40, 0
    v_accvgpr_write_b32 a41, 0
    v_accvgpr_write_b32 a42, 0
    v_accvgpr_write_b32 a43, 0
    v_accvgpr_write_b32 a44, 0
    v_accvgpr_write_b32 a45, 0
    v_accvgpr_write_b32 a46, 0
    v_accvgpr_write_b32 a47, 0
    v_accvgpr_write_b32 a48, 0
    v_accvgpr_write_b32 a49, 0
    v_accvgpr_write_b32 a50, 0
    v_accvgpr_write_b32 a51, 0
    v_accvgpr_write_b32 a52, 0
    v_accvgpr_write_b32 a53, 0
    v_accvgpr_write_b32 a54, 0
    v_accvgpr_write_b32 a55, 0
    v_accvgpr_write_b32 a56, 0
    v_accvgpr_write_b32 a57, 0
    v_accvgpr_write_b32 a58, 0
    v_accvgpr_write_b32 a59, 0
    v_accvgpr_write_b32 a60, 0
    v_accvgpr_write_b32 a61, 0
    v_accvgpr_write_b32 a62, 0
    v_accvgpr_write_b32 a63, 0
    v_accvgpr_write_b32 a64, 0
    v_accvgpr_write_b32 a65, 0
    v_accvgpr_write_b32 a66, 0
    v_accvgpr_write_b32 a67, 0
    v_accvgpr_write_b32 a68, 0
    v_accvgpr_write_b32 a69, 0
    v_accvgpr_write_b32 a70, 0
    v_accvgpr_write_b32 a71, 0
    v_accvgpr_write_b32 a72, 0
    v_accvgpr_write_b32 a73, 0
    v_accvgpr_write_b32 a74, 0
    v_accvgpr_write_b32 a75, 0
    v_accvgpr_write_b32 a76, 0
    v_accvgpr_write_b32 a77, 0
    v_accvgpr_write_b32 a78, 0
    v_accvgpr_write_b32 a79, 0
    v_accvgpr_write_b32 a80, 0
    v_accvgpr_write_b32 a81, 0
    v_accvgpr_write_b32 a82, 0
    v_accvgpr_write_b32 a83, 0
    v_accvgpr_write_b32 a84, 0
    v_accvgpr_write_b32 a85, 0
    v_accvgpr_write_b32 a86, 0
    v_accvgpr_write_b32 a87, 0
    v_accvgpr_write_b32 a88, 0
    v_accvgpr_write_b32 a89, 0
    v_accvgpr_write_b32 a90, 0
    v_accvgpr_write_b32 a91, 0
    v_accvgpr_write_b32 a92, 0
    v_accvgpr_write_b32 a93, 0
    v_accvgpr_write_b32 a94, 0
    v_accvgpr_write_b32 a95, 0
    v_accvgpr_write_b32 a96, 0
    v_accvgpr_write_b32 a97, 0
    v_accvgpr_write_b32 a98, 0
    v_accvgpr_write_b32 a99, 0
    v_accvgpr_write_b32 a100, 0
    v_accvgpr_write_b32 a101, 0
    v_accvgpr_write_b32 a102, 0
    v_accvgpr_write_b32 a103, 0
    v_accvgpr_write_b32 a104, 0
    v_accvgpr_write_b32 a105, 0
    v_accvgpr_write_b32 a106, 0
    v_accvgpr_write_b32 a107, 0
    v_accvgpr_write_b32 a108, 0
    v_accvgpr_write_b32 a109, 0
    v_accvgpr_write_b32 a110, 0
    v_accvgpr_write_b32 a111, 0
    v_accvgpr_write_b32 a112, 0
    v_accvgpr_write_b32 a113, 0
    v_accvgpr_write_b32 a114, 0
    v_accvgpr_write_b32 a115, 0
    v_accvgpr_write_b32 a116, 0
    v_accvgpr_write_b32 a117, 0
    v_accvgpr_write_b32 a118, 0
    v_accvgpr_write_b32 a119, 0
    v_accvgpr_write_b32 a120, 0
    v_accvgpr_write_b32 a121, 0
    v_accvgpr_write_b32 a122, 0
    v_accvgpr_write_b32 a123, 0
    v_accvgpr_write_b32 a124, 0
    v_accvgpr_write_b32 a125, 0
    v_accvgpr_write_b32 a126, 0
    v_accvgpr_write_b32 a127, 0
    s_mov_b32 s82, 0
    s_mov_b32 s83, 0
    s_add_u32 m0, s72, 32768
SLOW_A:
    s_barrier
    buffer_load_dwordx4 v254, s[52:55], s82 offen lds
    buffer_load_dwordx4 v254, s[52:55], s82 offen offset:1024 lds
    s_add_u32 s82, s82, 8192
    s_and_b32 s82, s82, 0x1ffff
    buffer_load_dwordx4 v255, s[56:59], s83 offen offset:2048 lds
    buffer_load_dwordx4 v255, s[56:59], s83 offen offset:3072 lds
    s_add_u32 s83, s83, 8192
    s_and_b32 s83, s83, 0x1ffff
    s_waitcnt vmcnt(0)
    s_barrier
    ds_read_b128 a[128:131], v208 offset:32768
    ds_read_b128 a[132:135], v209 offset:32768
    ds_read_b128 a[136:139], v210 offset:32768
    ds_read_b128 a[140:143], v211 offset:32768
    ds_read_b128 a[144:147], v212 offset:32768
    ds_read_b128 a[148:151], v213 offset:32768
    ds_read_b128 a[152:155], v214 offset:32768
    ds_read_b128 a[156:159], v215 offset:32768
    ds_read_b64_tr_b16 a[160:161], v216 offset:32768
    ds_read_b64_tr_b16 a[162:163], v216 offset:36864
    ds_read_b64_tr_b16 a[164:165], v217 offset:32768
    ds_read_b64_tr_b16 a[166:167], v217 offset:36864
    ds_read_b64_tr_b16 a[168:169], v218 offset:32768
    ds_read_b64_tr_b16 a[170:171], v218 offset:36864
    ds_read_b64_tr_b16 a[172:173], v219 offset:32768
    ds_read_b64_tr_b16 a[174:175], v219 offset:36864
    ds_read_b64_tr_b16 a[176:177], v216 offset:40960
    ds_read_b64_tr_b16 a[178:179], v216 offset:45056
    ds_read_b64_tr_b16 a[180:181], v217 offset:40960
    ds_read_b64_tr_b16 a[182:183], v217 offset:45056
    ds_read_b64_tr_b16 a[184:185], v218 offset:40960
    ds_read_b64_tr_b16 a[186:187], v218 offset:45056
    ds_read_b64_tr_b16 a[188:189], v219 offset:40960
    ds_read_b64_tr_b16 a[190:191], v219 offset:45056
    s_waitcnt lgkmcnt(0)
    v_mfma_f32_32x32x16_bf16 v[64:79], a[128:131], v[0:3], 0
    v_mfma_f32_32x32x16_bf16 v[80:95], a[128:131], v[8:11], 0
    v_mfma_f32_32x32x16_bf16 v[64:79], a[132:135], v[4:7], v[64:79]
    v_mfma_f32_32x32x16_bf16 v[80:95], a[132:135], v[12:15], v[80:95]
    v_mfma_f32_32x32x16_bf16 v[64:79], a[136:139], v[16:19], v[64:79]
    v_mfma_f32_32x32x16_bf16 v[80:95], a[136:139], v[24:27], v[80:95]
    v_mfma_f32_32x32x16_bf16 v[64:79], a[140:143], v[20:23], v[64:79]
    v_mfma_f32_32x32x16_bf16 v[80:95], a[140:143], v[28:31], v[80:95]
    v_mfma_f32_32x32x16_bf16 v[64:79], a[144:147], v[32:35], v[64:79]
    v_mfma_f32_32x32x16_bf16 v[80:95], a[144:147], v[40:43], v[80:95]
    v_mfma_f32_32x32x16_bf16 v[64:79], a[148:151], v[36:39], v[64:79]
    v_mfma_f32_32x32x16_bf16 v[80:95], a[148:151], v[44:47], v[80:95]
    v_mfma_f32_32x32x16_bf16 v[64:79], a[152:155], v[48:51], v[64:79]
    v_mfma_f32_32x32x16_bf16 v[80:95], a[152:155], v[56:59], v[80:95]
    v_mfma_f32_32x32x16_bf16 v[64:79], a[156:159], v[52:55], v[64:79]
    v_mfma_f32_32x32x16_bf16 v[80:95], a[156:159], v[60:63], v[80:95]
    s_nop 10
    v_max3_f32 v224, v64, v65, v66
    v_max3_f32 v224, v224, v67, v68
    v_max3_f32 v224, v224, v69, v70
    v_max3_f32 v224, v224, v71, v72
    v_max3_f32 v224, v224, v73, v74
    v_max3_f32 v224, v224, v75, v76
    v_max3_f32 v224, v224, v77, v78
    v_max_f32 v224, v224, v79
    v_mov_b32 v225, v224
    v_max3_f32 v226, v80, v81, v82
    v_max3_f32 v226, v226, v83, v84
    v_max3_f32 v226, v226, v85, v86
    v_max3_f32 v226, v226, v87, v88
    v_max3_f32 v226, v226, v89, v90
    v_max3_f32 v226, v226, v91, v92
    v_max3_f32 v226, v226, v93, v94
    v_max_f32 v226, v226, v95
    v_mov_b32 v227, v226
    v_permlane32_swap_b32 v224, v225
    s_nop 0
    v_permlane32_swap_b32 v226, v227
    v_max_f32 v224, v224, v225
    v_max_f32 v226, v226, v227
    v_max_f32 v224, v224, v192
    v_sub_f32 v194, v192, v224
    v_exp_f32 v194, v194
    v_mov_b32 v192, v224
    v_mul_f32 v220, v220, v194
    v_mul_f32 v221, v221, v194
    v_sub_f32 v64, v64, v224
    v_sub_f32 v65, v65, v224
    v_sub_f32 v66, v66, v224
    v_sub_f32 v67, v67, v224
    v_sub_f32 v68, v68, v224
    v_sub_f32 v69, v69, v224
    v_sub_f32 v70, v70, v224
    v_sub_f32 v71, v71, v224
    v_sub_f32 v72, v72, v224
    v_sub_f32 v73, v73, v224
    v_sub_f32 v74, v74, v224
    v_sub_f32 v75, v75, v224
    v_sub_f32 v76, v76, v224
    v_sub_f32 v77, v77, v224
    v_sub_f32 v78, v78, v224
    v_sub_f32 v79, v79, v224
    v_accvgpr_read_b32 v96, a0
    v_accvgpr_read_b32 v97, a1
    v_accvgpr_read_b32 v98, a2
    v_accvgpr_read_b32 v99, a3
    v_accvgpr_read_b32 v100, a4
    v_accvgpr_read_b32 v101, a5
    v_accvgpr_read_b32 v102, a6
    v_accvgpr_read_b32 v103, a7
    v_accvgpr_read_b32 v104, a8
    v_accvgpr_read_b32 v105, a9
    v_accvgpr_read_b32 v106, a10
    v_accvgpr_read_b32 v107, a11
    v_accvgpr_read_b32 v108, a12
    v_accvgpr_read_b32 v109, a13
    v_accvgpr_read_b32 v110, a14
    v_accvgpr_read_b32 v111, a15
    v_mul_f32 v96, v96, v194
    v_mul_f32 v97, v97, v194
    v_mul_f32 v98, v98, v194
    v_mul_f32 v99, v99, v194
    v_mul_f32 v100, v100, v194
    v_mul_f32 v101, v101, v194
    v_mul_f32 v102, v102, v194
    v_mul_f32 v103, v103, v194
    v_mul_f32 v104, v104, v194
    v_mul_f32 v105, v105, v194
    v_mul_f32 v106, v106, v194
    v_mul_f32 v107, v107, v194
    v_mul_f32 v108, v108, v194
    v_mul_f32 v109, v109, v194
    v_mul_f32 v110, v110, v194
    v_mul_f32 v111, v111, v194
    v_accvgpr_write_b32 a0, v96
    v_accvgpr_write_b32 a1, v97
    v_accvgpr_write_b32 a2, v98
    v_accvgpr_write_b32 a3, v99
    v_accvgpr_write_b32 a4, v100
    v_accvgpr_write_b32 a5, v101
    v_accvgpr_write_b32 a6, v102
    v_accvgpr_write_b32 a7, v103
    v_accvgpr_write_b32 a8, v104
    v_accvgpr_write_b32 a9, v105
    v_accvgpr_write_b32 a10, v106
    v_accvgpr_write_b32 a11, v107
    v_accvgpr_write_b32 a12, v108
    v_accvgpr_write_b32 a13, v109
    v_accvgpr_write_b32 a14, v110
    v_accvgpr_write_b32 a15, v111
    v_accvgpr_read_b32 v96, a32
    v_accvgpr_read_b32 v97, a33
    v_accvgpr_read_b32 v98, a34
    v_accvgpr_read_b32 v99, a35
    v_accvgpr_read_b32 v100, a36
    v_accvgpr_read_b32 v101, a37
    v_accvgpr_read_b32 v102, a38
    v_accvgpr_read_b32 v103, a39
    v_accvgpr_read_b32 v104, a40
    v_accvgpr_read_b32 v105, a41
    v_accvgpr_read_b32 v106, a42
    v_accvgpr_read_b32 v107, a43
    v_accvgpr_read_b32 v108, a44
    v_accvgpr_read_b32 v109, a45
    v_accvgpr_read_b32 v110, a46
    v_accvgpr_read_b32 v111, a47
    v_mul_f32 v96, v96, v194
    v_mul_f32 v97, v97, v194
    v_mul_f32 v98, v98, v194
    v_mul_f32 v99, v99, v194
    v_mul_f32 v100, v100, v194
    v_mul_f32 v101, v101, v194
    v_mul_f32 v102, v102, v194
    v_mul_f32 v103, v103, v194
    v_mul_f32 v104, v104, v194
    v_mul_f32 v105, v105, v194
    v_mul_f32 v106, v106, v194
    v_mul_f32 v107, v107, v194
    v_mul_f32 v108, v108, v194
    v_mul_f32 v109, v109, v194
    v_mul_f32 v110, v110, v194
    v_mul_f32 v111, v111, v194
    v_accvgpr_write_b32 a32, v96
    v_accvgpr_write_b32 a33, v97
    v_accvgpr_write_b32 a34, v98
    v_accvgpr_write_b32 a35, v99
    v_accvgpr_write_b32 a36, v100
    v_accvgpr_write_b32 a37, v101
    v_accvgpr_write_b32 a38, v102
    v_accvgpr_write_b32 a39, v103
    v_accvgpr_write_b32 a40, v104
    v_accvgpr_write_b32 a41, v105
    v_accvgpr_write_b32 a42, v106
    v_accvgpr_write_b32 a43, v107
    v_accvgpr_write_b32 a44, v108
    v_accvgpr_write_b32 a45, v109
    v_accvgpr_write_b32 a46, v110
    v_accvgpr_write_b32 a47, v111
    v_accvgpr_read_b32 v96, a64
    v_accvgpr_read_b32 v97, a65
    v_accvgpr_read_b32 v98, a66
    v_accvgpr_read_b32 v99, a67
    v_accvgpr_read_b32 v100, a68
    v_accvgpr_read_b32 v101, a69
    v_accvgpr_read_b32 v102, a70
    v_accvgpr_read_b32 v103, a71
    v_accvgpr_read_b32 v104, a72
    v_accvgpr_read_b32 v105, a73
    v_accvgpr_read_b32 v106, a74
    v_accvgpr_read_b32 v107, a75
    v_accvgpr_read_b32 v108, a76
    v_accvgpr_read_b32 v109, a77
    v_accvgpr_read_b32 v110, a78
    v_accvgpr_read_b32 v111, a79
    v_mul_f32 v96, v96, v194
    v_mul_f32 v97, v97, v194
    v_mul_f32 v98, v98, v194
    v_mul_f32 v99, v99, v194
    v_mul_f32 v100, v100, v194
    v_mul_f32 v101, v101, v194
    v_mul_f32 v102, v102, v194
    v_mul_f32 v103, v103, v194
    v_mul_f32 v104, v104, v194
    v_mul_f32 v105, v105, v194
    v_mul_f32 v106, v106, v194
    v_mul_f32 v107, v107, v194
    v_mul_f32 v108, v108, v194
    v_mul_f32 v109, v109, v194
    v_mul_f32 v110, v110, v194
    v_mul_f32 v111, v111, v194
    v_accvgpr_write_b32 a64, v96
    v_accvgpr_write_b32 a65, v97
    v_accvgpr_write_b32 a66, v98
    v_accvgpr_write_b32 a67, v99
    v_accvgpr_write_b32 a68, v100
    v_accvgpr_write_b32 a69, v101
    v_accvgpr_write_b32 a70, v102
    v_accvgpr_write_b32 a71, v103
    v_accvgpr_write_b32 a72, v104
    v_accvgpr_write_b32 a73, v105
    v_accvgpr_write_b32 a74, v106
    v_accvgpr_write_b32 a75, v107
    v_accvgpr_write_b32 a76, v108
    v_accvgpr_write_b32 a77, v109
    v_accvgpr_write_b32 a78, v110
    v_accvgpr_write_b32 a79, v111
    v_accvgpr_read_b32 v96, a96
    v_accvgpr_read_b32 v97, a97
    v_accvgpr_read_b32 v98, a98
    v_accvgpr_read_b32 v99, a99
    v_accvgpr_read_b32 v100, a100
    v_accvgpr_read_b32 v101, a101
    v_accvgpr_read_b32 v102, a102
    v_accvgpr_read_b32 v103, a103
    v_accvgpr_read_b32 v104, a104
    v_accvgpr_read_b32 v105, a105
    v_accvgpr_read_b32 v106, a106
    v_accvgpr_read_b32 v107, a107
    v_accvgpr_read_b32 v108, a108
    v_accvgpr_read_b32 v109, a109
    v_accvgpr_read_b32 v110, a110
    v_accvgpr_read_b32 v111, a111
    v_mul_f32 v96, v96, v194
    v_mul_f32 v97, v97, v194
    v_mul_f32 v98, v98, v194
    v_mul_f32 v99, v99, v194
    v_mul_f32 v100, v100, v194
    v_mul_f32 v101, v101, v194
    v_mul_f32 v102, v102, v194
    v_mul_f32 v103, v103, v194
    v_mul_f32 v104, v104, v194
    v_mul_f32 v105, v105, v194
    v_mul_f32 v106, v106, v194
    v_mul_f32 v107, v107, v194
    v_mul_f32 v108, v108, v194
    v_mul_f32 v109, v109, v194
    v_mul_f32 v110, v110, v194
    v_mul_f32 v111, v111, v194
    v_accvgpr_write_b32 a96, v96
    v_accvgpr_write_b32 a97, v97
    v_accvgpr_write_b32 a98, v98
    v_accvgpr_write_b32 a99, v99
    v_accvgpr_write_b32 a100, v100
    v_accvgpr_write_b32 a101, v101
    v_accvgpr_write_b32 a102, v102
    v_accvgpr_write_b32 a103, v103
    v_accvgpr_write_b32 a104, v104
    v_accvgpr_write_b32 a105, v105
    v_accvgpr_write_b32 a106, v106
    v_accvgpr_write_b32 a107, v107
    v_accvgpr_write_b32 a108, v108
    v_accvgpr_write_b32 a109, v109
    v_accvgpr_write_b32 a110, v110
    v_accvgpr_write_b32 a111, v111
    v_max_f32 v226, v226, v193
    v_sub_f32 v195, v193, v226
    v_exp_f32 v195, v195
    v_mov_b32 v193, v226
    v_mul_f32 v222, v222, v195
    v_mul_f32 v223, v223, v195
    v_sub_f32 v80, v80, v226
    v_sub_f32 v81, v81, v226
    v_sub_f32 v82, v82, v226
    v_sub_f32 v83, v83, v226
    v_sub_f32 v84, v84, v226
    v_sub_f32 v85, v85, v226
    v_sub_f32 v86, v86, v226
    v_sub_f32 v87, v87, v226
    v_sub_f32 v88, v88, v226
    v_sub_f32 v89, v89, v226
    v_sub_f32 v90, v90, v226
    v_sub_f32 v91, v91, v226
    v_sub_f32 v92, v92, v226
    v_sub_f32 v93, v93, v226
    v_sub_f32 v94, v94, v226
    v_sub_f32 v95, v95, v226
    v_accvgpr_read_b32 v96, a16
    v_accvgpr_read_b32 v97, a17
    v_accvgpr_read_b32 v98, a18
    v_accvgpr_read_b32 v99, a19
    v_accvgpr_read_b32 v100, a20
    v_accvgpr_read_b32 v101, a21
    v_accvgpr_read_b32 v102, a22
    v_accvgpr_read_b32 v103, a23
    v_accvgpr_read_b32 v104, a24
    v_accvgpr_read_b32 v105, a25
    v_accvgpr_read_b32 v106, a26
    v_accvgpr_read_b32 v107, a27
    v_accvgpr_read_b32 v108, a28
    v_accvgpr_read_b32 v109, a29
    v_accvgpr_read_b32 v110, a30
    v_accvgpr_read_b32 v111, a31
    v_mul_f32 v96, v96, v195
    v_mul_f32 v97, v97, v195
    v_mul_f32 v98, v98, v195
    v_mul_f32 v99, v99, v195
    v_mul_f32 v100, v100, v195
    v_mul_f32 v101, v101, v195
    v_mul_f32 v102, v102, v195
    v_mul_f32 v103, v103, v195
    v_mul_f32 v104, v104, v195
    v_mul_f32 v105, v105, v195
    v_mul_f32 v106, v106, v195
    v_mul_f32 v107, v107, v195
    v_mul_f32 v108, v108, v195
    v_mul_f32 v109, v109, v195
    v_mul_f32 v110, v110, v195
    v_mul_f32 v111, v111, v195
    v_accvgpr_write_b32 a16, v96
    v_accvgpr_write_b32 a17, v97
    v_accvgpr_write_b32 a18, v98
    v_accvgpr_write_b32 a19, v99
    v_accvgpr_write_b32 a20, v100
    v_accvgpr_write_b32 a21, v101
    v_accvgpr_write_b32 a22, v102
    v_accvgpr_write_b32 a23, v103
    v_accvgpr_write_b32 a24, v104
    v_accvgpr_write_b32 a25, v105
    v_accvgpr_write_b32 a26, v106
    v_accvgpr_write_b32 a27, v107
    v_accvgpr_write_b32 a28, v108
    v_accvgpr_write_b32 a29, v109
    v_accvgpr_write_b32 a30, v110
    v_accvgpr_write_b32 a31, v111
    v_accvgpr_read_b32 v96, a48
    v_accvgpr_read_b32 v97, a49
    v_accvgpr_read_b32 v98, a50
    v_accvgpr_read_b32 v99, a51
    v_accvgpr_read_b32 v100, a52
    v_accvgpr_read_b32 v101, a53
    v_accvgpr_read_b32 v102, a54
    v_accvgpr_read_b32 v103, a55
    v_accvgpr_read_b32 v104, a56
    v_accvgpr_read_b32 v105, a57
    v_accvgpr_read_b32 v106, a58
    v_accvgpr_read_b32 v107, a59
    v_accvgpr_read_b32 v108, a60
    v_accvgpr_read_b32 v109, a61
    v_accvgpr_read_b32 v110, a62
    v_accvgpr_read_b32 v111, a63
    v_mul_f32 v96, v96, v195
    v_mul_f32 v97, v97, v195
    v_mul_f32 v98, v98, v195
    v_mul_f32 v99, v99, v195
    v_mul_f32 v100, v100, v195
    v_mul_f32 v101, v101, v195
    v_mul_f32 v102, v102, v195
    v_mul_f32 v103, v103, v195
    v_mul_f32 v104, v104, v195
    v_mul_f32 v105, v105, v195
    v_mul_f32 v106, v106, v195
    v_mul_f32 v107, v107, v195
    v_mul_f32 v108, v108, v195
    v_mul_f32 v109, v109, v195
    v_mul_f32 v110, v110, v195
    v_mul_f32 v111, v111, v195
    v_accvgpr_write_b32 a48, v96
    v_accvgpr_write_b32 a49, v97
    v_accvgpr_write_b32 a50, v98
    v_accvgpr_write_b32 a51, v99
    v_accvgpr_write_b32 a52, v100
    v_accvgpr_write_b32 a53, v101
    v_accvgpr_write_b32 a54, v102
    v_accvgpr_write_b32 a55, v103
    v_accvgpr_write_b32 a56, v104
    v_accvgpr_write_b32 a57, v105
    v_accvgpr_write_b32 a58, v106
    v_accvgpr_write_b32 a59, v107
    v_accvgpr_write_b32 a60, v108
    v_accvgpr_write_b32 a61, v109
    v_accvgpr_write_b32 a62, v110
    v_accvgpr_write_b32 a63, v111
    v_accvgpr_read_b32 v96, a80
    v_accvgpr_read_b32 v97, a81
    v_accvgpr_read_b32 v98, a82
    v_accvgpr_read_b32 v99, a83
    v_accvgpr_read_b32 v100, a84
    v_accvgpr_read_b32 v101, a85
    v_accvgpr_read_b32 v102, a86
    v_accvgpr_read_b32 v103, a87
    v_accvgpr_read_b32 v104, a88
    v_accvgpr_read_b32 v105, a89
    v_accvgpr_read_b32 v106, a90
    v_accvgpr_read_b32 v107, a91
    v_accvgpr_read_b32 v108, a92
    v_accvgpr_read_b32 v109, a93
    v_accvgpr_read_b32 v110, a94
    v_accvgpr_read_b32 v111, a95
    v_mul_f32 v96, v96, v195
    v_mul_f32 v97, v97, v195
    v_mul_f32 v98, v98, v195
    v_mul_f32 v99, v99, v195
    v_mul_f32 v100, v100, v195
    v_mul_f32 v101, v101, v195
    v_mul_f32 v102, v102, v195
    v_mul_f32 v103, v103, v195
    v_mul_f32 v104, v104, v195
    v_mul_f32 v105, v105, v195
    v_mul_f32 v106, v106, v195
    v_mul_f32 v107, v107, v195
    v_mul_f32 v108, v108, v195
    v_mul_f32 v109, v109, v195
    v_mul_f32 v110, v110, v195
    v_mul_f32 v111, v111, v195
    v_accvgpr_write_b32 a80, v96
    v_accvgpr_write_b32 a81, v97
    v_accvgpr_write_b32 a82, v98
    v_accvgpr_write_b32 a83, v99
    v_accvgpr_write_b32 a84, v100
    v_accvgpr_write_b32 a85, v101
    v_accvgpr_write_b32 a86, v102
    v_accvgpr_write_b32 a87, v103
    v_accvgpr_write_b32 a88, v104
    v_accvgpr_write_b32 a89, v105
    v_accvgpr_write_b32 a90, v106
    v_accvgpr_write_b32 a91, v107
    v_accvgpr_write_b32 a92, v108
    v_accvgpr_write_b32 a93, v109
    v_accvgpr_write_b32 a94, v110
    v_accvgpr_write_b32 a95, v111
    v_accvgpr_read_b32 v96, a112
    v_accvgpr_read_b32 v97, a113
    v_accvgpr_read_b32 v98, a114
    v_accvgpr_read_b32 v99, a115
    v_accvgpr_read_b32 v100, a116
    v_accvgpr_read_b32 v101, a117
    v_accvgpr_read_b32 v102, a118
    v_accvgpr_read_b32 v103, a119
    v_accvgpr_read_b32 v104, a120
    v_accvgpr_read_b32 v105, a121
    v_accvgpr_read_b32 v106, a122
    v_accvgpr_read_b32 v107, a123
    v_accvgpr_read_b32 v108, a124
    v_accvgpr_read_b32 v109, a125
    v_accvgpr_read_b32 v110, a126
    v_accvgpr_read_b32 v111, a127
    v_mul_f32 v96, v96, v195
    v_mul_f32 v97, v97, v195
    v_mul_f32 v98, v98, v195
    v_mul_f32 v99, v99, v195
    v_mul_f32 v100, v100, v195
    v_mul_f32 v101, v101, v195
    v_mul_f32 v102, v102, v195
    v_mul_f32 v103, v103, v195
    v_mul_f32 v104, v104, v195
    v_mul_f32 v105, v105, v195
    v_mul_f32 v106, v106, v195
    v_mul_f32 v107, v107, v195
    v_mul_f32 v108, v108, v195
    v_mul_f32 v109, v109, v195
    v_mul_f32 v110, v110, v195
    v_mul_f32 v111, v111, v195
    v_accvgpr_write_b32 a112, v96
    v_accvgpr_write_b32 a113, v97
    v_accvgpr_write_b32 a114, v98
    v_accvgpr_write_b32 a115, v99
    v_accvgpr_write_b32 a116, v100
    v_accvgpr_write_b32 a117, v101
    v_accvgpr_write_b32 a118, v102
    v_accvgpr_write_b32 a119, v103
    v_accvgpr_write_b32 a120, v104
    v_accvgpr_write_b32 a121, v105
    v_accvgpr_write_b32 a122, v106
    v_accvgpr_write_b32 a123, v107
    v_accvgpr_write_b32 a124, v108
    v_accvgpr_write_b32 a125, v109
    v_accvgpr_write_b32 a126, v110
    v_accvgpr_write_b32 a127, v111
    v_exp_f32 v64, v64
    v_exp_f32 v65, v65
    v_exp_f32 v66, v66
    v_exp_f32 v67, v67
    v_add_f32 v220, v220, v64
    v_add_f32 v221, v221, v65
    v_cvt_pk_bf16_f32 v160, v64, v65
    v_exp_f32 v68, v68
    v_exp_f32 v69, v69
    v_add_f32 v220, v220, v66
    v_add_f32 v221, v221, v67
    v_cvt_pk_bf16_f32 v161, v66, v67
    v_exp_f32 v70, v70
    v_exp_f32 v71, v71
    v_add_f32 v220, v220, v68
    v_add_f32 v221, v221, v69
    v_cvt_pk_bf16_f32 v162, v68, v69
    v_exp_f32 v80, v80
    v_exp_f32 v81, v81
    v_add_f32 v220, v220, v70
    v_add_f32 v221, v221, v71
    v_cvt_pk_bf16_f32 v163, v70, v71
    v_exp_f32 v82, v82
    v_exp_f32 v83, v83
    v_add_f32 v222, v222, v80
    v_add_f32 v223, v223, v81
    v_cvt_pk_bf16_f32 v168, v80, v81
    v_exp_f32 v84, v84
    v_exp_f32 v85, v85
    v_add_f32 v222, v222, v82
    v_add_f32 v223, v223, v83
    v_cvt_pk_bf16_f32 v169, v82, v83
    v_exp_f32 v86, v86
    v_exp_f32 v87, v87
    v_add_f32 v222, v222, v84
    v_add_f32 v223, v223, v85
    v_cvt_pk_bf16_f32 v170, v84, v85
    v_exp_f32 v72, v72
    v_exp_f32 v73, v73
    v_add_f32 v222, v222, v86
    v_add_f32 v223, v223, v87
    v_cvt_pk_bf16_f32 v171, v86, v87
    v_exp_f32 v74, v74
    v_exp_f32 v75, v75
    v_add_f32 v220, v220, v72
    v_add_f32 v221, v221, v73
    v_cvt_pk_bf16_f32 v164, v72, v73
    v_exp_f32 v76, v76
    v_exp_f32 v77, v77
    v_add_f32 v220, v220, v74
    v_add_f32 v221, v221, v75
    v_cvt_pk_bf16_f32 v165, v74, v75
    v_exp_f32 v78, v78
    v_exp_f32 v79, v79
    v_add_f32 v220, v220, v76
    v_add_f32 v221, v221, v77
    v_cvt_pk_bf16_f32 v166, v76, v77
    v_exp_f32 v88, v88
    v_exp_f32 v89, v89
    v_add_f32 v220, v220, v78
    v_add_f32 v221, v221, v79
    v_cvt_pk_bf16_f32 v167, v78, v79
    v_exp_f32 v90, v90
    v_exp_f32 v91, v91
    v_add_f32 v222, v222, v88
    v_add_f32 v223, v223, v89
    v_cvt_pk_bf16_f32 v172, v88, v89
    v_exp_f32 v92, v92
    v_exp_f32 v93, v93
    v_add_f32 v222, v222, v90
    v_add_f32 v223, v223, v91
    v_cvt_pk_bf16_f32 v173, v90, v91
    v_exp_f32 v94, v94
    v_exp_f32 v95, v95
    v_add_f32 v222, v222, v92
    v_add_f32 v223, v223, v93
    v_cvt_pk_bf16_f32 v174, v92, v93
    v_add_f32 v222, v222, v94
    v_add_f32 v223, v223, v95
    v_cvt_pk_bf16_f32 v175, v94, v95
    v_mfma_f32_32x32x16_bf16 a[0:15], a[160:163], v[160:163], a[0:15]
    v_mfma_f32_32x32x16_bf16 a[16:31], a[160:163], v[168:171], a[16:31]
    v_mfma_f32_32x32x16_bf16 a[32:47], a[164:167], v[160:163], a[32:47]
    v_mfma_f32_32x32x16_bf16 a[48:63], a[164:167], v[168:171], a[48:63]
    v_mfma_f32_32x32x16_bf16 a[64:79], a[168:171], v[160:163], a[64:79]
    v_mfma_f32_32x32x16_bf16 a[80:95], a[168:171], v[168:171], a[80:95]
    v_mfma_f32_32x32x16_bf16 a[96:111], a[172:175], v[160:163], a[96:111]
    v_mfma_f32_32x32x16_bf16 a[112:127], a[172:175], v[168:171], a[112:127]
    v_mfma_f32_32x32x16_bf16 a[0:15], a[176:179], v[164:167], a[0:15]
    v_mfma_f32_32x32x16_bf16 a[16:31], a[176:179], v[172:175], a[16:31]
    v_mfma_f32_32x32x16_bf16 a[32:47], a[180:183], v[164:167], a[32:47]
    v_mfma_f32_32x32x16_bf16 a[48:63], a[180:183], v[172:175], a[48:63]
    v_mfma_f32_32x32x16_bf16 a[64:79], a[184:187], v[164:167], a[64:79]
    v_mfma_f32_32x32x16_bf16 a[80:95], a[184:187], v[172:175], a[80:95]
    v_mfma_f32_32x32x16_bf16 a[96:111], a[188:191], v[164:167], a[96:111]
    v_mfma_f32_32x32x16_bf16 a[112:127], a[188:191], v[172:175], a[112:127]
    s_cmp_lg_u32 s82, 0
    s_cbranch_scc1 SLOW_A
    s_lshl_b32 s80, s67, 4
    s_lshl_b32 s81, s64, 2
    s_add_u32 s80, s80, s81
    s_lshl_b32 s80, s80, 17
    s_lshl_b32 s81, s66, 12
    s_add_u32 s80, s80, s81
    s_add_u32 s46, s80, 33554432
    s_add_u32 s47, s46, 0x40000
    s_lshl_b32 s48, s67, 5
    s_add_u32 s48, s48, s66
    s_lshl_b32 s80, s67, 14
    s_lshl_b32 s81, s64, 12
    s_add_u32 s80, s80, s81
    s_lshl_b32 s81, s66, 7
    s_add_u32 s80, s80, s81
    s_add_u32 s49, s80, 3670016
    s_lshl_b32 s81, s64, 5
    s_lshl_b32 s82, s23, 9
    s_add_u32 s82, s82, s81
    s_lshl_b32 s82, s82, 10
    s_add_u32 s44, s82, 33554432
    s_lshl_b32 s83, s22, 7
    s_add_u32 s83, s83, s81
    s_mul_i32 s83, s83, 5120
    s_add_u32 s52, s83, 10485760
    s_add_u32 s53, s83, 10490880
    s_add_u32 s54, s83, 10496000
    s_add_u32 s55, s83, 10501120
    s_add_u32 s56, s83, 10506240
    s_add_u32 s57, s83, 10511360
    s_add_u32 s58, s83, 10516480
    s_add_u32 s59, s83, 10521600
    v_mov_b32 v0, v245
    v_add_u32 v4, 0, v0
    v_add_u32 v5, 4096, v0
    v_add_u32 v248, 40960, v0
    v_add_u32 v249, 45056, v0
    v_add_u32 v250, 81920, v0
    v_add_u32 v251, 86016, v0
    v_add_u32 v252, 122880, v0
    v_add_u32 v253, 126976, v0
    buffer_load_dwordx4 a[192:195], v4, s[32:35], s52 offen sc1
    buffer_load_dwordx4 a[196:199], v4, s[32:35], s52 offen offset:1024 sc1
    buffer_load_dwordx4 a[200:203], v4, s[32:35], s52 offen offset:2048 sc1
    buffer_load_dwordx4 a[208:211], v4, s[32:35], s52 offen offset:3072 sc1
    buffer_load_dwordx4 a[212:215], v5, s[32:35], s52 offen sc1
    buffer_load_dwordx4 v[200:203], v4, s[32:35], s53 offen sc1
    buffer_load_dwordx4 v[204:207], v4, s[32:35], s53 offen offset:1024 sc1
    buffer_load_dwordx4 v[240:243], v4, s[32:35], s53 offen offset:2048 sc1
    buffer_load_dwordx4 v[228:231], v4, s[32:35], s53 offen offset:3072 sc1
    buffer_load_dwordx4 v[232:235], v5, s[32:35], s53 offen sc1
    buffer_load_dwordx4 v[196:199], v4, s[32:35], s54 offen sc1
    buffer_load_dwordx4 a[216:219], v4, s[32:35], s54 offen offset:1024 sc1
    buffer_load_dwordx4 a[220:223], v4, s[32:35], s54 offen offset:2048 sc1
    buffer_load_dwordx4 a[224:227], v4, s[32:35], s54 offen offset:3072 sc1
    buffer_load_dwordx4 a[228:231], v5, s[32:35], s54 offen sc1
    buffer_load_dwordx4 a[232:235], v4, s[32:35], s55 offen sc1
    buffer_load_dwordx4 v[128:131], v4, s[32:35], s55 offen offset:1024 sc1
    buffer_load_dwordx4 v[132:135], v4, s[32:35], s55 offen offset:2048 sc1
    buffer_load_dwordx4 v[136:139], v4, s[32:35], s55 offen offset:3072 sc1
    buffer_load_dwordx4 v[140:143], v5, s[32:35], s55 offen sc1
    buffer_load_dwordx4 v[144:147], v4, s[32:35], s56 offen sc1
    buffer_load_dwordx4 v[148:151], v4, s[32:35], s56 offen offset:1024 sc1
    buffer_load_dwordx4 v[152:155], v4, s[32:35], s56 offen offset:2048 sc1
    buffer_load_dwordx4 v[156:159], v4, s[32:35], s56 offen offset:3072 sc1
    buffer_load_dwordx4 v[32:35], v5, s[32:35], s56 offen sc1
    buffer_load_dwordx4 v[36:39], v4, s[32:35], s57 offen sc1
    buffer_load_dwordx4 v[40:43], v4, s[32:35], s57 offen offset:1024 sc1
    buffer_load_dwordx4 v[44:47], v4, s[32:35], s57 offen offset:2048 sc1
    buffer_load_dwordx4 v[48:51], v4, s[32:35], s57 offen offset:3072 sc1
    buffer_load_dwordx4 v[52:55], v5, s[32:35], s57 offen sc1
    buffer_load_dwordx4 v[56:59], v4, s[32:35], s58 offen sc1
    buffer_load_dwordx4 v[60:63], v4, s[32:35], s58 offen offset:1024 sc1
    buffer_load_dwordx4 v[64:67], v4, s[32:35], s58 offen offset:2048 sc1
    buffer_load_dwordx4 v[68:71], v4, s[32:35], s58 offen offset:3072 sc1
    buffer_load_dwordx4 v[72:75], v5, s[32:35], s58 offen sc1
    buffer_load_dwordx4 v[76:79], v4, s[32:35], s59 offen sc1
    buffer_load_dwordx4 v[80:83], v4, s[32:35], s59 offen offset:1024 sc1
    buffer_load_dwordx4 v[84:87], v4, s[32:35], s59 offen offset:2048 sc1
    s_barrier
    s_lshl_b32 s71, s22, 2
    s_add_u32 s71, s71, s64
    s_mul_i32 s71, s71, 163840
    s_add_u32 s71, s71, 10613760
    s_mul_i32 s75, s64, 5120
    s_add_u32 m0, s75, 140800
    s_nop 0
    buffer_load_dwordx4 v245, s[32:35], s71 offen offset:0 sc1 lds
    buffer_load_dwordx4 v245, s[32:35], s71 offen offset:1024 sc1 lds
    buffer_load_dwordx4 v245, s[32:35], s71 offen offset:2048 sc1 lds
    buffer_load_dwordx4 v245, s[32:35], s71 offen offset:3072 sc1 lds
    s_add_u32 m0, m0, 1024
    s_add_u32 s71, s71, 1024
    buffer_load_dwordx4 v245, s[32:35], s71 offen offset:3072 sc1 lds
    s_add_u32 m0, s72, 0
    s_add_u32 s71, s71, 4096
    buffer_load_dwordx4 v245, s[32:35], s71 offen offset:0 sc1 lds
    s_nop 0
    buffer_load_dwordx4 v245, s[32:35], s71 offen offset:1024 sc1 lds
    buffer_load_dwordx4 v245, s[32:35], s71 offen offset:2048 sc1 lds
    buffer_load_dwordx4 v245, s[32:35], s71 offen offset:3072 sc1 lds
    s_add_u32 m0, s72, 98304
    s_add_u32 s71, s71, 4096
    buffer_load_dwordx4 v245, s[32:35], s71 offen offset:0 sc1 lds
    s_nop 0
    buffer_load_dwordx4 v245, s[32:35], s71 offen offset:1024 sc1 lds
    buffer_load_dwordx4 v245, s[32:35], s71 offen offset:2048 sc1 lds
    buffer_load_dwordx4 v245, s[32:35], s71 offen offset:3072 sc1 lds
    s_add_u32 m0, s72, 114688
    s_add_u32 s71, s71, 4096
    buffer_load_dwordx4 v245, s[32:35], s71 offen offset:0 sc1 lds
    s_nop 0
    buffer_load_dwordx4 v245, s[32:35], s71 offen offset:1024 sc1 lds
    buffer_load_dwordx4 v245, s[32:35], s71 offen offset:2048 sc1 lds
    buffer_load_dwordx4 v245, s[32:35], s71 offen offset:3072 sc1 lds
    s_add_u32 m0, s72, 16384
    s_add_u32 s71, s71, 4096
    buffer_load_dwordx4 v245, s[32:35], s71 offen offset:0 sc1 lds
    s_nop 0
    buffer_load_dwordx4 v245, s[32:35], s71 offen offset:1024 sc1 lds
    buffer_load_dwordx4 v245, s[32:35], s71 offen offset:2048 sc1 lds
    buffer_load_dwordx4 v245, s[32:35], s71 offen offset:3072 sc1 lds
    v_add_f32 v220, v220, v221
    v_mov_b32 v221, v220
    v_accvgpr_read_b32 v224, a204
    s_nop 0
    v_permlane32_swap_b32 v220, v221
    s_nop 0
    v_add_f32 v220, v220, v221
    v_rcp_f32 v221, v220
    s_nop 0
    v_add_f32 v222, v222, v223
    v_mov_b32 v223, v222
    s_nop 1
    v_permlane32_swap_b32 v222, v223
    s_nop 0
    v_add_f32 v222, v222, v223
    v_rcp_f32 v223, v222
    s_nop 0
    v_mov_b32 v227, 140544
    s_waitcnt vmcnt(0)
    s_nop 7
    s_cmp_eq_u32 s74, 0
    s_cbranch_scc1 P1_SKIP
    s_nop 1
    s_branch P1_EPI
    s_endpgm
    s_nop 0
    s_nop 0
    s_nop 0
F_CODE_END:
.section .rodata,"a"
.p2align 6
.amdhsa_kernel adaLN_cond__sliding_block_cached__glu_gated_reglu__prompt_kernel
  .amdhsa_next_free_vgpr 512
  .amdhsa_next_free_sgpr 102
  .amdhsa_accum_offset 256
  .amdhsa_group_segment_fixed_size 0
  .amdhsa_kernarg_size 112
  .amdhsa_user_sgpr_count 2
  .amdhsa_user_sgpr_kernarg_segment_ptr 1
  .amdhsa_system_sgpr_workgroup_id_x 1
.end_amdhsa_kernel
```
